```python
import torch

def _softmax(x, axis=-1):
    return torch.softmax(x, dim=axis)

def _gelu(x):
    return torch.nn.functional.gelu(x, approximate='tanh')

def _silu(x):
    return torch.nn.functional.silu(x)

def _sigmoid(x):
    return torch.sigmoid(x)

def _layernorm(x, axis=-1, eps=1e-05):
    m = x.mean(dim=axis, keepdim=True)
    v = x.var(dim=axis, keepdim=True, unbiased=False)
    return (x - m) / torch.sqrt(v + eps)

def _scatter_add(tgt, idx, src, axis=0):
    return tgt.clone().index_add_(axis, idx, src)

def _segment_sum(src, seg, n):
    out = torch.zeros((n,) + src.shape[1:], dtype=src.dtype)
    return out.index_add_(0, seg, src)

def _pad(x, pw):
    flat = tuple((v for pair in reversed(pw) for v in pair))
    return torch.nn.functional.pad(x, flat)
kernel_name = 'interleave_layers__memory_aug_recurrent_mem_tr__glu_gated_geglu__prompt'

def setup_inputs():

    _w = lambda a: (lambda t: t.to(torch.bfloat16) if t.is_floating_point() else t)(torch.as_tensor(a))

    def _A_setup():
        B, S, Dm = (1, 2048, 1024)
        H, Dh = (32, 128)
        M, seg = (8, 32)
        seg = min(seg, S)
        S = S // seg * seg
        return {'x': _w((lambda *s: torch.randn(*s, dtype=torch.bfloat16) * 0.05)(B, S, Dm)), 'mem0': _w((lambda *s: torch.randn(*s, dtype=torch.bfloat16) * 0.2)(B, M, Dm)), 'Wq': _w((lambda *s: torch.randn(*s, dtype=torch.bfloat16) * 1.6)(Dm, H, Dh) * Dm ** (-0.5)), 'Wk': _w((lambda *s: torch.randn(*s, dtype=torch.bfloat16) * 1.6)(Dm, H, Dh) * Dm ** (-0.5)), 'Wv': _w((lambda *s: torch.randn(*s, dtype=torch.bfloat16) * 0.2)(Dm, H, Dh) * Dm ** (-0.5)), 'Wo': _w((lambda *s: torch.randn(*s, dtype=torch.bfloat16) * 0.2)(H, Dh, Dm) * (H * Dh) ** (-0.5)), 'seg_len': seg}
    _A_in = _A_setup()

    def _B_setup():
        B, S, Dm, Df = (1, 2048, 1024, 3584)
        return {'x': _w((lambda *s: torch.randn(*s, dtype=torch.bfloat16) * 0.05)(B, S, Dm)), 'w_gate': _w((lambda *s: torch.randn(*s, dtype=torch.bfloat16) * 0.4)(Dm, Df) * Dm ** (-0.5)), 'w_up': _w((lambda *s: torch.randn(*s, dtype=torch.bfloat16) * 0.4)(Dm, Df) * Dm ** (-0.5)), 'w_down': _w((lambda *s: torch.randn(*s, dtype=torch.bfloat16) * 0.4)(Df, Dm) * Df ** (-0.5))}
    _B_in = _B_setup()
    return {'A_x': _A_in['x'], 'A_mem0': _A_in['mem0'], 'A_Wq': _A_in['Wq'], 'A_Wk': _A_in['Wk'], 'A_Wv': _A_in['Wv'], 'A_Wo': _A_in['Wo'], 'A_seg_len': _A_in['seg_len'], 'B_x': _B_in['x'], 'B_w_gate': _B_in['w_gate'], 'B_w_up': _B_in['w_up'], 'B_w_down': _B_in['w_down']}

def reference(A_x, A_mem0, A_Wq, A_Wk, A_Wv, A_Wo, A_seg_len, B_x, B_w_gate, B_w_up, B_w_down):

    def _A_ref(x, mem0, Wq, Wk, Wv, Wo, seg_len):
        B, S, Dm = x.shape
        H, Dh = (Wq.shape[1], Wq.shape[2])
        M = mem0.shape[1]
        scale = Dh ** (-0.5)
        n_seg = S // seg_len
        L = M + seg_len
        idx = torch.arange(L)
        mask = (idx[:, None] < M) | (idx[:, None] >= idx[None, :])
        mem = mem0
        outs = []
        for s in range(n_seg):
            xs = x[:, s * seg_len:(s + 1) * seg_len, :].clone()
            h = torch.concatenate([mem, xs], axis=1)
            q = torch.einsum('btd,dhe->bhte', h, Wq)
            k = torch.einsum('btd,dhe->bhte', h, Wk)
            v = torch.einsum('btd,dhe->bhte', h, Wv)
            scores = torch.einsum('bhqe,bhke->bhqk', q, k) * scale
            scores = torch.where(mask[None, None], scores, -1000000000.0)
            p = _softmax(scores, axis=-1)
            o = torch.einsum('bhqk,bhke->bhqe', p, v)
            o = torch.einsum('bhte,hed->btd', o, Wo)
            mem = o[:, :M, :].clone()
            outs.append(o[:, M:, :])
        return torch.concatenate(outs, axis=1)

    def _B_ref(x, w_gate, w_up, w_down):
        g = torch.einsum('bsd,df->bsf', x, w_gate)
        u = torch.einsum('bsd,df->bsf', x, w_up)
        h = _gelu(g) * u
        return torch.einsum('bsf,fd->bsd', h, w_down)
    x = A_x
    x = x + _A_ref(_layernorm(x, axis=-1), A_mem0, A_Wq, A_Wk, A_Wv, A_Wo, A_seg_len)
    x = x + _B_ref(_layernorm(x, axis=-1), B_w_gate, B_w_up, B_w_down)
    x = x + _A_ref(_layernorm(x, axis=-1), A_mem0, A_Wq, A_Wk, A_Wv, A_Wo, A_seg_len)
    x = x + _B_ref(_layernorm(x, axis=-1), B_w_gate, B_w_up, B_w_down)
    return x
```

```asm
; @launch grid=(256,1,1) block=(256,1,1) lds=163840
.amdgcn_target "amdgcn-amd-amdhsa--gfx950"
.text
.globl interleave_layers__memory_aug_recurrent_mem_tr__glu_gated_geglu__prompt_kernel
.p2align 8
.type interleave_layers__memory_aug_recurrent_mem_tr__glu_gated_geglu__prompt_kernel,@function
interleave_layers__memory_aug_recurrent_mem_tr__glu_gated_geglu__prompt_kernel:
s_cmp_ge_u32 s2, 0x100
s_cbranch_scc1 L_done
v_lshrrev_b32 v1, 6, v0
s_nop 0
v_readfirstlane_b32 s48, v1
s_getreg_b32 s101, hwreg(HW_REG_XCC_ID)
s_and_b32 s101, s101, 7
s_lshl_b32 s60, s101, 2
s_lshr_b32 s50, 0x76543120, s60
s_and_b32 s50, s50, 7
s_mov_b32 s100, 0
s_mov_b32 s96, 0
s_branch L_begin
L_restart:
s_and_b32 s50, s2, 7
s_mov_b32 s100, 1
s_barrier
L_begin:
s_load_dwordx8 s[24:31], s[0:1], 0
s_load_dwordx4 s[32:35], s[0:1], 32
s_load_dwordx8 s[36:43], s[0:1], 64
s_load_dwordx4 s[44:47], s[0:1], 96
v_mbcnt_lo_u32_b32 v0, -1, 0
v_mbcnt_hi_u32_b32 v0, -1, v0
s_mov_b32 s3, 0
s_lshr_b32 s49, s2, 3
s_mov_b32 s52, 0
s_waitcnt lgkmcnt(0)
s_mov_b32 s4, s46
s_and_b32 s5, s47, 0xffff
s_mov_b32 s6, 0x10000000
s_mov_b32 s7, 0x20000
s_mov_b32 s8, s46
s_and_b32 s9, s47, 0xffff
s_mov_b32 s10, 0x10000000
s_mov_b32 s11, 0x20000
s_mov_b32 s20, s44
s_and_b32 s21, s45, 0xffff
s_mov_b32 s22, 0x100
s_mov_b32 s23, 0x20000
s_lshl_b32 s60, s50, 5
s_add_u32 s60, s60, s49
s_sub_u32 s49, s60, 64
s_cmp_ge_u32 s49, 24
s_cbranch_scc1 Ldisp_1
s_branch L_P
Ldisp_1:
s_sub_u32 s49, s60, 96
s_cmp_ge_u32 s49, 16
s_cbranch_scc1 Ldisp_2
s_add_u32 s49, s49, 24
s_branch L_P
Ldisp_2:
s_sub_u32 s49, s60, 128
s_cmp_ge_u32 s49, 14
s_cbranch_scc1 Ldisp_3
s_add_u32 s49, s49, 40
s_branch L_P
Ldisp_3:
s_sub_u32 s49, s60, 192
s_cmp_ge_u32 s49, 10
s_cbranch_scc1 Ldisp_4
s_add_u32 s49, s49, 54
s_branch L_P
Ldisp_4:
s_sub_u32 s49, s60, 142
s_cmp_ge_u32 s49, 4
s_cbranch_scc1 Ldisp_5
s_branch L_AT
Ldisp_5:
s_sub_u32 s49, s60, 160
s_cmp_ge_u32 s49, 6
s_cbranch_scc1 Ldisp_6
s_add_u32 s49, s49, 4
s_branch L_AT
Ldisp_6:
s_sub_u32 s49, s60, 202
s_cmp_ge_u32 s49, 6
s_cbranch_scc1 Ldisp_7
s_add_u32 s49, s49, 10
s_branch L_AT
Ldisp_7:
s_sub_u32 s49, s60, 146
s_cmp_ge_u32 s49, 14
s_cbranch_scc1 Ldisp_8
s_branch L_GU
Ldisp_8:
s_sub_u32 s49, s60, 166
s_cmp_ge_u32 s49, 26
s_cbranch_scc1 Ldisp_9
s_add_u32 s49, s49, 14
s_branch L_GU
Ldisp_9:
s_sub_u32 s49, s60, 208
s_cmp_ge_u32 s49, 16
s_cbranch_scc1 Ldisp_10
s_add_u32 s49, s49, 40
s_branch L_GU
Ldisp_10:
s_sub_u32 s49, s60, 224
s_cmp_ge_u32 s49, 24
s_cbranch_scc1 Ldisp_11
s_branch L_WOP
Ldisp_11:
s_sub_u32 s49, s60, 248
s_cmp_ge_u32 s49, 8
s_cbranch_scc1 Ldisp_12
s_branch L_WOF
Ldisp_12:
s_sub_u32 s49, s60, 112
s_cmp_ge_u32 s49, 16
s_cbranch_scc1 Ldisp_13
s_branch L_DNP
Ldisp_13:
s_sub_u32 s49, s60, 88
s_cmp_ge_u32 s49, 8
s_cbranch_scc1 Ldisp_14
s_branch L_DNF
Ldisp_14:
s_sub_u32 s49, s60, 0
s_cmp_ge_u32 s49, 16
s_cbranch_scc1 Ldisp_15
s_branch L_QK
Ldisp_15:
s_sub_u32 s49, s60, 16
s_cmp_ge_u32 s49, 8
s_cbranch_scc1 Ldisp_16
s_branch L_VM
Ldisp_16:
s_sub_u32 s49, s60, 24
s_cmp_ge_u32 s49, 8
s_cbranch_scc1 Ldisp_17
s_branch L_WM
Ldisp_17:
s_sub_u32 s49, s60, 32
s_cmp_ge_u32 s49, 16
s_cbranch_scc1 Ldisp_18
s_branch L_QK
Ldisp_18:
s_sub_u32 s49, s60, 48
s_cmp_ge_u32 s49, 8
s_cbranch_scc1 Ldisp_19
s_branch L_VM
Ldisp_19:
s_sub_u32 s49, s60, 56
s_cmp_ge_u32 s49, 8
s_cbranch_scc1 Ldisp_20
s_branch L_WM
Ldisp_20:
s_waitcnt vmcnt(0)
s_barrier
s_cmp_lg_u32 s48, 0
s_cbranch_scc1 Larr_21
s_mov_b32 s60, 0
v_mov_b32 v2, s60
v_mov_b32 v1, 0x40000000
v_cmp_gt_u32 vcc, 1, v0
s_nop 1
v_cndmask_b32 v2, v1, v2, vcc
s_sub_u32 s61, s101, s2
s_and_b32 s61, s61, 7
s_lshl_b32 s61, s61, 2
s_add_u32 s61, s61, 128
s_cmp_eq_u32 s100, 0
s_cselect_b32 s61, s61, 0
v_mov_b32 v3, 1
buffer_atomic_add v3, v2, s[20:23], s61 offen sc1
Larr_21:
v_mov_b32 v16, 0
s_cmp_lg_u32 s100, 0
s_cbranch_scc1 Lws1_23
s_cmp_eq_u32 s48, 0
s_cbranch_scc1 Lws_22
s_barrier
Lws_22:
v_mov_b32 v16, 0
buffer_load_dwordx4 v[8:11], v16, s[20:23], 0 offen offset:128 sc1
buffer_load_dwordx4 v[12:15], v16, s[20:23], 0 offen offset:144 sc1
buffer_load_dword v18, v16, s[20:23], 0 offen offset:160 sc1
Lwsw1_26:
s_waitcnt vmcnt(0)
v_readfirstlane_b32 s97, v18
v_add3_u32 v17, v8, v9, v10
v_add3_u32 v17, v17, v11, v12
v_add3_u32 v17, v17, v13, v14
v_add_u32 v17, v17, v15
v_cmp_le_u32 vcc, 0x100, v17
s_nop 0
s_cmp_eq_u64 vcc, -1
s_cbranch_scc0 Lrt_27
s_cmp_lg_u32 s48, 0
s_cbranch_scc1 Lwsw_25
s_barrier
Lwsw_25:
v_or3_b32 v17, v8, v9, v10
v_or3_b32 v17, v17, v11, v12
v_or3_b32 v17, v17, v13, v14
v_or_b32 v17, v17, v15
v_cmp_eq_u32 vcc, 256, v17
s_nop 0
s_cmp_eq_u64 vcc, -1
s_cbranch_scc1 Lws2_24
s_branch L_restart
Lws1_23:
buffer_load_dword v8, v16, s[20:23], 0 offen sc1
s_waitcnt vmcnt(0)
v_cmp_le_u32 vcc, 0x100, v8
s_nop 0
s_cmp_eq_u64 vcc, -1
s_cbranch_scc0 Lrt_28
Lws2_24:
L_done:
s_endpgm
Lrt_27:
s_add_u32 s96, s96, 1
s_cmp_lt_u32 s96, 1048576
s_cbranch_scc1 Lws_22
s_mov_b32 s97, 1
s_branch L_fail
Lrt_28:
s_add_u32 s96, s96, 1
s_cmp_lt_u32 s96, 1048576
s_cbranch_scc1 Lws1_23
s_mov_b32 s97, 1
s_branch L_fail
L_fail:
s_lshl_b32 s60, s2, 16
s_lshl_b32 s61, s48, 8
s_or_b32 s60, s60, s61
s_or_b32 s60, s60, s52
s_bitset1_b32 s60, 31
v_mov_b32 v1, s60
s_lshl_b32 s61, s97, 2
s_add_u32 s61, s61, 16
v_mov_b32 v2, 0
buffer_store_dword v1, v2, s[20:23], s61 offen sc1
s_waitcnt vmcnt(0)
s_endpgm
L_P:
s_mul_i32 s60, s49, 256
s_add_u32 s60, s60, 4096
s_and_b32 s61, s60, 0xffffe000
s_add_u32 s60, s60, s61
v_mov_b32 v117, s60
v_mov_b32 v1, 0x40000000
v_cmp_gt_u32 vcc, 1, v0
s_nop 1
v_cndmask_b32 v117, v1, v117, vcc
s_cmp_eq_u32 s48, 1
s_cselect_b32 s60, 0, 0x40000000
v_or_b32 v117, s60, v117
v_mov_b32 v1, 0
s_mov_b32 s60, 0x0
buffer_store_dword v1, v117, s[4:7], s60 offen sc1
s_mov_b32 s60, 0x2000
buffer_store_dword v1, v117, s[4:7], s60 offen sc1
s_mov_b32 s60, 0x40000
buffer_store_dword v1, v117, s[4:7], s60 offen sc1
s_mov_b32 s60, 0x42000
buffer_store_dword v1, v117, s[4:7], s60 offen sc1
s_waitcnt vmcnt(0)
s_barrier
s_cmp_lg_u32 s48, 0
s_cbranch_scc1 Larr_29
s_mov_b32 s60, 0
v_mov_b32 v2, s60
v_mov_b32 v1, 0x40000000
v_cmp_gt_u32 vcc, 1, v0
s_nop 1
v_cndmask_b32 v2, v1, v2, vcc
s_sub_u32 s61, s101, s2
s_and_b32 s61, s61, 7
s_lshl_b32 s61, s61, 2
s_add_u32 s61, s61, 128
s_cmp_eq_u32 s100, 0
s_cselect_b32 s61, s61, 0
v_mov_b32 v3, 1
buffer_atomic_add v3, v2, s[20:23], s61 offen sc1
Larr_29:
L_P2:
s_mul_i32 s71, s49, 3
s_add_u32 s71, s71, 0
s_cmp_lt_u32 s71, 64
s_cselect_b32 s8, s28, s30
s_cselect_b32 s9, s29, s31
s_cmp_lt_u32 s71, 128
s_cselect_b32 s8, s8, s32
s_cselect_b32 s9, s9, s33
s_and_b32 s9, s9, 0xffff
s_mov_b32 s10, 0x800000
s_mov_b32 s11, 0x20000
s_and_b32 s66, s71, 63
s_lshl_b32 s66, s66, 7
s_mul_i32 s72, s49, 3
s_add_u32 s72, s72, 1
s_cmp_lt_u32 s72, 64
s_cselect_b32 s12, s28, s30
s_cselect_b32 s13, s29, s31
s_cmp_lt_u32 s72, 128
s_cselect_b32 s12, s12, s32
s_cselect_b32 s13, s13, s33
s_and_b32 s13, s13, 0xffff
s_mov_b32 s14, 0x800000
s_mov_b32 s15, 0x20000
s_and_b32 s67, s72, 63
s_lshl_b32 s67, s67, 7
s_mul_i32 s73, s49, 3
s_add_u32 s73, s73, 2
s_cmp_lt_u32 s73, 64
s_cselect_b32 s16, s28, s30
s_cselect_b32 s17, s29, s31
s_cmp_lt_u32 s73, 128
s_cselect_b32 s16, s16, s32
s_cselect_b32 s17, s17, s33
s_and_b32 s17, s17, 0xffff
s_mov_b32 s18, 0x800000
s_mov_b32 s19, 0x20000
s_and_b32 s68, s73, 63
s_lshl_b32 s68, s68, 7
s_lshl_b32 s61, s48, 5
v_lshrrev_b32 v1, 4, v0
v_bfe_u32 v2, v0, 2, 2
v_and_b32 v3, 3, v0
v_mul_u32_u24 v1, 8, v1
v_add_u32 v1, v1, v2
v_mul_u32_u24 v1, 128, v1
v_mul_u32_u24 v3, 8, v3
v_add3_u32 v8, v1, v3, s61
v_lshrrev_b32 v1, 3, v0
s_lshl_b32 s60, s48, 3
v_add_u32 v1, s60, v1
v_mul_u32_u24 v1, 8192, v1
v_and_b32 v2, 7, v0
v_lshlrev_b32 v2, 4, v2
v_add_u32 v11, v1, v2
v_add_u32 v9, 61440, v8
v_add_u32 v10, 122880, v8
s_lshl_b32 s62, s48, 10
s_add_u32 m0, s62, 0
s_add_u32 s63, s66, 0x0
buffer_load_dwordx4 v11, s[8:11], s63 offen lds
s_add_u32 m0, s62, 4096
s_add_u32 s63, s67, 0x0
buffer_load_dwordx4 v11, s[12:15], s63 offen lds
s_add_u32 m0, s62, 8192
s_add_u32 s63, s68, 0x0
buffer_load_dwordx4 v11, s[16:19], s63 offen lds
s_add_u32 m0, s62, 12288
s_add_u32 s63, s66, 0x40000
buffer_load_dwordx4 v11, s[8:11], s63 offen lds
s_add_u32 m0, s62, 16384
s_add_u32 s63, s67, 0x40000
buffer_load_dwordx4 v11, s[12:15], s63 offen lds
s_add_u32 m0, s62, 20480
s_add_u32 s63, s68, 0x40000
buffer_load_dwordx4 v11, s[16:19], s63 offen lds
s_add_u32 m0, s62, 24576
s_add_u32 s63, s66, 0x80000
buffer_load_dwordx4 v11, s[8:11], s63 offen lds
s_add_u32 m0, s62, 28672
s_add_u32 s63, s67, 0x80000
buffer_load_dwordx4 v11, s[12:15], s63 offen lds
s_add_u32 m0, s62, 32768
s_add_u32 s63, s68, 0x80000
buffer_load_dwordx4 v11, s[16:19], s63 offen lds
s_add_u32 m0, s62, 36864
s_add_u32 s63, s66, 0xc0000
buffer_load_dwordx4 v11, s[8:11], s63 offen lds
s_add_u32 m0, s62, 40960
s_add_u32 s63, s67, 0xc0000
buffer_load_dwordx4 v11, s[12:15], s63 offen lds
s_add_u32 m0, s62, 45056
s_add_u32 s63, s68, 0xc0000
buffer_load_dwordx4 v11, s[16:19], s63 offen lds
s_add_u32 m0, s62, 49152
s_add_u32 s63, s66, 0x100000
buffer_load_dwordx4 v11, s[8:11], s63 offen lds
s_add_u32 m0, s62, 53248
s_add_u32 s63, s67, 0x100000
buffer_load_dwordx4 v11, s[12:15], s63 offen lds
s_add_u32 m0, s62, 57344
s_add_u32 s63, s68, 0x100000
buffer_load_dwordx4 v11, s[16:19], s63 offen lds
s_add_u32 m0, s62, 61440
s_add_u32 s63, s66, 0x140000
buffer_load_dwordx4 v11, s[8:11], s63 offen lds
s_add_u32 m0, s62, 65536
s_add_u32 s63, s67, 0x140000
buffer_load_dwordx4 v11, s[12:15], s63 offen lds
s_add_u32 m0, s62, 69632
s_add_u32 s63, s68, 0x140000
buffer_load_dwordx4 v11, s[16:19], s63 offen lds
s_add_u32 m0, s62, 73728
s_add_u32 s63, s66, 0x180000
buffer_load_dwordx4 v11, s[8:11], s63 offen lds
s_add_u32 m0, s62, 77824
s_add_u32 s63, s67, 0x180000
buffer_load_dwordx4 v11, s[12:15], s63 offen lds
s_add_u32 m0, s62, 81920
s_add_u32 s63, s68, 0x180000
buffer_load_dwordx4 v11, s[16:19], s63 offen lds
s_add_u32 m0, s62, 86016
s_add_u32 s63, s66, 0x1c0000
buffer_load_dwordx4 v11, s[8:11], s63 offen lds
s_add_u32 m0, s62, 90112
s_add_u32 s63, s67, 0x1c0000
buffer_load_dwordx4 v11, s[12:15], s63 offen lds
s_add_u32 m0, s62, 94208
s_add_u32 s63, s68, 0x1c0000
buffer_load_dwordx4 v11, s[16:19], s63 offen lds
s_add_u32 m0, s62, 98304
s_add_u32 s63, s66, 0x200000
buffer_load_dwordx4 v11, s[8:11], s63 offen lds
s_add_u32 m0, s62, 102400
s_add_u32 s63, s67, 0x200000
buffer_load_dwordx4 v11, s[12:15], s63 offen lds
s_add_u32 m0, s62, 106496
s_add_u32 s63, s68, 0x200000
buffer_load_dwordx4 v11, s[16:19], s63 offen lds
s_add_u32 m0, s62, 110592
s_add_u32 s63, s66, 0x240000
buffer_load_dwordx4 v11, s[8:11], s63 offen lds
s_add_u32 m0, s62, 114688
s_add_u32 s63, s67, 0x240000
buffer_load_dwordx4 v11, s[12:15], s63 offen lds
s_add_u32 m0, s62, 118784
s_add_u32 s63, s68, 0x240000
buffer_load_dwordx4 v11, s[16:19], s63 offen lds
s_add_u32 m0, s62, 122880
s_add_u32 s63, s66, 0x280000
buffer_load_dwordx4 v11, s[8:11], s63 offen lds
s_add_u32 m0, s62, 126976
s_add_u32 s63, s67, 0x280000
buffer_load_dwordx4 v11, s[12:15], s63 offen lds
s_add_u32 m0, s62, 131072
s_add_u32 s63, s68, 0x280000
buffer_load_dwordx4 v11, s[16:19], s63 offen lds
s_add_u32 m0, s62, 135168
s_add_u32 s63, s66, 0x2c0000
buffer_load_dwordx4 v11, s[8:11], s63 offen lds
s_add_u32 m0, s62, 139264
s_add_u32 s63, s67, 0x2c0000
buffer_load_dwordx4 v11, s[12:15], s63 offen lds
s_add_u32 m0, s62, 143360
s_add_u32 s63, s68, 0x2c0000
buffer_load_dwordx4 v11, s[16:19], s63 offen lds
s_add_u32 m0, s62, 147456
s_add_u32 s63, s66, 0x300000
buffer_load_dwordx4 v11, s[8:11], s63 offen lds
s_add_u32 m0, s62, 151552
s_add_u32 s63, s67, 0x300000
buffer_load_dwordx4 v11, s[12:15], s63 offen lds
s_add_u32 m0, s62, 155648
s_add_u32 s63, s68, 0x300000
buffer_load_dwordx4 v11, s[16:19], s63 offen lds
s_waitcnt vmcnt(36) lgkmcnt(0)
s_barrier
ds_read_b64_tr_b16 a[0:1], v8 offset:0
ds_read_b64_tr_b16 a[2:3], v8 offset:512
ds_read_b64_tr_b16 a[4:5], v8 offset:4096
ds_read_b64_tr_b16 a[6:7], v8 offset:4608
ds_read_b64_tr_b16 a[8:9], v8 offset:8192
ds_read_b64_tr_b16 a[10:11], v8 offset:8704
s_waitcnt vmcnt(33) lgkmcnt(0)
s_barrier
s_add_u32 m0, s62, 0
s_add_u32 s63, s66, 0x340000
buffer_load_dwordx4 v11, s[8:11], s63 offen lds
s_add_u32 m0, s62, 4096
s_add_u32 s63, s67, 0x340000
buffer_load_dwordx4 v11, s[12:15], s63 offen lds
s_add_u32 m0, s62, 8192
s_add_u32 s63, s68, 0x340000
buffer_load_dwordx4 v11, s[16:19], s63 offen lds
ds_read_b64_tr_b16 a[12:13], v8 offset:12288
ds_read_b64_tr_b16 a[14:15], v8 offset:12800
ds_read_b64_tr_b16 a[16:17], v8 offset:16384
ds_read_b64_tr_b16 a[18:19], v8 offset:16896
ds_read_b64_tr_b16 a[20:21], v8 offset:20480
ds_read_b64_tr_b16 a[22:23], v8 offset:20992
v_mov_b32 v12, 0x3f803f80
v_mov_b32 v13, 0x3f803f80
v_mov_b32 v14, 0x3f803f80
v_mov_b32 v15, 0x3f803f80
s_nop 1
v_mfma_f32_16x16x32_bf16 v[88:91], a[0:3], v[12:15], 0
v_mfma_f32_16x16x32_bf16 v[92:95], a[4:7], v[12:15], 0
v_mfma_f32_16x16x32_bf16 v[96:99], a[8:11], v[12:15], 0
s_waitcnt vmcnt(33) lgkmcnt(0)
s_barrier
s_add_u32 m0, s62, 12288
s_add_u32 s63, s66, 0x380000
buffer_load_dwordx4 v11, s[8:11], s63 offen lds
s_add_u32 m0, s62, 16384
s_add_u32 s63, s67, 0x380000
buffer_load_dwordx4 v11, s[12:15], s63 offen lds
s_add_u32 m0, s62, 20480
s_add_u32 s63, s68, 0x380000
buffer_load_dwordx4 v11, s[16:19], s63 offen lds
ds_read_b64_tr_b16 a[24:25], v8 offset:24576
ds_read_b64_tr_b16 a[26:27], v8 offset:25088
ds_read_b64_tr_b16 a[28:29], v8 offset:28672
ds_read_b64_tr_b16 a[30:31], v8 offset:29184
ds_read_b64_tr_b16 a[32:33], v8 offset:32768
ds_read_b64_tr_b16 a[34:35], v8 offset:33280
v_mfma_f32_16x16x32_bf16 v[88:91], a[12:15], v[12:15], v[88:91]
v_mfma_f32_16x16x32_bf16 v[92:95], a[16:19], v[12:15], v[92:95]
v_mfma_f32_16x16x32_bf16 v[96:99], a[20:23], v[12:15], v[96:99]
s_waitcnt vmcnt(33) lgkmcnt(0)
s_barrier
s_add_u32 m0, s62, 24576
s_add_u32 s63, s66, 0x3c0000
buffer_load_dwordx4 v11, s[8:11], s63 offen lds
s_add_u32 m0, s62, 28672
s_add_u32 s63, s67, 0x3c0000
buffer_load_dwordx4 v11, s[12:15], s63 offen lds
s_add_u32 m0, s62, 32768
s_add_u32 s63, s68, 0x3c0000
buffer_load_dwordx4 v11, s[16:19], s63 offen lds
ds_read_b64_tr_b16 a[36:37], v8 offset:36864
ds_read_b64_tr_b16 a[38:39], v8 offset:37376
ds_read_b64_tr_b16 a[40:41], v8 offset:40960
ds_read_b64_tr_b16 a[42:43], v8 offset:41472
ds_read_b64_tr_b16 a[44:45], v8 offset:45056
ds_read_b64_tr_b16 a[46:47], v8 offset:45568
v_mfma_f32_16x16x32_bf16 v[88:91], a[24:27], v[12:15], v[88:91]
v_mfma_f32_16x16x32_bf16 v[92:95], a[28:31], v[12:15], v[92:95]
v_mfma_f32_16x16x32_bf16 v[96:99], a[32:35], v[12:15], v[96:99]
s_waitcnt vmcnt(33) lgkmcnt(0)
s_barrier
s_add_u32 m0, s62, 36864
s_add_u32 s63, s66, 0x400000
buffer_load_dwordx4 v11, s[8:11], s63 offen lds
s_add_u32 m0, s62, 40960
s_add_u32 s63, s67, 0x400000
buffer_load_dwordx4 v11, s[12:15], s63 offen lds
s_add_u32 m0, s62, 45056
s_add_u32 s63, s68, 0x400000
buffer_load_dwordx4 v11, s[16:19], s63 offen lds
ds_read_b64_tr_b16 a[48:49], v8 offset:49152
ds_read_b64_tr_b16 a[50:51], v8 offset:49664
ds_read_b64_tr_b16 a[52:53], v8 offset:53248
ds_read_b64_tr_b16 a[54:55], v8 offset:53760
ds_read_b64_tr_b16 a[56:57], v8 offset:57344
ds_read_b64_tr_b16 a[58:59], v8 offset:57856
v_mfma_f32_16x16x32_bf16 v[88:91], a[36:39], v[12:15], v[88:91]
v_mfma_f32_16x16x32_bf16 v[92:95], a[40:43], v[12:15], v[92:95]
v_mfma_f32_16x16x32_bf16 v[96:99], a[44:47], v[12:15], v[96:99]
s_waitcnt vmcnt(33) lgkmcnt(0)
s_barrier
s_add_u32 m0, s62, 49152
s_add_u32 s63, s66, 0x440000
buffer_load_dwordx4 v11, s[8:11], s63 offen lds
s_add_u32 m0, s62, 53248
s_add_u32 s63, s67, 0x440000
buffer_load_dwordx4 v11, s[12:15], s63 offen lds
s_add_u32 m0, s62, 57344
s_add_u32 s63, s68, 0x440000
buffer_load_dwordx4 v11, s[16:19], s63 offen lds
ds_read_b64_tr_b16 a[60:61], v9 offset:0
ds_read_b64_tr_b16 a[62:63], v9 offset:512
ds_read_b64_tr_b16 a[64:65], v9 offset:4096
ds_read_b64_tr_b16 a[66:67], v9 offset:4608
ds_read_b64_tr_b16 a[68:69], v9 offset:8192
ds_read_b64_tr_b16 a[70:71], v9 offset:8704
v_mfma_f32_16x16x32_bf16 v[88:91], a[48:51], v[12:15], v[88:91]
v_mfma_f32_16x16x32_bf16 v[92:95], a[52:55], v[12:15], v[92:95]
v_mfma_f32_16x16x32_bf16 v[96:99], a[56:59], v[12:15], v[96:99]
s_waitcnt vmcnt(33) lgkmcnt(0)
s_barrier
s_add_u32 m0, s62, 61440
s_add_u32 s63, s66, 0x480000
buffer_load_dwordx4 v11, s[8:11], s63 offen lds
s_add_u32 m0, s62, 65536
s_add_u32 s63, s67, 0x480000
buffer_load_dwordx4 v11, s[12:15], s63 offen lds
s_add_u32 m0, s62, 69632
s_add_u32 s63, s68, 0x480000
buffer_load_dwordx4 v11, s[16:19], s63 offen lds
ds_read_b64_tr_b16 a[72:73], v9 offset:12288
ds_read_b64_tr_b16 a[74:75], v9 offset:12800
ds_read_b64_tr_b16 a[76:77], v9 offset:16384
ds_read_b64_tr_b16 a[78:79], v9 offset:16896
ds_read_b64_tr_b16 a[80:81], v9 offset:20480
ds_read_b64_tr_b16 a[82:83], v9 offset:20992
v_mfma_f32_16x16x32_bf16 v[88:91], a[60:63], v[12:15], v[88:91]
v_mfma_f32_16x16x32_bf16 v[92:95], a[64:67], v[12:15], v[92:95]
v_mfma_f32_16x16x32_bf16 v[96:99], a[68:71], v[12:15], v[96:99]
s_waitcnt vmcnt(33) lgkmcnt(0)
s_barrier
s_add_u32 m0, s62, 73728
s_add_u32 s63, s66, 0x4c0000
buffer_load_dwordx4 v11, s[8:11], s63 offen lds
s_add_u32 m0, s62, 77824
s_add_u32 s63, s67, 0x4c0000
buffer_load_dwordx4 v11, s[12:15], s63 offen lds
s_add_u32 m0, s62, 81920
s_add_u32 s63, s68, 0x4c0000
buffer_load_dwordx4 v11, s[16:19], s63 offen lds
ds_read_b64_tr_b16 a[84:85], v9 offset:24576
ds_read_b64_tr_b16 a[86:87], v9 offset:25088
ds_read_b64_tr_b16 a[88:89], v9 offset:28672
ds_read_b64_tr_b16 a[90:91], v9 offset:29184
ds_read_b64_tr_b16 a[92:93], v9 offset:32768
ds_read_b64_tr_b16 a[94:95], v9 offset:33280
v_mfma_f32_16x16x32_bf16 v[88:91], a[72:75], v[12:15], v[88:91]
v_mfma_f32_16x16x32_bf16 v[92:95], a[76:79], v[12:15], v[92:95]
v_mfma_f32_16x16x32_bf16 v[96:99], a[80:83], v[12:15], v[96:99]
s_waitcnt vmcnt(33) lgkmcnt(0)
s_barrier
s_add_u32 m0, s62, 86016
s_add_u32 s63, s66, 0x500000
buffer_load_dwordx4 v11, s[8:11], s63 offen lds
s_add_u32 m0, s62, 90112
s_add_u32 s63, s67, 0x500000
buffer_load_dwordx4 v11, s[12:15], s63 offen lds
s_add_u32 m0, s62, 94208
s_add_u32 s63, s68, 0x500000
buffer_load_dwordx4 v11, s[16:19], s63 offen lds
ds_read_b64_tr_b16 a[96:97], v9 offset:36864
ds_read_b64_tr_b16 a[98:99], v9 offset:37376
ds_read_b64_tr_b16 a[100:101], v9 offset:40960
ds_read_b64_tr_b16 a[102:103], v9 offset:41472
ds_read_b64_tr_b16 a[104:105], v9 offset:45056
ds_read_b64_tr_b16 a[106:107], v9 offset:45568
v_mfma_f32_16x16x32_bf16 v[88:91], a[84:87], v[12:15], v[88:91]
v_mfma_f32_16x16x32_bf16 v[92:95], a[88:91], v[12:15], v[92:95]
v_mfma_f32_16x16x32_bf16 v[96:99], a[92:95], v[12:15], v[96:99]
s_waitcnt vmcnt(33) lgkmcnt(0)
s_barrier
s_add_u32 m0, s62, 98304
s_add_u32 s63, s66, 0x540000
buffer_load_dwordx4 v11, s[8:11], s63 offen lds
s_add_u32 m0, s62, 102400
s_add_u32 s63, s67, 0x540000
buffer_load_dwordx4 v11, s[12:15], s63 offen lds
s_add_u32 m0, s62, 106496
s_add_u32 s63, s68, 0x540000
buffer_load_dwordx4 v11, s[16:19], s63 offen lds
ds_read_b64_tr_b16 a[108:109], v9 offset:49152
ds_read_b64_tr_b16 a[110:111], v9 offset:49664
ds_read_b64_tr_b16 a[112:113], v9 offset:53248
ds_read_b64_tr_b16 a[114:115], v9 offset:53760
ds_read_b64_tr_b16 a[116:117], v9 offset:57344
ds_read_b64_tr_b16 a[118:119], v9 offset:57856
v_mfma_f32_16x16x32_bf16 v[88:91], a[96:99], v[12:15], v[88:91]
v_mfma_f32_16x16x32_bf16 v[92:95], a[100:103], v[12:15], v[92:95]
v_mfma_f32_16x16x32_bf16 v[96:99], a[104:107], v[12:15], v[96:99]
s_waitcnt vmcnt(33) lgkmcnt(0)
s_barrier
s_add_u32 m0, s62, 110592
s_add_u32 s63, s66, 0x580000
buffer_load_dwordx4 v11, s[8:11], s63 offen lds
s_add_u32 m0, s62, 114688
s_add_u32 s63, s67, 0x580000
buffer_load_dwordx4 v11, s[12:15], s63 offen lds
s_add_u32 m0, s62, 118784
s_add_u32 s63, s68, 0x580000
buffer_load_dwordx4 v11, s[16:19], s63 offen lds
ds_read_b64_tr_b16 a[120:121], v10 offset:0
ds_read_b64_tr_b16 a[122:123], v10 offset:512
ds_read_b64_tr_b16 a[124:125], v10 offset:4096
ds_read_b64_tr_b16 a[126:127], v10 offset:4608
ds_read_b64_tr_b16 a[128:129], v10 offset:8192
ds_read_b64_tr_b16 a[130:131], v10 offset:8704
v_mfma_f32_16x16x32_bf16 v[88:91], a[108:111], v[12:15], v[88:91]
v_mfma_f32_16x16x32_bf16 v[92:95], a[112:115], v[12:15], v[92:95]
v_mfma_f32_16x16x32_bf16 v[96:99], a[116:119], v[12:15], v[96:99]
s_waitcnt vmcnt(33) lgkmcnt(0)
s_barrier
s_add_u32 m0, s62, 122880
s_add_u32 s63, s66, 0x5c0000
buffer_load_dwordx4 v11, s[8:11], s63 offen lds
s_add_u32 m0, s62, 126976
s_add_u32 s63, s67, 0x5c0000
buffer_load_dwordx4 v11, s[12:15], s63 offen lds
s_add_u32 m0, s62, 131072
s_add_u32 s63, s68, 0x5c0000
buffer_load_dwordx4 v11, s[16:19], s63 offen lds
ds_read_b64_tr_b16 a[132:133], v10 offset:12288
ds_read_b64_tr_b16 a[134:135], v10 offset:12800
ds_read_b64_tr_b16 a[136:137], v10 offset:16384
ds_read_b64_tr_b16 a[138:139], v10 offset:16896
ds_read_b64_tr_b16 a[140:141], v10 offset:20480
ds_read_b64_tr_b16 a[142:143], v10 offset:20992
v_mfma_f32_16x16x32_bf16 v[88:91], a[120:123], v[12:15], v[88:91]
v_mfma_f32_16x16x32_bf16 v[92:95], a[124:127], v[12:15], v[92:95]
v_mfma_f32_16x16x32_bf16 v[96:99], a[128:131], v[12:15], v[96:99]
s_waitcnt vmcnt(33) lgkmcnt(0)
s_barrier
s_add_u32 m0, s62, 135168
s_add_u32 s63, s66, 0x600000
buffer_load_dwordx4 v11, s[8:11], s63 offen lds
s_add_u32 m0, s62, 139264
s_add_u32 s63, s67, 0x600000
buffer_load_dwordx4 v11, s[12:15], s63 offen lds
s_add_u32 m0, s62, 143360
s_add_u32 s63, s68, 0x600000
buffer_load_dwordx4 v11, s[16:19], s63 offen lds
ds_read_b64_tr_b16 a[144:145], v10 offset:24576
ds_read_b64_tr_b16 a[146:147], v10 offset:25088
ds_read_b64_tr_b16 a[148:149], v10 offset:28672
ds_read_b64_tr_b16 a[150:151], v10 offset:29184
ds_read_b64_tr_b16 a[152:153], v10 offset:32768
ds_read_b64_tr_b16 a[154:155], v10 offset:33280
v_mfma_f32_16x16x32_bf16 v[88:91], a[132:135], v[12:15], v[88:91]
v_mfma_f32_16x16x32_bf16 v[92:95], a[136:139], v[12:15], v[92:95]
v_mfma_f32_16x16x32_bf16 v[96:99], a[140:143], v[12:15], v[96:99]
s_waitcnt vmcnt(33) lgkmcnt(0)
s_barrier
s_add_u32 m0, s62, 147456
s_add_u32 s63, s66, 0x640000
buffer_load_dwordx4 v11, s[8:11], s63 offen lds
s_add_u32 m0, s62, 151552
s_add_u32 s63, s67, 0x640000
buffer_load_dwordx4 v11, s[12:15], s63 offen lds
s_add_u32 m0, s62, 155648
s_add_u32 s63, s68, 0x640000
buffer_load_dwordx4 v11, s[16:19], s63 offen lds
ds_read_b64_tr_b16 a[156:157], v8 offset:0
ds_read_b64_tr_b16 a[158:159], v8 offset:512
ds_read_b64_tr_b16 a[160:161], v8 offset:4096
ds_read_b64_tr_b16 a[162:163], v8 offset:4608
ds_read_b64_tr_b16 a[164:165], v8 offset:8192
ds_read_b64_tr_b16 a[166:167], v8 offset:8704
v_mfma_f32_16x16x32_bf16 v[88:91], a[144:147], v[12:15], v[88:91]
v_mfma_f32_16x16x32_bf16 v[92:95], a[148:151], v[12:15], v[92:95]
v_mfma_f32_16x16x32_bf16 v[96:99], a[152:155], v[12:15], v[96:99]
s_waitcnt vmcnt(33) lgkmcnt(0)
s_barrier
s_add_u32 m0, s62, 0
s_add_u32 s63, s66, 0x680000
buffer_load_dwordx4 v11, s[8:11], s63 offen lds
s_add_u32 m0, s62, 4096
s_add_u32 s63, s67, 0x680000
buffer_load_dwordx4 v11, s[12:15], s63 offen lds
s_add_u32 m0, s62, 8192
s_add_u32 s63, s68, 0x680000
buffer_load_dwordx4 v11, s[16:19], s63 offen lds
ds_read_b64_tr_b16 a[168:169], v8 offset:12288
ds_read_b64_tr_b16 a[170:171], v8 offset:12800
ds_read_b64_tr_b16 a[172:173], v8 offset:16384
ds_read_b64_tr_b16 a[174:175], v8 offset:16896
ds_read_b64_tr_b16 a[176:177], v8 offset:20480
ds_read_b64_tr_b16 a[178:179], v8 offset:20992
v_mfma_f32_16x16x32_bf16 v[88:91], a[156:159], v[12:15], v[88:91]
v_mfma_f32_16x16x32_bf16 v[92:95], a[160:163], v[12:15], v[92:95]
v_mfma_f32_16x16x32_bf16 v[96:99], a[164:167], v[12:15], v[96:99]
s_waitcnt vmcnt(33) lgkmcnt(0)
s_barrier
s_add_u32 m0, s62, 12288
s_add_u32 s63, s66, 0x6c0000
buffer_load_dwordx4 v11, s[8:11], s63 offen lds
s_add_u32 m0, s62, 16384
s_add_u32 s63, s67, 0x6c0000
buffer_load_dwordx4 v11, s[12:15], s63 offen lds
s_add_u32 m0, s62, 20480
s_add_u32 s63, s68, 0x6c0000
buffer_load_dwordx4 v11, s[16:19], s63 offen lds
ds_read_b64_tr_b16 a[180:181], v8 offset:24576
ds_read_b64_tr_b16 a[182:183], v8 offset:25088
ds_read_b64_tr_b16 a[184:185], v8 offset:28672
ds_read_b64_tr_b16 a[186:187], v8 offset:29184
ds_read_b64_tr_b16 a[188:189], v8 offset:32768
ds_read_b64_tr_b16 a[190:191], v8 offset:33280
v_mfma_f32_16x16x32_bf16 v[88:91], a[168:171], v[12:15], v[88:91]
v_mfma_f32_16x16x32_bf16 v[92:95], a[172:175], v[12:15], v[92:95]
v_mfma_f32_16x16x32_bf16 v[96:99], a[176:179], v[12:15], v[96:99]
s_waitcnt vmcnt(33) lgkmcnt(0)
s_barrier
s_add_u32 m0, s62, 24576
s_add_u32 s63, s66, 0x700000
buffer_load_dwordx4 v11, s[8:11], s63 offen lds
s_add_u32 m0, s62, 28672
s_add_u32 s63, s67, 0x700000
buffer_load_dwordx4 v11, s[12:15], s63 offen lds
s_add_u32 m0, s62, 32768
s_add_u32 s63, s68, 0x700000
buffer_load_dwordx4 v11, s[16:19], s63 offen lds
ds_read_b64_tr_b16 a[192:193], v8 offset:36864
ds_read_b64_tr_b16 a[194:195], v8 offset:37376
ds_read_b64_tr_b16 a[196:197], v8 offset:40960
ds_read_b64_tr_b16 a[198:199], v8 offset:41472
ds_read_b64_tr_b16 a[200:201], v8 offset:45056
ds_read_b64_tr_b16 a[202:203], v8 offset:45568
v_mfma_f32_16x16x32_bf16 v[88:91], a[180:183], v[12:15], v[88:91]
v_mfma_f32_16x16x32_bf16 v[92:95], a[184:187], v[12:15], v[92:95]
v_mfma_f32_16x16x32_bf16 v[96:99], a[188:191], v[12:15], v[96:99]
s_waitcnt vmcnt(33) lgkmcnt(0)
s_barrier
s_add_u32 m0, s62, 36864
s_add_u32 s63, s66, 0x740000
buffer_load_dwordx4 v11, s[8:11], s63 offen lds
s_add_u32 m0, s62, 40960
s_add_u32 s63, s67, 0x740000
buffer_load_dwordx4 v11, s[12:15], s63 offen lds
s_add_u32 m0, s62, 45056
s_add_u32 s63, s68, 0x740000
buffer_load_dwordx4 v11, s[16:19], s63 offen lds
ds_read_b64_tr_b16 a[204:205], v8 offset:49152
ds_read_b64_tr_b16 a[206:207], v8 offset:49664
ds_read_b64_tr_b16 a[208:209], v8 offset:53248
ds_read_b64_tr_b16 a[210:211], v8 offset:53760
ds_read_b64_tr_b16 a[212:213], v8 offset:57344
ds_read_b64_tr_b16 a[214:215], v8 offset:57856
v_mfma_f32_16x16x32_bf16 v[88:91], a[192:195], v[12:15], v[88:91]
v_mfma_f32_16x16x32_bf16 v[92:95], a[196:199], v[12:15], v[92:95]
v_mfma_f32_16x16x32_bf16 v[96:99], a[200:203], v[12:15], v[96:99]
s_waitcnt vmcnt(33) lgkmcnt(0)
s_barrier
s_add_u32 m0, s62, 49152
s_add_u32 s63, s66, 0x780000
buffer_load_dwordx4 v11, s[8:11], s63 offen lds
s_add_u32 m0, s62, 53248
s_add_u32 s63, s67, 0x780000
buffer_load_dwordx4 v11, s[12:15], s63 offen lds
s_add_u32 m0, s62, 57344
s_add_u32 s63, s68, 0x780000
buffer_load_dwordx4 v11, s[16:19], s63 offen lds
ds_read_b64_tr_b16 a[216:217], v9 offset:0
ds_read_b64_tr_b16 a[218:219], v9 offset:512
ds_read_b64_tr_b16 a[220:221], v9 offset:4096
ds_read_b64_tr_b16 a[222:223], v9 offset:4608
ds_read_b64_tr_b16 a[224:225], v9 offset:8192
ds_read_b64_tr_b16 a[226:227], v9 offset:8704
v_mfma_f32_16x16x32_bf16 v[88:91], a[204:207], v[12:15], v[88:91]
v_mfma_f32_16x16x32_bf16 v[92:95], a[208:211], v[12:15], v[92:95]
v_mfma_f32_16x16x32_bf16 v[96:99], a[212:215], v[12:15], v[96:99]
s_waitcnt vmcnt(33) lgkmcnt(0)
s_barrier
s_add_u32 m0, s62, 61440
s_add_u32 s63, s66, 0x7c0000
buffer_load_dwordx4 v11, s[8:11], s63 offen lds
s_add_u32 m0, s62, 65536
s_add_u32 s63, s67, 0x7c0000
buffer_load_dwordx4 v11, s[12:15], s63 offen lds
s_add_u32 m0, s62, 69632
s_add_u32 s63, s68, 0x7c0000
buffer_load_dwordx4 v11, s[16:19], s63 offen lds
ds_read_b64_tr_b16 a[228:229], v9 offset:12288
ds_read_b64_tr_b16 a[230:231], v9 offset:12800
ds_read_b64_tr_b16 a[232:233], v9 offset:16384
ds_read_b64_tr_b16 a[234:235], v9 offset:16896
ds_read_b64_tr_b16 a[236:237], v9 offset:20480
ds_read_b64_tr_b16 a[238:239], v9 offset:20992
v_mfma_f32_16x16x32_bf16 v[88:91], a[216:219], v[12:15], v[88:91]
v_mfma_f32_16x16x32_bf16 v[92:95], a[220:223], v[12:15], v[92:95]
v_mfma_f32_16x16x32_bf16 v[96:99], a[224:227], v[12:15], v[96:99]
s_waitcnt vmcnt(33) lgkmcnt(0)
s_barrier
ds_read_b64_tr_b16 a[240:241], v9 offset:24576
ds_read_b64_tr_b16 a[242:243], v9 offset:25088
ds_read_b64_tr_b16 a[244:245], v9 offset:28672
ds_read_b64_tr_b16 a[246:247], v9 offset:29184
ds_read_b64_tr_b16 a[248:249], v9 offset:32768
ds_read_b64_tr_b16 a[250:251], v9 offset:33280
v_mfma_f32_16x16x32_bf16 v[88:91], a[228:231], v[12:15], v[88:91]
v_mfma_f32_16x16x32_bf16 v[92:95], a[232:235], v[12:15], v[92:95]
v_mfma_f32_16x16x32_bf16 v[96:99], a[236:239], v[12:15], v[96:99]
s_waitcnt vmcnt(30) lgkmcnt(0)
s_barrier
ds_read_b64_tr_b16 a[252:253], v9 offset:36864
ds_read_b64_tr_b16 a[254:255], v9 offset:37376
ds_read_b64_tr_b16 v[128:129], v9 offset:40960
ds_read_b64_tr_b16 v[130:131], v9 offset:41472
ds_read_b64_tr_b16 v[132:133], v9 offset:45056
ds_read_b64_tr_b16 v[134:135], v9 offset:45568
v_mfma_f32_16x16x32_bf16 v[88:91], a[240:243], v[12:15], v[88:91]
v_mfma_f32_16x16x32_bf16 v[92:95], a[244:247], v[12:15], v[92:95]
v_mfma_f32_16x16x32_bf16 v[96:99], a[248:251], v[12:15], v[96:99]
s_waitcnt vmcnt(27) lgkmcnt(0)
s_barrier
ds_read_b64_tr_b16 v[136:137], v9 offset:49152
ds_read_b64_tr_b16 v[138:139], v9 offset:49664
ds_read_b64_tr_b16 v[140:141], v9 offset:53248
ds_read_b64_tr_b16 v[142:143], v9 offset:53760
ds_read_b64_tr_b16 v[144:145], v9 offset:57344
ds_read_b64_tr_b16 v[146:147], v9 offset:57856
v_mfma_f32_16x16x32_bf16 v[88:91], a[252:255], v[12:15], v[88:91]
v_mfma_f32_16x16x32_bf16 v[92:95], v[128:131], v[12:15], v[92:95]
v_mfma_f32_16x16x32_bf16 v[96:99], v[132:135], v[12:15], v[96:99]
s_waitcnt vmcnt(24) lgkmcnt(0)
s_barrier
ds_read_b64_tr_b16 v[148:149], v10 offset:0
ds_read_b64_tr_b16 v[150:151], v10 offset:512
ds_read_b64_tr_b16 v[152:153], v10 offset:4096
ds_read_b64_tr_b16 v[154:155], v10 offset:4608
ds_read_b64_tr_b16 v[156:157], v10 offset:8192
ds_read_b64_tr_b16 v[158:159], v10 offset:8704
v_mfma_f32_16x16x32_bf16 v[88:91], v[136:139], v[12:15], v[88:91]
v_mfma_f32_16x16x32_bf16 v[92:95], v[140:143], v[12:15], v[92:95]
v_mfma_f32_16x16x32_bf16 v[96:99], v[144:147], v[12:15], v[96:99]
s_waitcnt vmcnt(21) lgkmcnt(0)
s_barrier
v_mov_b32 v56, 0
buffer_load_dwordx4 v[48:51], v56, s[20:23], 0 offen offset:128 sc1
buffer_load_dwordx4 v[52:55], v56, s[20:23], 0 offen offset:144 sc1
buffer_load_dword v58, v56, s[20:23], 0 offen offset:160 sc1
ds_read_b64_tr_b16 v[160:161], v10 offset:12288
ds_read_b64_tr_b16 v[162:163], v10 offset:12800
ds_read_b64_tr_b16 v[164:165], v10 offset:16384
ds_read_b64_tr_b16 v[166:167], v10 offset:16896
ds_read_b64_tr_b16 v[168:169], v10 offset:20480
ds_read_b64_tr_b16 v[170:171], v10 offset:20992
v_mfma_f32_16x16x32_bf16 v[88:91], v[148:151], v[12:15], v[88:91]
v_mfma_f32_16x16x32_bf16 v[92:95], v[152:155], v[12:15], v[92:95]
v_mfma_f32_16x16x32_bf16 v[96:99], v[156:159], v[12:15], v[96:99]
s_waitcnt vmcnt(18) lgkmcnt(0)
s_barrier
ds_read_b64_tr_b16 v[172:173], v10 offset:24576
ds_read_b64_tr_b16 v[174:175], v10 offset:25088
ds_read_b64_tr_b16 v[176:177], v10 offset:28672
ds_read_b64_tr_b16 v[178:179], v10 offset:29184
ds_read_b64_tr_b16 v[180:181], v10 offset:32768
ds_read_b64_tr_b16 v[182:183], v10 offset:33280
v_mfma_f32_16x16x32_bf16 v[88:91], v[160:163], v[12:15], v[88:91]
v_mfma_f32_16x16x32_bf16 v[92:95], v[164:167], v[12:15], v[92:95]
v_mfma_f32_16x16x32_bf16 v[96:99], v[168:171], v[12:15], v[96:99]
s_waitcnt vmcnt(15) lgkmcnt(0)
s_barrier
ds_read_b64_tr_b16 v[184:185], v8 offset:0
ds_read_b64_tr_b16 v[186:187], v8 offset:512
ds_read_b64_tr_b16 v[188:189], v8 offset:4096
ds_read_b64_tr_b16 v[190:191], v8 offset:4608
ds_read_b64_tr_b16 v[192:193], v8 offset:8192
ds_read_b64_tr_b16 v[194:195], v8 offset:8704
v_mfma_f32_16x16x32_bf16 v[88:91], v[172:175], v[12:15], v[88:91]
v_mfma_f32_16x16x32_bf16 v[92:95], v[176:179], v[12:15], v[92:95]
v_mfma_f32_16x16x32_bf16 v[96:99], v[180:183], v[12:15], v[96:99]
s_waitcnt vmcnt(12) lgkmcnt(0)
s_barrier
ds_read_b64_tr_b16 v[196:197], v8 offset:12288
ds_read_b64_tr_b16 v[198:199], v8 offset:12800
ds_read_b64_tr_b16 v[200:201], v8 offset:16384
ds_read_b64_tr_b16 v[202:203], v8 offset:16896
ds_read_b64_tr_b16 v[204:205], v8 offset:20480
ds_read_b64_tr_b16 v[206:207], v8 offset:20992
v_mfma_f32_16x16x32_bf16 v[88:91], v[184:187], v[12:15], v[88:91]
v_mfma_f32_16x16x32_bf16 v[92:95], v[188:191], v[12:15], v[92:95]
v_mfma_f32_16x16x32_bf16 v[96:99], v[192:195], v[12:15], v[96:99]
s_waitcnt vmcnt(9) lgkmcnt(0)
s_barrier
ds_read_b64_tr_b16 v[208:209], v8 offset:24576
ds_read_b64_tr_b16 v[210:211], v8 offset:25088
ds_read_b64_tr_b16 v[212:213], v8 offset:28672
ds_read_b64_tr_b16 v[214:215], v8 offset:29184
ds_read_b64_tr_b16 v[216:217], v8 offset:32768
ds_read_b64_tr_b16 v[218:219], v8 offset:33280
v_mfma_f32_16x16x32_bf16 v[88:91], v[196:199], v[12:15], v[88:91]
v_mfma_f32_16x16x32_bf16 v[92:95], v[200:203], v[12:15], v[92:95]
v_mfma_f32_16x16x32_bf16 v[96:99], v[204:207], v[12:15], v[96:99]
s_waitcnt vmcnt(6) lgkmcnt(0)
s_barrier
ds_read_b64_tr_b16 v[220:221], v8 offset:36864
ds_read_b64_tr_b16 v[222:223], v8 offset:37376
ds_read_b64_tr_b16 v[224:225], v8 offset:40960
ds_read_b64_tr_b16 v[226:227], v8 offset:41472
ds_read_b64_tr_b16 v[228:229], v8 offset:45056
ds_read_b64_tr_b16 v[230:231], v8 offset:45568
v_mfma_f32_16x16x32_bf16 v[88:91], v[208:211], v[12:15], v[88:91]
v_mfma_f32_16x16x32_bf16 v[92:95], v[212:215], v[12:15], v[92:95]
v_mfma_f32_16x16x32_bf16 v[96:99], v[216:219], v[12:15], v[96:99]
s_waitcnt vmcnt(3) lgkmcnt(0)
s_barrier
ds_read_b64_tr_b16 v[232:233], v8 offset:49152
ds_read_b64_tr_b16 v[234:235], v8 offset:49664
ds_read_b64_tr_b16 v[236:237], v8 offset:53248
ds_read_b64_tr_b16 v[238:239], v8 offset:53760
ds_read_b64_tr_b16 v[240:241], v8 offset:57344
ds_read_b64_tr_b16 v[242:243], v8 offset:57856
v_mfma_f32_16x16x32_bf16 v[88:91], v[220:223], v[12:15], v[88:91]
v_mfma_f32_16x16x32_bf16 v[92:95], v[224:227], v[12:15], v[92:95]
v_mfma_f32_16x16x32_bf16 v[96:99], v[228:231], v[12:15], v[96:99]
s_waitcnt vmcnt(0) lgkmcnt(0)
s_barrier
ds_read_b64_tr_b16 v[244:245], v9 offset:0
ds_read_b64_tr_b16 v[246:247], v9 offset:512
ds_read_b64_tr_b16 v[248:249], v9 offset:4096
ds_read_b64_tr_b16 v[250:251], v9 offset:4608
ds_read_b64_tr_b16 v[252:253], v9 offset:8192
ds_read_b64_tr_b16 v[254:255], v9 offset:8704
v_mfma_f32_16x16x32_bf16 v[88:91], v[232:235], v[12:15], v[88:91]
v_mfma_f32_16x16x32_bf16 v[92:95], v[236:239], v[12:15], v[92:95]
v_mfma_f32_16x16x32_bf16 v[96:99], v[240:243], v[12:15], v[96:99]
s_waitcnt lgkmcnt(0)
v_mfma_f32_16x16x32_bf16 v[88:91], v[244:247], v[12:15], v[88:91]
v_mfma_f32_16x16x32_bf16 v[92:95], v[248:251], v[12:15], v[92:95]
v_mfma_f32_16x16x32_bf16 v[96:99], v[252:255], v[12:15], v[96:99]
s_mov_b32 s8, s46
s_and_b32 s9, s47, 0xffff
s_mov_b32 s10, 0x10000000
s_mov_b32 s11, 0x20000
v_lshlrev_b32 v113, 4, v0
v_and_b32 v1, 31, v0
v_lshrrev_b32 v2, 5, v0
v_lshlrev_b32 v1, 4, v1
v_lshlrev_b32 v2, 10, v2
v_add_u32 v119, v1, v2
s_mov_b32 s62, 0
v_lshrrev_b32 v1, 3, v0
v_mul_u32_u24 v1, 256, v1
v_and_b32 v2, 7, v0
v_lshlrev_b32 v2, 2, v2
v_add_u32 v1, v1, v2
v_add_u32 v115, 0, v1
s_and_b32 s62, s71, 63
s_lshl_b32 s62, s62, 2
s_add_u32 s62, s62, s48
s_lshr_b32 s60, s62, 1
s_lshl_b32 s60, s60, 11
s_and_b32 s61, s62, 1
s_lshl_b32 s61, s61, 9
s_add_u32 s60, s60, s61
v_bfe_u32 v1, v0, 4, 1
v_lshlrev_b32 v1, 10, v1
v_lshrrev_b32 v2, 5, v0
v_lshlrev_b32 v2, 8, v2
v_add_u32 v1, v1, v2
v_and_b32 v2, 15, v0
v_lshlrev_b32 v2, 4, v2
v_add3_u32 v120, v1, v2, s60
s_lshr_b32 s60, s71, 6
s_mul_i32 s60, s60, 0x2000000
v_add_u32 v120, s60, v120
s_and_b32 s62, s72, 63
s_lshl_b32 s62, s62, 2
s_add_u32 s62, s62, s48
s_lshr_b32 s60, s62, 1
s_lshl_b32 s60, s60, 11
s_and_b32 s61, s62, 1
s_lshl_b32 s61, s61, 9
s_add_u32 s60, s60, s61
v_bfe_u32 v1, v0, 4, 1
v_lshlrev_b32 v1, 10, v1
v_lshrrev_b32 v2, 5, v0
v_lshlrev_b32 v2, 8, v2
v_add_u32 v1, v1, v2
v_and_b32 v2, 15, v0
v_lshlrev_b32 v2, 4, v2
v_add3_u32 v121, v1, v2, s60
s_lshr_b32 s60, s72, 6
s_mul_i32 s60, s60, 0x2000000
v_add_u32 v121, s60, v121
s_and_b32 s62, s73, 63
s_lshl_b32 s62, s62, 2
s_add_u32 s62, s62, s48
s_lshr_b32 s60, s62, 1
s_lshl_b32 s60, s60, 11
s_and_b32 s61, s62, 1
s_lshl_b32 s61, s61, 9
s_add_u32 s60, s60, s61
v_bfe_u32 v1, v0, 4, 1
v_lshlrev_b32 v1, 10, v1
v_lshrrev_b32 v2, 5, v0
v_lshlrev_b32 v2, 8, v2
v_add_u32 v1, v1, v2
v_and_b32 v2, 15, v0
v_lshlrev_b32 v2, 4, v2
v_add3_u32 v122, v1, v2, s60
s_lshr_b32 s60, s73, 6
s_mul_i32 s60, s60, 0x2000000
v_add_u32 v122, s60, v122
v_mov_b32 v56, 0
s_cmp_lg_u32 s100, 0
s_cbranch_scc1 Lws1_31
s_branch Lwsw1_34
Lws_30:
v_mov_b32 v56, 0
buffer_load_dwordx4 v[48:51], v56, s[20:23], 0 offen offset:128 sc1
buffer_load_dwordx4 v[52:55], v56, s[20:23], 0 offen offset:144 sc1
buffer_load_dword v58, v56, s[20:23], 0 offen offset:160 sc1
Lwsw1_34:
s_waitcnt vmcnt(0)
v_readfirstlane_b32 s97, v58
v_add3_u32 v57, v48, v49, v50
v_add3_u32 v57, v57, v51, v52
v_add3_u32 v57, v57, v53, v54
v_add_u32 v57, v57, v55
v_cmp_le_u32 vcc, 0x100, v57
s_nop 0
s_cmp_eq_u64 vcc, -1
s_cbranch_scc0 Lrt_35
v_or3_b32 v57, v48, v49, v50
v_or3_b32 v57, v57, v51, v52
v_or3_b32 v57, v57, v53, v54
v_or_b32 v57, v57, v55
v_cmp_eq_u32 vcc, 256, v57
s_nop 0
s_cmp_eq_u64 vcc, -1
s_cbranch_scc1 Lws2_32
s_branch L_restart
Lws1_31:
buffer_load_dword v48, v56, s[20:23], 0 offen sc1
s_waitcnt vmcnt(0)
v_cmp_le_u32 vcc, 0x100, v48
s_nop 0
s_cmp_eq_u64 vcc, -1
s_cbranch_scc0 Lrt_36
Lws2_32:
s_barrier
s_cmp_lg_u32 s3, 0
s_cbranch_scc1 Lnh_37
s_mov_b32 s62, 0
s_cmp_lg_u32 s100, 0
s_cbranch_scc1 Lnear2_39
s_cmp_lg_u32 s97, 0
s_cbranch_scc1 Lnear3_40
v_mov_b32 v1, 160
Lnear_38:
buffer_load_dword v1, v1, s[20:23], 0 offen sc1
s_waitcnt vmcnt(0)
v_readfirstlane_b32 s97, v1
v_mov_b32 v1, 160
s_cmp_eq_u32 s97, 0
s_cbranch_scc1 Lrt_41
Lnear3_40:
s_and_b32 s62, s97, 2
s_lshl_b32 s62, s62, 12
Lnear2_39:
s_xor_b32 s63, s62, 0x2000
v_add_u32 v117, s62, v117
Lnh_37:
s_mul_i32 s25, s48, 16384
v_add_u32 v114, s25, v113
s_add_u32 s65, s25, 65536
s_add_u32 s28, s49, 0
s_and_b32 s28, s28, 3
s_mul_i32 s28, s28, 4096
s_add_u32 s29, s49, 1
s_and_b32 s29, s29, 3
s_mul_i32 s29, s29, 4096
s_add_u32 s30, s49, 2
s_and_b32 s30, s30, 3
s_mul_i32 s30, s30, 4096
s_add_u32 s31, s49, 3
s_and_b32 s31, s31, 3
s_mul_i32 s31, s31, 4096
s_lshl_b32 s27, s48, 9
s_add_u32 s27, s27, 131072
v_lshrrev_b32 v116, 2, v113
v_add_u32 v116, 131072, v116
s_cmp_eq_u32 s48, 0
s_cselect_b32 s60, 0, 0x40000000
v_or_b32 v115, s60, v115
s_mov_b32 s53, 0
s_mov_b32 s54, 0
s_mov_b32 s52, 0
v_mov_b32 v112, v113
s_mov_b32 s59, 0x40000000
v_mov_b32 v118, 0
s_mov_b32 s44, 0xfbd00000
s_mov_b32 s45, 0xdfbf7efd
s_mov_b32 s46, 0xfdfbf7ef
s_mov_b32 s47, 0x3f7e
s_mov_b32 s98, 64
s_mov_b32 s99, 0
s_cmp_eq_u32 s3, 0
s_cselect_b32 s74, 8, 13
s_cselect_b32 s75, 13, 0x80
s_cselect_b32 s53, 0, 8
s_cselect_b64 s[44:45], s[44:45], 0
s_mov_b32 s70, 0x40000000
s_add_u32 s60, s53, 1
s_cmp_eq_u32 s60, s74
s_cselect_b32 s60, s75, s60
s_bitcmp1_b64 s[44:45], s99
s_cselect_b32 s24, s98, s60
s_cselect_b32 s98, s60, s98
s_add_u32 s99, s99, 1
s_cmp_eq_u32 s99, 64
s_cselect_b64 s[44:45], s[46:47], s[44:45]
s_min_u32 s99, s99, 127
s_branch LP_slow
.p2align 6
LP_top:
s_waitcnt lgkmcnt(4)
v_mfma_f32_16x16x32_bf16 v[8:11], a[0:3], v[32:35], 0
s_mov_b32 s52, s53
ds_read_b128 v[56:59], v112 offset:6144
s_mov_b32 s53, s24
v_mfma_f32_16x16x32_bf16 v[12:15], a[4:7], v[32:35], 0
s_mov_b32 s10, s51
ds_read_b128 v[60:63], v112 offset:7168
s_mul_i32 s55, s53, 0x10000
v_mfma_f32_16x16x32_bf16 v[16:19], a[8:11], v[32:35], 0
s_add_u32 s55, s55, 0x400000
s_sub_u32 s56, s65, s54
s_cmp_eq_u32 s52, 13
s_cbranch_scc1 Lgate_42
Lgatec_43:
v_mfma_f32_16x16x32_bf16 v[28:31], a[8:11], v[36:39], 0
s_add_u32 m0, s56, s28
s_add_u32 s32, s55, s28
buffer_load_dwordx4 v114, s[8:11], s32 offen offset:0 sc1 lds
v_mfma_f32_16x16x32_bf16 v[24:27], a[4:7], v[36:39], 0
s_and_b32 s26, s52, 64
s_lshl_b32 s26, s26, 12
s_xor_b32 s27, s27, 2048
v_mfma_f32_16x16x32_bf16 v[20:23], a[0:3], v[36:39], 0
s_waitcnt lgkmcnt(4)
v_xor_b32 v116, 2048, v116
v_mfma_f32_16x16x32_bf16 v[8:11], a[12:15], v[40:43], v[8:11]
ds_read_b128 v[32:35], v112 offset:8192
v_fmac_f32 v64, v102, v88
v_mfma_f32_16x16x32_bf16 v[12:15], a[16:19], v[40:43], v[12:15]
ds_read_b128 v[36:39], v112 offset:9216
v_fmac_f32 v65, v102, v89
v_mfma_f32_16x16x32_bf16 v[16:19], a[20:23], v[40:43], v[16:19]
v_fmac_f32 v66, v102, v90
v_mfma_f32_16x16x32_bf16 v[28:31], a[20:23], v[44:47], v[28:31]
v_fmac_f32 v67, v102, v91
v_mul_f32 v64, v100, v64
v_mfma_f32_16x16x32_bf16 v[24:27], a[16:19], v[44:47], v[24:27]
buffer_load_dwordx4 v114, s[8:11], s32 offen offset:1024 sc1 lds
v_mul_f32 v65, v100, v65
v_mfma_f32_16x16x32_bf16 v[20:23], a[12:15], v[44:47], v[20:23]
s_waitcnt lgkmcnt(4)
v_mul_f32 v66, v100, v66
v_mfma_f32_16x16x32_bf16 v[8:11], a[24:27], v[48:51], v[8:11]
ds_read_b128 v[40:43], v112 offset:10240
v_mul_f32 v67, v100, v67
v_mfma_f32_16x16x32_bf16 v[12:15], a[28:31], v[48:51], v[12:15]
ds_read_b128 v[44:47], v112 offset:11264
v_fmac_f32 v76, v103, v88
v_mfma_f32_16x16x32_bf16 v[16:19], a[32:35], v[48:51], v[16:19]
v_fmac_f32 v77, v103, v89
v_mfma_f32_16x16x32_bf16 v[28:31], a[32:35], v[52:55], v[28:31]
v_fmac_f32 v78, v103, v90
v_fmac_f32 v79, v103, v91
v_mfma_f32_16x16x32_bf16 v[24:27], a[28:31], v[52:55], v[24:27]
v_mul_f32 v76, v101, v76
v_mfma_f32_16x16x32_bf16 v[20:23], a[24:27], v[52:55], v[20:23]
s_waitcnt lgkmcnt(4)
buffer_load_dwordx4 v114, s[8:11], s32 offen offset:2048 sc1 lds
v_mul_f32 v77, v101, v77
v_mfma_f32_16x16x32_bf16 v[8:11], a[36:39], v[56:59], v[8:11]
ds_read_b128 v[48:51], v112 offset:12288
v_mul_f32 v78, v101, v78
v_mfma_f32_16x16x32_bf16 v[12:15], a[40:43], v[56:59], v[12:15]
ds_read_b128 v[52:55], v112 offset:13312
v_mul_f32 v79, v101, v79
v_mfma_f32_16x16x32_bf16 v[16:19], a[44:47], v[56:59], v[16:19]
v_cvt_pk_bf16_f32 v64, v64, v65
v_mfma_f32_16x16x32_bf16 v[28:31], a[44:47], v[60:63], v[28:31]
v_cvt_pk_bf16_f32 v65, v66, v67
v_cvt_pk_bf16_f32 v66, v76, v77
v_mfma_f32_16x16x32_bf16 v[24:27], a[40:43], v[60:63], v[24:27]
v_cvt_pk_bf16_f32 v67, v78, v79
v_mfma_f32_16x16x32_bf16 v[20:23], a[36:39], v[60:63], v[20:23]
s_waitcnt lgkmcnt(4)
v_fmac_f32 v68, v102, v92
v_mfma_f32_16x16x32_bf16 v[8:11], a[48:51], v[32:35], v[8:11]
ds_read_b128 v[56:59], v112 offset:14336
v_fmac_f32 v69, v102, v93
v_mfma_f32_16x16x32_bf16 v[12:15], a[52:55], v[32:35], v[12:15]
ds_read_b128 v[60:63], v112 offset:15360
v_mfma_f32_16x16x32_bf16 v[16:19], a[56:59], v[32:35], v[16:19]
v_permlane16_swap_b32 v64, v66
v_mfma_f32_16x16x32_bf16 v[28:31], a[56:59], v[36:39], v[28:31]
v_permlane16_swap_b32 v65, v67
v_mfma_f32_16x16x32_bf16 v[24:27], a[52:55], v[36:39], v[24:27]
buffer_store_dwordx4 v[64:67], v120, s[4:7], s70 offen sc1
v_fmac_f32 v70, v102, v94
v_mfma_f32_16x16x32_bf16 v[20:23], a[48:51], v[36:39], v[20:23]
s_waitcnt lgkmcnt(4)
v_fmac_f32 v71, v102, v95
v_mfma_f32_16x16x32_bf16 v[8:11], a[60:63], v[40:43], v[8:11]
ds_read_b128 v[32:35], v112 offset:16384
v_mul_f32 v68, v100, v68
v_mfma_f32_16x16x32_bf16 v[12:15], a[64:67], v[40:43], v[12:15]
ds_read_b128 v[36:39], v112 offset:17408
v_mul_f32 v69, v100, v69
v_mfma_f32_16x16x32_bf16 v[16:19], a[68:71], v[40:43], v[16:19]
v_mul_f32 v70, v100, v70
v_mfma_f32_16x16x32_bf16 v[28:31], a[68:71], v[44:47], v[28:31]
v_mul_f32 v71, v100, v71
v_fmac_f32 v80, v103, v92
v_mfma_f32_16x16x32_bf16 v[24:27], a[64:67], v[44:47], v[24:27]
buffer_load_dwordx4 v114, s[8:11], s32 offen offset:3072 sc1 lds
v_fmac_f32 v81, v103, v93
v_mfma_f32_16x16x32_bf16 v[20:23], a[60:63], v[44:47], v[20:23]
s_waitcnt lgkmcnt(4)
v_fmac_f32 v82, v103, v94
v_mfma_f32_16x16x32_bf16 v[8:11], a[72:75], v[48:51], v[8:11]
ds_read_b128 v[40:43], v112 offset:18432
v_fmac_f32 v83, v103, v95
v_mfma_f32_16x16x32_bf16 v[12:15], a[76:79], v[48:51], v[12:15]
ds_read_b128 v[44:47], v112 offset:19456
v_mul_f32 v80, v101, v80
v_mfma_f32_16x16x32_bf16 v[16:19], a[80:83], v[48:51], v[16:19]
v_mul_f32 v81, v101, v81
s_add_u32 m0, s56, s29
v_mfma_f32_16x16x32_bf16 v[28:31], a[80:83], v[52:55], v[28:31]
s_add_u32 s32, s55, s29
buffer_load_dwordx4 v114, s[8:11], s32 offen offset:0 sc1 lds
v_mul_f32 v82, v101, v82
v_mfma_f32_16x16x32_bf16 v[24:27], a[76:79], v[52:55], v[24:27]
v_mul_f32 v83, v101, v83
v_mfma_f32_16x16x32_bf16 v[20:23], a[72:75], v[52:55], v[20:23]
s_waitcnt lgkmcnt(4)
v_cvt_pk_bf16_f32 v68, v68, v69
v_mfma_f32_16x16x32_bf16 v[8:11], a[84:87], v[56:59], v[8:11]
ds_read_b128 v[48:51], v112 offset:20480
v_cvt_pk_bf16_f32 v69, v70, v71
v_mfma_f32_16x16x32_bf16 v[12:15], a[88:91], v[56:59], v[12:15]
ds_read_b128 v[52:55], v112 offset:21504
v_cvt_pk_bf16_f32 v70, v80, v81
v_mfma_f32_16x16x32_bf16 v[16:19], a[92:95], v[56:59], v[16:19]
buffer_load_dwordx4 v114, s[8:11], s32 offen offset:1024 sc1 lds
v_cvt_pk_bf16_f32 v71, v82, v83
v_mfma_f32_16x16x32_bf16 v[28:31], a[92:95], v[60:63], v[28:31]
v_fmac_f32 v72, v102, v96
v_fmac_f32 v73, v102, v97
v_mfma_f32_16x16x32_bf16 v[24:27], a[88:91], v[60:63], v[24:27]
v_permlane16_swap_b32 v68, v70
v_mfma_f32_16x16x32_bf16 v[20:23], a[84:87], v[60:63], v[20:23]
s_waitcnt lgkmcnt(4)
v_permlane16_swap_b32 v69, v71
v_mfma_f32_16x16x32_bf16 v[8:11], a[96:99], v[32:35], v[8:11]
ds_read_b128 v[56:59], v112 offset:22528
v_fmac_f32 v74, v102, v98
v_mfma_f32_16x16x32_bf16 v[12:15], a[100:103], v[32:35], v[12:15]
ds_read_b128 v[60:63], v112 offset:23552
buffer_store_dwordx4 v[68:71], v121, s[4:7], s70 offen sc1
v_mfma_f32_16x16x32_bf16 v[16:19], a[104:107], v[32:35], v[16:19]
v_fmac_f32 v75, v102, v99
v_mfma_f32_16x16x32_bf16 v[28:31], a[104:107], v[36:39], v[28:31]
v_mul_f32 v72, v100, v72
v_mul_f32 v73, v100, v73
v_mfma_f32_16x16x32_bf16 v[24:27], a[100:103], v[36:39], v[24:27]
v_mul_f32 v74, v100, v74
v_mfma_f32_16x16x32_bf16 v[20:23], a[96:99], v[36:39], v[20:23]
s_waitcnt lgkmcnt(4)
v_mul_f32 v75, v100, v75
v_mfma_f32_16x16x32_bf16 v[8:11], a[108:111], v[40:43], v[8:11]
ds_read_b128 v[32:35], v112 offset:24576
v_fmac_f32 v84, v103, v96
v_mfma_f32_16x16x32_bf16 v[12:15], a[112:115], v[40:43], v[12:15]
ds_read_b128 v[36:39], v112 offset:25600
buffer_load_dwordx4 v114, s[8:11], s32 offen offset:2048 sc1 lds
v_mfma_f32_16x16x32_bf16 v[16:19], a[116:119], v[40:43], v[16:19]
v_fmac_f32 v85, v103, v97
v_mfma_f32_16x16x32_bf16 v[28:31], a[116:119], v[44:47], v[28:31]
v_fmac_f32 v86, v103, v98
v_fmac_f32 v87, v103, v99
v_mfma_f32_16x16x32_bf16 v[24:27], a[112:115], v[44:47], v[24:27]
v_mul_f32 v84, v101, v84
v_mfma_f32_16x16x32_bf16 v[20:23], a[108:111], v[44:47], v[20:23]
s_waitcnt lgkmcnt(4)
v_mul_f32 v85, v101, v85
s_lshl_b32 s62, s52, 11
v_mfma_f32_16x16x32_bf16 v[8:11], a[120:123], v[48:51], v[8:11]
s_add_u32 s62, s62, 0x180000
ds_read_b128 v[40:43], v112 offset:26624
buffer_load_dwordx4 v[104:107], v119, s[4:7], s62 offen offset:0 sc1
v_mfma_f32_16x16x32_bf16 v[12:15], a[124:127], v[48:51], v[12:15]
ds_read_b128 v[44:47], v112 offset:27648
v_mul_f32 v86, v101, v86
v_mfma_f32_16x16x32_bf16 v[16:19], a[128:131], v[48:51], v[16:19]
v_mul_f32 v87, v101, v87
v_mfma_f32_16x16x32_bf16 v[28:31], a[128:131], v[52:55], v[28:31]
v_cvt_pk_bf16_f32 v72, v72, v73
v_cvt_pk_bf16_f32 v73, v74, v75
v_mfma_f32_16x16x32_bf16 v[24:27], a[124:127], v[52:55], v[24:27]
v_cvt_pk_bf16_f32 v74, v84, v85
v_mfma_f32_16x16x32_bf16 v[20:23], a[120:123], v[52:55], v[20:23]
s_waitcnt lgkmcnt(4)
buffer_load_dwordx4 v[108:111], v119, s[4:7], s62 offen offset:512 sc1
v_cvt_pk_bf16_f32 v75, v86, v87
v_mfma_f32_16x16x32_bf16 v[8:11], a[132:135], v[56:59], v[8:11]
ds_read_b128 v[48:51], v112 offset:28672
v_mfma_f32_16x16x32_bf16 v[12:15], a[136:139], v[56:59], v[12:15]
ds_read_b128 v[52:55], v112 offset:29696
v_mfma_f32_16x16x32_bf16 v[16:19], a[140:143], v[56:59], v[16:19]
v_permlane16_swap_b32 v72, v74
v_mfma_f32_16x16x32_bf16 v[28:31], a[140:143], v[60:63], v[28:31]
v_permlane16_swap_b32 v73, v75
v_mfma_f32_16x16x32_bf16 v[24:27], a[136:139], v[60:63], v[24:27]
buffer_load_dwordx4 v114, s[8:11], s32 offen offset:3072 sc1 lds
v_mfma_f32_16x16x32_bf16 v[20:23], a[132:135], v[60:63], v[20:23]
s_waitcnt lgkmcnt(4)
v_mfma_f32_16x16x32_bf16 v[8:11], a[144:147], v[32:35], v[8:11]
ds_read_b128 v[56:59], v112 offset:30720
v_mfma_f32_16x16x32_bf16 v[12:15], a[148:151], v[32:35], v[12:15]
ds_read_b128 v[60:63], v112 offset:31744
v_mfma_f32_16x16x32_bf16 v[16:19], a[152:155], v[32:35], v[16:19]
v_mfma_f32_16x16x32_bf16 v[28:31], a[152:155], v[36:39], v[28:31]
buffer_store_dwordx4 v[72:75], v122, s[4:7], s70 offen sc1
v_mfma_f32_16x16x32_bf16 v[24:27], a[148:151], v[36:39], v[24:27]
v_mfma_f32_16x16x32_bf16 v[20:23], a[144:147], v[36:39], v[20:23]
s_waitcnt lgkmcnt(4)
v_mfma_f32_16x16x32_bf16 v[8:11], a[156:159], v[40:43], v[8:11]
ds_read_b128 v[32:35], v112 offset:32768
v_mfma_f32_16x16x32_bf16 v[12:15], a[160:163], v[40:43], v[12:15]
ds_read_b128 v[36:39], v112 offset:33792
v_mfma_f32_16x16x32_bf16 v[16:19], a[164:167], v[40:43], v[16:19]
v_mfma_f32_16x16x32_bf16 v[28:31], a[164:167], v[44:47], v[28:31]
s_add_u32 m0, s56, s30
s_add_u32 s32, s55, s30
buffer_load_dwordx4 v114, s[8:11], s32 offen offset:0 sc1 lds
v_mfma_f32_16x16x32_bf16 v[24:27], a[160:163], v[44:47], v[24:27]
v_mfma_f32_16x16x32_bf16 v[20:23], a[156:159], v[44:47], v[20:23]
s_waitcnt lgkmcnt(4)
v_mfma_f32_16x16x32_bf16 v[8:11], a[168:171], v[48:51], v[8:11]
ds_read_b128 v[40:43], v112 offset:34816
v_mfma_f32_16x16x32_bf16 v[12:15], a[172:175], v[48:51], v[12:15]
ds_read_b128 v[44:47], v112 offset:35840
v_mfma_f32_16x16x32_bf16 v[16:19], a[176:179], v[48:51], v[16:19]
buffer_load_dwordx4 v114, s[8:11], s32 offen offset:1024 sc1 lds
v_mfma_f32_16x16x32_bf16 v[28:31], a[176:179], v[52:55], v[28:31]
v_mfma_f32_16x16x32_bf16 v[24:27], a[172:175], v[52:55], v[24:27]
v_mfma_f32_16x16x32_bf16 v[20:23], a[168:171], v[52:55], v[20:23]
s_waitcnt lgkmcnt(4)
v_mfma_f32_16x16x32_bf16 v[8:11], a[180:183], v[56:59], v[8:11]
ds_read_b128 v[48:51], v112 offset:36864
v_mfma_f32_16x16x32_bf16 v[12:15], a[184:187], v[56:59], v[12:15]
ds_read_b128 v[52:55], v112 offset:37888
buffer_load_dwordx4 v114, s[8:11], s32 offen offset:2048 sc1 lds
v_mfma_f32_16x16x32_bf16 v[16:19], a[188:191], v[56:59], v[16:19]
v_mfma_f32_16x16x32_bf16 v[28:31], a[188:191], v[60:63], v[28:31]
v_mfma_f32_16x16x32_bf16 v[24:27], a[184:187], v[60:63], v[24:27]
v_mfma_f32_16x16x32_bf16 v[20:23], a[180:183], v[60:63], v[20:23]
s_waitcnt lgkmcnt(4)
v_mfma_f32_16x16x32_bf16 v[8:11], a[192:195], v[32:35], v[8:11]
ds_read_b128 v[56:59], v112 offset:38912
buffer_load_dwordx4 v114, s[8:11], s32 offen offset:3072 sc1 lds
v_mfma_f32_16x16x32_bf16 v[12:15], a[196:199], v[32:35], v[12:15]
ds_read_b128 v[60:63], v112 offset:39936
v_mfma_f32_16x16x32_bf16 v[16:19], a[200:203], v[32:35], v[16:19]
v_mfma_f32_16x16x32_bf16 v[28:31], a[200:203], v[36:39], v[28:31]
v_mfma_f32_16x16x32_bf16 v[24:27], a[196:199], v[36:39], v[24:27]
v_mfma_f32_16x16x32_bf16 v[20:23], a[192:195], v[36:39], v[20:23]
s_waitcnt lgkmcnt(4)
s_add_u32 m0, s56, s31
s_add_u32 s32, s55, s31
v_mfma_f32_16x16x32_bf16 v[8:11], a[204:207], v[40:43], v[8:11]
ds_read_b128 v[32:35], v112 offset:40960
buffer_load_dwordx4 v114, s[8:11], s32 offen offset:0 sc1 lds
v_mfma_f32_16x16x32_bf16 v[12:15], a[208:211], v[40:43], v[12:15]
ds_read_b128 v[36:39], v112 offset:41984
v_mfma_f32_16x16x32_bf16 v[16:19], a[212:215], v[40:43], v[16:19]
v_mfma_f32_16x16x32_bf16 v[28:31], a[212:215], v[44:47], v[28:31]
v_mfma_f32_16x16x32_bf16 v[24:27], a[208:211], v[44:47], v[24:27]
v_mfma_f32_16x16x32_bf16 v[20:23], a[204:207], v[44:47], v[20:23]
s_waitcnt lgkmcnt(4)
buffer_load_dwordx4 v114, s[8:11], s32 offen offset:1024 sc1 lds
v_mfma_f32_16x16x32_bf16 v[8:11], a[216:219], v[48:51], v[8:11]
ds_read_b128 v[40:43], v112 offset:43008
v_mfma_f32_16x16x32_bf16 v[12:15], a[220:223], v[48:51], v[12:15]
ds_read_b128 v[44:47], v112 offset:44032
v_mfma_f32_16x16x32_bf16 v[16:19], a[224:227], v[48:51], v[16:19]
v_mfma_f32_16x16x32_bf16 v[28:31], a[224:227], v[52:55], v[28:31]
v_mfma_f32_16x16x32_bf16 v[24:27], a[220:223], v[52:55], v[24:27]
buffer_load_dwordx4 v114, s[8:11], s32 offen offset:2048 sc1 lds
v_mfma_f32_16x16x32_bf16 v[20:23], a[216:219], v[52:55], v[20:23]
s_waitcnt lgkmcnt(4)
v_mfma_f32_16x16x32_bf16 v[8:11], a[228:231], v[56:59], v[8:11]
ds_read_b128 v[48:51], v112 offset:45056
v_mfma_f32_16x16x32_bf16 v[12:15], a[232:235], v[56:59], v[12:15]
ds_read_b128 v[52:55], v112 offset:46080
v_mfma_f32_16x16x32_bf16 v[16:19], a[236:239], v[56:59], v[16:19]
v_mfma_f32_16x16x32_bf16 v[28:31], a[236:239], v[60:63], v[28:31]
buffer_load_dwordx4 v114, s[8:11], s32 offen offset:3072 sc1 lds
v_mfma_f32_16x16x32_bf16 v[24:27], a[232:235], v[60:63], v[24:27]
v_mfma_f32_16x16x32_bf16 v[20:23], a[228:231], v[60:63], v[20:23]
s_waitcnt lgkmcnt(4)
s_add_u32 s60, s53, 1
s_cmp_eq_u32 s60, s74
v_mfma_f32_16x16x32_bf16 v[8:11], a[240:243], v[32:35], v[8:11]
s_cselect_b32 s60, s75, s60
ds_read_b128 v[56:59], v112 offset:47104
s_bitcmp1_b64 s[44:45], s99
v_mfma_f32_16x16x32_bf16 v[12:15], a[244:247], v[32:35], v[12:15]
s_cselect_b32 s24, s98, s60
ds_read_b128 v[60:63], v112 offset:48128
s_cselect_b32 s98, s60, s98
v_mfma_f32_16x16x32_bf16 v[16:19], a[248:251], v[32:35], v[16:19]
s_add_u32 s99, s99, 1
s_cmp_eq_u32 s99, 64
s_cselect_b64 s[44:45], s[46:47], s[44:45]
v_mfma_f32_16x16x32_bf16 v[28:31], a[248:251], v[36:39], v[28:31]
s_min_u32 s99, s99, 127
s_mov_b32 m0, s27
s_cmp_lt_u32 s24, 64
v_mfma_f32_16x16x32_bf16 v[24:27], a[244:247], v[36:39], v[24:27]
s_cselect_b32 s58, 0, 0x40000
buffer_load_dword v115, s[4:7], s58 offen sc1 lds
s_waitcnt vmcnt(11)
v_mfma_f32_16x16x32_bf16 v[20:23], a[240:243], v[36:39], v[20:23]
s_waitcnt lgkmcnt(4)
v_add_f32 v104, v104, v106
v_mfma_f32_16x16x32_bf16 v[8:11], a[252:255], v[40:43], v[8:11]
ds_read_b128 v[32:35], v112 offset:49152
v_add_f32 v105, v105, v107
v_mfma_f32_16x16x32_bf16 v[12:15], v[128:131], v[40:43], v[12:15]
ds_read_b128 v[36:39], v112 offset:50176
v_add_f32 v108, v108, v110
v_mfma_f32_16x16x32_bf16 v[16:19], v[132:135], v[40:43], v[16:19]
v_add_f32 v109, v109, v111
v_mfma_f32_16x16x32_bf16 v[28:31], v[132:135], v[44:47], v[28:31]
v_add_f32 v104, v104, v108
v_add_f32 v105, v105, v109
v_mfma_f32_16x16x32_bf16 v[24:27], v[128:131], v[44:47], v[24:27]
s_nop 0
v_permlane32_swap_b32 v104, v105
v_mfma_f32_16x16x32_bf16 v[20:23], a[252:255], v[44:47], v[20:23]
s_waitcnt lgkmcnt(4)
v_add_f32 v104, v104, v105
v_mfma_f32_16x16x32_bf16 v[8:11], v[136:139], v[48:51], v[8:11]
ds_read_b128 v[40:43], v112 offset:51200
v_mov_b32 v105, v104
v_mfma_f32_16x16x32_bf16 v[12:15], v[140:143], v[48:51], v[12:15]
ds_read_b128 v[44:47], v112 offset:52224
v_mfma_f32_16x16x32_bf16 v[16:19], v[144:147], v[48:51], v[16:19]
v_permlane32_swap_b32 v104, v105
v_mfma_f32_16x16x32_bf16 v[28:31], v[144:147], v[52:55], v[28:31]
v_mul_f32 v104, 0x3a800000, v104
v_mul_f32 v105, 0x3a800000, v105
v_mfma_f32_16x16x32_bf16 v[24:27], v[140:143], v[52:55], v[24:27]
v_fma_f32 v105, -v104, v104, v105
v_mfma_f32_16x16x32_bf16 v[20:23], v[136:139], v[52:55], v[20:23]
s_waitcnt lgkmcnt(4)
s_waitcnt vmcnt(9)
s_barrier
v_mfma_f32_16x16x32_bf16 v[8:11], v[148:151], v[56:59], v[8:11]
ds_read_b128 v[48:51], v112 offset:53248
buffer_store_dword v118, v117, s[4:7], s59 offen sc1
v_mfma_f32_16x16x32_bf16 v[12:15], v[152:155], v[56:59], v[12:15]
ds_read_b128 v[52:55], v112 offset:54272
v_max_f32 v105, 0, v105
v_mfma_f32_16x16x32_bf16 v[16:19], v[156:159], v[56:59], v[16:19]
v_cvt_pk_bf16_f32 v106, v104, v105
v_mfma_f32_16x16x32_bf16 v[28:31], v[156:159], v[60:63], v[28:31]
v_lshlrev_b32 v104, 16, v106
v_and_b32 v105, 0xffff0000, v106
v_mfma_f32_16x16x32_bf16 v[24:27], v[152:155], v[60:63], v[24:27]
v_add_f32 v105, 0x3727c5ac, v105
v_mfma_f32_16x16x32_bf16 v[20:23], v[148:151], v[60:63], v[20:23]
s_waitcnt lgkmcnt(4)
v_mfma_f32_16x16x32_bf16 v[8:11], v[160:163], v[32:35], v[8:11]
ds_read_b128 v[56:59], v112 offset:55296
v_cvt_pk_bf16_f32 v105, v105, v105
v_mfma_f32_16x16x32_bf16 v[12:15], v[164:167], v[32:35], v[12:15]
ds_read_b128 v[60:63], v112 offset:56320
v_lshlrev_b32 v105, 16, v105
v_mfma_f32_16x16x32_bf16 v[16:19], v[168:171], v[32:35], v[16:19]
v_sqrt_f32 v105, v105
v_mfma_f32_16x16x32_bf16 v[28:31], v[168:171], v[36:39], v[28:31]
v_mfma_f32_16x16x32_bf16 v[24:27], v[164:167], v[36:39], v[24:27]
v_cvt_pk_bf16_f32 v105, v105, v105
v_mfma_f32_16x16x32_bf16 v[20:23], v[160:163], v[36:39], v[20:23]
s_waitcnt lgkmcnt(4)
v_lshlrev_b32 v105, 16, v105
v_mfma_f32_16x16x32_bf16 v[8:11], v[172:175], v[40:43], v[8:11]
ds_read_b128 v[32:35], v112 offset:57344
v_mfma_f32_16x16x32_bf16 v[12:15], v[176:179], v[40:43], v[12:15]
ds_read_b128 v[36:39], v112 offset:58368
v_mfma_f32_16x16x32_bf16 v[16:19], v[180:183], v[40:43], v[16:19]
v_rcp_f32 v100, v105
v_mfma_f32_16x16x32_bf16 v[28:31], v[180:183], v[44:47], v[28:31]
v_sub_f32 v102, 0, v104
v_mov_b32 v101, v100
v_mfma_f32_16x16x32_bf16 v[24:27], v[176:179], v[44:47], v[24:27]
v_mov_b32 v103, v102
v_mfma_f32_16x16x32_bf16 v[20:23], v[172:175], v[44:47], v[20:23]
s_waitcnt lgkmcnt(4)
v_mfma_f32_16x16x32_bf16 v[8:11], v[184:187], v[48:51], v[8:11]
ds_read_b128 v[40:43], v112 offset:59392
v_mfma_f32_16x16x32_bf16 v[12:15], v[188:191], v[48:51], v[12:15]
ds_read_b128 v[44:47], v112 offset:60416
v_mfma_f32_16x16x32_bf16 v[16:19], v[192:195], v[48:51], v[16:19]
v_permlane16_swap_b32 v100, v101
v_mfma_f32_16x16x32_bf16 v[28:31], v[192:195], v[52:55], v[28:31]
v_permlane16_swap_b32 v102, v103
v_mfma_f32_16x16x32_bf16 v[24:27], v[188:191], v[52:55], v[24:27]
v_mfma_f32_16x16x32_bf16 v[20:23], v[184:187], v[52:55], v[20:23]
s_waitcnt lgkmcnt(4)
s_lshl_b32 s70, s52, 18
s_add_u32 s70, s70, 0x1400000
v_mfma_f32_16x16x32_bf16 v[8:11], v[196:199], v[56:59], v[8:11]
ds_read_b128 v[48:51], v112 offset:61440
v_mfma_f32_16x16x32_bf16 v[12:15], v[200:203], v[56:59], v[12:15]
ds_read_b128 v[52:55], v112 offset:62464
v_mfma_f32_16x16x32_bf16 v[16:19], v[204:207], v[56:59], v[16:19]
s_add_u32 s60, s52, 1
s_mov_b32 s59, s26
v_mov_b32 v118, s60
v_mfma_f32_16x16x32_bf16 v[28:31], v[204:207], v[60:63], v[28:31]
v_mfma_f32_16x16x32_bf16 v[24:27], v[200:203], v[60:63], v[24:27]
v_mfma_f32_16x16x32_bf16 v[20:23], v[196:199], v[60:63], v[20:23]
s_waitcnt lgkmcnt(4)
v_mfma_f32_16x16x32_bf16 v[8:11], v[208:211], v[32:35], v[8:11]
ds_read_b128 v[56:59], v112 offset:63488
v_mfma_f32_16x16x32_bf16 v[12:15], v[212:215], v[32:35], v[12:15]
ds_read_b128 v[60:63], v112 offset:64512
v_mfma_f32_16x16x32_bf16 v[16:19], v[216:219], v[32:35], v[16:19]
v_mfma_f32_16x16x32_bf16 v[28:31], v[216:219], v[36:39], v[28:31]
v_mfma_f32_16x16x32_bf16 v[24:27], v[212:215], v[36:39], v[24:27]
v_mfma_f32_16x16x32_bf16 v[20:23], v[208:211], v[36:39], v[20:23]
s_waitcnt lgkmcnt(4)
v_mfma_f32_16x16x32_bf16 v[8:11], v[220:223], v[40:43], v[8:11]
s_sub_u32 s54, 65536, s54
v_add_u32 v112, s54, v113
v_mfma_f32_16x16x32_bf16 v[12:15], v[224:227], v[40:43], v[12:15]
v_mfma_f32_16x16x32_bf16 v[16:19], v[228:231], v[40:43], v[16:19]
v_mfma_f32_16x16x32_bf16 v[28:31], v[228:231], v[44:47], v[28:31]
v_mfma_f32_16x16x32_bf16 v[24:27], v[224:227], v[44:47], v[24:27]
v_mfma_f32_16x16x32_bf16 v[20:23], v[220:223], v[44:47], v[20:23]
s_waitcnt lgkmcnt(0)
s_waitcnt vmcnt(1)
s_barrier
v_mfma_f32_16x16x32_bf16 v[8:11], v[232:235], v[48:51], v[8:11]
s_nop 0
ds_read_b32 v4, v116
ds_read_b128 v[32:35], v112 offset:0
v_mfma_f32_16x16x32_bf16 v[12:15], v[236:239], v[48:51], v[12:15]
ds_read_b128 v[36:39], v112 offset:1024
ds_read_b128 v[40:43], v112 offset:2048
v_mfma_f32_16x16x32_bf16 v[16:19], v[240:243], v[48:51], v[16:19]
ds_read_b128 v[44:47], v112 offset:3072
v_mfma_f32_16x16x32_bf16 v[28:31], v[240:243], v[52:55], v[28:31]
v_mfma_f32_16x16x32_bf16 v[24:27], v[236:239], v[52:55], v[24:27]
v_mfma_f32_16x16x32_bf16 v[20:23], v[232:235], v[52:55], v[20:23]
v_mfma_f32_16x16x32_bf16 v[64:67], v[244:247], v[56:59], v[8:11]
ds_read_b128 v[48:51], v112 offset:4096
v_mfma_f32_16x16x32_bf16 v[68:71], v[248:251], v[56:59], v[12:15]
s_waitcnt lgkmcnt(5)
ds_read_b128 v[52:55], v112 offset:5120
v_cmp_lt_u32 vcc, s24, v4
v_mfma_f32_16x16x32_bf16 v[72:75], v[252:255], v[56:59], v[16:19]
s_cmp_eq_u64 vcc, -1
s_cselect_b32 s51, 0x10000000, 0
s_xor_b32 s61, s53, s24
v_mfma_f32_16x16x32_bf16 v[84:87], v[252:255], v[60:63], v[28:31]
s_and_b32 s61, s61, 0xc0
s_cmp_lg_u32 s61, 64
s_cselect_b32 s57, -1, s51
v_mfma_f32_16x16x32_bf16 v[80:83], v[248:251], v[60:63], v[24:27]
s_and_b32 s57, s57, s10
v_mfma_f32_16x16x32_bf16 v[76:79], v[244:247], v[60:63], v[20:23]
s_cbranch_scc1 LP_top
v_fmac_f32 v64, v102, v88
v_fmac_f32 v65, v102, v89
v_fmac_f32 v66, v102, v90
v_fmac_f32 v67, v102, v91
v_mul_f32 v64, v100, v64
v_mul_f32 v65, v100, v65
v_mul_f32 v66, v100, v66
v_mul_f32 v67, v100, v67
v_fmac_f32 v76, v103, v88
v_fmac_f32 v77, v103, v89
v_fmac_f32 v78, v103, v90
v_fmac_f32 v79, v103, v91
v_mul_f32 v76, v101, v76
v_mul_f32 v77, v101, v77
v_mul_f32 v78, v101, v78
v_mul_f32 v79, v101, v79
v_cvt_pk_bf16_f32 v64, v64, v65
v_cvt_pk_bf16_f32 v65, v66, v67
v_cvt_pk_bf16_f32 v66, v76, v77
v_cvt_pk_bf16_f32 v67, v78, v79
v_fmac_f32 v68, v102, v92
v_fmac_f32 v69, v102, v93
v_permlane16_swap_b32 v64, v66
v_permlane16_swap_b32 v65, v67
buffer_store_dwordx4 v[64:67], v120, s[4:7], s70 offen sc1
v_fmac_f32 v70, v102, v94
v_fmac_f32 v71, v102, v95
v_mul_f32 v68, v100, v68
v_mul_f32 v69, v100, v69
v_mul_f32 v70, v100, v70
v_mul_f32 v71, v100, v71
v_fmac_f32 v80, v103, v92
v_fmac_f32 v81, v103, v93
v_fmac_f32 v82, v103, v94
v_fmac_f32 v83, v103, v95
v_mul_f32 v80, v101, v80
v_mul_f32 v81, v101, v81
v_mul_f32 v82, v101, v82
v_mul_f32 v83, v101, v83
v_cvt_pk_bf16_f32 v68, v68, v69
v_cvt_pk_bf16_f32 v69, v70, v71
v_cvt_pk_bf16_f32 v70, v80, v81
v_cvt_pk_bf16_f32 v71, v82, v83
v_fmac_f32 v72, v102, v96
v_fmac_f32 v73, v102, v97
v_permlane16_swap_b32 v68, v70
v_permlane16_swap_b32 v69, v71
buffer_store_dwordx4 v[68:71], v121, s[4:7], s70 offen sc1
v_fmac_f32 v74, v102, v98
v_fmac_f32 v75, v102, v99
v_mul_f32 v72, v100, v72
v_mul_f32 v73, v100, v73
v_mul_f32 v74, v100, v74
v_mul_f32 v75, v100, v75
v_fmac_f32 v84, v103, v96
v_fmac_f32 v85, v103, v97
v_fmac_f32 v86, v103, v98
v_fmac_f32 v87, v103, v99
v_mul_f32 v84, v101, v84
v_mul_f32 v85, v101, v85
v_mul_f32 v86, v101, v86
v_mul_f32 v87, v101, v87
v_cvt_pk_bf16_f32 v72, v72, v73
v_cvt_pk_bf16_f32 v73, v74, v75
v_cvt_pk_bf16_f32 v74, v84, v85
v_cvt_pk_bf16_f32 v75, v86, v87
s_nop 0
v_permlane16_swap_b32 v72, v74
v_permlane16_swap_b32 v73, v75
buffer_store_dwordx4 v[72:75], v122, s[4:7], s70 offen sc1
s_mov_b32 s70, 0x40000000
s_cmp_lg_u32 s10, 0
s_cbranch_scc1 Lsc_47
s_xor_b32 s27, s27, 2048
v_xor_b32 v116, 2048, v116
s_min_u32 s61, s24, 127
s_xor_b32 s61, s61, s53
s_cmp_ge_u32 s61, 64
s_cbranch_scc1 Lnomed_54
v_cmp_lt_u32 vcc, s53, v4
s_nop 0
s_cmp_eq_u64 vcc, -1
s_cbranch_scc1 Lmed_53
Lnomed_54:
s_mov_b32 m0, s27
s_cmp_lt_u32 s53, 64
s_cselect_b32 s58, 0, 0x40000
buffer_load_dword v115, s[4:7], s58 offen sc1 lds
s_mul_i32 s55, s53, 0x10000
s_add_u32 s55, s55, 0x400000
s_add_u32 s56, s25, s54
s_waitcnt vmcnt(0) lgkmcnt(0)
s_barrier
ds_read_b32 v4, v116
buffer_store_dword v118, v117, s[4:7], s59 offen sc1
s_cmp_ge_u32 s53, 128
s_cbranch_scc1 LP_exit
s_xor_b32 s27, s27, 2048
v_xor_b32 v116, 2048, v116
s_waitcnt lgkmcnt(0)
v_cmp_lt_u32 vcc, s53, v4
s_nop 0
s_cmp_eq_u64 vcc, -1
s_cbranch_scc1 Lgo_46
LP_slow:
s_and_b32 s58, s53, 64
s_lshl_b32 s58, s58, 12
s_mul_i32 s55, s53, 0x10000
s_add_u32 s55, s55, 0x400000
s_add_u32 s56, s25, s54
s_cmp_lg_u32 s48, 0
s_cbranch_scc1 Lspd_56
Lsp_55:
buffer_load_dword v4, v115, s[4:7], s58 offen sc1
s_waitcnt vmcnt(0)
v_cmp_lt_u32 vcc, s53, v4
s_nop 0
s_cmp_eq_u64 vcc, -1
s_cbranch_scc0 Lrt_57
Lspd_56:
s_barrier
Lgo_46:
s_mov_b32 m0, s27
s_cmp_lt_u32 s24, 64
s_cselect_b32 s58, 0, 0x40000
buffer_load_dword v115, s[4:7], s58 offen sc1 lds
s_lshl_b32 s61, s48, 10
s_add_u32 s55, s55, s61
s_add_u32 s56, s54, s61
s_add_u32 m0, s56, 0
s_add_u32 s32, s55, 0
buffer_load_dwordx4 v113, s[4:7], s32 offen sc1 lds
s_add_u32 m0, s56, 4096
s_add_u32 s32, s55, 4096
buffer_load_dwordx4 v113, s[4:7], s32 offen sc1 lds
s_add_u32 m0, s56, 8192
s_add_u32 s32, s55, 8192
buffer_load_dwordx4 v113, s[4:7], s32 offen sc1 lds
s_add_u32 m0, s56, 12288
s_add_u32 s32, s55, 12288
buffer_load_dwordx4 v113, s[4:7], s32 offen sc1 lds
s_add_u32 m0, s56, 16384
s_add_u32 s32, s55, 16384
buffer_load_dwordx4 v113, s[4:7], s32 offen sc1 lds
s_add_u32 m0, s56, 20480
s_add_u32 s32, s55, 20480
buffer_load_dwordx4 v113, s[4:7], s32 offen sc1 lds
s_add_u32 m0, s56, 24576
s_add_u32 s32, s55, 24576
buffer_load_dwordx4 v113, s[4:7], s32 offen sc1 lds
s_add_u32 m0, s56, 28672
s_add_u32 s32, s55, 28672
buffer_load_dwordx4 v113, s[4:7], s32 offen sc1 lds
s_add_u32 m0, s56, 32768
s_add_u32 s32, s55, 32768
buffer_load_dwordx4 v113, s[4:7], s32 offen sc1 lds
s_add_u32 m0, s56, 36864
s_add_u32 s32, s55, 36864
buffer_load_dwordx4 v113, s[4:7], s32 offen sc1 lds
s_add_u32 m0, s56, 40960
s_add_u32 s32, s55, 40960
buffer_load_dwordx4 v113, s[4:7], s32 offen sc1 lds
s_add_u32 m0, s56, 45056
s_add_u32 s32, s55, 45056
buffer_load_dwordx4 v113, s[4:7], s32 offen sc1 lds
s_add_u32 m0, s56, 49152
s_add_u32 s32, s55, 49152
buffer_load_dwordx4 v113, s[4:7], s32 offen sc1 lds
s_add_u32 m0, s56, 53248
s_add_u32 s32, s55, 53248
buffer_load_dwordx4 v113, s[4:7], s32 offen sc1 lds
s_add_u32 m0, s56, 57344
s_add_u32 s32, s55, 57344
buffer_load_dwordx4 v113, s[4:7], s32 offen sc1 lds
s_add_u32 m0, s56, 61440
s_add_u32 s32, s55, 61440
buffer_load_dwordx4 v113, s[4:7], s32 offen sc1 lds
s_waitcnt vmcnt(3)
Lrd_51:
s_barrier
Lrd2_52:
ds_read_b32 v4, v116
ds_read_b128 v[32:35], v112 offset:0
ds_read_b128 v[36:39], v112 offset:1024
ds_read_b128 v[40:43], v112 offset:2048
ds_read_b128 v[44:47], v112 offset:3072
ds_read_b128 v[48:51], v112 offset:4096
ds_read_b128 v[52:55], v112 offset:5120
s_waitcnt lgkmcnt(6)
v_cmp_lt_u32 vcc, s24, v4
s_nop 0
s_cmp_eq_u64 vcc, -1
s_cselect_b32 s51, 0x10000000, 0
s_branch LP_top
LP_exit:
s_cmp_eq_u32 s3, 0
s_cbranch_scc1 Llv_58
s_waitcnt vmcnt(0) lgkmcnt(0)
s_barrier
s_load_dwordx8 s[24:31], s[0:1], 0
s_load_dwordx4 s[32:35], s[0:1], 32
s_load_dwordx8 s[36:43], s[0:1], 64
s_load_dwordx4 s[44:47], s[0:1], 96
v_mbcnt_lo_u32_b32 v0, -1, 0
v_mbcnt_hi_u32_b32 v0, -1, v0
s_mov_b32 s49, s50
s_waitcnt lgkmcnt(0)
s_mov_b32 s8, s46
s_and_b32 s9, s47, 0xffff
s_mov_b32 s10, 0x10000000
s_mov_b32 s11, 0x20000
s_cmp_eq_u32 s3, 1
s_cbranch_scc1 L_GU2
s_branch L_DNF2
Llv_58:
s_waitcnt vmcnt(0)
s_endpgm
Lrt_35:
s_add_u32 s96, s96, 1
s_cmp_lt_u32 s96, 1048576
s_cbranch_scc1 Lws_30
s_mov_b32 s97, 1
s_branch L_fail
Lrt_36:
s_add_u32 s96, s96, 1
s_cmp_lt_u32 s96, 1048576
s_cbranch_scc1 Lws1_31
s_mov_b32 s97, 1
s_branch L_fail
Lrt_41:
s_add_u32 s96, s96, 1
s_cmp_lt_u32 s96, 1048576
s_cbranch_scc1 Lnear_38
s_mov_b32 s97, 24
s_branch L_fail
Lrt_45:
s_add_u32 s96, s96, 1
s_cmp_lt_u32 s96, 1048576
s_cbranch_scc1 Lgatel_44
s_mov_b32 s97, 25
s_branch L_fail
Lgate_42:
s_cmp_lg_u32 s48, 1
s_cbranch_scc1 Lgatec_43
s_mul_i32 s61, s49, 256
s_add_u32 s61, s61, 96256
s_and_b32 s63, s61, 0xffffe000
s_add_u32 s61, s61, s63
v_mov_b32 v6, 0
Lgatel_44:
buffer_load_dword v7, v6, s[4:7], s61 offen sc1
s_waitcnt vmcnt(0)
v_cmp_le_u32 vcc, 13, v7
s_nop 0
s_cmp_eq_u64 vcc, -1
s_cbranch_scc1 Lgatec_43
s_branch Lrt_45
Lrt_50:
s_add_u32 s96, s96, 1
s_cmp_lt_u32 s96, 1048576
s_cbranch_scc1 Lsp_48
s_mov_b32 s97, 2
s_branch L_fail
Lsc_47:
s_xor_b32 s27, s27, 2048
v_xor_b32 v116, 2048, v116
s_mov_b32 m0, s27
s_cmp_lt_u32 s24, 64
s_cselect_b32 s58, 0, 0x40000
buffer_load_dword v115, s[4:7], s58 offen sc1 lds
s_waitcnt vmcnt(0) lgkmcnt(0)
s_barrier
ds_read_b32 v4, v116
buffer_store_dword v118, v117, s[4:7], s59 offen sc1
s_mov_b32 s51, 0x10000000
s_waitcnt lgkmcnt(0)
v_cmp_lt_u32 vcc, s24, v4
s_nop 0
s_cmp_eq_u64 vcc, -1
s_cbranch_scc1 LP_top
s_cmp_lg_u32 s48, 0
s_cbranch_scc1 Lspd_49
Lsp_48:
buffer_load_dword v4, v115, s[4:7], s58 offen sc1
s_waitcnt vmcnt(0)
v_cmp_lt_u32 vcc, s24, v4
s_nop 0
s_cmp_eq_u64 vcc, -1
s_cbranch_scc0 Lrt_50
Lspd_49:
s_barrier
s_branch LP_top
Lmed_53:
s_mul_i32 s55, s53, 0x10000
s_add_u32 s55, s55, 0x400000
s_add_u32 s56, s25, s54
s_add_u32 m0, s56, s28
s_add_u32 s32, s55, s28
buffer_load_dwordx4 v114, s[4:7], s32 offen offset:0 sc1 lds
buffer_load_dwordx4 v114, s[4:7], s32 offen offset:1024 sc1 lds
buffer_load_dwordx4 v114, s[4:7], s32 offen offset:2048 sc1 lds
buffer_load_dwordx4 v114, s[4:7], s32 offen offset:3072 sc1 lds
s_add_u32 m0, s56, s29
s_add_u32 s32, s55, s29
buffer_load_dwordx4 v114, s[4:7], s32 offen offset:0 sc1 lds
buffer_load_dwordx4 v114, s[4:7], s32 offen offset:1024 sc1 lds
buffer_load_dwordx4 v114, s[4:7], s32 offen offset:2048 sc1 lds
buffer_load_dwordx4 v114, s[4:7], s32 offen offset:3072 sc1 lds
s_add_u32 m0, s56, s30
s_add_u32 s32, s55, s30
buffer_load_dwordx4 v114, s[4:7], s32 offen offset:0 sc1 lds
buffer_load_dwordx4 v114, s[4:7], s32 offen offset:1024 sc1 lds
buffer_load_dwordx4 v114, s[4:7], s32 offen offset:2048 sc1 lds
buffer_load_dwordx4 v114, s[4:7], s32 offen offset:3072 sc1 lds
s_add_u32 m0, s56, s31
s_add_u32 s32, s55, s31
buffer_load_dwordx4 v114, s[4:7], s32 offen offset:0 sc1 lds
buffer_load_dwordx4 v114, s[4:7], s32 offen offset:1024 sc1 lds
buffer_load_dwordx4 v114, s[4:7], s32 offen offset:2048 sc1 lds
buffer_load_dwordx4 v114, s[4:7], s32 offen offset:3072 sc1 lds
s_mov_b32 m0, s27
s_cmp_lt_u32 s24, 64
s_cselect_b32 s58, 0, 0x40000
buffer_load_dword v115, s[4:7], s58 offen sc1 lds
s_waitcnt vmcnt(17) lgkmcnt(0)
s_barrier
buffer_store_dword v118, v117, s[4:7], s59 offen sc1
s_waitcnt vmcnt(1)
s_branch Lrd_51
Lrt_57:
s_add_u32 s96, s96, 1
s_cmp_lt_u32 s96, 1048576
s_cbranch_scc1 Lsp_55
s_mov_b32 s97, 2
s_branch L_fail
L_GU:
s_mul_i32 s60, s49, 256
s_add_u32 s60, s60, 69632
s_and_b32 s61, s60, 0xffffe000
s_add_u32 s60, s60, s61
v_mov_b32 v109, s60
v_mov_b32 v1, 0x40000000
v_cmp_gt_u32 vcc, 1, v0
s_nop 1
v_cndmask_b32 v109, v1, v109, vcc
s_cmp_eq_u32 s48, 1
s_cselect_b32 s60, 0, 0x40000000
v_or_b32 v109, s60, v109
v_mov_b32 v1, 0
s_mov_b32 s60, 0x0
buffer_store_dword v1, v109, s[4:7], s60 offen sc1
s_mov_b32 s60, 0x2000
buffer_store_dword v1, v109, s[4:7], s60 offen sc1
s_mov_b32 s60, 0x40000
buffer_store_dword v1, v109, s[4:7], s60 offen sc1
s_mov_b32 s60, 0x42000
buffer_store_dword v1, v109, s[4:7], s60 offen sc1
s_mov_b32 s50, s49
s_add_i32 s61, s50, 40
s_cmp_ge_u32 s50, 0
s_cselect_b32 s49, s61, s49
s_add_i32 s61, s50, -6
s_cmp_ge_u32 s50, 14
s_cselect_b32 s49, s61, s49
s_add_i32 s61, s50, 14
s_cmp_ge_u32 s50, 40
s_cselect_b32 s49, s61, s49
s_add_i32 s61, s50, -16
s_cmp_ge_u32 s50, 50
s_cselect_b32 s49, s61, s49
s_mul_i32 s60, s49, 256
s_add_u32 s60, s60, 96256
s_and_b32 s61, s60, 0xffffe000
s_add_u32 s60, s60, s61
v_mov_b32 v117, s60
v_mov_b32 v1, 0x40000000
v_cmp_gt_u32 vcc, 1, v0
s_nop 1
v_cndmask_b32 v117, v1, v117, vcc
s_cmp_eq_u32 s48, 1
s_cselect_b32 s60, 0, 0x40000000
v_or_b32 v117, s60, v117
v_mov_b32 v1, 0
s_mov_b32 s60, 0x0
buffer_store_dword v1, v117, s[4:7], s60 offen sc1
s_mov_b32 s60, 0x2000
buffer_store_dword v1, v117, s[4:7], s60 offen sc1
s_waitcnt vmcnt(0)
s_barrier
s_cmp_lg_u32 s48, 0
s_cbranch_scc1 Larr_59
s_mov_b32 s60, 0
v_mov_b32 v2, s60
v_mov_b32 v1, 0x40000000
v_cmp_gt_u32 vcc, 1, v0
s_nop 1
v_cndmask_b32 v2, v1, v2, vcc
s_sub_u32 s61, s101, s2
s_and_b32 s61, s61, 7
s_lshl_b32 s61, s61, 2
s_add_u32 s61, s61, 128
s_cmp_eq_u32 s100, 0
s_cselect_b32 s61, s61, 0
v_mov_b32 v3, 1
buffer_atomic_add v3, v2, s[20:23], s61 offen sc1
Larr_59:
s_mov_b32 s3, 1
s_branch L_P2
L_GU2:
s_mul_i32 s60, s49, 256
s_add_u32 s60, s60, 69632
s_and_b32 s61, s60, 0xffffe000
s_add_u32 s60, s60, s61
v_mov_b32 v109, s60
v_mov_b32 v1, 0x40000000
v_cmp_gt_u32 vcc, 1, v0
s_nop 1
v_cndmask_b32 v109, v1, v109, vcc
s_cmp_eq_u32 s48, 1
s_cselect_b32 s60, 0, 0x40000000
v_or_b32 v109, s60, v109
s_mov_b32 s12, s36
s_and_b32 s13, s37, 0xffff
s_mov_b32 s14, 0x700000
s_mov_b32 s15, 0x20000
s_mov_b32 s16, s38
s_and_b32 s17, s39, 0xffff
s_mov_b32 s18, 0x700000
s_mov_b32 s19, 0x20000
s_lshl_b32 s66, s49, 2
s_add_u32 s66, s66, s48
s_lshl_b32 s69, s49, 7
s_lshl_b32 s61, s48, 5
v_lshrrev_b32 v1, 4, v0
v_bfe_u32 v2, v0, 2, 2
v_and_b32 v3, 3, v0
v_mul_u32_u24 v1, 8, v1
v_add_u32 v1, v1, v2
v_mul_u32_u24 v1, 128, v1
v_mul_u32_u24 v3, 8, v3
v_add3_u32 v8, v1, v3, s61
v_lshrrev_b32 v1, 3, v0
s_lshl_b32 s60, s48, 3
v_add_u32 v1, s60, v1
v_mul_u32_u24 v1, 7168, v1
v_and_b32 v2, 7, v0
v_lshlrev_b32 v2, 4, v2
v_add_u32 v11, v1, v2
v_add_u32 v9, 65536, v8
v_add_u32 v10, 131072, v8
s_lshl_b32 s62, s48, 10
s_add_u32 m0, s62, 0
s_add_u32 s63, s69, 0x0
buffer_load_dwordx4 v11, s[12:15], s63 offen lds
s_add_u32 m0, s62, 4096
s_add_u32 s63, s69, 0x0
buffer_load_dwordx4 v11, s[16:19], s63 offen lds
s_add_u32 m0, s62, 8192
s_add_u32 s63, s69, 0x38000
buffer_load_dwordx4 v11, s[12:15], s63 offen lds
s_add_u32 m0, s62, 12288
s_add_u32 s63, s69, 0x38000
buffer_load_dwordx4 v11, s[16:19], s63 offen lds
s_add_u32 m0, s62, 16384
s_add_u32 s63, s69, 0x70000
buffer_load_dwordx4 v11, s[12:15], s63 offen lds
s_add_u32 m0, s62, 20480
s_add_u32 s63, s69, 0x70000
buffer_load_dwordx4 v11, s[16:19], s63 offen lds
s_add_u32 m0, s62, 24576
s_add_u32 s63, s69, 0xa8000
buffer_load_dwordx4 v11, s[12:15], s63 offen lds
s_add_u32 m0, s62, 28672
s_add_u32 s63, s69, 0xa8000
buffer_load_dwordx4 v11, s[16:19], s63 offen lds
s_add_u32 m0, s62, 32768
s_add_u32 s63, s69, 0xe0000
buffer_load_dwordx4 v11, s[12:15], s63 offen lds
s_add_u32 m0, s62, 36864
s_add_u32 s63, s69, 0xe0000
buffer_load_dwordx4 v11, s[16:19], s63 offen lds
s_add_u32 m0, s62, 40960
s_add_u32 s63, s69, 0x118000
buffer_load_dwordx4 v11, s[12:15], s63 offen lds
s_add_u32 m0, s62, 45056
s_add_u32 s63, s69, 0x118000
buffer_load_dwordx4 v11, s[16:19], s63 offen lds
s_add_u32 m0, s62, 49152
s_add_u32 s63, s69, 0x150000
buffer_load_dwordx4 v11, s[12:15], s63 offen lds
s_add_u32 m0, s62, 53248
s_add_u32 s63, s69, 0x150000
buffer_load_dwordx4 v11, s[16:19], s63 offen lds
s_add_u32 m0, s62, 57344
s_add_u32 s63, s69, 0x188000
buffer_load_dwordx4 v11, s[12:15], s63 offen lds
s_add_u32 m0, s62, 61440
s_add_u32 s63, s69, 0x188000
buffer_load_dwordx4 v11, s[16:19], s63 offen lds
s_add_u32 m0, s62, 65536
s_add_u32 s63, s69, 0x1c0000
buffer_load_dwordx4 v11, s[12:15], s63 offen lds
s_add_u32 m0, s62, 69632
s_add_u32 s63, s69, 0x1c0000
buffer_load_dwordx4 v11, s[16:19], s63 offen lds
s_add_u32 m0, s62, 73728
s_add_u32 s63, s69, 0x1f8000
buffer_load_dwordx4 v11, s[12:15], s63 offen lds
s_add_u32 m0, s62, 77824
s_add_u32 s63, s69, 0x1f8000
buffer_load_dwordx4 v11, s[16:19], s63 offen lds
s_add_u32 m0, s62, 81920
s_add_u32 s63, s69, 0x230000
buffer_load_dwordx4 v11, s[12:15], s63 offen lds
s_add_u32 m0, s62, 86016
s_add_u32 s63, s69, 0x230000
buffer_load_dwordx4 v11, s[16:19], s63 offen lds
s_add_u32 m0, s62, 90112
s_add_u32 s63, s69, 0x268000
buffer_load_dwordx4 v11, s[12:15], s63 offen lds
s_add_u32 m0, s62, 94208
s_add_u32 s63, s69, 0x268000
buffer_load_dwordx4 v11, s[16:19], s63 offen lds
s_add_u32 m0, s62, 98304
s_add_u32 s63, s69, 0x2a0000
buffer_load_dwordx4 v11, s[12:15], s63 offen lds
s_add_u32 m0, s62, 102400
s_add_u32 s63, s69, 0x2a0000
buffer_load_dwordx4 v11, s[16:19], s63 offen lds
s_add_u32 m0, s62, 106496
s_add_u32 s63, s69, 0x2d8000
buffer_load_dwordx4 v11, s[12:15], s63 offen lds
s_add_u32 m0, s62, 110592
s_add_u32 s63, s69, 0x2d8000
buffer_load_dwordx4 v11, s[16:19], s63 offen lds
s_add_u32 m0, s62, 114688
s_add_u32 s63, s69, 0x310000
buffer_load_dwordx4 v11, s[12:15], s63 offen lds
s_add_u32 m0, s62, 118784
s_add_u32 s63, s69, 0x310000
buffer_load_dwordx4 v11, s[16:19], s63 offen lds
s_add_u32 m0, s62, 122880
s_add_u32 s63, s69, 0x348000
buffer_load_dwordx4 v11, s[12:15], s63 offen lds
s_add_u32 m0, s62, 126976
s_add_u32 s63, s69, 0x348000
buffer_load_dwordx4 v11, s[16:19], s63 offen lds
s_add_u32 m0, s62, 131072
s_add_u32 s63, s69, 0x380000
buffer_load_dwordx4 v11, s[12:15], s63 offen lds
s_add_u32 m0, s62, 135168
s_add_u32 s63, s69, 0x380000
buffer_load_dwordx4 v11, s[16:19], s63 offen lds
s_add_u32 m0, s62, 139264
s_add_u32 s63, s69, 0x3b8000
buffer_load_dwordx4 v11, s[12:15], s63 offen lds
s_add_u32 m0, s62, 143360
s_add_u32 s63, s69, 0x3b8000
buffer_load_dwordx4 v11, s[16:19], s63 offen lds
s_add_u32 m0, s62, 147456
s_add_u32 s63, s69, 0x3f0000
buffer_load_dwordx4 v11, s[12:15], s63 offen lds
s_add_u32 m0, s62, 151552
s_add_u32 s63, s69, 0x3f0000
buffer_load_dwordx4 v11, s[16:19], s63 offen lds
s_add_u32 m0, s62, 155648
s_add_u32 s63, s69, 0x428000
buffer_load_dwordx4 v11, s[12:15], s63 offen lds
s_add_u32 m0, s62, 159744
s_add_u32 s63, s69, 0x428000
buffer_load_dwordx4 v11, s[16:19], s63 offen lds
s_waitcnt vmcnt(38) lgkmcnt(0)
s_barrier
ds_read_b64_tr_b16 a[0:1], v8 offset:0
ds_read_b64_tr_b16 a[2:3], v8 offset:512
ds_read_b64_tr_b16 a[4:5], v8 offset:4096
ds_read_b64_tr_b16 a[6:7], v8 offset:4608
s_waitcnt vmcnt(36) lgkmcnt(0)
s_barrier
s_add_u32 m0, s62, 0
s_add_u32 s63, s69, 0x460000
buffer_load_dwordx4 v11, s[12:15], s63 offen lds
s_add_u32 m0, s62, 4096
s_add_u32 s63, s69, 0x460000
buffer_load_dwordx4 v11, s[16:19], s63 offen lds
ds_read_b64_tr_b16 a[8:9], v8 offset:8192
ds_read_b64_tr_b16 a[10:11], v8 offset:8704
ds_read_b64_tr_b16 a[12:13], v8 offset:12288
ds_read_b64_tr_b16 a[14:15], v8 offset:12800
v_mov_b32 v12, 0x3f803f80
v_mov_b32 v13, 0x3f803f80
v_mov_b32 v14, 0x3f803f80
v_mov_b32 v15, 0x3f803f80
s_nop 1
v_mfma_f32_16x16x32_bf16 v[80:83], a[0:3], v[12:15], 0
v_mfma_f32_16x16x32_bf16 v[84:87], a[4:7], v[12:15], 0
s_waitcnt vmcnt(36) lgkmcnt(0)
s_barrier
s_add_u32 m0, s62, 8192
s_add_u32 s63, s69, 0x498000
buffer_load_dwordx4 v11, s[12:15], s63 offen lds
s_add_u32 m0, s62, 12288
s_add_u32 s63, s69, 0x498000
buffer_load_dwordx4 v11, s[16:19], s63 offen lds
ds_read_b64_tr_b16 a[16:17], v8 offset:16384
ds_read_b64_tr_b16 a[18:19], v8 offset:16896
ds_read_b64_tr_b16 a[20:21], v8 offset:20480
ds_read_b64_tr_b16 a[22:23], v8 offset:20992
v_mfma_f32_16x16x32_bf16 v[80:83], a[8:11], v[12:15], v[80:83]
v_mfma_f32_16x16x32_bf16 v[84:87], a[12:15], v[12:15], v[84:87]
s_waitcnt vmcnt(36) lgkmcnt(0)
s_barrier
s_add_u32 m0, s62, 16384
s_add_u32 s63, s69, 0x4d0000
buffer_load_dwordx4 v11, s[12:15], s63 offen lds
s_add_u32 m0, s62, 20480
s_add_u32 s63, s69, 0x4d0000
buffer_load_dwordx4 v11, s[16:19], s63 offen lds
ds_read_b64_tr_b16 a[24:25], v8 offset:24576
ds_read_b64_tr_b16 a[26:27], v8 offset:25088
ds_read_b64_tr_b16 a[28:29], v8 offset:28672
ds_read_b64_tr_b16 a[30:31], v8 offset:29184
v_mfma_f32_16x16x32_bf16 v[80:83], a[16:19], v[12:15], v[80:83]
v_mfma_f32_16x16x32_bf16 v[84:87], a[20:23], v[12:15], v[84:87]
s_waitcnt vmcnt(36) lgkmcnt(0)
s_barrier
s_add_u32 m0, s62, 24576
s_add_u32 s63, s69, 0x508000
buffer_load_dwordx4 v11, s[12:15], s63 offen lds
s_add_u32 m0, s62, 28672
s_add_u32 s63, s69, 0x508000
buffer_load_dwordx4 v11, s[16:19], s63 offen lds
ds_read_b64_tr_b16 a[32:33], v8 offset:32768
ds_read_b64_tr_b16 a[34:35], v8 offset:33280
ds_read_b64_tr_b16 a[36:37], v8 offset:36864
ds_read_b64_tr_b16 a[38:39], v8 offset:37376
v_mfma_f32_16x16x32_bf16 v[80:83], a[24:27], v[12:15], v[80:83]
v_mfma_f32_16x16x32_bf16 v[84:87], a[28:31], v[12:15], v[84:87]
s_waitcnt vmcnt(36) lgkmcnt(0)
s_barrier
s_add_u32 m0, s62, 32768
s_add_u32 s63, s69, 0x540000
buffer_load_dwordx4 v11, s[12:15], s63 offen lds
s_add_u32 m0, s62, 36864
s_add_u32 s63, s69, 0x540000
buffer_load_dwordx4 v11, s[16:19], s63 offen lds
ds_read_b64_tr_b16 a[40:41], v8 offset:40960
ds_read_b64_tr_b16 a[42:43], v8 offset:41472
ds_read_b64_tr_b16 a[44:45], v8 offset:45056
ds_read_b64_tr_b16 a[46:47], v8 offset:45568
v_mfma_f32_16x16x32_bf16 v[80:83], a[32:35], v[12:15], v[80:83]
v_mfma_f32_16x16x32_bf16 v[84:87], a[36:39], v[12:15], v[84:87]
s_waitcnt vmcnt(36) lgkmcnt(0)
s_barrier
s_add_u32 m0, s62, 40960
s_add_u32 s63, s69, 0x578000
buffer_load_dwordx4 v11, s[12:15], s63 offen lds
s_add_u32 m0, s62, 45056
s_add_u32 s63, s69, 0x578000
buffer_load_dwordx4 v11, s[16:19], s63 offen lds
ds_read_b64_tr_b16 a[48:49], v8 offset:49152
ds_read_b64_tr_b16 a[50:51], v8 offset:49664
ds_read_b64_tr_b16 a[52:53], v8 offset:53248
ds_read_b64_tr_b16 a[54:55], v8 offset:53760
v_mfma_f32_16x16x32_bf16 v[80:83], a[40:43], v[12:15], v[80:83]
v_mfma_f32_16x16x32_bf16 v[84:87], a[44:47], v[12:15], v[84:87]
s_waitcnt vmcnt(36) lgkmcnt(0)
s_barrier
s_add_u32 m0, s62, 49152
s_add_u32 s63, s69, 0x5b0000
buffer_load_dwordx4 v11, s[12:15], s63 offen lds
s_add_u32 m0, s62, 53248
s_add_u32 s63, s69, 0x5b0000
buffer_load_dwordx4 v11, s[16:19], s63 offen lds
ds_read_b64_tr_b16 a[56:57], v8 offset:57344
ds_read_b64_tr_b16 a[58:59], v8 offset:57856
ds_read_b64_tr_b16 a[60:61], v8 offset:61440
ds_read_b64_tr_b16 a[62:63], v8 offset:61952
v_mfma_f32_16x16x32_bf16 v[80:83], a[48:51], v[12:15], v[80:83]
v_mfma_f32_16x16x32_bf16 v[84:87], a[52:55], v[12:15], v[84:87]
s_waitcnt vmcnt(36) lgkmcnt(0)
s_barrier
s_add_u32 m0, s62, 57344
s_add_u32 s63, s69, 0x5e8000
buffer_load_dwordx4 v11, s[12:15], s63 offen lds
s_add_u32 m0, s62, 61440
s_add_u32 s63, s69, 0x5e8000
buffer_load_dwordx4 v11, s[16:19], s63 offen lds
ds_read_b64_tr_b16 a[64:65], v9 offset:0
ds_read_b64_tr_b16 a[66:67], v9 offset:512
ds_read_b64_tr_b16 a[68:69], v9 offset:4096
ds_read_b64_tr_b16 a[70:71], v9 offset:4608
v_mfma_f32_16x16x32_bf16 v[80:83], a[56:59], v[12:15], v[80:83]
v_mfma_f32_16x16x32_bf16 v[84:87], a[60:63], v[12:15], v[84:87]
s_waitcnt vmcnt(36) lgkmcnt(0)
s_barrier
s_add_u32 m0, s62, 65536
s_add_u32 s63, s69, 0x620000
buffer_load_dwordx4 v11, s[12:15], s63 offen lds
s_add_u32 m0, s62, 69632
s_add_u32 s63, s69, 0x620000
buffer_load_dwordx4 v11, s[16:19], s63 offen lds
ds_read_b64_tr_b16 a[72:73], v9 offset:8192
ds_read_b64_tr_b16 a[74:75], v9 offset:8704
ds_read_b64_tr_b16 a[76:77], v9 offset:12288
ds_read_b64_tr_b16 a[78:79], v9 offset:12800
v_mfma_f32_16x16x32_bf16 v[80:83], a[64:67], v[12:15], v[80:83]
v_mfma_f32_16x16x32_bf16 v[84:87], a[68:71], v[12:15], v[84:87]
s_waitcnt vmcnt(36) lgkmcnt(0)
s_barrier
s_add_u32 m0, s62, 73728
s_add_u32 s63, s69, 0x658000
buffer_load_dwordx4 v11, s[12:15], s63 offen lds
s_add_u32 m0, s62, 77824
s_add_u32 s63, s69, 0x658000
buffer_load_dwordx4 v11, s[16:19], s63 offen lds
ds_read_b64_tr_b16 a[80:81], v9 offset:16384
ds_read_b64_tr_b16 a[82:83], v9 offset:16896
ds_read_b64_tr_b16 a[84:85], v9 offset:20480
ds_read_b64_tr_b16 a[86:87], v9 offset:20992
v_mfma_f32_16x16x32_bf16 v[80:83], a[72:75], v[12:15], v[80:83]
v_mfma_f32_16x16x32_bf16 v[84:87], a[76:79], v[12:15], v[84:87]
s_waitcnt vmcnt(36) lgkmcnt(0)
s_barrier
s_add_u32 m0, s62, 81920
s_add_u32 s63, s69, 0x690000
buffer_load_dwordx4 v11, s[12:15], s63 offen lds
s_add_u32 m0, s62, 86016
s_add_u32 s63, s69, 0x690000
buffer_load_dwordx4 v11, s[16:19], s63 offen lds
ds_read_b64_tr_b16 a[88:89], v9 offset:24576
ds_read_b64_tr_b16 a[90:91], v9 offset:25088
ds_read_b64_tr_b16 a[92:93], v9 offset:28672
ds_read_b64_tr_b16 a[94:95], v9 offset:29184
v_mfma_f32_16x16x32_bf16 v[80:83], a[80:83], v[12:15], v[80:83]
v_mfma_f32_16x16x32_bf16 v[84:87], a[84:87], v[12:15], v[84:87]
s_waitcnt vmcnt(36) lgkmcnt(0)
s_barrier
s_add_u32 m0, s62, 90112
s_add_u32 s63, s69, 0x6c8000
buffer_load_dwordx4 v11, s[12:15], s63 offen lds
s_add_u32 m0, s62, 94208
s_add_u32 s63, s69, 0x6c8000
buffer_load_dwordx4 v11, s[16:19], s63 offen lds
ds_read_b64_tr_b16 a[96:97], v9 offset:32768
ds_read_b64_tr_b16 a[98:99], v9 offset:33280
ds_read_b64_tr_b16 a[100:101], v9 offset:36864
ds_read_b64_tr_b16 a[102:103], v9 offset:37376
v_mfma_f32_16x16x32_bf16 v[80:83], a[88:91], v[12:15], v[80:83]
v_mfma_f32_16x16x32_bf16 v[84:87], a[92:95], v[12:15], v[84:87]
s_waitcnt vmcnt(36) lgkmcnt(0)
s_barrier
ds_read_b64_tr_b16 a[104:105], v9 offset:40960
ds_read_b64_tr_b16 a[106:107], v9 offset:41472
ds_read_b64_tr_b16 a[108:109], v9 offset:45056
ds_read_b64_tr_b16 a[110:111], v9 offset:45568
v_mfma_f32_16x16x32_bf16 v[80:83], a[96:99], v[12:15], v[80:83]
v_mfma_f32_16x16x32_bf16 v[84:87], a[100:103], v[12:15], v[84:87]
s_waitcnt vmcnt(34) lgkmcnt(0)
s_barrier
ds_read_b64_tr_b16 a[112:113], v9 offset:49152
ds_read_b64_tr_b16 a[114:115], v9 offset:49664
ds_read_b64_tr_b16 a[116:117], v9 offset:53248
ds_read_b64_tr_b16 a[118:119], v9 offset:53760
v_mfma_f32_16x16x32_bf16 v[80:83], a[104:107], v[12:15], v[80:83]
v_mfma_f32_16x16x32_bf16 v[84:87], a[108:111], v[12:15], v[84:87]
s_waitcnt vmcnt(32) lgkmcnt(0)
s_barrier
ds_read_b64_tr_b16 a[120:121], v9 offset:57344
ds_read_b64_tr_b16 a[122:123], v9 offset:57856
ds_read_b64_tr_b16 a[124:125], v9 offset:61440
ds_read_b64_tr_b16 a[126:127], v9 offset:61952
v_mfma_f32_16x16x32_bf16 v[80:83], a[112:115], v[12:15], v[80:83]
v_mfma_f32_16x16x32_bf16 v[84:87], a[116:119], v[12:15], v[84:87]
s_waitcnt vmcnt(30) lgkmcnt(0)
s_barrier
ds_read_b64_tr_b16 a[128:129], v10 offset:0
ds_read_b64_tr_b16 a[130:131], v10 offset:512
ds_read_b64_tr_b16 a[132:133], v10 offset:4096
ds_read_b64_tr_b16 a[134:135], v10 offset:4608
v_mfma_f32_16x16x32_bf16 v[80:83], a[120:123], v[12:15], v[80:83]
v_mfma_f32_16x16x32_bf16 v[84:87], a[124:127], v[12:15], v[84:87]
s_waitcnt vmcnt(28) lgkmcnt(0)
s_barrier
ds_read_b64_tr_b16 a[136:137], v10 offset:8192
ds_read_b64_tr_b16 a[138:139], v10 offset:8704
ds_read_b64_tr_b16 a[140:141], v10 offset:12288
ds_read_b64_tr_b16 a[142:143], v10 offset:12800
v_mfma_f32_16x16x32_bf16 v[80:83], a[128:131], v[12:15], v[80:83]
v_mfma_f32_16x16x32_bf16 v[84:87], a[132:135], v[12:15], v[84:87]
s_waitcnt vmcnt(26) lgkmcnt(0)
s_barrier
ds_read_b64_tr_b16 a[144:145], v10 offset:16384
ds_read_b64_tr_b16 a[146:147], v10 offset:16896
ds_read_b64_tr_b16 a[148:149], v10 offset:20480
ds_read_b64_tr_b16 a[150:151], v10 offset:20992
v_mfma_f32_16x16x32_bf16 v[80:83], a[136:139], v[12:15], v[80:83]
v_mfma_f32_16x16x32_bf16 v[84:87], a[140:143], v[12:15], v[84:87]
s_waitcnt vmcnt(24) lgkmcnt(0)
s_barrier
ds_read_b64_tr_b16 a[152:153], v10 offset:24576
ds_read_b64_tr_b16 a[154:155], v10 offset:25088
ds_read_b64_tr_b16 a[156:157], v10 offset:28672
ds_read_b64_tr_b16 a[158:159], v10 offset:29184
v_mfma_f32_16x16x32_bf16 v[80:83], a[144:147], v[12:15], v[80:83]
v_mfma_f32_16x16x32_bf16 v[84:87], a[148:151], v[12:15], v[84:87]
s_waitcnt vmcnt(22) lgkmcnt(0)
s_barrier
ds_read_b64_tr_b16 a[160:161], v8 offset:0
ds_read_b64_tr_b16 a[162:163], v8 offset:512
ds_read_b64_tr_b16 a[164:165], v8 offset:4096
ds_read_b64_tr_b16 a[166:167], v8 offset:4608
v_mfma_f32_16x16x32_bf16 v[80:83], a[152:155], v[12:15], v[80:83]
v_mfma_f32_16x16x32_bf16 v[84:87], a[156:159], v[12:15], v[84:87]
s_waitcnt vmcnt(20) lgkmcnt(0)
s_barrier
ds_read_b64_tr_b16 a[168:169], v8 offset:8192
ds_read_b64_tr_b16 a[170:171], v8 offset:8704
ds_read_b64_tr_b16 a[172:173], v8 offset:12288
ds_read_b64_tr_b16 a[174:175], v8 offset:12800
v_mfma_f32_16x16x32_bf16 v[80:83], a[160:163], v[12:15], v[80:83]
v_mfma_f32_16x16x32_bf16 v[84:87], a[164:167], v[12:15], v[84:87]
s_waitcnt vmcnt(18) lgkmcnt(0)
s_barrier
ds_read_b64_tr_b16 a[176:177], v8 offset:16384
ds_read_b64_tr_b16 a[178:179], v8 offset:16896
ds_read_b64_tr_b16 a[180:181], v8 offset:20480
ds_read_b64_tr_b16 a[182:183], v8 offset:20992
v_mfma_f32_16x16x32_bf16 v[80:83], a[168:171], v[12:15], v[80:83]
v_mfma_f32_16x16x32_bf16 v[84:87], a[172:175], v[12:15], v[84:87]
s_waitcnt vmcnt(16) lgkmcnt(0)
s_barrier
ds_read_b64_tr_b16 a[184:185], v8 offset:24576
ds_read_b64_tr_b16 a[186:187], v8 offset:25088
ds_read_b64_tr_b16 a[188:189], v8 offset:28672
ds_read_b64_tr_b16 a[190:191], v8 offset:29184
v_mfma_f32_16x16x32_bf16 v[80:83], a[176:179], v[12:15], v[80:83]
v_mfma_f32_16x16x32_bf16 v[84:87], a[180:183], v[12:15], v[84:87]
s_waitcnt vmcnt(14) lgkmcnt(0)
s_barrier
ds_read_b64_tr_b16 a[192:193], v8 offset:32768
ds_read_b64_tr_b16 a[194:195], v8 offset:33280
ds_read_b64_tr_b16 a[196:197], v8 offset:36864
ds_read_b64_tr_b16 a[198:199], v8 offset:37376
v_mfma_f32_16x16x32_bf16 v[80:83], a[184:187], v[12:15], v[80:83]
v_mfma_f32_16x16x32_bf16 v[84:87], a[188:191], v[12:15], v[84:87]
s_waitcnt vmcnt(12) lgkmcnt(0)
s_barrier
ds_read_b64_tr_b16 a[200:201], v8 offset:40960
ds_read_b64_tr_b16 a[202:203], v8 offset:41472
ds_read_b64_tr_b16 a[204:205], v8 offset:45056
ds_read_b64_tr_b16 a[206:207], v8 offset:45568
v_mfma_f32_16x16x32_bf16 v[80:83], a[192:195], v[12:15], v[80:83]
v_mfma_f32_16x16x32_bf16 v[84:87], a[196:199], v[12:15], v[84:87]
s_waitcnt vmcnt(10) lgkmcnt(0)
s_barrier
ds_read_b64_tr_b16 a[208:209], v8 offset:49152
ds_read_b64_tr_b16 a[210:211], v8 offset:49664
ds_read_b64_tr_b16 a[212:213], v8 offset:53248
ds_read_b64_tr_b16 a[214:215], v8 offset:53760
v_mfma_f32_16x16x32_bf16 v[80:83], a[200:203], v[12:15], v[80:83]
v_mfma_f32_16x16x32_bf16 v[84:87], a[204:207], v[12:15], v[84:87]
s_waitcnt vmcnt(8) lgkmcnt(0)
s_barrier
ds_read_b64_tr_b16 a[216:217], v8 offset:57344
ds_read_b64_tr_b16 a[218:219], v8 offset:57856
ds_read_b64_tr_b16 a[220:221], v8 offset:61440
ds_read_b64_tr_b16 a[222:223], v8 offset:61952
v_mfma_f32_16x16x32_bf16 v[80:83], a[208:211], v[12:15], v[80:83]
v_mfma_f32_16x16x32_bf16 v[84:87], a[212:215], v[12:15], v[84:87]
s_waitcnt vmcnt(6) lgkmcnt(0)
s_barrier
ds_read_b64_tr_b16 a[224:225], v9 offset:0
ds_read_b64_tr_b16 a[226:227], v9 offset:512
ds_read_b64_tr_b16 a[228:229], v9 offset:4096
ds_read_b64_tr_b16 a[230:231], v9 offset:4608
v_mfma_f32_16x16x32_bf16 v[80:83], a[216:219], v[12:15], v[80:83]
v_mfma_f32_16x16x32_bf16 v[84:87], a[220:223], v[12:15], v[84:87]
s_waitcnt vmcnt(4) lgkmcnt(0)
s_barrier
ds_read_b64_tr_b16 a[232:233], v9 offset:8192
ds_read_b64_tr_b16 a[234:235], v9 offset:8704
ds_read_b64_tr_b16 a[236:237], v9 offset:12288
ds_read_b64_tr_b16 a[238:239], v9 offset:12800
v_mfma_f32_16x16x32_bf16 v[80:83], a[224:227], v[12:15], v[80:83]
v_mfma_f32_16x16x32_bf16 v[84:87], a[228:231], v[12:15], v[84:87]
s_waitcnt vmcnt(2) lgkmcnt(0)
s_barrier
ds_read_b64_tr_b16 a[240:241], v9 offset:16384
ds_read_b64_tr_b16 a[242:243], v9 offset:16896
ds_read_b64_tr_b16 a[244:245], v9 offset:20480
ds_read_b64_tr_b16 a[246:247], v9 offset:20992
v_mfma_f32_16x16x32_bf16 v[80:83], a[232:235], v[12:15], v[80:83]
v_mfma_f32_16x16x32_bf16 v[84:87], a[236:239], v[12:15], v[84:87]
s_waitcnt vmcnt(0) lgkmcnt(0)
s_barrier
ds_read_b64_tr_b16 a[248:249], v9 offset:24576
ds_read_b64_tr_b16 a[250:251], v9 offset:25088
ds_read_b64_tr_b16 a[252:253], v9 offset:28672
ds_read_b64_tr_b16 a[254:255], v9 offset:29184
v_mfma_f32_16x16x32_bf16 v[80:83], a[240:243], v[12:15], v[80:83]
v_mfma_f32_16x16x32_bf16 v[84:87], a[244:247], v[12:15], v[84:87]
s_waitcnt lgkmcnt(0)
v_mfma_f32_16x16x32_bf16 v[80:83], a[248:251], v[12:15], v[80:83]
v_mfma_f32_16x16x32_bf16 v[84:87], a[252:255], v[12:15], v[84:87]
v_lshlrev_b32 v105, 4, v0
v_and_b32 v1, 31, v0
v_lshrrev_b32 v2, 5, v0
v_lshlrev_b32 v1, 4, v1
v_lshlrev_b32 v2, 10, v2
v_add_u32 v111, v1, v2
s_mov_b32 s62, 0
v_min_u32 v1, 7, v0
v_add_u32 v1, s62, v1
v_mul_u32_u24 v1, 256, v1
v_add_u32 v107, 2048, v1
v_and_b32 v1, 0xffffe000, v107
v_add_u32 v107, v1, v107
s_lshr_b32 s60, s66, 1
s_lshl_b32 s60, s60, 11
s_and_b32 s61, s66, 1
s_lshl_b32 s61, s61, 9
s_add_u32 s60, s60, s61
v_bfe_u32 v1, v0, 4, 1
v_lshlrev_b32 v1, 10, v1
v_lshrrev_b32 v2, 5, v0
v_lshlrev_b32 v2, 8, v2
v_add_u32 v1, v1, v2
v_and_b32 v2, 15, v0
v_lshlrev_b32 v2, 4, v2
v_add3_u32 v112, v1, v2, s60
s_mov_b32 s70, 0xbdd2d3e8
v_mov_b32 v113, 0xc0135761
s_barrier
s_mov_b32 s62, 0
s_cmp_lg_u32 s100, 0
s_cbranch_scc1 Lnear2_61
s_cmp_lg_u32 s97, 0
s_cbranch_scc1 Lnear3_62
v_mov_b32 v1, 160
Lnear_60:
buffer_load_dword v1, v1, s[20:23], 0 offen sc1
s_waitcnt vmcnt(0)
v_readfirstlane_b32 s97, v1
v_mov_b32 v1, 160
s_cmp_eq_u32 s97, 0
s_cbranch_scc1 Lrt_63
Lnear3_62:
s_and_b32 s62, s97, 2
s_lshl_b32 s62, s62, 12
Lnear2_61:
s_xor_b32 s63, s62, 0x2000
v_add_u32 v109, s62, v109
v_add_u32 v107, s63, v107
s_mul_i32 s25, s48, 16384
v_add_u32 v106, s25, v105
s_add_u32 s65, s25, 65536
s_add_u32 s28, s49, 0
s_and_b32 s28, s28, 3
s_mul_i32 s28, s28, 4096
s_add_u32 s29, s49, 1
s_and_b32 s29, s29, 3
s_mul_i32 s29, s29, 4096
s_add_u32 s30, s49, 2
s_and_b32 s30, s30, 3
s_mul_i32 s30, s30, 4096
s_add_u32 s31, s49, 3
s_and_b32 s31, s31, 3
s_mul_i32 s31, s31, 4096
s_lshl_b32 s27, s48, 9
s_add_u32 s27, s27, 131072
v_lshrrev_b32 v108, 2, v105
v_add_u32 v108, 131072, v108
s_cmp_eq_u32 s48, 0
s_cselect_b32 s60, 0, 0x40000000
v_or_b32 v107, s60, v107
s_mov_b32 s53, 0
s_mov_b32 s54, 0
s_mov_b32 s52, 0
v_mov_b32 v104, v105
s_mov_b32 s59, 0x40000000
v_mov_b32 v110, 0
s_mov_b32 s98, 64
s_mov_b32 s99, 0xffffffef
s_mov_b32 s71, 0x40000000
s_add_u32 s60, s53, 1
s_add_u32 s99, s99, 1
s_cmp_lt_u32 s99, 95
s_cselect_b32 s24, s98, s60
s_cselect_b32 s98, s60, s98
s_branch LGU_slow
.p2align 6
LGU_top:
s_waitcnt lgkmcnt(4)
v_mfma_f32_16x16x32_bf16 v[8:11], a[0:3], v[32:35], 0
s_mov_b32 s52, s53
ds_read_b128 v[56:59], v104 offset:6144
s_mov_b32 s53, s24
s_mov_b32 s10, s51
v_mfma_f32_16x16x32_bf16 v[12:15], a[4:7], v[32:35], 0
s_mul_i32 s55, s53, 0x10000
ds_read_b128 v[60:63], v104 offset:7168
s_add_u32 s55, s55, 0xc00000
s_sub_u32 s56, s65, s54
v_mfma_f32_16x16x32_bf16 v[20:23], a[4:7], v[36:39], 0
s_add_u32 m0, s56, s28
s_add_u32 s32, s55, s28
buffer_load_dwordx4 v106, s[8:11], s32 offen offset:0 sc1 lds
s_and_b32 s26, s52, 64
v_mfma_f32_16x16x32_bf16 v[16:19], a[0:3], v[36:39], 0
s_waitcnt lgkmcnt(4)
s_lshl_b32 s26, s26, 12
s_xor_b32 s27, s27, 2048
v_xor_b32 v108, 2048, v108
v_mfma_f32_16x16x32_bf16 v[8:11], a[8:11], v[40:43], v[8:11]
ds_read_b128 v[32:35], v104 offset:8192
v_fmac_f32 v64, v94, v80
v_fmac_f32 v65, v94, v81
v_mfma_f32_16x16x32_bf16 v[12:15], a[12:15], v[40:43], v[12:15]
s_lshl_b32 s62, s52, 11
ds_read_b128 v[36:39], v104 offset:9216
s_add_u32 s62, s62, 0x1c0000
buffer_load_dwordx4 v[96:99], v111, s[4:7], s62 offen offset:0 sc1
v_mfma_f32_16x16x32_bf16 v[20:23], a[12:15], v[44:47], v[20:23]
v_fmac_f32 v66, v94, v82
v_fmac_f32 v67, v94, v83
v_fmac_f32 v68, v94, v84
v_mfma_f32_16x16x32_bf16 v[16:19], a[8:11], v[44:47], v[16:19]
s_waitcnt lgkmcnt(4)
v_fmac_f32 v69, v94, v85
v_fmac_f32 v70, v94, v86
v_fmac_f32 v71, v94, v87
v_mfma_f32_16x16x32_bf16 v[8:11], a[16:19], v[48:51], v[8:11]
ds_read_b128 v[40:43], v104 offset:10240
v_mul_f32 v64, v92, v64
buffer_load_dwordx4 v[100:103], v111, s[4:7], s62 offen offset:512 sc1
v_mfma_f32_16x16x32_bf16 v[12:15], a[20:23], v[48:51], v[12:15]
ds_read_b128 v[44:47], v104 offset:11264
v_mul_f32 v65, v92, v65
v_mul_f32 v66, v92, v66
v_mfma_f32_16x16x32_bf16 v[20:23], a[20:23], v[52:55], v[20:23]
v_mul_f32 v67, v92, v67
v_mul_f32 v68, v92, v68
v_mul_f32 v69, v92, v69
v_mfma_f32_16x16x32_bf16 v[16:19], a[16:19], v[52:55], v[16:19]
s_waitcnt lgkmcnt(4)
v_mul_f32 v70, v92, v70
v_mul_f32 v71, v92, v71
buffer_load_dwordx4 v106, s[8:11], s32 offen offset:1024 sc1 lds
v_mfma_f32_16x16x32_bf16 v[8:11], a[24:27], v[56:59], v[8:11]
ds_read_b128 v[48:51], v104 offset:12288
v_fmac_f32 v72, v95, v80
v_fmac_f32 v73, v95, v81
v_mfma_f32_16x16x32_bf16 v[12:15], a[28:31], v[56:59], v[12:15]
ds_read_b128 v[52:55], v104 offset:13312
v_fmac_f32 v74, v95, v82
v_fmac_f32 v75, v95, v83
v_mfma_f32_16x16x32_bf16 v[20:23], a[28:31], v[60:63], v[20:23]
v_fmac_f32 v76, v95, v84
v_fmac_f32 v77, v95, v85
buffer_load_dwordx4 v106, s[8:11], s32 offen offset:2048 sc1 lds
v_mfma_f32_16x16x32_bf16 v[16:19], a[24:27], v[60:63], v[16:19]
s_waitcnt lgkmcnt(4)
v_fmac_f32 v78, v95, v86
v_fmac_f32 v79, v95, v87
v_mul_f32 v72, v93, v72
v_mfma_f32_16x16x32_bf16 v[8:11], a[32:35], v[32:35], v[8:11]
ds_read_b128 v[56:59], v104 offset:14336
v_mul_f32 v73, v93, v73
v_mul_f32 v74, v93, v74
v_mfma_f32_16x16x32_bf16 v[12:15], a[36:39], v[32:35], v[12:15]
ds_read_b128 v[60:63], v104 offset:15360
v_mul_f32 v75, v93, v75
buffer_load_dwordx4 v106, s[8:11], s32 offen offset:3072 sc1 lds
v_mfma_f32_16x16x32_bf16 v[20:23], a[36:39], v[36:39], v[20:23]
v_mul_f32 v76, v93, v76
v_mul_f32 v77, v93, v77
v_mul_f32 v78, v93, v78
v_mfma_f32_16x16x32_bf16 v[16:19], a[32:35], v[36:39], v[16:19]
s_waitcnt lgkmcnt(4)
v_mul_f32 v79, v93, v79
v_mul_f32 v116, v64, v64
v_mul_f32 v117, v65, v65
v_mfma_f32_16x16x32_bf16 v[8:11], a[40:43], v[40:43], v[8:11]
ds_read_b128 v[32:35], v104 offset:16384
s_add_u32 m0, s56, s29
s_add_u32 s32, s55, s29
v_mfma_f32_16x16x32_bf16 v[12:15], a[44:47], v[40:43], v[12:15]
ds_read_b128 v[36:39], v104 offset:17408
buffer_load_dwordx4 v106, s[8:11], s32 offen offset:0 sc1 lds
v_mul_f32 v118, v66, v66
v_mfma_f32_16x16x32_bf16 v[20:23], a[44:47], v[44:47], v[20:23]
v_mul_f32 v119, v67, v67
v_mul_f32 v120, v72, v72
v_mul_f32 v121, v73, v73
v_mfma_f32_16x16x32_bf16 v[16:19], a[40:43], v[44:47], v[16:19]
s_waitcnt lgkmcnt(4)
v_mul_f32 v122, v74, v74
v_mul_f32 v123, v75, v75
v_fma_f32 v116, v116, s70, v113
v_mfma_f32_16x16x32_bf16 v[8:11], a[48:51], v[48:51], v[8:11]
ds_read_b128 v[40:43], v104 offset:18432
buffer_load_dwordx4 v106, s[8:11], s32 offen offset:1024 sc1 lds
v_fma_f32 v117, v117, s70, v113
v_mfma_f32_16x16x32_bf16 v[12:15], a[52:55], v[48:51], v[12:15]
ds_read_b128 v[44:47], v104 offset:19456
v_fma_f32 v118, v118, s70, v113
v_fma_f32 v119, v119, s70, v113
v_mfma_f32_16x16x32_bf16 v[20:23], a[52:55], v[52:55], v[20:23]
v_fma_f32 v120, v120, s70, v113
v_fma_f32 v121, v121, s70, v113
v_fma_f32 v122, v122, s70, v113
v_mfma_f32_16x16x32_bf16 v[16:19], a[48:51], v[52:55], v[16:19]
s_waitcnt lgkmcnt(4)
v_fma_f32 v123, v123, s70, v113
buffer_load_dwordx4 v106, s[8:11], s32 offen offset:2048 sc1 lds
v_mul_f32 v116, v116, v64
v_mfma_f32_16x16x32_bf16 v[8:11], a[56:59], v[56:59], v[8:11]
ds_read_b128 v[48:51], v104 offset:20480
v_mul_f32 v117, v117, v65
v_mul_f32 v118, v118, v66
v_mfma_f32_16x16x32_bf16 v[12:15], a[60:63], v[56:59], v[12:15]
ds_read_b128 v[52:55], v104 offset:21504
v_mul_f32 v119, v119, v67
v_mul_f32 v120, v120, v72
v_mfma_f32_16x16x32_bf16 v[20:23], a[60:63], v[60:63], v[20:23]
v_mul_f32 v121, v121, v73
buffer_load_dwordx4 v106, s[8:11], s32 offen offset:3072 sc1 lds
v_mul_f32 v122, v122, v74
v_mfma_f32_16x16x32_bf16 v[16:19], a[56:59], v[60:63], v[16:19]
s_waitcnt lgkmcnt(4)
v_mul_f32 v123, v123, v75
v_exp_f32 v116, v116
v_mfma_f32_16x16x32_bf16 v[8:11], a[64:67], v[32:35], v[8:11]
ds_read_b128 v[56:59], v104 offset:22528
v_mul_f32 v68, v68, v64
v_mfma_f32_16x16x32_bf16 v[12:15], a[68:71], v[32:35], v[12:15]
ds_read_b128 v[60:63], v104 offset:23552
s_add_u32 m0, s56, s30
s_add_u32 s32, s55, s30
v_mfma_f32_16x16x32_bf16 v[20:23], a[68:71], v[36:39], v[20:23]
buffer_load_dwordx4 v106, s[8:11], s32 offen offset:0 sc1 lds
v_exp_f32 v117, v117
v_mfma_f32_16x16x32_bf16 v[16:19], a[64:67], v[36:39], v[16:19]
s_waitcnt lgkmcnt(4)
v_mul_f32 v69, v69, v65
v_exp_f32 v118, v118
v_mfma_f32_16x16x32_bf16 v[8:11], a[72:75], v[40:43], v[8:11]
ds_read_b128 v[32:35], v104 offset:24576
v_mul_f32 v70, v70, v66
v_mfma_f32_16x16x32_bf16 v[12:15], a[76:79], v[40:43], v[12:15]
ds_read_b128 v[36:39], v104 offset:25600
buffer_load_dwordx4 v106, s[8:11], s32 offen offset:1024 sc1 lds
v_mfma_f32_16x16x32_bf16 v[20:23], a[76:79], v[44:47], v[20:23]
v_exp_f32 v119, v119
v_mul_f32 v71, v71, v67
v_mfma_f32_16x16x32_bf16 v[16:19], a[72:75], v[44:47], v[16:19]
s_waitcnt lgkmcnt(4)
v_exp_f32 v120, v120
v_mul_f32 v76, v76, v72
v_mfma_f32_16x16x32_bf16 v[8:11], a[80:83], v[48:51], v[8:11]
ds_read_b128 v[40:43], v104 offset:26624
v_exp_f32 v121, v121
v_mfma_f32_16x16x32_bf16 v[12:15], a[84:87], v[48:51], v[12:15]
ds_read_b128 v[44:47], v104 offset:27648
buffer_load_dwordx4 v106, s[8:11], s32 offen offset:2048 sc1 lds
v_mul_f32 v77, v77, v73
v_mfma_f32_16x16x32_bf16 v[20:23], a[84:87], v[52:55], v[20:23]
v_exp_f32 v122, v122
v_mul_f32 v78, v78, v74
v_mfma_f32_16x16x32_bf16 v[16:19], a[80:83], v[52:55], v[16:19]
s_waitcnt lgkmcnt(4)
s_waitcnt vmcnt(10)
s_barrier
v_mfma_f32_16x16x32_bf16 v[8:11], a[88:91], v[56:59], v[8:11]
ds_read_b128 v[48:51], v104 offset:28672
v_exp_f32 v123, v123
v_mfma_f32_16x16x32_bf16 v[12:15], a[92:95], v[56:59], v[12:15]
ds_read_b128 v[52:55], v104 offset:29696
buffer_load_dwordx4 v106, s[8:11], s32 offen offset:3072 sc1 lds
v_mul_f32 v79, v79, v75
v_mfma_f32_16x16x32_bf16 v[20:23], a[92:95], v[60:63], v[20:23]
v_add_f32 v116, 1.0, v116
v_add_f32 v117, 1.0, v117
v_mfma_f32_16x16x32_bf16 v[16:19], a[88:91], v[60:63], v[16:19]
s_waitcnt lgkmcnt(4)
v_rcp_f32 v116, v116
v_add_f32 v118, 1.0, v118
v_mfma_f32_16x16x32_bf16 v[8:11], a[96:99], v[32:35], v[8:11]
ds_read_b128 v[56:59], v104 offset:30720
s_add_u32 m0, s56, s31
s_add_u32 s32, s55, s31
v_mfma_f32_16x16x32_bf16 v[12:15], a[100:103], v[32:35], v[12:15]
ds_read_b128 v[60:63], v104 offset:31744
buffer_load_dwordx4 v106, s[8:11], s32 offen offset:0 sc1 lds
v_mfma_f32_16x16x32_bf16 v[20:23], a[100:103], v[36:39], v[20:23]
v_rcp_f32 v117, v117
v_add_f32 v119, 1.0, v119
v_mfma_f32_16x16x32_bf16 v[16:19], a[96:99], v[36:39], v[16:19]
s_waitcnt lgkmcnt(4)
v_rcp_f32 v118, v118
v_add_f32 v120, 1.0, v120
v_mfma_f32_16x16x32_bf16 v[8:11], a[104:107], v[40:43], v[8:11]
ds_read_b128 v[32:35], v104 offset:32768
v_rcp_f32 v119, v119
v_mfma_f32_16x16x32_bf16 v[12:15], a[108:111], v[40:43], v[12:15]
ds_read_b128 v[36:39], v104 offset:33792
v_add_f32 v121, 1.0, v121
v_mfma_f32_16x16x32_bf16 v[20:23], a[108:111], v[44:47], v[20:23]
v_rcp_f32 v120, v120
v_add_f32 v122, 1.0, v122
v_mfma_f32_16x16x32_bf16 v[16:19], a[104:107], v[44:47], v[16:19]
s_waitcnt lgkmcnt(4)
v_rcp_f32 v121, v121
v_add_f32 v123, 1.0, v123
v_mfma_f32_16x16x32_bf16 v[8:11], a[112:115], v[48:51], v[8:11]
ds_read_b128 v[40:43], v104 offset:34816
v_rcp_f32 v122, v122
v_mfma_f32_16x16x32_bf16 v[12:15], a[116:119], v[48:51], v[12:15]
ds_read_b128 v[44:47], v104 offset:35840
v_rcp_f32 v123, v123
v_mfma_f32_16x16x32_bf16 v[20:23], a[116:119], v[52:55], v[20:23]
v_mul_f32 v116, v116, v68
v_mul_f32 v117, v117, v69
v_mul_f32 v118, v118, v70
v_mfma_f32_16x16x32_bf16 v[16:19], a[112:115], v[52:55], v[16:19]
s_waitcnt lgkmcnt(4)
v_mul_f32 v119, v119, v71
v_mul_f32 v120, v120, v76
v_mul_f32 v121, v121, v77
v_mfma_f32_16x16x32_bf16 v[8:11], a[120:123], v[56:59], v[8:11]
ds_read_b128 v[48:51], v104 offset:36864
v_mul_f32 v122, v122, v78
v_mfma_f32_16x16x32_bf16 v[12:15], a[124:127], v[56:59], v[12:15]
ds_read_b128 v[52:55], v104 offset:37888
v_mul_f32 v123, v123, v79
v_mfma_f32_16x16x32_bf16 v[20:23], a[124:127], v[60:63], v[20:23]
v_cvt_pk_bf16_f32 v124, v116, v117
v_cvt_pk_bf16_f32 v126, v120, v121
v_mfma_f32_16x16x32_bf16 v[16:19], a[120:123], v[60:63], v[16:19]
s_waitcnt lgkmcnt(4)
v_cvt_pk_bf16_f32 v125, v118, v119
v_cvt_pk_bf16_f32 v127, v122, v123
v_mfma_f32_16x16x32_bf16 v[8:11], a[128:131], v[32:35], v[8:11]
ds_read_b128 v[56:59], v104 offset:38912
v_mfma_f32_16x16x32_bf16 v[12:15], a[132:135], v[32:35], v[12:15]
ds_read_b128 v[60:63], v104 offset:39936
v_mfma_f32_16x16x32_bf16 v[20:23], a[132:135], v[36:39], v[20:23]
v_permlane16_swap_b32 v124, v126
v_mfma_f32_16x16x32_bf16 v[16:19], a[128:131], v[36:39], v[16:19]
s_waitcnt lgkmcnt(4)
v_permlane16_swap_b32 v125, v127
v_mfma_f32_16x16x32_bf16 v[8:11], a[136:139], v[40:43], v[8:11]
ds_read_b128 v[32:35], v104 offset:40960
buffer_store_dwordx4 v[124:127], v112, s[4:7], s71 offen sc1
v_mfma_f32_16x16x32_bf16 v[12:15], a[140:143], v[40:43], v[12:15]
ds_read_b128 v[36:39], v104 offset:41984
v_mfma_f32_16x16x32_bf16 v[20:23], a[140:143], v[44:47], v[20:23]
v_mfma_f32_16x16x32_bf16 v[16:19], a[136:139], v[44:47], v[16:19]
s_waitcnt lgkmcnt(4)
v_mfma_f32_16x16x32_bf16 v[8:11], a[144:147], v[48:51], v[8:11]
ds_read_b128 v[40:43], v104 offset:43008
v_mfma_f32_16x16x32_bf16 v[12:15], a[148:151], v[48:51], v[12:15]
ds_read_b128 v[44:47], v104 offset:44032
buffer_load_dwordx4 v106, s[8:11], s32 offen offset:1024 sc1 lds
v_mfma_f32_16x16x32_bf16 v[20:23], a[148:151], v[52:55], v[20:23]
v_mfma_f32_16x16x32_bf16 v[16:19], a[144:147], v[52:55], v[16:19]
s_waitcnt lgkmcnt(4)
v_mfma_f32_16x16x32_bf16 v[8:11], a[152:155], v[56:59], v[8:11]
ds_read_b128 v[48:51], v104 offset:45056
v_mfma_f32_16x16x32_bf16 v[12:15], a[156:159], v[56:59], v[12:15]
ds_read_b128 v[52:55], v104 offset:46080
buffer_load_dwordx4 v106, s[8:11], s32 offen offset:2048 sc1 lds
v_mfma_f32_16x16x32_bf16 v[20:23], a[156:159], v[60:63], v[20:23]
v_mfma_f32_16x16x32_bf16 v[16:19], a[152:155], v[60:63], v[16:19]
s_waitcnt lgkmcnt(4)
s_waitcnt vmcnt(15)
v_add_f32 v96, v96, v98
v_mfma_f32_16x16x32_bf16 v[8:11], a[160:163], v[32:35], v[8:11]
ds_read_b128 v[56:59], v104 offset:47104
v_add_f32 v97, v97, v99
v_mfma_f32_16x16x32_bf16 v[12:15], a[164:167], v[32:35], v[12:15]
ds_read_b128 v[60:63], v104 offset:48128
buffer_load_dwordx4 v106, s[8:11], s32 offen offset:3072 sc1 lds
v_mfma_f32_16x16x32_bf16 v[20:23], a[164:167], v[36:39], v[20:23]
v_add_f32 v100, v100, v102
v_add_f32 v101, v101, v103
v_mfma_f32_16x16x32_bf16 v[16:19], a[160:163], v[36:39], v[16:19]
s_waitcnt lgkmcnt(4)
s_add_u32 s60, s53, 1
s_add_u32 s99, s99, 1
v_mfma_f32_16x16x32_bf16 v[8:11], a[168:171], v[40:43], v[8:11]
s_cmp_lt_u32 s99, 95
ds_read_b128 v[32:35], v104 offset:49152
s_cselect_b32 s24, s98, s60
v_mfma_f32_16x16x32_bf16 v[12:15], a[172:175], v[40:43], v[12:15]
s_cselect_b32 s98, s60, s98
ds_read_b128 v[36:39], v104 offset:50176
s_mov_b32 m0, s27
v_mfma_f32_16x16x32_bf16 v[20:23], a[172:175], v[44:47], v[20:23]
s_cmp_lt_u32 s24, 64
s_cselect_b32 s58, 0, 0x40000
buffer_load_dword v107, s[4:7], s58 offen sc1 lds
v_mfma_f32_16x16x32_bf16 v[16:19], a[168:171], v[44:47], v[16:19]
s_waitcnt lgkmcnt(4)
v_add_f32 v96, v96, v100
v_add_f32 v97, v97, v101
v_mfma_f32_16x16x32_bf16 v[8:11], a[176:179], v[48:51], v[8:11]
ds_read_b128 v[40:43], v104 offset:51200
v_mfma_f32_16x16x32_bf16 v[12:15], a[180:183], v[48:51], v[12:15]
ds_read_b128 v[44:47], v104 offset:52224
v_mfma_f32_16x16x32_bf16 v[20:23], a[180:183], v[52:55], v[20:23]
v_permlane32_swap_b32 v96, v97
v_mfma_f32_16x16x32_bf16 v[16:19], a[176:179], v[52:55], v[16:19]
s_waitcnt lgkmcnt(4)
v_add_f32 v96, v96, v97
v_mov_b32 v97, v96
v_mfma_f32_16x16x32_bf16 v[8:11], a[184:187], v[56:59], v[8:11]
ds_read_b128 v[48:51], v104 offset:53248
v_mfma_f32_16x16x32_bf16 v[12:15], a[188:191], v[56:59], v[12:15]
ds_read_b128 v[52:55], v104 offset:54272
v_mfma_f32_16x16x32_bf16 v[20:23], a[188:191], v[60:63], v[20:23]
v_permlane32_swap_b32 v96, v97
v_mfma_f32_16x16x32_bf16 v[16:19], a[184:187], v[60:63], v[16:19]
s_waitcnt lgkmcnt(4)
v_mul_f32 v96, 0x3a800000, v96
v_mul_f32 v97, 0x3a800000, v97
v_mfma_f32_16x16x32_bf16 v[8:11], a[192:195], v[32:35], v[8:11]
ds_read_b128 v[56:59], v104 offset:55296
v_fma_f32 v97, -v96, v96, v97
v_mfma_f32_16x16x32_bf16 v[12:15], a[196:199], v[32:35], v[12:15]
ds_read_b128 v[60:63], v104 offset:56320
v_max_f32 v97, 0, v97
v_mfma_f32_16x16x32_bf16 v[20:23], a[196:199], v[36:39], v[20:23]
v_cvt_pk_bf16_f32 v98, v96, v97
v_lshlrev_b32 v96, 16, v98
v_mfma_f32_16x16x32_bf16 v[16:19], a[192:195], v[36:39], v[16:19]
s_waitcnt lgkmcnt(4)
v_and_b32 v97, 0xffff0000, v98
v_add_f32 v97, 0x3727c5ac, v97
v_mfma_f32_16x16x32_bf16 v[8:11], a[200:203], v[40:43], v[8:11]
ds_read_b128 v[32:35], v104 offset:57344
v_cvt_pk_bf16_f32 v97, v97, v97
v_mfma_f32_16x16x32_bf16 v[12:15], a[204:207], v[40:43], v[12:15]
ds_read_b128 v[36:39], v104 offset:58368
v_lshlrev_b32 v97, 16, v97
v_mfma_f32_16x16x32_bf16 v[20:23], a[204:207], v[44:47], v[20:23]
v_sqrt_f32 v97, v97
v_mfma_f32_16x16x32_bf16 v[16:19], a[200:203], v[44:47], v[16:19]
s_waitcnt lgkmcnt(4)
v_cvt_pk_bf16_f32 v97, v97, v97
v_lshlrev_b32 v97, 16, v97
v_mfma_f32_16x16x32_bf16 v[8:11], a[208:211], v[48:51], v[8:11]
ds_read_b128 v[40:43], v104 offset:59392
v_mfma_f32_16x16x32_bf16 v[12:15], a[212:215], v[48:51], v[12:15]
ds_read_b128 v[44:47], v104 offset:60416
v_mfma_f32_16x16x32_bf16 v[20:23], a[212:215], v[52:55], v[20:23]
v_rcp_f32 v92, v97
v_mfma_f32_16x16x32_bf16 v[16:19], a[208:211], v[52:55], v[16:19]
s_waitcnt lgkmcnt(4)
v_sub_f32 v94, 0, v96
v_mov_b32 v93, v92
v_mfma_f32_16x16x32_bf16 v[8:11], a[216:219], v[56:59], v[8:11]
ds_read_b128 v[48:51], v104 offset:61440
v_mov_b32 v95, v94
v_mfma_f32_16x16x32_bf16 v[12:15], a[220:223], v[56:59], v[12:15]
ds_read_b128 v[52:55], v104 offset:62464
v_mfma_f32_16x16x32_bf16 v[20:23], a[220:223], v[60:63], v[20:23]
v_permlane16_swap_b32 v92, v93
v_mfma_f32_16x16x32_bf16 v[16:19], a[216:219], v[60:63], v[16:19]
s_waitcnt lgkmcnt(4)
v_permlane16_swap_b32 v94, v95
v_mfma_f32_16x16x32_bf16 v[8:11], a[224:227], v[32:35], v[8:11]
s_mul_i32 s71, s52, 0x38000
ds_read_b128 v[56:59], v104 offset:63488
s_add_u32 s71, s71, 0xb400000
v_mfma_f32_16x16x32_bf16 v[12:15], a[228:231], v[32:35], v[12:15]
ds_read_b128 v[60:63], v104 offset:64512
v_mfma_f32_16x16x32_bf16 v[20:23], a[228:231], v[36:39], v[20:23]
v_mfma_f32_16x16x32_bf16 v[16:19], a[224:227], v[36:39], v[16:19]
s_waitcnt lgkmcnt(4)
v_mfma_f32_16x16x32_bf16 v[8:11], a[232:235], v[40:43], v[8:11]
s_sub_u32 s54, 65536, s54
v_add_u32 v104, s54, v105
v_mfma_f32_16x16x32_bf16 v[12:15], a[236:239], v[40:43], v[12:15]
v_mfma_f32_16x16x32_bf16 v[20:23], a[236:239], v[44:47], v[20:23]
v_mfma_f32_16x16x32_bf16 v[16:19], a[232:235], v[44:47], v[16:19]
s_waitcnt lgkmcnt(0)
s_waitcnt vmcnt(0)
s_barrier
v_mfma_f32_16x16x32_bf16 v[8:11], a[240:243], v[48:51], v[8:11]
ds_read_b32 v4, v108
ds_read_b128 v[32:35], v104 offset:0
v_mfma_f32_16x16x32_bf16 v[12:15], a[244:247], v[48:51], v[12:15]
ds_read_b128 v[36:39], v104 offset:1024
ds_read_b128 v[40:43], v104 offset:2048
v_mfma_f32_16x16x32_bf16 v[20:23], a[244:247], v[52:55], v[20:23]
ds_read_b128 v[44:47], v104 offset:3072
buffer_store_dword v110, v109, s[4:7], s59 offen sc1
v_mfma_f32_16x16x32_bf16 v[16:19], a[240:243], v[52:55], v[16:19]
s_add_u32 s60, s52, 1
s_mov_b32 s59, s26
v_mfma_f32_16x16x32_bf16 v[64:67], a[248:251], v[56:59], v[8:11]
ds_read_b128 v[48:51], v104 offset:4096
v_mov_b32 v110, s60
v_mfma_f32_16x16x32_bf16 v[68:71], a[252:255], v[56:59], v[12:15]
s_nop 0
ds_read_b128 v[52:55], v104 offset:5120
s_waitcnt lgkmcnt(6)
v_mfma_f32_16x16x32_bf16 v[76:79], a[252:255], v[60:63], v[20:23]
v_cmp_lt_u32 vcc, s24, v4
s_nop 0
s_cmp_eq_u64 vcc, -1
v_mfma_f32_16x16x32_bf16 v[72:75], a[248:251], v[60:63], v[16:19]
s_cselect_b32 s51, 0x10000000, 0
s_add_u32 s61, s53, 1
s_cmp_eq_u32 s61, s24
s_cselect_b32 s57, -1, s51
s_and_b32 s57, s57, s10
s_cbranch_scc1 LGU_top
v_fmac_f32 v64, v94, v80
v_fmac_f32 v65, v94, v81
v_fmac_f32 v66, v94, v82
v_fmac_f32 v67, v94, v83
v_fmac_f32 v68, v94, v84
v_fmac_f32 v69, v94, v85
v_fmac_f32 v70, v94, v86
v_fmac_f32 v71, v94, v87
v_mul_f32 v64, v92, v64
v_mul_f32 v65, v92, v65
v_mul_f32 v66, v92, v66
v_mul_f32 v67, v92, v67
v_mul_f32 v68, v92, v68
v_mul_f32 v69, v92, v69
v_mul_f32 v70, v92, v70
v_mul_f32 v71, v92, v71
v_fmac_f32 v72, v95, v80
v_fmac_f32 v73, v95, v81
v_fmac_f32 v74, v95, v82
v_fmac_f32 v75, v95, v83
v_fmac_f32 v76, v95, v84
v_fmac_f32 v77, v95, v85
v_fmac_f32 v78, v95, v86
v_fmac_f32 v79, v95, v87
v_mul_f32 v72, v93, v72
v_mul_f32 v73, v93, v73
v_mul_f32 v74, v93, v74
v_mul_f32 v75, v93, v75
v_mul_f32 v76, v93, v76
v_mul_f32 v77, v93, v77
v_mul_f32 v78, v93, v78
v_mul_f32 v79, v93, v79
v_mul_f32 v116, v64, v64
v_mul_f32 v117, v65, v65
v_mul_f32 v118, v66, v66
v_mul_f32 v119, v67, v67
v_mul_f32 v120, v72, v72
v_mul_f32 v121, v73, v73
v_mul_f32 v122, v74, v74
v_mul_f32 v123, v75, v75
v_fma_f32 v116, v116, s70, v113
v_fma_f32 v117, v117, s70, v113
v_fma_f32 v118, v118, s70, v113
v_fma_f32 v119, v119, s70, v113
v_fma_f32 v120, v120, s70, v113
v_fma_f32 v121, v121, s70, v113
v_fma_f32 v122, v122, s70, v113
v_fma_f32 v123, v123, s70, v113
v_mul_f32 v116, v116, v64
v_mul_f32 v117, v117, v65
v_mul_f32 v118, v118, v66
v_mul_f32 v119, v119, v67
v_mul_f32 v120, v120, v72
v_mul_f32 v121, v121, v73
v_mul_f32 v122, v122, v74
v_mul_f32 v123, v123, v75
v_exp_f32 v116, v116
v_mul_f32 v68, v68, v64
v_exp_f32 v117, v117
v_mul_f32 v69, v69, v65
v_exp_f32 v118, v118
v_mul_f32 v70, v70, v66
v_exp_f32 v119, v119
v_mul_f32 v71, v71, v67
v_exp_f32 v120, v120
v_mul_f32 v76, v76, v72
v_exp_f32 v121, v121
v_mul_f32 v77, v77, v73
v_exp_f32 v122, v122
v_mul_f32 v78, v78, v74
v_exp_f32 v123, v123
v_mul_f32 v79, v79, v75
v_add_f32 v116, 1.0, v116
v_add_f32 v117, 1.0, v117
v_rcp_f32 v116, v116
v_add_f32 v118, 1.0, v118
v_rcp_f32 v117, v117
v_add_f32 v119, 1.0, v119
v_rcp_f32 v118, v118
v_add_f32 v120, 1.0, v120
v_rcp_f32 v119, v119
v_add_f32 v121, 1.0, v121
v_rcp_f32 v120, v120
v_add_f32 v122, 1.0, v122
v_rcp_f32 v121, v121
v_add_f32 v123, 1.0, v123
v_rcp_f32 v122, v122
v_rcp_f32 v123, v123
v_mul_f32 v116, v116, v68
v_mul_f32 v117, v117, v69
v_mul_f32 v118, v118, v70
v_mul_f32 v119, v119, v71
v_mul_f32 v120, v120, v76
v_mul_f32 v121, v121, v77
v_mul_f32 v122, v122, v78
v_mul_f32 v123, v123, v79
v_cvt_pk_bf16_f32 v124, v116, v117
v_cvt_pk_bf16_f32 v126, v120, v121
v_cvt_pk_bf16_f32 v125, v118, v119
v_cvt_pk_bf16_f32 v127, v122, v123
v_permlane16_swap_b32 v124, v126
s_nop 0
v_permlane16_swap_b32 v125, v127
buffer_store_dwordx4 v[124:127], v112, s[4:7], s71 offen sc1
s_mov_b32 s71, 0x40000000
s_cmp_lg_u32 s10, 0
s_cbranch_scc1 Lsc_65
s_xor_b32 s27, s27, 2048
v_xor_b32 v108, 2048, v108
s_min_u32 s61, s24, 127
s_xor_b32 s61, s61, s53
s_cmp_ge_u32 s61, 64
s_cbranch_scc1 Lnomed_72
v_cmp_lt_u32 vcc, s53, v4
s_nop 0
s_cmp_eq_u64 vcc, -1
s_cbranch_scc1 Lmed_71
Lnomed_72:
s_mov_b32 m0, s27
s_cmp_lt_u32 s53, 64
s_cselect_b32 s58, 0, 0x40000
buffer_load_dword v107, s[4:7], s58 offen sc1 lds
s_mul_i32 s55, s53, 0x10000
s_add_u32 s55, s55, 0xc00000
s_add_u32 s56, s25, s54
s_waitcnt vmcnt(0) lgkmcnt(0)
s_barrier
ds_read_b32 v4, v108
buffer_store_dword v110, v109, s[4:7], s59 offen sc1
s_cmp_ge_u32 s53, 128
s_cbranch_scc1 LGU_exit
s_xor_b32 s27, s27, 2048
v_xor_b32 v108, 2048, v108
s_waitcnt lgkmcnt(0)
v_cmp_lt_u32 vcc, s53, v4
s_nop 0
s_cmp_eq_u64 vcc, -1
s_cbranch_scc1 Lgo_64
LGU_slow:
s_and_b32 s58, s53, 64
s_lshl_b32 s58, s58, 12
s_mul_i32 s55, s53, 0x10000
s_add_u32 s55, s55, 0xc00000
s_add_u32 s56, s25, s54
s_cmp_lg_u32 s48, 0
s_cbranch_scc1 Lspd_74
Lsp_73:
buffer_load_dword v4, v107, s[4:7], s58 offen sc1
s_waitcnt vmcnt(0)
v_cmp_lt_u32 vcc, s53, v4
s_nop 0
s_cmp_eq_u64 vcc, -1
s_cbranch_scc0 Lrt_75
Lspd_74:
s_barrier
Lgo_64:
s_mov_b32 m0, s27
s_cmp_lt_u32 s24, 64
s_cselect_b32 s58, 0, 0x40000
buffer_load_dword v107, s[4:7], s58 offen sc1 lds
s_lshl_b32 s61, s48, 10
s_add_u32 s55, s55, s61
s_add_u32 s56, s54, s61
s_add_u32 m0, s56, 0
s_add_u32 s32, s55, 0
buffer_load_dwordx4 v105, s[4:7], s32 offen sc1 lds
s_add_u32 m0, s56, 4096
s_add_u32 s32, s55, 4096
buffer_load_dwordx4 v105, s[4:7], s32 offen sc1 lds
s_add_u32 m0, s56, 8192
s_add_u32 s32, s55, 8192
buffer_load_dwordx4 v105, s[4:7], s32 offen sc1 lds
s_add_u32 m0, s56, 12288
s_add_u32 s32, s55, 12288
buffer_load_dwordx4 v105, s[4:7], s32 offen sc1 lds
s_add_u32 m0, s56, 16384
s_add_u32 s32, s55, 16384
buffer_load_dwordx4 v105, s[4:7], s32 offen sc1 lds
s_add_u32 m0, s56, 20480
s_add_u32 s32, s55, 20480
buffer_load_dwordx4 v105, s[4:7], s32 offen sc1 lds
s_add_u32 m0, s56, 24576
s_add_u32 s32, s55, 24576
buffer_load_dwordx4 v105, s[4:7], s32 offen sc1 lds
s_add_u32 m0, s56, 28672
s_add_u32 s32, s55, 28672
buffer_load_dwordx4 v105, s[4:7], s32 offen sc1 lds
s_add_u32 m0, s56, 32768
s_add_u32 s32, s55, 32768
buffer_load_dwordx4 v105, s[4:7], s32 offen sc1 lds
s_add_u32 m0, s56, 36864
s_add_u32 s32, s55, 36864
buffer_load_dwordx4 v105, s[4:7], s32 offen sc1 lds
s_add_u32 m0, s56, 40960
s_add_u32 s32, s55, 40960
buffer_load_dwordx4 v105, s[4:7], s32 offen sc1 lds
s_add_u32 m0, s56, 45056
s_add_u32 s32, s55, 45056
buffer_load_dwordx4 v105, s[4:7], s32 offen sc1 lds
s_add_u32 m0, s56, 49152
s_add_u32 s32, s55, 49152
buffer_load_dwordx4 v105, s[4:7], s32 offen sc1 lds
s_add_u32 m0, s56, 53248
s_add_u32 s32, s55, 53248
buffer_load_dwordx4 v105, s[4:7], s32 offen sc1 lds
s_add_u32 m0, s56, 57344
s_add_u32 s32, s55, 57344
buffer_load_dwordx4 v105, s[4:7], s32 offen sc1 lds
s_add_u32 m0, s56, 61440
s_add_u32 s32, s55, 61440
buffer_load_dwordx4 v105, s[4:7], s32 offen sc1 lds
s_waitcnt vmcnt(9)
Lrd_69:
s_barrier
Lrd2_70:
ds_read_b32 v4, v108
ds_read_b128 v[32:35], v104 offset:0
ds_read_b128 v[36:39], v104 offset:1024
ds_read_b128 v[40:43], v104 offset:2048
ds_read_b128 v[44:47], v104 offset:3072
ds_read_b128 v[48:51], v104 offset:4096
ds_read_b128 v[52:55], v104 offset:5120
s_waitcnt lgkmcnt(6)
v_cmp_lt_u32 vcc, s24, v4
s_nop 0
s_cmp_eq_u64 vcc, -1
s_cselect_b32 s51, 0x10000000, 0
s_branch LGU_top
LGU_exit:
s_waitcnt vmcnt(0)
s_endpgm
Lrt_63:
s_add_u32 s96, s96, 1
s_cmp_lt_u32 s96, 1048576
s_cbranch_scc1 Lnear_60
s_mov_b32 s97, 24
s_branch L_fail
Lrt_68:
s_add_u32 s96, s96, 1
s_cmp_lt_u32 s96, 1048576
s_cbranch_scc1 Lsp_66
s_mov_b32 s97, 4
s_branch L_fail
Lsc_65:
s_xor_b32 s27, s27, 2048
v_xor_b32 v108, 2048, v108
s_mov_b32 m0, s27
s_cmp_lt_u32 s24, 64
s_cselect_b32 s58, 0, 0x40000
buffer_load_dword v107, s[4:7], s58 offen sc1 lds
s_waitcnt vmcnt(0) lgkmcnt(0)
s_barrier
ds_read_b32 v4, v108
buffer_store_dword v110, v109, s[4:7], s59 offen sc1
s_mov_b32 s51, 0x10000000
s_waitcnt lgkmcnt(0)
v_cmp_lt_u32 vcc, s24, v4
s_nop 0
s_cmp_eq_u64 vcc, -1
s_cbranch_scc1 LGU_top
s_cmp_lg_u32 s48, 0
s_cbranch_scc1 Lspd_67
Lsp_66:
buffer_load_dword v4, v107, s[4:7], s58 offen sc1
s_waitcnt vmcnt(0)
v_cmp_lt_u32 vcc, s24, v4
s_nop 0
s_cmp_eq_u64 vcc, -1
s_cbranch_scc0 Lrt_68
Lspd_67:
s_barrier
s_branch LGU_top
Lmed_71:
s_mul_i32 s55, s53, 0x10000
s_add_u32 s55, s55, 0xc00000
s_add_u32 s56, s25, s54
s_add_u32 m0, s56, s28
s_add_u32 s32, s55, s28
buffer_load_dwordx4 v106, s[4:7], s32 offen offset:0 sc1 lds
buffer_load_dwordx4 v106, s[4:7], s32 offen offset:1024 sc1 lds
buffer_load_dwordx4 v106, s[4:7], s32 offen offset:2048 sc1 lds
buffer_load_dwordx4 v106, s[4:7], s32 offen offset:3072 sc1 lds
s_add_u32 m0, s56, s29
s_add_u32 s32, s55, s29
buffer_load_dwordx4 v106, s[4:7], s32 offen offset:0 sc1 lds
buffer_load_dwordx4 v106, s[4:7], s32 offen offset:1024 sc1 lds
buffer_load_dwordx4 v106, s[4:7], s32 offen offset:2048 sc1 lds
buffer_load_dwordx4 v106, s[4:7], s32 offen offset:3072 sc1 lds
s_add_u32 m0, s56, s30
s_add_u32 s32, s55, s30
buffer_load_dwordx4 v106, s[4:7], s32 offen offset:0 sc1 lds
buffer_load_dwordx4 v106, s[4:7], s32 offen offset:1024 sc1 lds
buffer_load_dwordx4 v106, s[4:7], s32 offen offset:2048 sc1 lds
buffer_load_dwordx4 v106, s[4:7], s32 offen offset:3072 sc1 lds
s_add_u32 m0, s56, s31
s_add_u32 s32, s55, s31
buffer_load_dwordx4 v106, s[4:7], s32 offen offset:0 sc1 lds
buffer_load_dwordx4 v106, s[4:7], s32 offen offset:1024 sc1 lds
buffer_load_dwordx4 v106, s[4:7], s32 offen offset:2048 sc1 lds
buffer_load_dwordx4 v106, s[4:7], s32 offen offset:3072 sc1 lds
s_mov_b32 m0, s27
s_cmp_lt_u32 s24, 64
s_cselect_b32 s58, 0, 0x40000
buffer_load_dword v107, s[4:7], s58 offen sc1 lds
s_waitcnt vmcnt(17) lgkmcnt(0)
s_barrier
buffer_store_dword v110, v109, s[4:7], s59 offen sc1
s_waitcnt vmcnt(1)
s_branch Lrd_69
Lrt_75:
s_add_u32 s96, s96, 1
s_cmp_lt_u32 s96, 1048576
s_cbranch_scc1 Lsp_73
s_mov_b32 s97, 4
s_branch L_fail
L_WOP:
s_mov_b32 s12, s34
s_and_b32 s13, s35, 0xffff
s_mov_b32 s14, 0x800000
s_mov_b32 s15, 0x20000
s_lshr_b32 s66, s49, 3
s_and_b32 s67, s49, 7
s_lshl_b32 s68, s67, 2
s_add_u32 s68, s68, s48
s_mul_i32 s70, s66, 36
s_lshl_b32 s71, s70, 11
s_lshl_b32 s62, s67, 2
s_add_u32 s62, s62, s66
s_mul_i32 s60, s62, 256
s_add_u32 s60, s60, 83968
s_and_b32 s61, s60, 0xffffe000
s_add_u32 s60, s60, s61
v_mov_b32 v110, s60
v_mov_b32 v1, 0x40000000
v_cmp_gt_u32 vcc, 1, v0
s_nop 1
v_cndmask_b32 v110, v1, v110, vcc
s_cmp_eq_u32 s48, 1
s_cselect_b32 s60, 0, 0x40000000
v_or_b32 v110, s60, v110
v_mov_b32 v1, 0
s_mov_b32 s60, 0x0
buffer_store_dword v1, v110, s[4:7], s60 offen sc1
s_mov_b32 s60, 0x2000
buffer_store_dword v1, v110, s[4:7], s60 offen sc1
s_mov_b32 s60, 0x40000
buffer_store_dword v1, v110, s[4:7], s60 offen sc1
s_mov_b32 s60, 0x42000
buffer_store_dword v1, v110, s[4:7], s60 offen sc1
s_waitcnt vmcnt(0)
s_barrier
s_cmp_lg_u32 s48, 0
s_cbranch_scc1 Larr_76
s_mov_b32 s60, 0
v_mov_b32 v2, s60
v_mov_b32 v1, 0x40000000
v_cmp_gt_u32 vcc, 1, v0
s_nop 1
v_cndmask_b32 v2, v1, v2, vcc
s_sub_u32 s61, s101, s2
s_and_b32 s61, s61, 7
s_lshl_b32 s61, s61, 2
s_add_u32 s61, s61, 128
s_cmp_eq_u32 s100, 0
s_cselect_b32 s61, s61, 0
v_mov_b32 v3, 1
buffer_atomic_add v3, v2, s[20:23], s61 offen sc1
Larr_76:
s_lshr_b32 s61, s48, 1
s_lshl_b32 s61, s61, 12
s_and_b32 s60, s48, 1
s_lshl_b32 s60, s60, 6
s_add_u32 s61, s61, s60
v_lshrrev_b32 v1, 4, v0
v_bfe_u32 v2, v0, 2, 2
v_and_b32 v3, 3, v0
v_mul_u32_u24 v1, 4, v1
v_add_u32 v1, v1, v2
v_mul_u32_u24 v1, 128, v1
v_mul_u32_u24 v3, 16, v3
v_add3_u32 v8, v1, v3, s61
s_lshl_b32 s72, s70, 16
s_lshl_b32 s60, s67, 8
s_add_u32 s72, s72, s60
s_add_u32 s69, s72, 128
v_lshrrev_b32 v1, 3, v0
s_lshl_b32 s60, s48, 3
v_add_u32 v1, s60, v1
v_mul_u32_u24 v1, 2048, v1
v_and_b32 v2, 7, v0
v_lshlrev_b32 v2, 4, v2
v_add_u32 v11, v1, v2
v_add_u32 v9, 65536, v8
v_add_u32 v10, 131072, v8
s_lshl_b32 s62, s48, 10
s_add_u32 m0, s62, 0
s_add_u32 s63, s72, 0x0
buffer_load_dwordx4 v11, s[12:15], s63 offen lds
s_add_u32 m0, s62, 4096
s_add_u32 s63, s69, 0x0
buffer_load_dwordx4 v11, s[12:15], s63 offen lds
s_add_u32 m0, s62, 8192
s_add_u32 s63, s72, 0x10000
buffer_load_dwordx4 v11, s[12:15], s63 offen lds
s_add_u32 m0, s62, 12288
s_add_u32 s63, s69, 0x10000
buffer_load_dwordx4 v11, s[12:15], s63 offen lds
s_add_u32 m0, s62, 16384
s_add_u32 s63, s72, 0x20000
buffer_load_dwordx4 v11, s[12:15], s63 offen lds
s_add_u32 m0, s62, 20480
s_add_u32 s63, s69, 0x20000
buffer_load_dwordx4 v11, s[12:15], s63 offen lds
s_add_u32 m0, s62, 24576
s_add_u32 s63, s72, 0x30000
buffer_load_dwordx4 v11, s[12:15], s63 offen lds
s_add_u32 m0, s62, 28672
s_add_u32 s63, s69, 0x30000
buffer_load_dwordx4 v11, s[12:15], s63 offen lds
s_add_u32 m0, s62, 32768
s_add_u32 s63, s72, 0x40000
buffer_load_dwordx4 v11, s[12:15], s63 offen lds
s_add_u32 m0, s62, 36864
s_add_u32 s63, s69, 0x40000
buffer_load_dwordx4 v11, s[12:15], s63 offen lds
s_add_u32 m0, s62, 40960
s_add_u32 s63, s72, 0x50000
buffer_load_dwordx4 v11, s[12:15], s63 offen lds
s_add_u32 m0, s62, 45056
s_add_u32 s63, s69, 0x50000
buffer_load_dwordx4 v11, s[12:15], s63 offen lds
s_add_u32 m0, s62, 49152
s_add_u32 s63, s72, 0x60000
buffer_load_dwordx4 v11, s[12:15], s63 offen lds
s_add_u32 m0, s62, 53248
s_add_u32 s63, s69, 0x60000
buffer_load_dwordx4 v11, s[12:15], s63 offen lds
s_add_u32 m0, s62, 57344
s_add_u32 s63, s72, 0x70000
buffer_load_dwordx4 v11, s[12:15], s63 offen lds
s_add_u32 m0, s62, 61440
s_add_u32 s63, s69, 0x70000
buffer_load_dwordx4 v11, s[12:15], s63 offen lds
s_add_u32 m0, s62, 65536
s_add_u32 s63, s72, 0x80000
buffer_load_dwordx4 v11, s[12:15], s63 offen lds
s_add_u32 m0, s62, 69632
s_add_u32 s63, s69, 0x80000
buffer_load_dwordx4 v11, s[12:15], s63 offen lds
s_add_u32 m0, s62, 73728
s_add_u32 s63, s72, 0x90000
buffer_load_dwordx4 v11, s[12:15], s63 offen lds
s_add_u32 m0, s62, 77824
s_add_u32 s63, s69, 0x90000
buffer_load_dwordx4 v11, s[12:15], s63 offen lds
s_add_u32 m0, s62, 81920
s_add_u32 s63, s72, 0xa0000
buffer_load_dwordx4 v11, s[12:15], s63 offen lds
s_add_u32 m0, s62, 86016
s_add_u32 s63, s69, 0xa0000
buffer_load_dwordx4 v11, s[12:15], s63 offen lds
s_add_u32 m0, s62, 90112
s_add_u32 s63, s72, 0xb0000
buffer_load_dwordx4 v11, s[12:15], s63 offen lds
s_add_u32 m0, s62, 94208
s_add_u32 s63, s69, 0xb0000
buffer_load_dwordx4 v11, s[12:15], s63 offen lds
s_add_u32 m0, s62, 98304
s_add_u32 s63, s72, 0xc0000
buffer_load_dwordx4 v11, s[12:15], s63 offen lds
s_add_u32 m0, s62, 102400
s_add_u32 s63, s69, 0xc0000
buffer_load_dwordx4 v11, s[12:15], s63 offen lds
s_add_u32 m0, s62, 106496
s_add_u32 s63, s72, 0xd0000
buffer_load_dwordx4 v11, s[12:15], s63 offen lds
s_add_u32 m0, s62, 110592
s_add_u32 s63, s69, 0xd0000
buffer_load_dwordx4 v11, s[12:15], s63 offen lds
s_add_u32 m0, s62, 114688
s_add_u32 s63, s72, 0xe0000
buffer_load_dwordx4 v11, s[12:15], s63 offen lds
s_add_u32 m0, s62, 118784
s_add_u32 s63, s69, 0xe0000
buffer_load_dwordx4 v11, s[12:15], s63 offen lds
s_add_u32 m0, s62, 122880
s_add_u32 s63, s72, 0xf0000
buffer_load_dwordx4 v11, s[12:15], s63 offen lds
s_add_u32 m0, s62, 126976
s_add_u32 s63, s69, 0xf0000
buffer_load_dwordx4 v11, s[12:15], s63 offen lds
s_add_u32 m0, s62, 131072
s_add_u32 s63, s72, 0x100000
buffer_load_dwordx4 v11, s[12:15], s63 offen lds
s_add_u32 m0, s62, 135168
s_add_u32 s63, s69, 0x100000
buffer_load_dwordx4 v11, s[12:15], s63 offen lds
s_add_u32 m0, s62, 139264
s_add_u32 s63, s72, 0x110000
buffer_load_dwordx4 v11, s[12:15], s63 offen lds
s_add_u32 m0, s62, 143360
s_add_u32 s63, s69, 0x110000
buffer_load_dwordx4 v11, s[12:15], s63 offen lds
s_add_u32 m0, s62, 147456
s_add_u32 s63, s72, 0x120000
buffer_load_dwordx4 v11, s[12:15], s63 offen lds
s_add_u32 m0, s62, 151552
s_add_u32 s63, s69, 0x120000
buffer_load_dwordx4 v11, s[12:15], s63 offen lds
s_add_u32 m0, s62, 155648
s_add_u32 s63, s72, 0x130000
buffer_load_dwordx4 v11, s[12:15], s63 offen lds
s_add_u32 m0, s62, 159744
s_add_u32 s63, s69, 0x130000
buffer_load_dwordx4 v11, s[12:15], s63 offen lds
s_waitcnt vmcnt(38) lgkmcnt(0)
s_barrier
ds_read_b64_tr_b16 a[0:1], v8 offset:0
ds_read_b64_tr_b16 a[2:3], v8 offset:2048
ds_read_b64_tr_b16 a[4:5], v8 offset:8
ds_read_b64_tr_b16 a[6:7], v8 offset:2056
s_waitcnt vmcnt(36) lgkmcnt(0)
s_barrier
s_add_u32 m0, s62, 0
s_add_u32 s63, s72, 0x140000
buffer_load_dwordx4 v11, s[12:15], s63 offen lds
s_add_u32 m0, s62, 4096
s_add_u32 s63, s69, 0x140000
buffer_load_dwordx4 v11, s[12:15], s63 offen lds
ds_read_b64_tr_b16 a[8:9], v8 offset:8192
ds_read_b64_tr_b16 a[10:11], v8 offset:10240
ds_read_b64_tr_b16 a[12:13], v8 offset:8200
ds_read_b64_tr_b16 a[14:15], v8 offset:10248
s_waitcnt vmcnt(36) lgkmcnt(0)
s_barrier
s_add_u32 m0, s62, 8192
s_add_u32 s63, s72, 0x150000
buffer_load_dwordx4 v11, s[12:15], s63 offen lds
s_add_u32 m0, s62, 12288
s_add_u32 s63, s69, 0x150000
buffer_load_dwordx4 v11, s[12:15], s63 offen lds
ds_read_b64_tr_b16 a[16:17], v8 offset:16384
ds_read_b64_tr_b16 a[18:19], v8 offset:18432
ds_read_b64_tr_b16 a[20:21], v8 offset:16392
ds_read_b64_tr_b16 a[22:23], v8 offset:18440
s_waitcnt vmcnt(36) lgkmcnt(0)
s_barrier
s_add_u32 m0, s62, 16384
s_add_u32 s63, s72, 0x160000
buffer_load_dwordx4 v11, s[12:15], s63 offen lds
s_add_u32 m0, s62, 20480
s_add_u32 s63, s69, 0x160000
buffer_load_dwordx4 v11, s[12:15], s63 offen lds
ds_read_b64_tr_b16 a[24:25], v8 offset:24576
ds_read_b64_tr_b16 a[26:27], v8 offset:26624
ds_read_b64_tr_b16 a[28:29], v8 offset:24584
ds_read_b64_tr_b16 a[30:31], v8 offset:26632
s_waitcnt vmcnt(36) lgkmcnt(0)
s_barrier
s_add_u32 m0, s62, 24576
s_add_u32 s63, s72, 0x170000
buffer_load_dwordx4 v11, s[12:15], s63 offen lds
s_add_u32 m0, s62, 28672
s_add_u32 s63, s69, 0x170000
buffer_load_dwordx4 v11, s[12:15], s63 offen lds
ds_read_b64_tr_b16 a[32:33], v8 offset:32768
ds_read_b64_tr_b16 a[34:35], v8 offset:34816
ds_read_b64_tr_b16 a[36:37], v8 offset:32776
ds_read_b64_tr_b16 a[38:39], v8 offset:34824
s_waitcnt vmcnt(36) lgkmcnt(0)
s_barrier
s_add_u32 m0, s62, 32768
s_add_u32 s63, s72, 0x180000
buffer_load_dwordx4 v11, s[12:15], s63 offen lds
s_add_u32 m0, s62, 36864
s_add_u32 s63, s69, 0x180000
buffer_load_dwordx4 v11, s[12:15], s63 offen lds
ds_read_b64_tr_b16 a[40:41], v8 offset:40960
ds_read_b64_tr_b16 a[42:43], v8 offset:43008
ds_read_b64_tr_b16 a[44:45], v8 offset:40968
ds_read_b64_tr_b16 a[46:47], v8 offset:43016
s_waitcnt vmcnt(36) lgkmcnt(0)
s_barrier
s_add_u32 m0, s62, 40960
s_add_u32 s63, s72, 0x190000
buffer_load_dwordx4 v11, s[12:15], s63 offen lds
s_add_u32 m0, s62, 45056
s_add_u32 s63, s69, 0x190000
buffer_load_dwordx4 v11, s[12:15], s63 offen lds
ds_read_b64_tr_b16 a[48:49], v8 offset:49152
ds_read_b64_tr_b16 a[50:51], v8 offset:51200
ds_read_b64_tr_b16 a[52:53], v8 offset:49160
ds_read_b64_tr_b16 a[54:55], v8 offset:51208
s_waitcnt vmcnt(36) lgkmcnt(0)
s_barrier
s_add_u32 m0, s62, 49152
s_add_u32 s63, s72, 0x1a0000
buffer_load_dwordx4 v11, s[12:15], s63 offen lds
s_add_u32 m0, s62, 53248
s_add_u32 s63, s69, 0x1a0000
buffer_load_dwordx4 v11, s[12:15], s63 offen lds
ds_read_b64_tr_b16 a[56:57], v8 offset:57344
ds_read_b64_tr_b16 a[58:59], v8 offset:59392
ds_read_b64_tr_b16 a[60:61], v8 offset:57352
ds_read_b64_tr_b16 a[62:63], v8 offset:59400
s_waitcnt vmcnt(36) lgkmcnt(0)
s_barrier
s_add_u32 m0, s62, 57344
s_add_u32 s63, s72, 0x1b0000
buffer_load_dwordx4 v11, s[12:15], s63 offen lds
s_add_u32 m0, s62, 61440
s_add_u32 s63, s69, 0x1b0000
buffer_load_dwordx4 v11, s[12:15], s63 offen lds
ds_read_b64_tr_b16 a[64:65], v9 offset:0
ds_read_b64_tr_b16 a[66:67], v9 offset:2048
ds_read_b64_tr_b16 a[68:69], v9 offset:8
ds_read_b64_tr_b16 a[70:71], v9 offset:2056
s_waitcnt vmcnt(36) lgkmcnt(0)
s_barrier
s_add_u32 m0, s62, 65536
s_add_u32 s63, s72, 0x1c0000
buffer_load_dwordx4 v11, s[12:15], s63 offen lds
s_add_u32 m0, s62, 69632
s_add_u32 s63, s69, 0x1c0000
buffer_load_dwordx4 v11, s[12:15], s63 offen lds
ds_read_b64_tr_b16 a[72:73], v9 offset:8192
ds_read_b64_tr_b16 a[74:75], v9 offset:10240
ds_read_b64_tr_b16 a[76:77], v9 offset:8200
ds_read_b64_tr_b16 a[78:79], v9 offset:10248
s_waitcnt vmcnt(36) lgkmcnt(0)
s_barrier
s_add_u32 m0, s62, 73728
s_add_u32 s63, s72, 0x1d0000
buffer_load_dwordx4 v11, s[12:15], s63 offen lds
s_add_u32 m0, s62, 77824
s_add_u32 s63, s69, 0x1d0000
buffer_load_dwordx4 v11, s[12:15], s63 offen lds
ds_read_b64_tr_b16 a[80:81], v9 offset:16384
ds_read_b64_tr_b16 a[82:83], v9 offset:18432
ds_read_b64_tr_b16 a[84:85], v9 offset:16392
ds_read_b64_tr_b16 a[86:87], v9 offset:18440
s_waitcnt vmcnt(36) lgkmcnt(0)
s_barrier
s_add_u32 m0, s62, 81920
s_add_u32 s63, s72, 0x1e0000
buffer_load_dwordx4 v11, s[12:15], s63 offen lds
s_add_u32 m0, s62, 86016
s_add_u32 s63, s69, 0x1e0000
buffer_load_dwordx4 v11, s[12:15], s63 offen lds
ds_read_b64_tr_b16 a[88:89], v9 offset:24576
ds_read_b64_tr_b16 a[90:91], v9 offset:26624
ds_read_b64_tr_b16 a[92:93], v9 offset:24584
ds_read_b64_tr_b16 a[94:95], v9 offset:26632
s_waitcnt vmcnt(36) lgkmcnt(0)
s_barrier
s_add_u32 m0, s62, 90112
s_add_u32 s63, s72, 0x1f0000
buffer_load_dwordx4 v11, s[12:15], s63 offen lds
s_add_u32 m0, s62, 94208
s_add_u32 s63, s69, 0x1f0000
buffer_load_dwordx4 v11, s[12:15], s63 offen lds
ds_read_b64_tr_b16 a[96:97], v9 offset:32768
ds_read_b64_tr_b16 a[98:99], v9 offset:34816
ds_read_b64_tr_b16 a[100:101], v9 offset:32776
ds_read_b64_tr_b16 a[102:103], v9 offset:34824
s_waitcnt vmcnt(36) lgkmcnt(0)
s_barrier
s_add_u32 m0, s62, 98304
s_add_u32 s63, s72, 0x200000
buffer_load_dwordx4 v11, s[12:15], s63 offen lds
s_add_u32 m0, s62, 102400
s_add_u32 s63, s69, 0x200000
buffer_load_dwordx4 v11, s[12:15], s63 offen lds
ds_read_b64_tr_b16 a[104:105], v9 offset:40960
ds_read_b64_tr_b16 a[106:107], v9 offset:43008
ds_read_b64_tr_b16 a[108:109], v9 offset:40968
ds_read_b64_tr_b16 a[110:111], v9 offset:43016
s_waitcnt vmcnt(36) lgkmcnt(0)
s_barrier
s_add_u32 m0, s62, 106496
s_add_u32 s63, s72, 0x210000
buffer_load_dwordx4 v11, s[12:15], s63 offen lds
s_add_u32 m0, s62, 110592
s_add_u32 s63, s69, 0x210000
buffer_load_dwordx4 v11, s[12:15], s63 offen lds
ds_read_b64_tr_b16 a[112:113], v9 offset:49152
ds_read_b64_tr_b16 a[114:115], v9 offset:51200
ds_read_b64_tr_b16 a[116:117], v9 offset:49160
ds_read_b64_tr_b16 a[118:119], v9 offset:51208
s_waitcnt vmcnt(36) lgkmcnt(0)
s_barrier
s_add_u32 m0, s62, 114688
s_add_u32 s63, s72, 0x220000
buffer_load_dwordx4 v11, s[12:15], s63 offen lds
s_add_u32 m0, s62, 118784
s_add_u32 s63, s69, 0x220000
buffer_load_dwordx4 v11, s[12:15], s63 offen lds
ds_read_b64_tr_b16 a[120:121], v9 offset:57344
ds_read_b64_tr_b16 a[122:123], v9 offset:59392
ds_read_b64_tr_b16 a[124:125], v9 offset:57352
ds_read_b64_tr_b16 a[126:127], v9 offset:59400
s_waitcnt vmcnt(36) lgkmcnt(0)
s_barrier
s_add_u32 m0, s62, 122880
s_add_u32 s63, s72, 0x230000
buffer_load_dwordx4 v11, s[12:15], s63 offen lds
s_add_u32 m0, s62, 126976
s_add_u32 s63, s69, 0x230000
buffer_load_dwordx4 v11, s[12:15], s63 offen lds
ds_read_b64_tr_b16 a[128:129], v10 offset:0
ds_read_b64_tr_b16 a[130:131], v10 offset:2048
ds_read_b64_tr_b16 a[132:133], v10 offset:8
ds_read_b64_tr_b16 a[134:135], v10 offset:2056
s_waitcnt vmcnt(36) lgkmcnt(0)
s_barrier
ds_read_b64_tr_b16 a[136:137], v10 offset:8192
ds_read_b64_tr_b16 a[138:139], v10 offset:10240
ds_read_b64_tr_b16 a[140:141], v10 offset:8200
ds_read_b64_tr_b16 a[142:143], v10 offset:10248
s_waitcnt vmcnt(34) lgkmcnt(0)
s_barrier
ds_read_b64_tr_b16 a[144:145], v10 offset:16384
ds_read_b64_tr_b16 a[146:147], v10 offset:18432
ds_read_b64_tr_b16 a[148:149], v10 offset:16392
ds_read_b64_tr_b16 a[150:151], v10 offset:18440
s_waitcnt vmcnt(32) lgkmcnt(0)
s_barrier
ds_read_b64_tr_b16 a[152:153], v10 offset:24576
ds_read_b64_tr_b16 a[154:155], v10 offset:26624
ds_read_b64_tr_b16 a[156:157], v10 offset:24584
ds_read_b64_tr_b16 a[158:159], v10 offset:26632
s_waitcnt vmcnt(30) lgkmcnt(0)
s_barrier
ds_read_b64_tr_b16 a[160:161], v8 offset:0
ds_read_b64_tr_b16 a[162:163], v8 offset:2048
ds_read_b64_tr_b16 a[164:165], v8 offset:8
ds_read_b64_tr_b16 a[166:167], v8 offset:2056
s_waitcnt vmcnt(28) lgkmcnt(0)
s_barrier
ds_read_b64_tr_b16 a[168:169], v8 offset:8192
ds_read_b64_tr_b16 a[170:171], v8 offset:10240
ds_read_b64_tr_b16 a[172:173], v8 offset:8200
ds_read_b64_tr_b16 a[174:175], v8 offset:10248
s_waitcnt vmcnt(26) lgkmcnt(0)
s_barrier
ds_read_b64_tr_b16 a[176:177], v8 offset:16384
ds_read_b64_tr_b16 a[178:179], v8 offset:18432
ds_read_b64_tr_b16 a[180:181], v8 offset:16392
ds_read_b64_tr_b16 a[182:183], v8 offset:18440
s_waitcnt vmcnt(24) lgkmcnt(0)
s_barrier
ds_read_b64_tr_b16 a[184:185], v8 offset:24576
ds_read_b64_tr_b16 a[186:187], v8 offset:26624
ds_read_b64_tr_b16 a[188:189], v8 offset:24584
ds_read_b64_tr_b16 a[190:191], v8 offset:26632
s_waitcnt vmcnt(22) lgkmcnt(0)
s_barrier
ds_read_b64_tr_b16 a[192:193], v8 offset:32768
ds_read_b64_tr_b16 a[194:195], v8 offset:34816
ds_read_b64_tr_b16 a[196:197], v8 offset:32776
ds_read_b64_tr_b16 a[198:199], v8 offset:34824
s_waitcnt vmcnt(20) lgkmcnt(0)
s_barrier
ds_read_b64_tr_b16 a[200:201], v8 offset:40960
ds_read_b64_tr_b16 a[202:203], v8 offset:43008
ds_read_b64_tr_b16 a[204:205], v8 offset:40968
ds_read_b64_tr_b16 a[206:207], v8 offset:43016
s_waitcnt vmcnt(18) lgkmcnt(0)
s_barrier
ds_read_b64_tr_b16 a[208:209], v8 offset:49152
ds_read_b64_tr_b16 a[210:211], v8 offset:51200
ds_read_b64_tr_b16 a[212:213], v8 offset:49160
ds_read_b64_tr_b16 a[214:215], v8 offset:51208
s_waitcnt vmcnt(16) lgkmcnt(0)
s_barrier
ds_read_b64_tr_b16 a[216:217], v8 offset:57344
ds_read_b64_tr_b16 a[218:219], v8 offset:59392
ds_read_b64_tr_b16 a[220:221], v8 offset:57352
ds_read_b64_tr_b16 a[222:223], v8 offset:59400
s_waitcnt vmcnt(14) lgkmcnt(0)
s_barrier
v_mov_b32 v56, 0
buffer_load_dwordx4 v[48:51], v56, s[20:23], 0 offen offset:128 sc1
buffer_load_dwordx4 v[52:55], v56, s[20:23], 0 offen offset:144 sc1
buffer_load_dword v58, v56, s[20:23], 0 offen offset:160 sc1
ds_read_b64_tr_b16 a[224:225], v9 offset:0
ds_read_b64_tr_b16 a[226:227], v9 offset:2048
ds_read_b64_tr_b16 a[228:229], v9 offset:8
ds_read_b64_tr_b16 a[230:231], v9 offset:2056
s_waitcnt vmcnt(12) lgkmcnt(0)
s_barrier
ds_read_b64_tr_b16 a[232:233], v9 offset:8192
ds_read_b64_tr_b16 a[234:235], v9 offset:10240
ds_read_b64_tr_b16 a[236:237], v9 offset:8200
ds_read_b64_tr_b16 a[238:239], v9 offset:10248
s_waitcnt vmcnt(10) lgkmcnt(0)
s_barrier
ds_read_b64_tr_b16 a[240:241], v9 offset:16384
ds_read_b64_tr_b16 a[242:243], v9 offset:18432
ds_read_b64_tr_b16 a[244:245], v9 offset:16392
ds_read_b64_tr_b16 a[246:247], v9 offset:18440
s_waitcnt vmcnt(8) lgkmcnt(0)
s_barrier
ds_read_b64_tr_b16 a[248:249], v9 offset:24576
ds_read_b64_tr_b16 a[250:251], v9 offset:26624
ds_read_b64_tr_b16 a[252:253], v9 offset:24584
ds_read_b64_tr_b16 a[254:255], v9 offset:26632
s_waitcnt vmcnt(6) lgkmcnt(0)
s_barrier
ds_read_b64_tr_b16 v[192:193], v9 offset:32768
ds_read_b64_tr_b16 v[194:195], v9 offset:34816
ds_read_b64_tr_b16 v[196:197], v9 offset:32776
ds_read_b64_tr_b16 v[198:199], v9 offset:34824
s_waitcnt vmcnt(4) lgkmcnt(0)
s_barrier
ds_read_b64_tr_b16 v[200:201], v9 offset:40960
ds_read_b64_tr_b16 v[202:203], v9 offset:43008
ds_read_b64_tr_b16 v[204:205], v9 offset:40968
ds_read_b64_tr_b16 v[206:207], v9 offset:43016
s_waitcnt vmcnt(2) lgkmcnt(0)
s_barrier
ds_read_b64_tr_b16 v[208:209], v9 offset:49152
ds_read_b64_tr_b16 v[210:211], v9 offset:51200
ds_read_b64_tr_b16 v[212:213], v9 offset:49160
ds_read_b64_tr_b16 v[214:215], v9 offset:51208
s_waitcnt vmcnt(0) lgkmcnt(0)
s_barrier
ds_read_b64_tr_b16 v[216:217], v9 offset:57344
ds_read_b64_tr_b16 v[218:219], v9 offset:59392
ds_read_b64_tr_b16 v[220:221], v9 offset:57352
ds_read_b64_tr_b16 v[222:223], v9 offset:59400
s_waitcnt lgkmcnt(0)
v_lshlrev_b32 v106, 4, v0
s_lshr_b32 s62, s70, 1
v_min_u32 v1, 17, v0
v_add_u32 v1, s62, v1
v_mul_u32_u24 v1, 256, v1
v_add_u32 v113, 53248, v1
v_and_b32 v1, 0xffffe000, v113
v_add_u32 v113, v1, v113
s_lshl_b32 s60, s68, 11
v_add_u32 v112, s60, v106
s_mul_i32 s73, s66, 0x10000
s_add_u32 s73, s73, 0xd000000
v_mov_b32 v56, 0
s_cmp_lg_u32 s100, 0
s_cbranch_scc1 Lws1_78
s_branch Lwsw1_81
Lws_77:
v_mov_b32 v56, 0
buffer_load_dwordx4 v[48:51], v56, s[20:23], 0 offen offset:128 sc1
buffer_load_dwordx4 v[52:55], v56, s[20:23], 0 offen offset:144 sc1
buffer_load_dword v58, v56, s[20:23], 0 offen offset:160 sc1
Lwsw1_81:
s_waitcnt vmcnt(0)
v_readfirstlane_b32 s97, v58
v_add3_u32 v57, v48, v49, v50
v_add3_u32 v57, v57, v51, v52
v_add3_u32 v57, v57, v53, v54
v_add_u32 v57, v57, v55
v_cmp_le_u32 vcc, 0x100, v57
s_nop 0
s_cmp_eq_u64 vcc, -1
s_cbranch_scc0 Lrt_82
v_or3_b32 v57, v48, v49, v50
v_or3_b32 v57, v57, v51, v52
v_or3_b32 v57, v57, v53, v54
v_or_b32 v57, v57, v55
v_cmp_eq_u32 vcc, 256, v57
s_nop 0
s_cmp_eq_u64 vcc, -1
s_cbranch_scc1 Lws2_79
s_branch L_restart
Lws1_78:
buffer_load_dword v48, v56, s[20:23], 0 offen sc1
s_waitcnt vmcnt(0)
v_cmp_le_u32 vcc, 0x100, v48
s_nop 0
s_cmp_eq_u64 vcc, -1
s_cbranch_scc0 Lrt_83
Lws2_79:
s_barrier
s_mov_b32 s62, 0
s_cmp_lg_u32 s100, 0
s_cbranch_scc1 Lnear2_85
s_cmp_lg_u32 s97, 0
s_cbranch_scc1 Lnear3_86
v_mov_b32 v1, 160
Lnear_84:
buffer_load_dword v1, v1, s[20:23], 0 offen sc1
s_waitcnt vmcnt(0)
v_readfirstlane_b32 s97, v1
v_mov_b32 v1, 160
s_cmp_eq_u32 s97, 0
s_cbranch_scc1 Lrt_87
Lnear3_86:
s_and_b32 s62, s97, 2
s_lshl_b32 s62, s62, 12
Lnear2_85:
s_xor_b32 s63, s62, 0x2000
v_add_u32 v110, s63, v110
v_add_u32 v113, s63, v113
s_add_u32 s71, s71, 0x9400000
s_mul_i32 s25, s48, 18432
v_add_u32 v107, s25, v106
s_add_u32 s65, s25, 73728
s_add_u32 s28, s49, 0
s_and_b32 s28, s28, 3
s_mul_i32 s28, s28, 4096
s_add_u32 s29, s49, 1
s_and_b32 s29, s29, 3
s_mul_i32 s29, s29, 4096
s_add_u32 s30, s49, 2
s_and_b32 s30, s30, 3
s_mul_i32 s30, s30, 4096
s_add_u32 s31, s49, 3
s_and_b32 s31, s31, 3
s_mul_i32 s31, s31, 4096
s_lshl_b32 s27, s48, 9
s_add_u32 s27, s27, 147456
v_lshrrev_b32 v120, 2, v106
v_add_u32 v120, 147456, v120
s_cmp_eq_u32 s48, 0
s_cselect_b32 s60, 0, 0x40000000
v_or_b32 v113, s60, v113
s_mov_b32 s53, 0
s_mov_b32 s54, 0
s_mov_b32 s52, 0
v_mov_b32 v104, v106
s_mov_b32 s59, 0x40000000
v_mov_b32 v111, 0
s_mov_b32 s98, 64
s_mov_b32 s99, 0xfffffff1
s_mov_b32 s74, 0x40000000
s_add_u32 s60, s53, 1
s_add_u32 s99, s99, 1
s_cmp_lt_u32 s99, 99
s_cselect_b32 s24, s98, s60
s_cselect_b32 s98, s60, s98
s_branch LWOP_slow
.p2align 6
LWOP_top:
s_waitcnt lgkmcnt(4)
v_mfma_f32_16x16x32_bf16 v[8:11], a[0:3], v[32:35], 0
s_mov_b32 s52, s53
ds_read_b128 v[56:59], v104 offset:6144
s_mov_b32 s53, s24
v_mfma_f32_16x16x32_bf16 v[12:15], a[4:7], v[32:35], 0
s_mov_b32 s10, s51
ds_read_b128 v[60:63], v104 offset:7168
s_mul_i32 s55, s53, 0x40000
v_mfma_f32_16x16x32_bf16 v[20:23], a[4:7], v[36:39], 0
s_add_u32 s55, s55, s71
s_sub_u32 s56, s65, s54
v_add_u32 v105, 0x10000, v104
v_mfma_f32_16x16x32_bf16 v[16:19], a[0:3], v[36:39], 0
s_waitcnt lgkmcnt(4)
s_and_b32 s26, s52, 64
s_lshl_b32 s26, s26, 12
v_mfma_f32_16x16x32_bf16 v[8:11], a[8:11], v[40:43], v[8:11]
s_xor_b32 s27, s27, 2048
ds_read_b128 v[32:35], v104 offset:8192
v_xor_b32 v120, 2048, v120
v_mfma_f32_16x16x32_bf16 v[12:15], a[12:15], v[40:43], v[12:15]
ds_read_b128 v[36:39], v104 offset:9216
v_cvt_pk_bf16_f32 v156, v72, v73
v_mfma_f32_16x16x32_bf16 v[20:23], a[12:15], v[44:47], v[20:23]
v_cvt_pk_bf16_f32 v157, v74, v75
v_cvt_pk_bf16_f32 v158, v76, v77
v_mfma_f32_16x16x32_bf16 v[16:19], a[8:11], v[44:47], v[16:19]
s_waitcnt lgkmcnt(4)
v_cvt_pk_bf16_f32 v159, v78, v79
buffer_store_dwordx4 v[156:159], v112, s[4:7], s74 offen offset:0 sc1
v_mfma_f32_16x16x32_bf16 v[8:11], a[16:19], v[48:51], v[8:11]
ds_read_b128 v[40:43], v104 offset:10240
v_cvt_pk_bf16_f32 v160, v80, v81
v_mfma_f32_16x16x32_bf16 v[12:15], a[20:23], v[48:51], v[12:15]
ds_read_b128 v[44:47], v104 offset:11264
v_cvt_pk_bf16_f32 v161, v82, v83
v_mfma_f32_16x16x32_bf16 v[20:23], a[20:23], v[52:55], v[20:23]
v_cvt_pk_bf16_f32 v162, v84, v85
v_cvt_pk_bf16_f32 v163, v86, v87
v_mfma_f32_16x16x32_bf16 v[16:19], a[16:19], v[52:55], v[16:19]
s_waitcnt lgkmcnt(4)
v_mfma_f32_16x16x32_bf16 v[8:11], a[24:27], v[56:59], v[8:11]
ds_read_b128 v[48:51], v104 offset:12288
buffer_store_dwordx4 v[160:163], v112, s[4:7], s74 offen offset:1024 sc1
v_mfma_f32_16x16x32_bf16 v[12:15], a[28:31], v[56:59], v[12:15]
ds_read_b128 v[52:55], v104 offset:13312
v_mfma_f32_16x16x32_bf16 v[20:23], a[28:31], v[60:63], v[20:23]
v_mfma_f32_16x16x32_bf16 v[16:19], a[24:27], v[60:63], v[16:19]
s_waitcnt lgkmcnt(4)
v_mfma_f32_16x16x32_bf16 v[8:11], a[32:35], v[32:35], v[8:11]
ds_read_b128 v[56:59], v104 offset:14336
v_mfma_f32_16x16x32_bf16 v[12:15], a[36:39], v[32:35], v[12:15]
s_add_u32 m0, s56, s28
ds_read_b128 v[60:63], v104 offset:15360
s_add_u32 s32, s55, s28
v_mfma_f32_16x16x32_bf16 v[20:23], a[36:39], v[36:39], v[20:23]
buffer_load_dwordx4 v107, s[8:11], s32 offen offset:0 sc1 lds
v_mfma_f32_16x16x32_bf16 v[16:19], a[32:35], v[36:39], v[16:19]
s_waitcnt lgkmcnt(4)
v_mfma_f32_16x16x32_bf16 v[8:11], a[40:43], v[40:43], v[8:11]
ds_read_b128 v[32:35], v104 offset:16384
v_mfma_f32_16x16x32_bf16 v[12:15], a[44:47], v[40:43], v[12:15]
ds_read_b128 v[36:39], v104 offset:17408
v_mfma_f32_16x16x32_bf16 v[20:23], a[44:47], v[44:47], v[20:23]
buffer_load_dwordx4 v107, s[8:11], s32 offen offset:1024 sc1 lds
v_mfma_f32_16x16x32_bf16 v[16:19], a[40:43], v[44:47], v[16:19]
s_waitcnt lgkmcnt(4)
v_mfma_f32_16x16x32_bf16 v[8:11], a[48:51], v[48:51], v[8:11]
ds_read_b128 v[40:43], v104 offset:18432
v_mfma_f32_16x16x32_bf16 v[12:15], a[52:55], v[48:51], v[12:15]
ds_read_b128 v[44:47], v104 offset:19456
v_mfma_f32_16x16x32_bf16 v[20:23], a[52:55], v[52:55], v[20:23]
buffer_load_dwordx4 v107, s[8:11], s32 offen offset:2048 sc1 lds
v_mfma_f32_16x16x32_bf16 v[16:19], a[48:51], v[52:55], v[16:19]
s_waitcnt lgkmcnt(4)
v_mfma_f32_16x16x32_bf16 v[8:11], a[56:59], v[56:59], v[8:11]
ds_read_b128 v[48:51], v104 offset:20480
v_mfma_f32_16x16x32_bf16 v[12:15], a[60:63], v[56:59], v[12:15]
ds_read_b128 v[52:55], v104 offset:21504
v_mfma_f32_16x16x32_bf16 v[20:23], a[60:63], v[60:63], v[20:23]
buffer_load_dwordx4 v107, s[8:11], s32 offen offset:3072 sc1 lds
v_mfma_f32_16x16x32_bf16 v[16:19], a[56:59], v[60:63], v[16:19]
s_waitcnt lgkmcnt(4)
v_mfma_f32_16x16x32_bf16 v[8:11], a[64:67], v[32:35], v[8:11]
ds_read_b128 v[56:59], v104 offset:22528
v_mfma_f32_16x16x32_bf16 v[12:15], a[68:71], v[32:35], v[12:15]
ds_read_b128 v[60:63], v104 offset:23552
s_add_u32 m0, s56, 16384
v_mfma_f32_16x16x32_bf16 v[20:23], a[68:71], v[36:39], v[20:23]
s_add_u32 s32, s55, 16384
buffer_load_dwordx4 v107, s[8:11], s32 offen offset:0 sc1 lds
v_mfma_f32_16x16x32_bf16 v[16:19], a[64:67], v[36:39], v[16:19]
s_waitcnt lgkmcnt(4)
v_mfma_f32_16x16x32_bf16 v[8:11], a[72:75], v[40:43], v[8:11]
ds_read_b128 v[32:35], v104 offset:24576
v_mfma_f32_16x16x32_bf16 v[12:15], a[76:79], v[40:43], v[12:15]
ds_read_b128 v[36:39], v104 offset:25600
v_mfma_f32_16x16x32_bf16 v[20:23], a[76:79], v[44:47], v[20:23]
buffer_load_dwordx4 v107, s[8:11], s32 offen offset:1024 sc1 lds
v_mfma_f32_16x16x32_bf16 v[16:19], a[72:75], v[44:47], v[16:19]
s_waitcnt lgkmcnt(4)
v_mfma_f32_16x16x32_bf16 v[8:11], a[80:83], v[48:51], v[8:11]
ds_read_b128 v[40:43], v104 offset:26624
v_mfma_f32_16x16x32_bf16 v[12:15], a[84:87], v[48:51], v[12:15]
ds_read_b128 v[44:47], v104 offset:27648
s_add_u32 m0, s56, s29
v_mfma_f32_16x16x32_bf16 v[20:23], a[84:87], v[52:55], v[20:23]
s_add_u32 s32, s55, s29
buffer_load_dwordx4 v107, s[8:11], s32 offen offset:0 sc1 lds
v_mfma_f32_16x16x32_bf16 v[16:19], a[80:83], v[52:55], v[16:19]
s_waitcnt lgkmcnt(4)
v_mfma_f32_16x16x32_bf16 v[8:11], a[88:91], v[56:59], v[8:11]
ds_read_b128 v[48:51], v104 offset:28672
v_mfma_f32_16x16x32_bf16 v[12:15], a[92:95], v[56:59], v[12:15]
ds_read_b128 v[52:55], v104 offset:29696
v_mfma_f32_16x16x32_bf16 v[20:23], a[92:95], v[60:63], v[20:23]
buffer_load_dwordx4 v107, s[8:11], s32 offen offset:1024 sc1 lds
v_mfma_f32_16x16x32_bf16 v[16:19], a[88:91], v[60:63], v[16:19]
s_waitcnt lgkmcnt(4)
v_mfma_f32_16x16x32_bf16 v[8:11], a[96:99], v[32:35], v[8:11]
ds_read_b128 v[56:59], v104 offset:30720
v_mfma_f32_16x16x32_bf16 v[12:15], a[100:103], v[32:35], v[12:15]
ds_read_b128 v[60:63], v104 offset:31744
v_mfma_f32_16x16x32_bf16 v[20:23], a[100:103], v[36:39], v[20:23]
buffer_load_dwordx4 v107, s[8:11], s32 offen offset:2048 sc1 lds
v_mfma_f32_16x16x32_bf16 v[16:19], a[96:99], v[36:39], v[16:19]
s_waitcnt lgkmcnt(4)
v_mfma_f32_16x16x32_bf16 v[8:11], a[104:107], v[40:43], v[8:11]
ds_read_b128 v[32:35], v104 offset:32768
v_mfma_f32_16x16x32_bf16 v[12:15], a[108:111], v[40:43], v[12:15]
ds_read_b128 v[36:39], v104 offset:33792
v_mfma_f32_16x16x32_bf16 v[20:23], a[108:111], v[44:47], v[20:23]
buffer_load_dwordx4 v107, s[8:11], s32 offen offset:3072 sc1 lds
v_mfma_f32_16x16x32_bf16 v[16:19], a[104:107], v[44:47], v[16:19]
s_waitcnt lgkmcnt(4)
v_mfma_f32_16x16x32_bf16 v[8:11], a[112:115], v[48:51], v[8:11]
ds_read_b128 v[40:43], v104 offset:34816
v_mfma_f32_16x16x32_bf16 v[12:15], a[116:119], v[48:51], v[12:15]
ds_read_b128 v[44:47], v104 offset:35840
s_add_u32 m0, s56, s30
v_mfma_f32_16x16x32_bf16 v[20:23], a[116:119], v[52:55], v[20:23]
s_add_u32 s32, s55, s30
buffer_load_dwordx4 v107, s[8:11], s32 offen offset:0 sc1 lds
v_mfma_f32_16x16x32_bf16 v[16:19], a[112:115], v[52:55], v[16:19]
s_waitcnt lgkmcnt(4)
v_mfma_f32_16x16x32_bf16 v[8:11], a[120:123], v[56:59], v[8:11]
ds_read_b128 v[48:51], v104 offset:36864
v_mfma_f32_16x16x32_bf16 v[12:15], a[124:127], v[56:59], v[12:15]
ds_read_b128 v[52:55], v104 offset:37888
v_mfma_f32_16x16x32_bf16 v[20:23], a[124:127], v[60:63], v[20:23]
buffer_load_dwordx4 v107, s[8:11], s32 offen offset:1024 sc1 lds
s_waitcnt vmcnt(12)
v_mfma_f32_16x16x32_bf16 v[16:19], a[120:123], v[60:63], v[16:19]
s_waitcnt lgkmcnt(4)
s_barrier
v_mfma_f32_16x16x32_bf16 v[8:11], a[128:131], v[32:35], v[8:11]
ds_read_b128 v[56:59], v104 offset:38912
v_mfma_f32_16x16x32_bf16 v[12:15], a[132:135], v[32:35], v[12:15]
ds_read_b128 v[60:63], v104 offset:39936
v_mfma_f32_16x16x32_bf16 v[20:23], a[132:135], v[36:39], v[20:23]
buffer_store_dword v111, v110, s[4:7], s59 offen sc1
v_mfma_f32_16x16x32_bf16 v[16:19], a[128:131], v[36:39], v[16:19]
s_waitcnt lgkmcnt(4)
v_mfma_f32_16x16x32_bf16 v[8:11], a[136:139], v[40:43], v[8:11]
ds_read_b128 v[32:35], v104 offset:40960
v_mfma_f32_16x16x32_bf16 v[12:15], a[140:143], v[40:43], v[12:15]
ds_read_b128 v[36:39], v104 offset:41984
v_mfma_f32_16x16x32_bf16 v[20:23], a[140:143], v[44:47], v[20:23]
buffer_load_dwordx4 v107, s[8:11], s32 offen offset:2048 sc1 lds
v_mfma_f32_16x16x32_bf16 v[16:19], a[136:139], v[44:47], v[16:19]
s_waitcnt lgkmcnt(4)
v_mfma_f32_16x16x32_bf16 v[8:11], a[144:147], v[48:51], v[8:11]
ds_read_b128 v[40:43], v104 offset:43008
v_mfma_f32_16x16x32_bf16 v[12:15], a[148:151], v[48:51], v[12:15]
ds_read_b128 v[44:47], v104 offset:44032
v_mfma_f32_16x16x32_bf16 v[20:23], a[148:151], v[52:55], v[20:23]
buffer_load_dwordx4 v107, s[8:11], s32 offen offset:3072 sc1 lds
v_mfma_f32_16x16x32_bf16 v[16:19], a[144:147], v[52:55], v[16:19]
s_waitcnt lgkmcnt(4)
v_mfma_f32_16x16x32_bf16 v[8:11], a[152:155], v[56:59], v[8:11]
ds_read_b128 v[48:51], v104 offset:45056
v_mfma_f32_16x16x32_bf16 v[12:15], a[156:159], v[56:59], v[12:15]
ds_read_b128 v[52:55], v104 offset:46080
s_add_u32 m0, s56, s31
v_mfma_f32_16x16x32_bf16 v[20:23], a[156:159], v[60:63], v[20:23]
s_add_u32 s32, s55, s31
buffer_load_dwordx4 v107, s[8:11], s32 offen offset:0 sc1 lds
v_mfma_f32_16x16x32_bf16 v[16:19], a[152:155], v[60:63], v[16:19]
s_waitcnt lgkmcnt(4)
v_mfma_f32_16x16x32_bf16 v[8:11], a[160:163], v[32:35], v[8:11]
ds_read_b128 v[56:59], v104 offset:47104
v_mfma_f32_16x16x32_bf16 v[12:15], a[164:167], v[32:35], v[12:15]
ds_read_b128 v[60:63], v104 offset:48128
v_mfma_f32_16x16x32_bf16 v[20:23], a[164:167], v[36:39], v[20:23]
buffer_load_dwordx4 v107, s[8:11], s32 offen offset:1024 sc1 lds
v_mfma_f32_16x16x32_bf16 v[16:19], a[160:163], v[36:39], v[16:19]
s_waitcnt lgkmcnt(4)
v_mfma_f32_16x16x32_bf16 v[8:11], a[168:171], v[40:43], v[8:11]
ds_read_b128 v[32:35], v104 offset:49152
v_mfma_f32_16x16x32_bf16 v[12:15], a[172:175], v[40:43], v[12:15]
ds_read_b128 v[36:39], v104 offset:50176
v_mfma_f32_16x16x32_bf16 v[20:23], a[172:175], v[44:47], v[20:23]
buffer_load_dwordx4 v107, s[8:11], s32 offen offset:2048 sc1 lds
v_mfma_f32_16x16x32_bf16 v[16:19], a[168:171], v[44:47], v[16:19]
s_waitcnt lgkmcnt(4)
v_mfma_f32_16x16x32_bf16 v[8:11], a[176:179], v[48:51], v[8:11]
ds_read_b128 v[40:43], v104 offset:51200
v_mfma_f32_16x16x32_bf16 v[12:15], a[180:183], v[48:51], v[12:15]
ds_read_b128 v[44:47], v104 offset:52224
v_mfma_f32_16x16x32_bf16 v[20:23], a[180:183], v[52:55], v[20:23]
buffer_load_dwordx4 v107, s[8:11], s32 offen offset:3072 sc1 lds
v_mfma_f32_16x16x32_bf16 v[16:19], a[176:179], v[52:55], v[16:19]
s_waitcnt lgkmcnt(4)
v_mfma_f32_16x16x32_bf16 v[8:11], a[184:187], v[56:59], v[8:11]
s_add_u32 s60, s53, 1
ds_read_b128 v[48:51], v104 offset:53248
s_add_u32 s99, s99, 1
v_mfma_f32_16x16x32_bf16 v[12:15], a[188:191], v[56:59], v[12:15]
s_cmp_lt_u32 s99, 99
ds_read_b128 v[52:55], v104 offset:54272
s_cselect_b32 s24, s98, s60
v_mfma_f32_16x16x32_bf16 v[20:23], a[188:191], v[60:63], v[20:23]
s_cselect_b32 s98, s60, s98
s_mov_b32 m0, s27
s_cmp_lt_u32 s24, 64
v_mfma_f32_16x16x32_bf16 v[16:19], a[184:187], v[60:63], v[16:19]
s_waitcnt lgkmcnt(4)
s_cselect_b32 s58, 0, 0x40000
buffer_load_dword v113, s[4:7], s58 offen sc1 lds
v_mfma_f32_16x16x32_bf16 v[8:11], a[192:195], v[32:35], v[8:11]
ds_read_b128 v[56:59], v104 offset:55296
v_mfma_f32_16x16x32_bf16 v[12:15], a[196:199], v[32:35], v[12:15]
ds_read_b128 v[60:63], v104 offset:56320
v_mfma_f32_16x16x32_bf16 v[20:23], a[196:199], v[36:39], v[20:23]
v_mfma_f32_16x16x32_bf16 v[16:19], a[192:195], v[36:39], v[16:19]
s_waitcnt lgkmcnt(4)
v_mfma_f32_16x16x32_bf16 v[8:11], a[200:203], v[40:43], v[8:11]
ds_read_b128 v[32:35], v104 offset:57344
v_mfma_f32_16x16x32_bf16 v[12:15], a[204:207], v[40:43], v[12:15]
ds_read_b128 v[36:39], v104 offset:58368
v_mfma_f32_16x16x32_bf16 v[20:23], a[204:207], v[44:47], v[20:23]
v_mfma_f32_16x16x32_bf16 v[16:19], a[200:203], v[44:47], v[16:19]
s_waitcnt lgkmcnt(4)
v_mfma_f32_16x16x32_bf16 v[8:11], a[208:211], v[48:51], v[8:11]
ds_read_b128 v[40:43], v104 offset:59392
v_mfma_f32_16x16x32_bf16 v[12:15], a[212:215], v[48:51], v[12:15]
ds_read_b128 v[44:47], v104 offset:60416
v_mfma_f32_16x16x32_bf16 v[20:23], a[212:215], v[52:55], v[20:23]
v_mfma_f32_16x16x32_bf16 v[16:19], a[208:211], v[52:55], v[16:19]
s_waitcnt lgkmcnt(4)
v_mfma_f32_16x16x32_bf16 v[8:11], a[216:219], v[56:59], v[8:11]
ds_read_b128 v[48:51], v104 offset:61440
v_mfma_f32_16x16x32_bf16 v[12:15], a[220:223], v[56:59], v[12:15]
ds_read_b128 v[52:55], v104 offset:62464
v_mfma_f32_16x16x32_bf16 v[20:23], a[220:223], v[60:63], v[20:23]
v_mfma_f32_16x16x32_bf16 v[16:19], a[216:219], v[60:63], v[16:19]
s_waitcnt lgkmcnt(4)
v_mfma_f32_16x16x32_bf16 v[8:11], a[224:227], v[32:35], v[8:11]
ds_read_b128 v[56:59], v104 offset:63488
v_mfma_f32_16x16x32_bf16 v[12:15], a[228:231], v[32:35], v[12:15]
ds_read_b128 v[60:63], v104 offset:64512
v_mfma_f32_16x16x32_bf16 v[20:23], a[228:231], v[36:39], v[20:23]
v_mfma_f32_16x16x32_bf16 v[16:19], a[224:227], v[36:39], v[16:19]
s_waitcnt lgkmcnt(4)
v_mfma_f32_16x16x32_bf16 v[8:11], a[232:235], v[40:43], v[8:11]
ds_read_b128 v[32:35], v105 offset:0
v_mfma_f32_16x16x32_bf16 v[12:15], a[236:239], v[40:43], v[12:15]
ds_read_b128 v[36:39], v105 offset:1024
v_mfma_f32_16x16x32_bf16 v[20:23], a[236:239], v[44:47], v[20:23]
v_mfma_f32_16x16x32_bf16 v[16:19], a[232:235], v[44:47], v[16:19]
s_waitcnt lgkmcnt(4)
v_mfma_f32_16x16x32_bf16 v[8:11], a[240:243], v[48:51], v[8:11]
ds_read_b128 v[40:43], v105 offset:2048
v_mfma_f32_16x16x32_bf16 v[12:15], a[244:247], v[48:51], v[12:15]
ds_read_b128 v[44:47], v105 offset:3072
v_mfma_f32_16x16x32_bf16 v[20:23], a[244:247], v[52:55], v[20:23]
v_mfma_f32_16x16x32_bf16 v[16:19], a[240:243], v[52:55], v[16:19]
s_waitcnt lgkmcnt(4)
s_mul_i32 s74, s52, 0x30000
s_add_u32 s74, s74, s73
v_mfma_f32_16x16x32_bf16 v[8:11], a[248:251], v[56:59], v[8:11]
ds_read_b128 v[48:51], v105 offset:4096
v_mfma_f32_16x16x32_bf16 v[12:15], a[252:255], v[56:59], v[12:15]
s_add_u32 s60, s52, 1
ds_read_b128 v[52:55], v105 offset:5120
s_mov_b32 s59, s26
v_mfma_f32_16x16x32_bf16 v[20:23], a[252:255], v[60:63], v[20:23]
v_mov_b32 v111, s60
v_mfma_f32_16x16x32_bf16 v[16:19], a[248:251], v[60:63], v[16:19]
s_waitcnt lgkmcnt(4)
v_mfma_f32_16x16x32_bf16 v[8:11], v[192:195], v[32:35], v[8:11]
ds_read_b128 v[56:59], v105 offset:6144
v_mfma_f32_16x16x32_bf16 v[12:15], v[196:199], v[32:35], v[12:15]
ds_read_b128 v[60:63], v105 offset:7168
v_mfma_f32_16x16x32_bf16 v[20:23], v[196:199], v[36:39], v[20:23]
v_mfma_f32_16x16x32_bf16 v[16:19], v[192:195], v[36:39], v[16:19]
s_waitcnt lgkmcnt(4)
v_mfma_f32_16x16x32_bf16 v[8:11], v[200:203], v[40:43], v[8:11]
s_sub_u32 s54, 73728, s54
v_add_u32 v104, s54, v106
v_mfma_f32_16x16x32_bf16 v[12:15], v[204:207], v[40:43], v[12:15]
v_mfma_f32_16x16x32_bf16 v[20:23], v[204:207], v[44:47], v[20:23]
v_mfma_f32_16x16x32_bf16 v[16:19], v[200:203], v[44:47], v[16:19]
s_waitcnt lgkmcnt(0)
s_waitcnt vmcnt(0)
s_barrier
v_mfma_f32_16x16x32_bf16 v[8:11], v[208:211], v[48:51], v[8:11]
s_nop 0
ds_read_b32 v108, v120
ds_read_b128 v[32:35], v104 offset:0
v_mfma_f32_16x16x32_bf16 v[12:15], v[212:215], v[48:51], v[12:15]
ds_read_b128 v[36:39], v104 offset:1024
ds_read_b128 v[40:43], v104 offset:2048
v_mfma_f32_16x16x32_bf16 v[20:23], v[212:215], v[52:55], v[20:23]
ds_read_b128 v[44:47], v104 offset:3072
v_mfma_f32_16x16x32_bf16 v[16:19], v[208:211], v[52:55], v[16:19]
v_mfma_f32_16x16x32_bf16 v[72:75], v[216:219], v[56:59], v[8:11]
s_waitcnt lgkmcnt(4)
ds_read_b128 v[48:51], v104 offset:4096
v_cmp_lt_u32 vcc, s24, v108
v_mfma_f32_16x16x32_bf16 v[76:79], v[220:223], v[56:59], v[12:15]
s_cmp_eq_u64 vcc, -1
ds_read_b128 v[52:55], v104 offset:5120
s_cselect_b32 s51, 0x10000000, 0
v_mfma_f32_16x16x32_bf16 v[84:87], v[220:223], v[60:63], v[20:23]
s_add_u32 s61, s53, 1
s_cmp_eq_u32 s61, s24
s_cselect_b32 s57, -1, s51
v_mfma_f32_16x16x32_bf16 v[80:83], v[216:219], v[60:63], v[16:19]
s_and_b32 s57, s57, s10
s_cbranch_scc1 LWOP_top
v_cvt_pk_bf16_f32 v156, v72, v73
v_cvt_pk_bf16_f32 v157, v74, v75
v_cvt_pk_bf16_f32 v158, v76, v77
v_cvt_pk_bf16_f32 v159, v78, v79
buffer_store_dwordx4 v[156:159], v112, s[4:7], s74 offen offset:0 sc1
s_nop 0
v_cvt_pk_bf16_f32 v160, v80, v81
v_cvt_pk_bf16_f32 v161, v82, v83
v_cvt_pk_bf16_f32 v162, v84, v85
v_cvt_pk_bf16_f32 v163, v86, v87
buffer_store_dwordx4 v[160:163], v112, s[4:7], s74 offen offset:1024 sc1
s_mov_b32 s74, 0x40000000
s_cmp_lg_u32 s10, 0
s_cbranch_scc1 Lsc_89
s_xor_b32 s27, s27, 2048
v_xor_b32 v120, 2048, v120
s_min_u32 s61, s24, 127
s_xor_b32 s61, s61, s53
s_cmp_ge_u32 s61, 64
s_cbranch_scc1 Lnomed_96
v_cmp_lt_u32 vcc, s53, v108
s_nop 0
s_cmp_eq_u64 vcc, -1
s_cbranch_scc1 Lmed_95
Lnomed_96:
s_mov_b32 m0, s27
s_cmp_lt_u32 s53, 64
s_cselect_b32 s58, 0, 0x40000
buffer_load_dword v113, s[4:7], s58 offen sc1 lds
s_mul_i32 s55, s53, 0x40000
s_add_u32 s55, s55, s71
s_add_u32 s56, s25, s54
s_waitcnt vmcnt(0) lgkmcnt(0)
s_barrier
ds_read_b32 v108, v120
buffer_store_dword v111, v110, s[4:7], s59 offen sc1
s_cmp_ge_u32 s53, 128
s_cbranch_scc1 LWOP_exit
s_xor_b32 s27, s27, 2048
v_xor_b32 v120, 2048, v120
s_waitcnt lgkmcnt(0)
v_cmp_lt_u32 vcc, s53, v108
s_nop 0
s_cmp_eq_u64 vcc, -1
s_cbranch_scc1 Lgo_88
LWOP_slow:
s_and_b32 s58, s53, 64
s_lshl_b32 s58, s58, 12
s_mul_i32 s55, s53, 0x40000
s_add_u32 s55, s55, s71
s_add_u32 s56, s25, s54
s_cmp_lg_u32 s48, 0
s_cbranch_scc1 Lspd_98
Lsp_97:
buffer_load_dword v108, v113, s[4:7], s58 offen sc1
s_waitcnt vmcnt(0)
v_cmp_lt_u32 vcc, s53, v108
s_nop 0
s_cmp_eq_u64 vcc, -1
s_cbranch_scc0 Lrt_99
Lspd_98:
s_barrier
Lgo_88:
s_mov_b32 m0, s27
s_cmp_lt_u32 s24, 64
s_cselect_b32 s58, 0, 0x40000
buffer_load_dword v113, s[4:7], s58 offen sc1 lds
s_lshl_b32 s61, s48, 10
s_add_u32 s55, s55, s61
s_add_u32 s56, s54, s61
s_add_u32 m0, s56, 0
s_add_u32 s32, s55, 0
buffer_load_dwordx4 v106, s[4:7], s32 offen sc1 lds
s_add_u32 m0, s56, 4096
s_add_u32 s32, s55, 4096
buffer_load_dwordx4 v106, s[4:7], s32 offen sc1 lds
s_add_u32 m0, s56, 8192
s_add_u32 s32, s55, 8192
buffer_load_dwordx4 v106, s[4:7], s32 offen sc1 lds
s_add_u32 m0, s56, 12288
s_add_u32 s32, s55, 12288
buffer_load_dwordx4 v106, s[4:7], s32 offen sc1 lds
s_add_u32 m0, s56, 16384
s_add_u32 s32, s55, 16384
buffer_load_dwordx4 v106, s[4:7], s32 offen sc1 lds
s_add_u32 m0, s56, 20480
s_add_u32 s32, s55, 20480
buffer_load_dwordx4 v106, s[4:7], s32 offen sc1 lds
s_add_u32 m0, s56, 24576
s_add_u32 s32, s55, 24576
buffer_load_dwordx4 v106, s[4:7], s32 offen sc1 lds
s_add_u32 m0, s56, 28672
s_add_u32 s32, s55, 28672
buffer_load_dwordx4 v106, s[4:7], s32 offen sc1 lds
s_add_u32 m0, s56, 32768
s_add_u32 s32, s55, 32768
buffer_load_dwordx4 v106, s[4:7], s32 offen sc1 lds
s_add_u32 m0, s56, 36864
s_add_u32 s32, s55, 36864
buffer_load_dwordx4 v106, s[4:7], s32 offen sc1 lds
s_add_u32 m0, s56, 40960
s_add_u32 s32, s55, 40960
buffer_load_dwordx4 v106, s[4:7], s32 offen sc1 lds
s_add_u32 m0, s56, 45056
s_add_u32 s32, s55, 45056
buffer_load_dwordx4 v106, s[4:7], s32 offen sc1 lds
s_add_u32 m0, s56, 49152
s_add_u32 s32, s55, 49152
buffer_load_dwordx4 v106, s[4:7], s32 offen sc1 lds
s_add_u32 m0, s56, 53248
s_add_u32 s32, s55, 53248
buffer_load_dwordx4 v106, s[4:7], s32 offen sc1 lds
s_add_u32 m0, s56, 57344
s_add_u32 s32, s55, 57344
buffer_load_dwordx4 v106, s[4:7], s32 offen sc1 lds
s_add_u32 m0, s56, 61440
s_add_u32 s32, s55, 61440
buffer_load_dwordx4 v106, s[4:7], s32 offen sc1 lds
s_add_u32 m0, s56, 65536
s_add_u32 s32, s55, 65536
buffer_load_dwordx4 v106, s[4:7], s32 offen sc1 lds
s_add_u32 m0, s56, 69632
s_add_u32 s32, s55, 69632
buffer_load_dwordx4 v106, s[4:7], s32 offen sc1 lds
s_waitcnt vmcnt(8)
Lrd_93:
s_barrier
Lrd2_94:
ds_read_b32 v108, v120
ds_read_b128 v[32:35], v104 offset:0
ds_read_b128 v[36:39], v104 offset:1024
ds_read_b128 v[40:43], v104 offset:2048
ds_read_b128 v[44:47], v104 offset:3072
ds_read_b128 v[48:51], v104 offset:4096
ds_read_b128 v[52:55], v104 offset:5120
s_waitcnt lgkmcnt(6)
v_cmp_lt_u32 vcc, s24, v108
s_nop 0
s_cmp_eq_u64 vcc, -1
s_cselect_b32 s51, 0x10000000, 0
s_branch LWOP_top
LWOP_exit:
s_waitcnt vmcnt(0)
s_endpgm
Lrt_82:
s_add_u32 s96, s96, 1
s_cmp_lt_u32 s96, 1048576
s_cbranch_scc1 Lws_77
s_mov_b32 s97, 1
s_branch L_fail
Lrt_83:
s_add_u32 s96, s96, 1
s_cmp_lt_u32 s96, 1048576
s_cbranch_scc1 Lws1_78
s_mov_b32 s97, 1
s_branch L_fail
Lrt_87:
s_add_u32 s96, s96, 1
s_cmp_lt_u32 s96, 1048576
s_cbranch_scc1 Lnear_84
s_mov_b32 s97, 24
s_branch L_fail
Lrt_92:
s_add_u32 s96, s96, 1
s_cmp_lt_u32 s96, 1048576
s_cbranch_scc1 Lsp_90
s_mov_b32 s97, 5
s_branch L_fail
Lsc_89:
s_xor_b32 s27, s27, 2048
v_xor_b32 v120, 2048, v120
s_mov_b32 m0, s27
s_cmp_lt_u32 s24, 64
s_cselect_b32 s58, 0, 0x40000
buffer_load_dword v113, s[4:7], s58 offen sc1 lds
s_waitcnt vmcnt(0) lgkmcnt(0)
s_barrier
ds_read_b32 v108, v120
buffer_store_dword v111, v110, s[4:7], s59 offen sc1
s_mov_b32 s51, 0x10000000
s_waitcnt lgkmcnt(0)
v_cmp_lt_u32 vcc, s24, v108
s_nop 0
s_cmp_eq_u64 vcc, -1
s_cbranch_scc1 LWOP_top
s_cmp_lg_u32 s48, 0
s_cbranch_scc1 Lspd_91
Lsp_90:
buffer_load_dword v108, v113, s[4:7], s58 offen sc1
s_waitcnt vmcnt(0)
v_cmp_lt_u32 vcc, s24, v108
s_nop 0
s_cmp_eq_u64 vcc, -1
s_cbranch_scc0 Lrt_92
Lspd_91:
s_barrier
s_branch LWOP_top
Lmed_95:
s_mul_i32 s55, s53, 0x40000
s_add_u32 s55, s55, s71
s_add_u32 s56, s25, s54
s_add_u32 m0, s56, s28
s_add_u32 s32, s55, s28
buffer_load_dwordx4 v107, s[4:7], s32 offen offset:0 sc1 lds
buffer_load_dwordx4 v107, s[4:7], s32 offen offset:1024 sc1 lds
buffer_load_dwordx4 v107, s[4:7], s32 offen offset:2048 sc1 lds
buffer_load_dwordx4 v107, s[4:7], s32 offen offset:3072 sc1 lds
s_add_u32 m0, s56, 16384
s_add_u32 s32, s55, 16384
buffer_load_dwordx4 v107, s[4:7], s32 offen offset:0 sc1 lds
buffer_load_dwordx4 v107, s[4:7], s32 offen offset:1024 sc1 lds
s_add_u32 m0, s56, s29
s_add_u32 s32, s55, s29
buffer_load_dwordx4 v107, s[4:7], s32 offen offset:0 sc1 lds
buffer_load_dwordx4 v107, s[4:7], s32 offen offset:1024 sc1 lds
buffer_load_dwordx4 v107, s[4:7], s32 offen offset:2048 sc1 lds
buffer_load_dwordx4 v107, s[4:7], s32 offen offset:3072 sc1 lds
s_add_u32 m0, s56, s30
s_add_u32 s32, s55, s30
buffer_load_dwordx4 v107, s[4:7], s32 offen offset:0 sc1 lds
buffer_load_dwordx4 v107, s[4:7], s32 offen offset:1024 sc1 lds
buffer_load_dwordx4 v107, s[4:7], s32 offen offset:2048 sc1 lds
buffer_load_dwordx4 v107, s[4:7], s32 offen offset:3072 sc1 lds
s_add_u32 m0, s56, s31
s_add_u32 s32, s55, s31
buffer_load_dwordx4 v107, s[4:7], s32 offen offset:0 sc1 lds
buffer_load_dwordx4 v107, s[4:7], s32 offen offset:1024 sc1 lds
buffer_load_dwordx4 v107, s[4:7], s32 offen offset:2048 sc1 lds
buffer_load_dwordx4 v107, s[4:7], s32 offen offset:3072 sc1 lds
s_mov_b32 m0, s27
s_cmp_lt_u32 s24, 64
s_cselect_b32 s58, 0, 0x40000
buffer_load_dword v113, s[4:7], s58 offen sc1 lds
s_waitcnt vmcnt(19) lgkmcnt(0)
s_barrier
buffer_store_dword v111, v110, s[4:7], s59 offen sc1
s_waitcnt vmcnt(1)
s_branch Lrd_93
Lrt_99:
s_add_u32 s96, s96, 1
s_cmp_lt_u32 s96, 1048576
s_cbranch_scc1 Lsp_97
s_mov_b32 s97, 5
s_branch L_fail
L_WOF:
s_mov_b32 s12, s34
s_and_b32 s13, s35, 0xffff
s_mov_b32 s14, 0x800000
s_mov_b32 s15, 0x20000
s_mov_b32 s66, 3
s_mov_b32 s67, s49
s_lshl_b32 s68, s67, 2
s_add_u32 s68, s68, s48
s_mul_i32 s70, s66, 36
s_lshl_b32 s71, s70, 11
s_mul_i32 s60, s67, 256
s_add_u32 s60, s60, 2048
s_and_b32 s61, s60, 0xffffe000
s_add_u32 s60, s60, s61
v_mov_b32 v110, s60
v_mov_b32 v1, 0x40000000
v_cmp_gt_u32 vcc, 1, v0
s_nop 1
v_cndmask_b32 v110, v1, v110, vcc
s_cmp_eq_u32 s48, 1
s_cselect_b32 s60, 0, 0x40000000
v_or_b32 v110, s60, v110
v_mov_b32 v1, 0
s_mov_b32 s60, 0x0
buffer_store_dword v1, v110, s[4:7], s60 offen sc1
s_mov_b32 s60, 0x2000
buffer_store_dword v1, v110, s[4:7], s60 offen sc1
s_mov_b32 s60, 0x40000
buffer_store_dword v1, v110, s[4:7], s60 offen sc1
s_mov_b32 s60, 0x42000
buffer_store_dword v1, v110, s[4:7], s60 offen sc1
s_waitcnt vmcnt(0)
s_barrier
s_cmp_lg_u32 s48, 0
s_cbranch_scc1 Larr_100
s_mov_b32 s60, 0
v_mov_b32 v2, s60
v_mov_b32 v1, 0x40000000
v_cmp_gt_u32 vcc, 1, v0
s_nop 1
v_cndmask_b32 v2, v1, v2, vcc
s_sub_u32 s61, s101, s2
s_and_b32 s61, s61, 7
s_lshl_b32 s61, s61, 2
s_add_u32 s61, s61, 128
s_cmp_eq_u32 s100, 0
s_cselect_b32 s61, s61, 0
v_mov_b32 v3, 1
buffer_atomic_add v3, v2, s[20:23], s61 offen sc1
Larr_100:
s_lshr_b32 s61, s48, 1
s_lshl_b32 s61, s61, 12
s_and_b32 s60, s48, 1
s_lshl_b32 s60, s60, 6
s_add_u32 s61, s61, s60
v_lshrrev_b32 v1, 4, v0
v_bfe_u32 v2, v0, 2, 2
v_and_b32 v3, 3, v0
v_mul_u32_u24 v1, 4, v1
v_add_u32 v1, v1, v2
v_mul_u32_u24 v1, 128, v1
v_mul_u32_u24 v3, 16, v3
v_add3_u32 v8, v1, v3, s61
s_lshl_b32 s72, s70, 16
s_lshl_b32 s60, s67, 8
s_add_u32 s72, s72, s60
s_add_u32 s69, s72, 128
v_lshrrev_b32 v1, 3, v0
s_lshl_b32 s60, s48, 3
v_add_u32 v1, s60, v1
v_mul_u32_u24 v1, 2048, v1
v_and_b32 v2, 7, v0
v_lshlrev_b32 v2, 4, v2
v_add_u32 v11, v1, v2
v_add_u32 v9, 65536, v8
v_add_u32 v10, 131072, v8
s_lshl_b32 s62, s48, 10
s_add_u32 m0, s62, 0
s_add_u32 s63, s72, 0x0
buffer_load_dwordx4 v11, s[12:15], s63 offen lds
s_add_u32 m0, s62, 4096
s_add_u32 s63, s69, 0x0
buffer_load_dwordx4 v11, s[12:15], s63 offen lds
s_add_u32 m0, s62, 8192
s_add_u32 s63, s72, 0x10000
buffer_load_dwordx4 v11, s[12:15], s63 offen lds
s_add_u32 m0, s62, 12288
s_add_u32 s63, s69, 0x10000
buffer_load_dwordx4 v11, s[12:15], s63 offen lds
s_add_u32 m0, s62, 16384
s_add_u32 s63, s72, 0x20000
buffer_load_dwordx4 v11, s[12:15], s63 offen lds
s_add_u32 m0, s62, 20480
s_add_u32 s63, s69, 0x20000
buffer_load_dwordx4 v11, s[12:15], s63 offen lds
s_add_u32 m0, s62, 24576
s_add_u32 s63, s72, 0x30000
buffer_load_dwordx4 v11, s[12:15], s63 offen lds
s_add_u32 m0, s62, 28672
s_add_u32 s63, s69, 0x30000
buffer_load_dwordx4 v11, s[12:15], s63 offen lds
s_add_u32 m0, s62, 32768
s_add_u32 s63, s72, 0x40000
buffer_load_dwordx4 v11, s[12:15], s63 offen lds
s_add_u32 m0, s62, 36864
s_add_u32 s63, s69, 0x40000
buffer_load_dwordx4 v11, s[12:15], s63 offen lds
s_add_u32 m0, s62, 40960
s_add_u32 s63, s72, 0x50000
buffer_load_dwordx4 v11, s[12:15], s63 offen lds
s_add_u32 m0, s62, 45056
s_add_u32 s63, s69, 0x50000
buffer_load_dwordx4 v11, s[12:15], s63 offen lds
s_add_u32 m0, s62, 49152
s_add_u32 s63, s72, 0x60000
buffer_load_dwordx4 v11, s[12:15], s63 offen lds
s_add_u32 m0, s62, 53248
s_add_u32 s63, s69, 0x60000
buffer_load_dwordx4 v11, s[12:15], s63 offen lds
s_add_u32 m0, s62, 57344
s_add_u32 s63, s72, 0x70000
buffer_load_dwordx4 v11, s[12:15], s63 offen lds
s_add_u32 m0, s62, 61440
s_add_u32 s63, s69, 0x70000
buffer_load_dwordx4 v11, s[12:15], s63 offen lds
s_add_u32 m0, s62, 65536
s_add_u32 s63, s72, 0x80000
buffer_load_dwordx4 v11, s[12:15], s63 offen lds
s_add_u32 m0, s62, 69632
s_add_u32 s63, s69, 0x80000
buffer_load_dwordx4 v11, s[12:15], s63 offen lds
s_add_u32 m0, s62, 73728
s_add_u32 s63, s72, 0x90000
buffer_load_dwordx4 v11, s[12:15], s63 offen lds
s_add_u32 m0, s62, 77824
s_add_u32 s63, s69, 0x90000
buffer_load_dwordx4 v11, s[12:15], s63 offen lds
s_add_u32 m0, s62, 81920
s_add_u32 s63, s72, 0xa0000
buffer_load_dwordx4 v11, s[12:15], s63 offen lds
s_add_u32 m0, s62, 86016
s_add_u32 s63, s69, 0xa0000
buffer_load_dwordx4 v11, s[12:15], s63 offen lds
s_add_u32 m0, s62, 90112
s_add_u32 s63, s72, 0xb0000
buffer_load_dwordx4 v11, s[12:15], s63 offen lds
s_add_u32 m0, s62, 94208
s_add_u32 s63, s69, 0xb0000
buffer_load_dwordx4 v11, s[12:15], s63 offen lds
s_add_u32 m0, s62, 98304
s_add_u32 s63, s72, 0xc0000
buffer_load_dwordx4 v11, s[12:15], s63 offen lds
s_add_u32 m0, s62, 102400
s_add_u32 s63, s69, 0xc0000
buffer_load_dwordx4 v11, s[12:15], s63 offen lds
s_add_u32 m0, s62, 106496
s_add_u32 s63, s72, 0xd0000
buffer_load_dwordx4 v11, s[12:15], s63 offen lds
s_add_u32 m0, s62, 110592
s_add_u32 s63, s69, 0xd0000
buffer_load_dwordx4 v11, s[12:15], s63 offen lds
s_add_u32 m0, s62, 114688
s_add_u32 s63, s72, 0xe0000
buffer_load_dwordx4 v11, s[12:15], s63 offen lds
s_add_u32 m0, s62, 118784
s_add_u32 s63, s69, 0xe0000
buffer_load_dwordx4 v11, s[12:15], s63 offen lds
s_add_u32 m0, s62, 122880
s_add_u32 s63, s72, 0xf0000
buffer_load_dwordx4 v11, s[12:15], s63 offen lds
s_add_u32 m0, s62, 126976
s_add_u32 s63, s69, 0xf0000
buffer_load_dwordx4 v11, s[12:15], s63 offen lds
s_add_u32 m0, s62, 131072
s_add_u32 s63, s72, 0x100000
buffer_load_dwordx4 v11, s[12:15], s63 offen lds
s_add_u32 m0, s62, 135168
s_add_u32 s63, s69, 0x100000
buffer_load_dwordx4 v11, s[12:15], s63 offen lds
s_add_u32 m0, s62, 139264
s_add_u32 s63, s72, 0x110000
buffer_load_dwordx4 v11, s[12:15], s63 offen lds
s_add_u32 m0, s62, 143360
s_add_u32 s63, s69, 0x110000
buffer_load_dwordx4 v11, s[12:15], s63 offen lds
s_add_u32 m0, s62, 147456
s_add_u32 s63, s72, 0x120000
buffer_load_dwordx4 v11, s[12:15], s63 offen lds
s_add_u32 m0, s62, 151552
s_add_u32 s63, s69, 0x120000
buffer_load_dwordx4 v11, s[12:15], s63 offen lds
s_add_u32 m0, s62, 155648
s_add_u32 s63, s72, 0x130000
buffer_load_dwordx4 v11, s[12:15], s63 offen lds
s_add_u32 m0, s62, 159744
s_add_u32 s63, s69, 0x130000
buffer_load_dwordx4 v11, s[12:15], s63 offen lds
s_waitcnt vmcnt(38) lgkmcnt(0)
s_barrier
ds_read_b64_tr_b16 a[0:1], v8 offset:0
ds_read_b64_tr_b16 a[2:3], v8 offset:2048
ds_read_b64_tr_b16 a[4:5], v8 offset:8
ds_read_b64_tr_b16 a[6:7], v8 offset:2056
s_waitcnt vmcnt(36) lgkmcnt(0)
s_barrier
ds_read_b64_tr_b16 a[8:9], v8 offset:8192
ds_read_b64_tr_b16 a[10:11], v8 offset:10240
ds_read_b64_tr_b16 a[12:13], v8 offset:8200
ds_read_b64_tr_b16 a[14:15], v8 offset:10248
s_waitcnt vmcnt(34) lgkmcnt(0)
s_barrier
ds_read_b64_tr_b16 a[16:17], v8 offset:16384
ds_read_b64_tr_b16 a[18:19], v8 offset:18432
ds_read_b64_tr_b16 a[20:21], v8 offset:16392
ds_read_b64_tr_b16 a[22:23], v8 offset:18440
s_waitcnt vmcnt(32) lgkmcnt(0)
s_barrier
ds_read_b64_tr_b16 a[24:25], v8 offset:24576
ds_read_b64_tr_b16 a[26:27], v8 offset:26624
ds_read_b64_tr_b16 a[28:29], v8 offset:24584
ds_read_b64_tr_b16 a[30:31], v8 offset:26632
s_waitcnt vmcnt(30) lgkmcnt(0)
s_barrier
ds_read_b64_tr_b16 a[32:33], v8 offset:32768
ds_read_b64_tr_b16 a[34:35], v8 offset:34816
ds_read_b64_tr_b16 a[36:37], v8 offset:32776
ds_read_b64_tr_b16 a[38:39], v8 offset:34824
s_waitcnt vmcnt(28) lgkmcnt(0)
s_barrier
ds_read_b64_tr_b16 a[40:41], v8 offset:40960
ds_read_b64_tr_b16 a[42:43], v8 offset:43008
ds_read_b64_tr_b16 a[44:45], v8 offset:40968
ds_read_b64_tr_b16 a[46:47], v8 offset:43016
s_waitcnt vmcnt(26) lgkmcnt(0)
s_barrier
ds_read_b64_tr_b16 a[48:49], v8 offset:49152
ds_read_b64_tr_b16 a[50:51], v8 offset:51200
ds_read_b64_tr_b16 a[52:53], v8 offset:49160
ds_read_b64_tr_b16 a[54:55], v8 offset:51208
s_waitcnt vmcnt(24) lgkmcnt(0)
s_barrier
ds_read_b64_tr_b16 a[56:57], v8 offset:57344
ds_read_b64_tr_b16 a[58:59], v8 offset:59392
ds_read_b64_tr_b16 a[60:61], v8 offset:57352
ds_read_b64_tr_b16 a[62:63], v8 offset:59400
s_waitcnt vmcnt(22) lgkmcnt(0)
s_barrier
ds_read_b64_tr_b16 a[64:65], v9 offset:0
ds_read_b64_tr_b16 a[66:67], v9 offset:2048
ds_read_b64_tr_b16 a[68:69], v9 offset:8
ds_read_b64_tr_b16 a[70:71], v9 offset:2056
s_waitcnt vmcnt(20) lgkmcnt(0)
s_barrier
ds_read_b64_tr_b16 a[72:73], v9 offset:8192
ds_read_b64_tr_b16 a[74:75], v9 offset:10240
ds_read_b64_tr_b16 a[76:77], v9 offset:8200
ds_read_b64_tr_b16 a[78:79], v9 offset:10248
s_waitcnt vmcnt(18) lgkmcnt(0)
s_barrier
ds_read_b64_tr_b16 a[80:81], v9 offset:16384
ds_read_b64_tr_b16 a[82:83], v9 offset:18432
ds_read_b64_tr_b16 a[84:85], v9 offset:16392
ds_read_b64_tr_b16 a[86:87], v9 offset:18440
s_waitcnt vmcnt(16) lgkmcnt(0)
s_barrier
ds_read_b64_tr_b16 a[88:89], v9 offset:24576
ds_read_b64_tr_b16 a[90:91], v9 offset:26624
ds_read_b64_tr_b16 a[92:93], v9 offset:24584
ds_read_b64_tr_b16 a[94:95], v9 offset:26632
s_waitcnt vmcnt(14) lgkmcnt(0)
s_barrier
v_mov_b32 v56, 0
buffer_load_dwordx4 v[48:51], v56, s[20:23], 0 offen offset:128 sc1
buffer_load_dwordx4 v[52:55], v56, s[20:23], 0 offen offset:144 sc1
buffer_load_dword v58, v56, s[20:23], 0 offen offset:160 sc1
ds_read_b64_tr_b16 a[96:97], v9 offset:32768
ds_read_b64_tr_b16 a[98:99], v9 offset:34816
ds_read_b64_tr_b16 a[100:101], v9 offset:32776
ds_read_b64_tr_b16 a[102:103], v9 offset:34824
s_waitcnt vmcnt(12) lgkmcnt(0)
s_barrier
ds_read_b64_tr_b16 a[104:105], v9 offset:40960
ds_read_b64_tr_b16 a[106:107], v9 offset:43008
ds_read_b64_tr_b16 a[108:109], v9 offset:40968
ds_read_b64_tr_b16 a[110:111], v9 offset:43016
s_waitcnt vmcnt(10) lgkmcnt(0)
s_barrier
ds_read_b64_tr_b16 a[112:113], v9 offset:49152
ds_read_b64_tr_b16 a[114:115], v9 offset:51200
ds_read_b64_tr_b16 a[116:117], v9 offset:49160
ds_read_b64_tr_b16 a[118:119], v9 offset:51208
s_waitcnt vmcnt(8) lgkmcnt(0)
s_barrier
ds_read_b64_tr_b16 a[120:121], v9 offset:57344
ds_read_b64_tr_b16 a[122:123], v9 offset:59392
ds_read_b64_tr_b16 a[124:125], v9 offset:57352
ds_read_b64_tr_b16 a[126:127], v9 offset:59400
s_waitcnt vmcnt(6) lgkmcnt(0)
s_barrier
ds_read_b64_tr_b16 a[128:129], v10 offset:0
ds_read_b64_tr_b16 a[130:131], v10 offset:2048
ds_read_b64_tr_b16 a[132:133], v10 offset:8
ds_read_b64_tr_b16 a[134:135], v10 offset:2056
s_waitcnt vmcnt(4) lgkmcnt(0)
s_barrier
ds_read_b64_tr_b16 a[136:137], v10 offset:8192
ds_read_b64_tr_b16 a[138:139], v10 offset:10240
ds_read_b64_tr_b16 a[140:141], v10 offset:8200
ds_read_b64_tr_b16 a[142:143], v10 offset:10248
s_waitcnt vmcnt(2) lgkmcnt(0)
s_barrier
ds_read_b64_tr_b16 a[144:145], v10 offset:16384
ds_read_b64_tr_b16 a[146:147], v10 offset:18432
ds_read_b64_tr_b16 a[148:149], v10 offset:16392
ds_read_b64_tr_b16 a[150:151], v10 offset:18440
s_waitcnt vmcnt(0) lgkmcnt(0)
s_barrier
ds_read_b64_tr_b16 a[152:153], v10 offset:24576
ds_read_b64_tr_b16 a[154:155], v10 offset:26624
ds_read_b64_tr_b16 a[156:157], v10 offset:24584
ds_read_b64_tr_b16 a[158:159], v10 offset:26632
s_waitcnt lgkmcnt(0)
v_lshlrev_b32 v106, 4, v0
s_lshr_b32 s62, s70, 1
v_min_u32 v1, 9, v0
v_add_u32 v1, s62, v1
v_mul_u32_u24 v1, 256, v1
v_add_u32 v113, 53248, v1
v_and_b32 v1, 0xffffe000, v113
v_add_u32 v113, v1, v113
s_lshl_b32 s60, s68, 11
v_add_u32 v112, s60, v106
s_lshl_b32 s62, s67, 2
v_min_u32 v1, 2, v0
v_add_u32 v1, s62, v1
v_mul_u32_u24 v1, 256, v1
v_add_u32 v119, 83968, v1
v_and_b32 v1, 0xffffe000, v119
v_add_u32 v119, v1, v119
v_lshrrev_b32 v1, 5, v0
v_lshlrev_b32 v1, 8, v1
v_and_b32 v2, 15, v0
v_lshlrev_b32 v2, 4, v2
v_add_u32 v1, v1, v2
v_bfe_u32 v2, v0, 4, 1
v_lshlrev_b32 v2, 2, v2
s_lshr_b32 s60, s67, 1
s_lshl_b32 s60, s60, 9
s_and_b32 s61, s67, 1
s_lshl_b32 s61, s61, 3
s_add_u32 s60, s60, s61
v_add3_u32 v114, v1, v2, s60
s_cmp_eq_u32 s48, 0
s_cselect_b32 s60, 0, 0x40000000
v_or_b32 v114, s60, v114
v_lshlrev_b32 v117, 2, v0
v_add_u32 v117, 86016, v117
s_lshl_b32 s60, s48, 8
v_add_u32 v118, s60, v117
s_mov_b32 s76, 0x3f803f80
v_bfe_u32 v1, v0, 2, 2
v_lshrrev_b32 v2, 4, v0
v_cmp_eq_u32 vcc, v1, v2
v_and_b32 v1, 1, v0
v_lshlrev_b32 v1, 4, v1
v_mov_b32 v2, 0x3f80
v_lshlrev_b32 v1, v1, v2
v_cndmask_b32 v1, 0, v1, vcc
v_and_b32 v2, 2, v0
v_cmp_eq_u32 vcc, 0, v2
s_nop 1
v_cndmask_b32 v24, 0, v1, vcc
v_sub_u32 v25, v1, v24
v_mov_b32 v26, 0
v_mov_b32 v27, 0
v_mov_b32 v28, 0
v_mov_b32 v29, 0
v_mov_b32 v30, v24
v_mov_b32 v31, v25
v_mov_b32 v56, 0
s_cmp_lg_u32 s100, 0
s_cbranch_scc1 Lws1_102
s_branch Lwsw1_105
Lws_101:
v_mov_b32 v56, 0
buffer_load_dwordx4 v[48:51], v56, s[20:23], 0 offen offset:128 sc1
buffer_load_dwordx4 v[52:55], v56, s[20:23], 0 offen offset:144 sc1
buffer_load_dword v58, v56, s[20:23], 0 offen offset:160 sc1
Lwsw1_105:
s_waitcnt vmcnt(0)
v_readfirstlane_b32 s97, v58
v_add3_u32 v57, v48, v49, v50
v_add3_u32 v57, v57, v51, v52
v_add3_u32 v57, v57, v53, v54
v_add_u32 v57, v57, v55
v_cmp_le_u32 vcc, 0x100, v57
s_nop 0
s_cmp_eq_u64 vcc, -1
s_cbranch_scc0 Lrt_106
v_or3_b32 v57, v48, v49, v50
v_or3_b32 v57, v57, v51, v52
v_or3_b32 v57, v57, v53, v54
v_or_b32 v57, v57, v55
v_cmp_eq_u32 vcc, 256, v57
s_nop 0
s_cmp_eq_u64 vcc, -1
s_cbranch_scc1 Lws2_103
s_branch L_restart
Lws1_102:
buffer_load_dword v48, v56, s[20:23], 0 offen sc1
s_waitcnt vmcnt(0)
v_cmp_le_u32 vcc, 0x100, v48
s_nop 0
s_cmp_eq_u64 vcc, -1
s_cbranch_scc0 Lrt_107
Lws2_103:
s_barrier
s_mov_b32 s62, 0
s_cmp_lg_u32 s100, 0
s_cbranch_scc1 Lnear2_109
s_cmp_lg_u32 s97, 0
s_cbranch_scc1 Lnear3_110
v_mov_b32 v1, 160
Lnear_108:
buffer_load_dword v1, v1, s[20:23], 0 offen sc1
s_waitcnt vmcnt(0)
v_readfirstlane_b32 s97, v1
v_mov_b32 v1, 160
s_cmp_eq_u32 s97, 0
s_cbranch_scc1 Lrt_111
Lnear3_110:
s_and_b32 s62, s97, 2
s_lshl_b32 s62, s62, 12
Lnear2_109:
s_xor_b32 s63, s62, 0x2000
v_add_u32 v110, s63, v110
v_add_u32 v113, s63, v113
v_add_u32 v119, s63, v119
s_mov_b32 s44, 0
s_mov_b32 s45, 0x40000000
s_add_u32 s71, s71, 0x9400000
s_mul_i32 s25, s48, 10240
v_add_u32 v107, s25, v106
s_add_u32 s65, s25, 40960
s_add_u32 s28, s49, 0
s_and_b32 s28, s28, 3
s_mul_i32 s28, s28, 2048
s_add_u32 s29, s49, 1
s_and_b32 s29, s29, 3
s_mul_i32 s29, s29, 2048
s_add_u32 s30, s49, 2
s_and_b32 s30, s30, 3
s_mul_i32 s30, s30, 2048
s_add_u32 s31, s49, 3
s_and_b32 s31, s31, 3
s_mul_i32 s31, s31, 2048
s_lshl_b32 s27, s48, 9
s_add_u32 s27, s27, 81920
v_lshrrev_b32 v120, 2, v106
v_add_u32 v120, 81920, v120
s_cmp_eq_u32 s48, 0
s_cselect_b32 s60, 0, 0x40000000
v_or_b32 v113, s60, v113
s_cmp_eq_u32 s48, 0
s_cselect_b32 s60, 0, 0x40000000
v_or_b32 v119, s60, v119
s_mov_b32 s53, 0
s_mov_b32 s54, 0
s_mov_b32 s52, 0
v_mov_b32 v104, v106
s_mov_b32 s59, 0x40000000
v_mov_b32 v111, 0
s_mov_b32 s98, 64
s_mov_b32 s99, 0xfffffff0
s_mov_b32 s77, 0x40000000
s_mov_b32 s79, 0x40000000
s_mov_b32 s12, s46
s_and_b32 s13, s47, 0xffff
s_mov_b32 s14, 0x10000000
s_mov_b32 s15, 0x20000
s_mov_b32 s41, 0
s_add_u32 s60, s53, 1
s_add_u32 s99, s99, 1
s_cmp_lt_u32 s99, 97
s_cselect_b32 s24, s98, s60
s_cselect_b32 s98, s60, s98
s_branch LWOF_slow
.p2align 6
LWOF_top:
s_waitcnt lgkmcnt(4)
v_mfma_f32_16x16x32_bf16 v[8:11], a[0:3], v[32:35], 0
s_mov_b32 s52, s53
ds_read_b128 v[56:59], v104 offset:6144
s_mov_b32 s53, s24
s_mov_b32 s10, s51
s_mul_i32 s55, s53, 0x40000
v_mfma_f32_16x16x32_bf16 v[12:15], a[4:7], v[32:35], 0
s_add_u32 s55, s55, s71
ds_read_b128 v[60:63], v104 offset:7168
s_sub_u32 s56, s65, s54
s_and_b32 s26, s52, 64
s_lshl_b32 s26, s26, 12
v_mfma_f32_16x16x32_bf16 v[20:23], a[4:7], v[36:39], 0
s_xor_b32 s27, s27, 2048
v_xor_b32 v120, 2048, v120
s_add_u32 m0, s27, 256
s_nop 0
buffer_load_dword v119, s[4:7], s26 offen sc1 lds
v_mfma_f32_16x16x32_bf16 v[16:19], a[0:3], v[36:39], 0
s_waitcnt lgkmcnt(4)
v_mfma_f32_16x16x32_bf16 v[8:11], a[8:11], v[40:43], v[8:11]
ds_read_b128 v[32:35], v104 offset:8192
v_mfma_f32_16x16x32_bf16 v[12:15], a[12:15], v[40:43], v[12:15]
ds_read_b128 v[36:39], v104 offset:9216
s_add_u32 m0, s56, s28
s_add_u32 s32, s55, s28
buffer_load_dwordx4 v107, s[8:11], s32 offen offset:0 sc1 lds
v_mfma_f32_16x16x32_bf16 v[20:23], a[12:15], v[44:47], v[20:23]
v_mfma_f32_16x16x32_bf16 v[16:19], a[8:11], v[44:47], v[16:19]
s_waitcnt lgkmcnt(4)
v_mfma_f32_16x16x32_bf16 v[8:11], a[16:19], v[48:51], v[8:11]
ds_read_b128 v[40:43], v104 offset:10240
v_mfma_f32_16x16x32_bf16 v[12:15], a[20:23], v[48:51], v[12:15]
ds_read_b128 v[44:47], v104 offset:11264
buffer_load_dwordx4 v107, s[8:11], s32 offen offset:1024 sc1 lds
v_mfma_f32_16x16x32_bf16 v[20:23], a[20:23], v[52:55], v[20:23]
v_mfma_f32_16x16x32_bf16 v[16:19], a[16:19], v[52:55], v[16:19]
s_waitcnt lgkmcnt(4)
v_mfma_f32_16x16x32_bf16 v[8:11], a[24:27], v[56:59], v[8:11]
ds_read_b128 v[48:51], v104 offset:12288
s_add_u32 m0, s56, 8192
s_add_u32 s32, s55, 8192
buffer_load_dwordx4 v107, s[8:11], s32 offen offset:0 sc1 lds
v_mfma_f32_16x16x32_bf16 v[12:15], a[28:31], v[56:59], v[12:15]
ds_read_b128 v[52:55], v104 offset:13312
v_mfma_f32_16x16x32_bf16 v[20:23], a[28:31], v[60:63], v[20:23]
v_mfma_f32_16x16x32_bf16 v[16:19], a[24:27], v[60:63], v[16:19]
s_waitcnt lgkmcnt(4)
s_waitcnt vmcnt(12)
s_barrier
buffer_load_dwordx4 v107, s[8:11], s32 offen offset:1024 sc1 lds
buffer_store_dword v111, v110, s[4:7], s59 offen sc1
v_mfma_f32_16x16x32_bf16 v[8:11], a[32:35], v[32:35], v[8:11]
ds_read_b128 v[56:59], v104 offset:14336
v_mfma_f32_16x16x32_bf16 v[12:15], a[36:39], v[32:35], v[12:15]
ds_read_b128 v[60:63], v104 offset:15360
v_mfma_f32_16x16x32_bf16 v[20:23], a[36:39], v[36:39], v[20:23]
v_mfma_f32_16x16x32_bf16 v[16:19], a[32:35], v[36:39], v[16:19]
s_waitcnt lgkmcnt(4)
s_add_u32 m0, s56, s29
s_add_u32 s32, s55, s29
buffer_load_dwordx4 v107, s[8:11], s32 offen offset:0 sc1 lds
v_mfma_f32_16x16x32_bf16 v[8:11], a[40:43], v[40:43], v[8:11]
ds_read_b128 v[32:35], v104 offset:16384
v_mfma_f32_16x16x32_bf16 v[12:15], a[44:47], v[40:43], v[12:15]
ds_read_b128 v[36:39], v104 offset:17408
v_mfma_f32_16x16x32_bf16 v[20:23], a[44:47], v[44:47], v[20:23]
v_mfma_f32_16x16x32_bf16 v[16:19], a[40:43], v[44:47], v[16:19]
s_waitcnt lgkmcnt(4)
buffer_load_dwordx4 v107, s[8:11], s32 offen offset:1024 sc1 lds
v_mfma_f32_16x16x32_bf16 v[8:11], a[48:51], v[48:51], v[8:11]
ds_read_b128 v[40:43], v104 offset:18432
v_mfma_f32_16x16x32_bf16 v[12:15], a[52:55], v[48:51], v[12:15]
ds_read_b128 v[44:47], v104 offset:19456
v_mfma_f32_16x16x32_bf16 v[20:23], a[52:55], v[52:55], v[20:23]
s_add_u32 m0, s56, s30
s_add_u32 s32, s55, s30
buffer_load_dwordx4 v107, s[8:11], s32 offen offset:0 sc1 lds
v_mfma_f32_16x16x32_bf16 v[16:19], a[48:51], v[52:55], v[16:19]
s_waitcnt lgkmcnt(4)
v_mfma_f32_16x16x32_bf16 v[8:11], a[56:59], v[56:59], v[8:11]
ds_read_b128 v[48:51], v104 offset:20480
v_mfma_f32_16x16x32_bf16 v[12:15], a[60:63], v[56:59], v[12:15]
ds_read_b128 v[52:55], v104 offset:21504
v_mfma_f32_16x16x32_bf16 v[20:23], a[60:63], v[60:63], v[20:23]
buffer_load_dwordx4 v107, s[8:11], s32 offen offset:1024 sc1 lds
v_mfma_f32_16x16x32_bf16 v[16:19], a[56:59], v[60:63], v[16:19]
s_waitcnt lgkmcnt(4)
v_mfma_f32_16x16x32_bf16 v[8:11], a[64:67], v[32:35], v[8:11]
ds_read_b128 v[56:59], v104 offset:22528
v_mfma_f32_16x16x32_bf16 v[12:15], a[68:71], v[32:35], v[12:15]
s_add_u32 m0, s56, s31
ds_read_b128 v[60:63], v104 offset:23552
s_add_u32 s32, s55, s31
buffer_load_dwordx4 v107, s[8:11], s32 offen offset:0 sc1 lds
v_mfma_f32_16x16x32_bf16 v[20:23], a[68:71], v[36:39], v[20:23]
v_mfma_f32_16x16x32_bf16 v[16:19], a[64:67], v[36:39], v[16:19]
s_waitcnt lgkmcnt(4)
v_mfma_f32_16x16x32_bf16 v[8:11], a[72:75], v[40:43], v[8:11]
s_waitcnt vmcnt(11)
ds_read_b128 v[32:35], v104 offset:24576
v_mfma_f32_16x16x32_bf16 v[72:75], v[24:27], v[124:127], v[72:75]
buffer_load_dwordx4 v107, s[8:11], s32 offen offset:1024 sc1 lds
v_mfma_f32_16x16x32_bf16 v[12:15], a[76:79], v[40:43], v[12:15]
ds_read_b128 v[36:39], v104 offset:25600
s_add_u32 s60, s53, 1
s_add_u32 s99, s99, 1
s_cmp_lt_u32 s99, 97
v_mfma_f32_16x16x32_bf16 v[20:23], a[76:79], v[44:47], v[20:23]
s_cselect_b32 s24, s98, s60
s_cselect_b32 s98, s60, s98
s_mov_b32 m0, s27
s_cmp_lt_u32 s24, 64
s_cselect_b32 s58, 0, 0x40000
v_mfma_f32_16x16x32_bf16 v[16:19], a[72:75], v[44:47], v[16:19]
s_waitcnt lgkmcnt(4)
buffer_load_dword v113, s[4:7], s58 offen sc1 lds
v_mfma_f32_16x16x32_bf16 v[76:79], v[28:31], v[124:127], v[76:79]
v_mfma_f32_16x16x32_bf16 v[80:83], v[24:27], v[128:131], v[80:83]
v_mfma_f32_16x16x32_bf16 v[84:87], v[28:31], v[128:131], v[84:87]
v_mfma_f32_16x16x32_bf16 v[72:75], v[24:27], v[132:135], v[72:75]
v_mfma_f32_16x16x32_bf16 v[76:79], v[28:31], v[132:135], v[76:79]
v_mfma_f32_16x16x32_bf16 v[80:83], v[24:27], v[136:139], v[80:83]
v_mfma_f32_16x16x32_bf16 v[84:87], v[28:31], v[136:139], v[84:87]
v_mfma_f32_16x16x32_bf16 v[72:75], v[24:27], v[140:143], v[72:75]
v_mfma_f32_16x16x32_bf16 v[76:79], v[28:31], v[140:143], v[76:79]
v_mfma_f32_16x16x32_bf16 v[80:83], v[24:27], v[144:147], v[80:83]
v_mfma_f32_16x16x32_bf16 v[84:87], v[28:31], v[144:147], v[84:87]
v_mfma_f32_16x16x32_bf16 v[72:75], v[24:27], v[148:151], v[72:75]
v_mfma_f32_16x16x32_bf16 v[76:79], v[28:31], v[148:151], v[76:79]
v_mfma_f32_16x16x32_bf16 v[80:83], v[24:27], v[152:155], v[80:83]
v_mfma_f32_16x16x32_bf16 v[8:11], a[80:83], v[48:51], v[8:11]
ds_read_b128 v[40:43], v104 offset:26624
v_mfma_f32_16x16x32_bf16 v[84:87], v[28:31], v[152:155], v[84:87]
v_mfma_f32_16x16x32_bf16 v[12:15], a[84:87], v[48:51], v[12:15]
ds_read_b128 v[44:47], v104 offset:27648
v_mfma_f32_16x16x32_bf16 v[20:23], a[84:87], v[52:55], v[20:23]
v_cvt_pk_bf16_f32 v156, v72, v73
v_cvt_pk_bf16_f32 v157, v74, v75
v_cvt_pk_bf16_f32 v158, v76, v77
v_cvt_pk_bf16_f32 v159, v78, v79
v_mfma_f32_16x16x32_bf16 v[16:19], a[80:83], v[52:55], v[16:19]
s_waitcnt lgkmcnt(4)
buffer_store_dwordx4 v[156:159], v112, s[4:7], s77 offen offset:0 sc1
v_cvt_pk_bf16_f32 v160, v80, v81
v_cvt_pk_bf16_f32 v161, v82, v83
v_cvt_pk_bf16_f32 v162, v84, v85
v_mfma_f32_16x16x32_bf16 v[8:11], a[88:91], v[56:59], v[8:11]
ds_read_b128 v[48:51], v104 offset:28672
v_cvt_pk_bf16_f32 v163, v86, v87
v_dot2_f32_bf16 v164, v156, s76, 0
v_dot2_f32_bf16 v166, v156, v156, 0
v_dot2_f32_bf16 v165, v160, s76, 0
v_dot2_f32_bf16 v167, v160, v160, 0
v_dot2_f32_bf16 v164, v157, s76, v164
v_dot2_f32_bf16 v166, v157, v157, v166
v_dot2_f32_bf16 v165, v161, s76, v165
v_dot2_f32_bf16 v167, v161, v161, v167
v_dot2_f32_bf16 v164, v158, s76, v164
v_dot2_f32_bf16 v166, v158, v158, v166
v_dot2_f32_bf16 v165, v162, s76, v165
v_dot2_f32_bf16 v167, v162, v162, v167
v_dot2_f32_bf16 v164, v159, s76, v164
v_dot2_f32_bf16 v166, v159, v159, v166
v_dot2_f32_bf16 v165, v163, s76, v165
v_dot2_f32_bf16 v167, v163, v163, v167
v_mfma_f32_16x16x32_bf16 v[12:15], a[92:95], v[56:59], v[12:15]
ds_read_b128 v[52:55], v104 offset:29696
buffer_store_dwordx4 v[160:163], v112, s[4:7], s77 offen offset:1024 sc1
v_mfma_f32_16x16x32_bf16 v[20:23], a[92:95], v[60:63], v[20:23]
v_permlane32_swap_b32 v164, v165
v_permlane32_swap_b32 v166, v167
v_mfma_f32_16x16x32_bf16 v[16:19], a[88:91], v[60:63], v[16:19]
s_waitcnt lgkmcnt(4)
v_add_f32 v164, v164, v165
v_add_f32 v166, v166, v167
v_mfma_f32_16x16x32_bf16 v[8:11], a[96:99], v[32:35], v[8:11]
ds_read_b128 v[56:59], v104 offset:30720
v_permlane16_swap_b32 v164, v166
v_add_f32 v164, v164, v166
v_mfma_f32_16x16x32_bf16 v[12:15], a[100:103], v[32:35], v[12:15]
ds_read_b128 v[60:63], v104 offset:31744
ds_write_b32 v118, v164
s_waitcnt lgkmcnt(0)
s_waitcnt vmcnt(14)
v_mfma_f32_16x16x32_bf16 v[20:23], a[100:103], v[36:39], v[20:23]
s_barrier
ds_read_b32 v109, v120 offset:256
ds_read2st64_b32 v[164:165], v117 offset0:0 offset1:1
ds_read2st64_b32 v[166:167], v117 offset0:2 offset1:3
v_mfma_f32_16x16x32_bf16 v[16:19], a[96:99], v[36:39], v[16:19]
v_mfma_f32_16x16x32_bf16 v[8:11], a[104:107], v[40:43], v[8:11]
ds_read_b128 v[32:35], v104 offset:32768
v_mfma_f32_16x16x32_bf16 v[12:15], a[108:111], v[40:43], v[12:15]
ds_read_b128 v[36:39], v104 offset:33792
v_mfma_f32_16x16x32_bf16 v[20:23], a[108:111], v[44:47], v[20:23]
s_waitcnt lgkmcnt(2)
v_add_f32 v164, v164, v165
v_add_f32 v166, v166, v167
v_add_f32 v164, v164, v166
buffer_store_dword v164, v114, s[4:7], s79 offen sc1
v_mfma_f32_16x16x32_bf16 v[16:19], a[104:107], v[44:47], v[16:19]
v_mfma_f32_16x16x32_bf16 v[8:11], a[112:115], v[48:51], v[8:11]
ds_read_b128 v[40:43], v104 offset:34816
v_cmp_lt_u32 vcc, s52, v109
s_nop 0
s_cmp_eq_u64 vcc, -1
s_cselect_b32 s14, 0x10000000, 0
v_mfma_f32_16x16x32_bf16 v[12:15], a[116:119], v[48:51], v[12:15]
s_lshl_b32 s73, s52, 16
ds_read_b128 v[44:47], v104 offset:35840
s_add_u32 s73, s73, 0x400000
buffer_load_dwordx4 v[148:151], v112, s[12:15], s73 offen offset:0 sc1
v_mfma_f32_16x16x32_bf16 v[20:23], a[116:119], v[52:55], v[20:23]
v_mfma_f32_16x16x32_bf16 v[16:19], a[112:115], v[52:55], v[16:19]
s_lshl_b32 s77, s52, 16
s_add_u32 s77, s77, 0xc00000
s_lshl_b32 s79, s52, 11
s_add_u32 s79, s79, 0x1c0000
v_mfma_f32_16x16x32_bf16 v[8:11], a[120:123], v[56:59], v[8:11]
ds_read_b128 v[48:51], v104 offset:36864
buffer_load_dwordx4 v[152:155], v112, s[12:15], s73 offen offset:1024 sc1
v_mfma_f32_16x16x32_bf16 v[12:15], a[124:127], v[56:59], v[12:15]
ds_read_b128 v[52:55], v104 offset:37888
v_mfma_f32_16x16x32_bf16 v[20:23], a[124:127], v[60:63], v[20:23]
v_mfma_f32_16x16x32_bf16 v[16:19], a[120:123], v[60:63], v[16:19]
s_waitcnt lgkmcnt(4)
s_mul_i32 s73, s52, 0x30000
s_add_u32 s73, s73, 0xd000000
buffer_load_dwordx4 v[124:127], v112, s[12:15], s73 offen offset:0 sc1
v_mfma_f32_16x16x32_bf16 v[8:11], a[128:131], v[32:35], v[8:11]
ds_read_b128 v[56:59], v104 offset:38912
v_mfma_f32_16x16x32_bf16 v[12:15], a[132:135], v[32:35], v[12:15]
ds_read_b128 v[60:63], v104 offset:39936
v_mfma_f32_16x16x32_bf16 v[20:23], a[132:135], v[36:39], v[20:23]
v_mfma_f32_16x16x32_bf16 v[16:19], a[128:131], v[36:39], v[16:19]
s_waitcnt lgkmcnt(4)
buffer_load_dwordx4 v[128:131], v112, s[12:15], s73 offen offset:1024 sc1
v_mfma_f32_16x16x32_bf16 v[8:11], a[136:139], v[40:43], v[8:11]
s_sub_u32 s54, 40960, s54
v_add_u32 v104, s54, v106
v_mfma_f32_16x16x32_bf16 v[12:15], a[140:143], v[40:43], v[12:15]
v_mfma_f32_16x16x32_bf16 v[20:23], a[140:143], v[44:47], v[20:23]
v_mfma_f32_16x16x32_bf16 v[16:19], a[136:139], v[44:47], v[16:19]
s_add_u32 s73, s73, 0x10000
buffer_load_dwordx4 v[132:135], v112, s[12:15], s73 offen offset:0 sc1
buffer_load_dwordx4 v[136:139], v112, s[12:15], s73 offen offset:1024 sc1
s_add_u32 s73, s73, 0x10000
buffer_load_dwordx4 v[140:143], v112, s[12:15], s73 offen offset:0 sc1
buffer_load_dwordx4 v[144:147], v112, s[12:15], s73 offen offset:1024 sc1
s_waitcnt lgkmcnt(0)
s_waitcnt vmcnt(11)
s_barrier
v_mfma_f32_16x16x32_bf16 v[8:11], a[144:147], v[48:51], v[8:11]
ds_read_b32 v108, v120
ds_read_b128 v[32:35], v104 offset:0
v_mov_b32 v111, s44
s_mov_b32 s59, s45
v_mfma_f32_16x16x32_bf16 v[12:15], a[148:151], v[48:51], v[12:15]
s_add_u32 s44, s52, 1
ds_read_b128 v[36:39], v104 offset:1024
ds_read_b128 v[40:43], v104 offset:2048
s_mov_b32 s45, s26
s_nop 0
v_mfma_f32_16x16x32_bf16 v[20:23], a[148:151], v[52:55], v[20:23]
ds_read_b128 v[44:47], v104 offset:3072
v_mfma_f32_16x16x32_bf16 v[16:19], a[144:147], v[52:55], v[16:19]
v_mfma_f32_16x16x32_bf16 v[72:75], a[152:155], v[56:59], v[8:11]
s_waitcnt lgkmcnt(4)
ds_read_b128 v[48:51], v104 offset:4096
v_cmp_lt_u32 vcc, s24, v108
s_nop 0
s_cmp_eq_u64 vcc, -1
s_cselect_b32 s51, 0x10000000, 0
v_mfma_f32_16x16x32_bf16 v[76:79], a[156:159], v[56:59], v[12:15]
s_and_b32 s64, s10, s14
ds_read_b128 v[52:55], v104 offset:5120
v_mfma_f32_16x16x32_bf16 v[84:87], a[156:159], v[60:63], v[20:23]
v_mfma_f32_16x16x32_bf16 v[80:83], a[152:155], v[60:63], v[16:19]
s_cbranch_scc1 LWOF_top
s_cmp_lg_u32 s14, 0
s_cbranch_scc1 Llw_112
s_xor_b32 s27, s27, 2048
v_xor_b32 v120, 2048, v120
s_mov_b32 m0, s27
s_cmp_lt_u32 s24, 64
s_cselect_b32 s58, 0, 0x40000
buffer_load_dword v113, s[4:7], s58 offen sc1 lds
s_add_u32 m0, s27, 256
s_nop 0
buffer_load_dword v119, s[4:7], s26 offen sc1 lds
s_waitcnt vmcnt(0) lgkmcnt(0)
s_barrier
ds_read2st64_b32 v[108:109], v120 offset0:0 offset1:1
buffer_store_dword v111, v110, s[4:7], s59 offen sc1
s_waitcnt lgkmcnt(0)
v_cmp_lt_u32 vcc, s52, v109
s_nop 0
s_cmp_eq_u64 vcc, -1
s_cbranch_scc1 Llg_113
s_xor_b32 s27, s27, 2048
v_xor_b32 v120, 2048, v120
s_cmp_lg_u32 s48, 0
s_cbranch_scc1 Lspd_115
Lsp_114:
s_mov_b32 m0, s27
s_cmp_lt_u32 s24, 64
s_cselect_b32 s58, 0, 0x40000
buffer_load_dword v113, s[4:7], s58 offen sc1 lds
buffer_load_dword v109, v119, s[4:7], s26 offen sc1
s_waitcnt vmcnt(0)
v_cmp_lt_u32 vcc, s52, v109
s_nop 0
s_cmp_eq_u64 vcc, -1
s_cbranch_scc0 Lrt_116
Lspd_115:
s_barrier
ds_read_b32 v108, v120
Llg_113:
s_lshl_b32 s73, s52, 16
s_add_u32 s73, s73, 0x400000
buffer_load_dwordx4 v[148:151], v112, s[4:7], s73 offen offset:0 sc1
buffer_load_dwordx4 v[152:155], v112, s[4:7], s73 offen offset:1024 sc1
s_mul_i32 s73, s52, 0x30000
s_add_u32 s73, s73, 0xd000000
buffer_load_dwordx4 v[124:127], v112, s[4:7], s73 offen offset:0 sc1
buffer_load_dwordx4 v[128:131], v112, s[4:7], s73 offen offset:1024 sc1
s_add_u32 s73, s73, 0x10000
buffer_load_dwordx4 v[132:135], v112, s[4:7], s73 offen offset:0 sc1
buffer_load_dwordx4 v[136:139], v112, s[4:7], s73 offen offset:1024 sc1
s_add_u32 s73, s73, 0x10000
buffer_load_dwordx4 v[140:143], v112, s[4:7], s73 offen offset:0 sc1
buffer_load_dwordx4 v[144:147], v112, s[4:7], s73 offen offset:1024 sc1
s_waitcnt lgkmcnt(0)
v_cmp_lt_u32 vcc, s24, v108
s_nop 0
s_cmp_eq_u64 vcc, -1
s_cselect_b32 s51, 0x10000000, 0
s_mov_b32 s61, 0x40000000
s_cmp_lg_u32 s10, 0
s_cbranch_scc1 LWOF_top
v_cmp_lt_u32 vcc, s53, v108
s_min_u32 s61, s24, 127
s_xor_b32 s61, s61, s53
s_cmp_eq_u64 vcc, -1
s_cselect_b32 s10, 0x10000000, 0
s_cmp_lt_u32 s61, 64
s_cselect_b32 s10, s10, 0
s_cmp_eq_u32 s10, 0
s_cbranch_scc1 Lfen_119
s_mul_i32 s55, s53, 0x40000
s_add_u32 s55, s55, s71
s_add_u32 s56, s25, s54
s_add_u32 m0, s56, s28
s_add_u32 s32, s55, s28
buffer_load_dwordx4 v107, s[4:7], s32 offen offset:0 sc1 lds
buffer_load_dwordx4 v107, s[4:7], s32 offen offset:1024 sc1 lds
s_add_u32 m0, s56, 8192
s_add_u32 s32, s55, 8192
buffer_load_dwordx4 v107, s[4:7], s32 offen offset:0 sc1 lds
buffer_load_dwordx4 v107, s[4:7], s32 offen offset:1024 sc1 lds
s_add_u32 m0, s56, s29
s_add_u32 s32, s55, s29
buffer_load_dwordx4 v107, s[4:7], s32 offen offset:0 sc1 lds
buffer_load_dwordx4 v107, s[4:7], s32 offen offset:1024 sc1 lds
s_add_u32 m0, s56, s30
s_add_u32 s32, s55, s30
buffer_load_dwordx4 v107, s[4:7], s32 offen offset:0 sc1 lds
buffer_load_dwordx4 v107, s[4:7], s32 offen offset:1024 sc1 lds
s_add_u32 m0, s56, s31
s_add_u32 s32, s55, s31
buffer_load_dwordx4 v107, s[4:7], s32 offen offset:0 sc1 lds
buffer_load_dwordx4 v107, s[4:7], s32 offen offset:1024 sc1 lds
s_waitcnt vmcnt(10)
s_branch Lfe_117
Lfen_119:
s_waitcnt vmcnt(0)
s_branch Lfe_117
Llw_112:
s_waitcnt vmcnt(0)
s_barrier
buffer_store_dword v111, v110, s[4:7], s59 offen sc1
Lfe_117:
v_mfma_f32_16x16x32_bf16 v[72:75], v[24:27], v[124:127], v[72:75]
v_mfma_f32_16x16x32_bf16 v[76:79], v[28:31], v[124:127], v[76:79]
v_mfma_f32_16x16x32_bf16 v[80:83], v[24:27], v[128:131], v[80:83]
v_mfma_f32_16x16x32_bf16 v[84:87], v[28:31], v[128:131], v[84:87]
v_mfma_f32_16x16x32_bf16 v[72:75], v[24:27], v[132:135], v[72:75]
v_mfma_f32_16x16x32_bf16 v[76:79], v[28:31], v[132:135], v[76:79]
v_mfma_f32_16x16x32_bf16 v[80:83], v[24:27], v[136:139], v[80:83]
v_mfma_f32_16x16x32_bf16 v[84:87], v[28:31], v[136:139], v[84:87]
v_mfma_f32_16x16x32_bf16 v[72:75], v[24:27], v[140:143], v[72:75]
v_mfma_f32_16x16x32_bf16 v[76:79], v[28:31], v[140:143], v[76:79]
v_mfma_f32_16x16x32_bf16 v[80:83], v[24:27], v[144:147], v[80:83]
v_mfma_f32_16x16x32_bf16 v[84:87], v[28:31], v[144:147], v[84:87]
v_mfma_f32_16x16x32_bf16 v[72:75], v[24:27], v[148:151], v[72:75]
v_mfma_f32_16x16x32_bf16 v[76:79], v[28:31], v[148:151], v[76:79]
v_mfma_f32_16x16x32_bf16 v[80:83], v[24:27], v[152:155], v[80:83]
v_mfma_f32_16x16x32_bf16 v[84:87], v[28:31], v[152:155], v[84:87]
s_nop 4
v_cvt_pk_bf16_f32 v156, v72, v73
v_cvt_pk_bf16_f32 v157, v74, v75
v_cvt_pk_bf16_f32 v158, v76, v77
v_cvt_pk_bf16_f32 v159, v78, v79
buffer_store_dwordx4 v[156:159], v112, s[4:7], s77 offen offset:0 sc1
v_cvt_pk_bf16_f32 v160, v80, v81
v_cvt_pk_bf16_f32 v161, v82, v83
v_cvt_pk_bf16_f32 v162, v84, v85
v_cvt_pk_bf16_f32 v163, v86, v87
buffer_store_dwordx4 v[160:163], v112, s[4:7], s77 offen offset:1024 sc1
v_dot2_f32_bf16 v164, v156, s76, 0
v_dot2_f32_bf16 v166, v156, v156, 0
v_dot2_f32_bf16 v165, v160, s76, 0
v_dot2_f32_bf16 v167, v160, v160, 0
v_dot2_f32_bf16 v164, v157, s76, v164
v_dot2_f32_bf16 v166, v157, v157, v166
v_dot2_f32_bf16 v165, v161, s76, v165
v_dot2_f32_bf16 v167, v161, v161, v167
v_dot2_f32_bf16 v164, v158, s76, v164
v_dot2_f32_bf16 v166, v158, v158, v166
v_dot2_f32_bf16 v165, v162, s76, v165
v_dot2_f32_bf16 v167, v162, v162, v167
v_dot2_f32_bf16 v164, v159, s76, v164
v_dot2_f32_bf16 v166, v159, v159, v166
v_dot2_f32_bf16 v165, v163, s76, v165
v_dot2_f32_bf16 v167, v163, v163, v167
s_nop 1
v_permlane32_swap_b32 v164, v165
v_permlane32_swap_b32 v166, v167
v_add_f32 v164, v164, v165
v_add_f32 v166, v166, v167
s_nop 1
v_permlane16_swap_b32 v164, v166
v_add_f32 v164, v164, v166
ds_write_b32 v118, v164
s_waitcnt lgkmcnt(0)
s_barrier
ds_read2st64_b32 v[164:165], v117 offset0:0 offset1:1
ds_read2st64_b32 v[166:167], v117 offset0:2 offset1:3
s_waitcnt lgkmcnt(0)
v_add_f32 v164, v164, v165
v_add_f32 v166, v166, v167
v_add_f32 v164, v164, v166
buffer_store_dword v164, v114, s[4:7], s79 offen sc1
s_mov_b32 s77, 0x40000000
s_mov_b32 s79, 0x40000000
v_mov_b32 v111, s44
s_mov_b32 s59, s45
s_xor_b32 s27, s27, 2048
v_xor_b32 v120, 2048, v120
s_cmp_lg_u32 s10, 0
s_cbranch_scc1 Lfef_118
s_min_u32 s61, s24, 127
s_xor_b32 s61, s61, s53
s_cmp_ge_u32 s61, 64
s_cbranch_scc1 Lnomed_124
v_cmp_lt_u32 vcc, s53, v108
s_nop 0
s_cmp_eq_u64 vcc, -1
s_cbranch_scc1 Lmed_123
Lnomed_124:
s_mov_b32 m0, s27
s_cmp_lt_u32 s53, 64
s_cselect_b32 s58, 0, 0x40000
buffer_load_dword v113, s[4:7], s58 offen sc1 lds
s_mul_i32 s55, s53, 0x40000
s_add_u32 s55, s55, s71
s_add_u32 s56, s25, s54
s_waitcnt vmcnt(0) lgkmcnt(0)
s_barrier
ds_read_b32 v108, v120
buffer_store_dword v111, v110, s[4:7], s59 offen sc1
s_cmp_ge_u32 s53, 128
s_cbranch_scc1 LWOF_exit
s_xor_b32 s27, s27, 2048
v_xor_b32 v120, 2048, v120
s_waitcnt lgkmcnt(0)
v_cmp_lt_u32 vcc, s53, v108
s_nop 0
s_cmp_eq_u64 vcc, -1
s_cbranch_scc1 Lgo_120
LWOF_slow:
s_and_b32 s58, s53, 64
s_lshl_b32 s58, s58, 12
s_mul_i32 s55, s53, 0x40000
s_add_u32 s55, s55, s71
s_add_u32 s56, s25, s54
s_cmp_lg_u32 s48, 0
s_cbranch_scc1 Lspd_126
Lsp_125:
buffer_load_dword v108, v113, s[4:7], s58 offen sc1
s_waitcnt vmcnt(0)
v_cmp_lt_u32 vcc, s53, v108
s_nop 0
s_cmp_eq_u64 vcc, -1
s_cbranch_scc0 Lrt_127
Lspd_126:
s_barrier
Lgo_120:
s_add_u32 m0, s56, s28
s_add_u32 s32, s55, s28
buffer_load_dwordx4 v107, s[4:7], s32 offen offset:0 sc1 lds
buffer_load_dwordx4 v107, s[4:7], s32 offen offset:1024 sc1 lds
s_add_u32 m0, s56, 8192
s_add_u32 s32, s55, 8192
buffer_load_dwordx4 v107, s[4:7], s32 offen offset:0 sc1 lds
buffer_load_dwordx4 v107, s[4:7], s32 offen offset:1024 sc1 lds
s_add_u32 m0, s56, s29
s_add_u32 s32, s55, s29
buffer_load_dwordx4 v107, s[4:7], s32 offen offset:0 sc1 lds
buffer_load_dwordx4 v107, s[4:7], s32 offen offset:1024 sc1 lds
s_add_u32 m0, s56, s30
s_add_u32 s32, s55, s30
buffer_load_dwordx4 v107, s[4:7], s32 offen offset:0 sc1 lds
buffer_load_dwordx4 v107, s[4:7], s32 offen offset:1024 sc1 lds
s_add_u32 m0, s56, s31
s_add_u32 s32, s55, s31
buffer_load_dwordx4 v107, s[4:7], s32 offen offset:0 sc1 lds
buffer_load_dwordx4 v107, s[4:7], s32 offen offset:1024 sc1 lds
s_mov_b32 m0, s27
s_cmp_lt_u32 s24, 64
s_cselect_b32 s58, 0, 0x40000
buffer_load_dword v113, s[4:7], s58 offen sc1 lds
s_waitcnt vmcnt(0)
Lrd_121:
s_barrier
Lrd2_122:
ds_read_b32 v108, v120
ds_read_b128 v[32:35], v104 offset:0
ds_read_b128 v[36:39], v104 offset:1024
ds_read_b128 v[40:43], v104 offset:2048
ds_read_b128 v[44:47], v104 offset:3072
ds_read_b128 v[48:51], v104 offset:4096
ds_read_b128 v[52:55], v104 offset:5120
s_waitcnt lgkmcnt(6)
v_cmp_lt_u32 vcc, s24, v108
s_nop 0
s_cmp_eq_u64 vcc, -1
s_cselect_b32 s51, 0x10000000, 0
s_branch LWOF_top
LWOF_exit:
s_waitcnt vmcnt(0)
s_endpgm
Lrt_106:
s_add_u32 s96, s96, 1
s_cmp_lt_u32 s96, 1048576
s_cbranch_scc1 Lws_101
s_mov_b32 s97, 1
s_branch L_fail
Lrt_107:
s_add_u32 s96, s96, 1
s_cmp_lt_u32 s96, 1048576
s_cbranch_scc1 Lws1_102
s_mov_b32 s97, 1
s_branch L_fail
Lrt_111:
s_add_u32 s96, s96, 1
s_cmp_lt_u32 s96, 1048576
s_cbranch_scc1 Lnear_108
s_mov_b32 s97, 24
s_branch L_fail
Lrt_116:
s_add_u32 s96, s96, 1
s_cmp_lt_u32 s96, 1048576
s_cbranch_scc1 Lsp_114
s_mov_b32 s97, 20
s_branch L_fail
Lfef_118:
s_mov_b32 m0, s27
s_cmp_lt_u32 s24, 64
s_cselect_b32 s58, 0, 0x40000
buffer_load_dword v113, s[4:7], s58 offen sc1 lds
s_waitcnt vmcnt(0) lgkmcnt(0)
s_barrier
buffer_store_dword v111, v110, s[4:7], s59 offen sc1
s_branch Lrd2_122
Lmed_123:
s_mul_i32 s55, s53, 0x40000
s_add_u32 s55, s55, s71
s_add_u32 s56, s25, s54
s_add_u32 m0, s56, s28
s_add_u32 s32, s55, s28
buffer_load_dwordx4 v107, s[4:7], s32 offen offset:0 sc1 lds
buffer_load_dwordx4 v107, s[4:7], s32 offen offset:1024 sc1 lds
s_add_u32 m0, s56, 8192
s_add_u32 s32, s55, 8192
buffer_load_dwordx4 v107, s[4:7], s32 offen offset:0 sc1 lds
buffer_load_dwordx4 v107, s[4:7], s32 offen offset:1024 sc1 lds
s_add_u32 m0, s56, s29
s_add_u32 s32, s55, s29
buffer_load_dwordx4 v107, s[4:7], s32 offen offset:0 sc1 lds
buffer_load_dwordx4 v107, s[4:7], s32 offen offset:1024 sc1 lds
s_add_u32 m0, s56, s30
s_add_u32 s32, s55, s30
buffer_load_dwordx4 v107, s[4:7], s32 offen offset:0 sc1 lds
buffer_load_dwordx4 v107, s[4:7], s32 offen offset:1024 sc1 lds
s_add_u32 m0, s56, s31
s_add_u32 s32, s55, s31
buffer_load_dwordx4 v107, s[4:7], s32 offen offset:0 sc1 lds
buffer_load_dwordx4 v107, s[4:7], s32 offen offset:1024 sc1 lds
s_mov_b32 m0, s27
s_cmp_lt_u32 s24, 64
s_cselect_b32 s58, 0, 0x40000
buffer_load_dword v113, s[4:7], s58 offen sc1 lds
s_waitcnt vmcnt(11) lgkmcnt(0)
s_barrier
buffer_store_dword v111, v110, s[4:7], s59 offen sc1
s_waitcnt vmcnt(1)
s_branch Lrd_121
Lrt_127:
s_add_u32 s96, s96, 1
s_cmp_lt_u32 s96, 1048576
s_cbranch_scc1 Lsp_125
s_mov_b32 s97, 6
s_branch L_fail
L_DNP:
s_cmp_lg_u32 s48, 3
s_cbranch_scc1 Lns_128
s_cmp_lg_u32 s49, 0
s_cbranch_scc1 Lns_128
s_mov_b32 s60, 0x3df00
v_mov_b32 v2, s60
v_mov_b32 v1, 0x40000000
v_cmp_gt_u32 vcc, 1, v0
s_nop 1
v_cndmask_b32 v2, v1, v2, vcc
s_mov_b32 s57, -1
s_mov_b32 s58, -1
s_mov_b32 s59, 0
s_mov_b32 s62, 0x2000
Lnsl_129:
s_memtime s[76:77]
s_waitcnt lgkmcnt(0)
buffer_store_dword v0, v2, s[4:7], 0 offen sc1
s_waitcnt vmcnt(0)
s_memtime s[78:79]
s_waitcnt lgkmcnt(0)
s_sub_u32 s61, s78, s76
s_min_u32 s57, s57, s61
s_add_u32 s59, s59, s61
s_memtime s[76:77]
s_waitcnt lgkmcnt(0)
buffer_store_dword v0, v2, s[4:7], s62 offen sc1
s_waitcnt vmcnt(0)
s_memtime s[78:79]
s_waitcnt lgkmcnt(0)
s_sub_u32 s61, s78, s76
s_min_u32 s58, s58, s61
s_add_u32 s59, s59, s61
s_cmp_lt_u32 s59, 5000
s_cbranch_scc1 Lnsl_129
Lns_128:
s_mov_b32 s12, s40
s_and_b32 s13, s41, 0xffff
s_mov_b32 s14, 0x700000
s_mov_b32 s15, 0x20000
s_lshr_b32 s66, s49, 3
s_and_b32 s67, s49, 7
s_lshl_b32 s68, s67, 2
s_add_u32 s68, s68, s48
s_mul_i32 s70, s66, 40
s_lshl_b32 s71, s70, 11
s_lshl_b32 s62, s67, 1
s_add_u32 s62, s62, s66
s_mul_i32 s60, s62, 256
s_add_u32 s60, s60, 92160
s_and_b32 s61, s60, 0xffffe000
s_add_u32 s60, s60, s61
v_mov_b32 v110, s60
v_mov_b32 v1, 0x40000000
v_cmp_gt_u32 vcc, 1, v0
s_nop 1
v_cndmask_b32 v110, v1, v110, vcc
s_cmp_eq_u32 s48, 1
s_cselect_b32 s60, 0, 0x40000000
v_or_b32 v110, s60, v110
v_mov_b32 v1, 0
s_mov_b32 s60, 0x0
buffer_store_dword v1, v110, s[4:7], s60 offen sc1
s_mov_b32 s60, 0x2000
buffer_store_dword v1, v110, s[4:7], s60 offen sc1
s_mov_b32 s60, 0x40000
buffer_store_dword v1, v110, s[4:7], s60 offen sc1
s_mov_b32 s60, 0x42000
buffer_store_dword v1, v110, s[4:7], s60 offen sc1
s_waitcnt vmcnt(0)
s_barrier
s_cmp_lg_u32 s48, 0
s_cbranch_scc1 Larr_130
s_mov_b32 s60, 0
v_mov_b32 v2, s60
v_mov_b32 v1, 0x40000000
v_cmp_gt_u32 vcc, 1, v0
s_nop 1
v_cndmask_b32 v2, v1, v2, vcc
s_sub_u32 s61, s101, s2
s_and_b32 s61, s61, 7
s_lshl_b32 s61, s61, 2
s_add_u32 s61, s61, 128
s_cmp_eq_u32 s100, 0
s_cselect_b32 s61, s61, 0
v_mov_b32 v3, 1
buffer_atomic_add v3, v2, s[20:23], s61 offen sc1
Larr_130:
s_cmp_lg_u32 s48, 3
s_cbranch_scc1 Lns_131
s_cmp_lg_u32 s49, 0
s_cbranch_scc1 Lns_131
s_mov_b32 s60, 0x3df00
v_mov_b32 v2, s60
v_mov_b32 v1, 0x40000000
v_cmp_gt_u32 vcc, 1, v0
s_nop 1
v_cndmask_b32 v2, v1, v2, vcc
s_mov_b32 s59, 0
s_mov_b32 s62, 0x2000
Lnsl_132:
s_memtime s[76:77]
s_waitcnt lgkmcnt(0)
buffer_store_dword v0, v2, s[4:7], 0 offen sc1
s_waitcnt vmcnt(0)
s_memtime s[78:79]
s_waitcnt lgkmcnt(0)
s_sub_u32 s61, s78, s76
s_min_u32 s57, s57, s61
s_add_u32 s59, s59, s61
s_memtime s[76:77]
s_waitcnt lgkmcnt(0)
buffer_store_dword v0, v2, s[4:7], s62 offen sc1
s_waitcnt vmcnt(0)
s_memtime s[78:79]
s_waitcnt lgkmcnt(0)
s_sub_u32 s61, s78, s76
s_min_u32 s58, s58, s61
s_add_u32 s59, s59, s61
s_cmp_lt_u32 s59, 8000
s_cbranch_scc1 Lnsl_132
s_cmp_lt_u32 s58, s57
s_cselect_b32 s61, 1, 0
s_lshr_b32 s62, s101, 2
s_xor_b32 s61, s61, s62
s_add_u32 s61, s61, 1
v_mov_b32 v3, s61
s_mov_b32 s60, 160
v_mov_b32 v2, s60
v_mov_b32 v1, 0x40000000
v_cmp_gt_u32 vcc, 1, v0
s_nop 1
v_cndmask_b32 v2, v1, v2, vcc
buffer_store_dword v3, v2, s[20:23], 0 offen sc1
Lns_131:
v_mov_b32 v16, 0
s_cmp_lg_u32 s100, 0
s_cbranch_scc1 Lws1_136
s_cmp_eq_u32 s48, 0
s_cbranch_scc1 Lws_135
s_barrier
Lws_135:
v_mov_b32 v16, 0
buffer_load_dwordx4 v[8:11], v16, s[20:23], 0 offen offset:128 sc1
buffer_load_dwordx4 v[12:15], v16, s[20:23], 0 offen offset:144 sc1
buffer_load_dword v18, v16, s[20:23], 0 offen offset:160 sc1
Lwsw1_139:
s_waitcnt vmcnt(0)
v_readfirstlane_b32 s97, v18
v_add3_u32 v17, v8, v9, v10
v_add3_u32 v17, v17, v11, v12
v_add3_u32 v17, v17, v13, v14
v_add_u32 v17, v17, v15
v_cmp_le_u32 vcc, 0x100, v17
s_nop 0
s_cmp_eq_u64 vcc, -1
s_cbranch_scc0 Lrt_140
s_cmp_lg_u32 s48, 0
s_cbranch_scc1 Lwsw_138
s_barrier
Lwsw_138:
v_or3_b32 v17, v8, v9, v10
v_or3_b32 v17, v17, v11, v12
v_or3_b32 v17, v17, v13, v14
v_or_b32 v17, v17, v15
v_cmp_eq_u32 vcc, 256, v17
s_nop 0
s_cmp_eq_u64 vcc, -1
s_cbranch_scc1 Lws2_137
s_branch L_restart
Lws1_136:
buffer_load_dword v8, v16, s[20:23], 0 offen sc1
s_waitcnt vmcnt(0)
v_cmp_le_u32 vcc, 0x100, v8
s_nop 0
s_cmp_eq_u64 vcc, -1
s_cbranch_scc0 Lrt_141
Lws2_137:
s_cmp_lg_u32 s48, 0
s_cbranch_scc1 Lwl2_134
v_mov_b32 v1, 12
Lwl_133:
buffer_load_dword v2, v1, s[20:23], 0 offen sc1
s_waitcnt vmcnt(0)
v_cmp_le_u32 vcc, 48, v2
s_nop 0
s_cmp_eq_u64 vcc, -1
s_cbranch_scc0 Lrt_142
Lwl2_134:
s_barrier
s_lshr_b32 s61, s48, 1
s_lshl_b32 s61, s61, 12
s_and_b32 s60, s48, 1
s_lshl_b32 s60, s60, 6
s_add_u32 s61, s61, s60
v_lshrrev_b32 v1, 4, v0
v_bfe_u32 v2, v0, 2, 2
v_and_b32 v3, 3, v0
v_mul_u32_u24 v1, 8, v1
v_add_u32 v1, v1, v2
v_mul_u32_u24 v1, 128, v1
v_mul_u32_u24 v3, 16, v3
v_add3_u32 v8, v1, v3, s61
s_lshl_b32 s72, s70, 16
s_lshl_b32 s60, s67, 8
s_add_u32 s72, s72, s60
s_add_u32 s69, s72, 128
v_lshrrev_b32 v1, 3, v0
s_lshl_b32 s60, s48, 3
v_add_u32 v1, s60, v1
v_mul_u32_u24 v1, 2048, v1
v_and_b32 v2, 7, v0
v_lshlrev_b32 v2, 4, v2
v_add_u32 v11, v1, v2
v_add_u32 v9, 65536, v8
v_add_u32 v10, 131072, v8
s_lshl_b32 s62, s48, 10
s_add_u32 m0, s62, 0
s_add_u32 s63, s72, 0x0
buffer_load_dwordx4 v11, s[12:15], s63 offen lds
s_add_u32 m0, s62, 4096
s_add_u32 s63, s69, 0x0
buffer_load_dwordx4 v11, s[12:15], s63 offen lds
s_add_u32 m0, s62, 8192
s_add_u32 s63, s72, 0x10000
buffer_load_dwordx4 v11, s[12:15], s63 offen lds
s_add_u32 m0, s62, 12288
s_add_u32 s63, s69, 0x10000
buffer_load_dwordx4 v11, s[12:15], s63 offen lds
s_add_u32 m0, s62, 16384
s_add_u32 s63, s72, 0x20000
buffer_load_dwordx4 v11, s[12:15], s63 offen lds
s_add_u32 m0, s62, 20480
s_add_u32 s63, s69, 0x20000
buffer_load_dwordx4 v11, s[12:15], s63 offen lds
s_add_u32 m0, s62, 24576
s_add_u32 s63, s72, 0x30000
buffer_load_dwordx4 v11, s[12:15], s63 offen lds
s_add_u32 m0, s62, 28672
s_add_u32 s63, s69, 0x30000
buffer_load_dwordx4 v11, s[12:15], s63 offen lds
s_add_u32 m0, s62, 32768
s_add_u32 s63, s72, 0x40000
buffer_load_dwordx4 v11, s[12:15], s63 offen lds
s_add_u32 m0, s62, 36864
s_add_u32 s63, s69, 0x40000
buffer_load_dwordx4 v11, s[12:15], s63 offen lds
s_add_u32 m0, s62, 40960
s_add_u32 s63, s72, 0x50000
buffer_load_dwordx4 v11, s[12:15], s63 offen lds
s_add_u32 m0, s62, 45056
s_add_u32 s63, s69, 0x50000
buffer_load_dwordx4 v11, s[12:15], s63 offen lds
s_add_u32 m0, s62, 49152
s_add_u32 s63, s72, 0x60000
buffer_load_dwordx4 v11, s[12:15], s63 offen lds
s_add_u32 m0, s62, 53248
s_add_u32 s63, s69, 0x60000
buffer_load_dwordx4 v11, s[12:15], s63 offen lds
s_add_u32 m0, s62, 57344
s_add_u32 s63, s72, 0x70000
buffer_load_dwordx4 v11, s[12:15], s63 offen lds
s_add_u32 m0, s62, 61440
s_add_u32 s63, s69, 0x70000
buffer_load_dwordx4 v11, s[12:15], s63 offen lds
s_add_u32 m0, s62, 65536
s_add_u32 s63, s72, 0x80000
buffer_load_dwordx4 v11, s[12:15], s63 offen lds
s_add_u32 m0, s62, 69632
s_add_u32 s63, s69, 0x80000
buffer_load_dwordx4 v11, s[12:15], s63 offen lds
s_add_u32 m0, s62, 73728
s_add_u32 s63, s72, 0x90000
buffer_load_dwordx4 v11, s[12:15], s63 offen lds
s_add_u32 m0, s62, 77824
s_add_u32 s63, s69, 0x90000
buffer_load_dwordx4 v11, s[12:15], s63 offen lds
s_add_u32 m0, s62, 81920
s_add_u32 s63, s72, 0xa0000
buffer_load_dwordx4 v11, s[12:15], s63 offen lds
s_add_u32 m0, s62, 86016
s_add_u32 s63, s69, 0xa0000
buffer_load_dwordx4 v11, s[12:15], s63 offen lds
s_add_u32 m0, s62, 90112
s_add_u32 s63, s72, 0xb0000
buffer_load_dwordx4 v11, s[12:15], s63 offen lds
s_add_u32 m0, s62, 94208
s_add_u32 s63, s69, 0xb0000
buffer_load_dwordx4 v11, s[12:15], s63 offen lds
s_add_u32 m0, s62, 98304
s_add_u32 s63, s72, 0xc0000
buffer_load_dwordx4 v11, s[12:15], s63 offen lds
s_add_u32 m0, s62, 102400
s_add_u32 s63, s69, 0xc0000
buffer_load_dwordx4 v11, s[12:15], s63 offen lds
s_add_u32 m0, s62, 106496
s_add_u32 s63, s72, 0xd0000
buffer_load_dwordx4 v11, s[12:15], s63 offen lds
s_add_u32 m0, s62, 110592
s_add_u32 s63, s69, 0xd0000
buffer_load_dwordx4 v11, s[12:15], s63 offen lds
s_add_u32 m0, s62, 114688
s_add_u32 s63, s72, 0xe0000
buffer_load_dwordx4 v11, s[12:15], s63 offen lds
s_add_u32 m0, s62, 118784
s_add_u32 s63, s69, 0xe0000
buffer_load_dwordx4 v11, s[12:15], s63 offen lds
s_add_u32 m0, s62, 122880
s_add_u32 s63, s72, 0xf0000
buffer_load_dwordx4 v11, s[12:15], s63 offen lds
s_add_u32 m0, s62, 126976
s_add_u32 s63, s69, 0xf0000
buffer_load_dwordx4 v11, s[12:15], s63 offen lds
s_add_u32 m0, s62, 131072
s_add_u32 s63, s72, 0x100000
buffer_load_dwordx4 v11, s[12:15], s63 offen lds
s_add_u32 m0, s62, 135168
s_add_u32 s63, s69, 0x100000
buffer_load_dwordx4 v11, s[12:15], s63 offen lds
s_add_u32 m0, s62, 139264
s_add_u32 s63, s72, 0x110000
buffer_load_dwordx4 v11, s[12:15], s63 offen lds
s_add_u32 m0, s62, 143360
s_add_u32 s63, s69, 0x110000
buffer_load_dwordx4 v11, s[12:15], s63 offen lds
s_add_u32 m0, s62, 147456
s_add_u32 s63, s72, 0x120000
buffer_load_dwordx4 v11, s[12:15], s63 offen lds
s_add_u32 m0, s62, 151552
s_add_u32 s63, s69, 0x120000
buffer_load_dwordx4 v11, s[12:15], s63 offen lds
s_add_u32 m0, s62, 155648
s_add_u32 s63, s72, 0x130000
buffer_load_dwordx4 v11, s[12:15], s63 offen lds
s_add_u32 m0, s62, 159744
s_add_u32 s63, s69, 0x130000
buffer_load_dwordx4 v11, s[12:15], s63 offen lds
s_waitcnt vmcnt(38) lgkmcnt(0)
s_barrier
ds_read_b64_tr_b16 a[0:1], v8 offset:0
ds_read_b64_tr_b16 a[2:3], v8 offset:512
ds_read_b64_tr_b16 a[4:5], v8 offset:8
ds_read_b64_tr_b16 a[6:7], v8 offset:520
s_waitcnt vmcnt(36) lgkmcnt(0)
s_barrier
s_add_u32 m0, s62, 0
s_add_u32 s63, s72, 0x140000
buffer_load_dwordx4 v11, s[12:15], s63 offen lds
s_add_u32 m0, s62, 4096
s_add_u32 s63, s69, 0x140000
buffer_load_dwordx4 v11, s[12:15], s63 offen lds
ds_read_b64_tr_b16 a[8:9], v8 offset:8192
ds_read_b64_tr_b16 a[10:11], v8 offset:8704
ds_read_b64_tr_b16 a[12:13], v8 offset:8200
ds_read_b64_tr_b16 a[14:15], v8 offset:8712
s_waitcnt vmcnt(36) lgkmcnt(0)
s_barrier
s_add_u32 m0, s62, 8192
s_add_u32 s63, s72, 0x150000
buffer_load_dwordx4 v11, s[12:15], s63 offen lds
s_add_u32 m0, s62, 12288
s_add_u32 s63, s69, 0x150000
buffer_load_dwordx4 v11, s[12:15], s63 offen lds
ds_read_b64_tr_b16 a[16:17], v8 offset:16384
ds_read_b64_tr_b16 a[18:19], v8 offset:16896
ds_read_b64_tr_b16 a[20:21], v8 offset:16392
ds_read_b64_tr_b16 a[22:23], v8 offset:16904
s_waitcnt vmcnt(36) lgkmcnt(0)
s_barrier
s_add_u32 m0, s62, 16384
s_add_u32 s63, s72, 0x160000
buffer_load_dwordx4 v11, s[12:15], s63 offen lds
s_add_u32 m0, s62, 20480
s_add_u32 s63, s69, 0x160000
buffer_load_dwordx4 v11, s[12:15], s63 offen lds
ds_read_b64_tr_b16 a[24:25], v8 offset:24576
ds_read_b64_tr_b16 a[26:27], v8 offset:25088
ds_read_b64_tr_b16 a[28:29], v8 offset:24584
ds_read_b64_tr_b16 a[30:31], v8 offset:25096
s_waitcnt vmcnt(36) lgkmcnt(0)
s_barrier
s_add_u32 m0, s62, 24576
s_add_u32 s63, s72, 0x170000
buffer_load_dwordx4 v11, s[12:15], s63 offen lds
s_add_u32 m0, s62, 28672
s_add_u32 s63, s69, 0x170000
buffer_load_dwordx4 v11, s[12:15], s63 offen lds
ds_read_b64_tr_b16 a[32:33], v8 offset:32768
ds_read_b64_tr_b16 a[34:35], v8 offset:33280
ds_read_b64_tr_b16 a[36:37], v8 offset:32776
ds_read_b64_tr_b16 a[38:39], v8 offset:33288
s_waitcnt vmcnt(36) lgkmcnt(0)
s_barrier
s_add_u32 m0, s62, 32768
s_add_u32 s63, s72, 0x180000
buffer_load_dwordx4 v11, s[12:15], s63 offen lds
s_add_u32 m0, s62, 36864
s_add_u32 s63, s69, 0x180000
buffer_load_dwordx4 v11, s[12:15], s63 offen lds
ds_read_b64_tr_b16 a[40:41], v8 offset:40960
ds_read_b64_tr_b16 a[42:43], v8 offset:41472
ds_read_b64_tr_b16 a[44:45], v8 offset:40968
ds_read_b64_tr_b16 a[46:47], v8 offset:41480
s_waitcnt vmcnt(36) lgkmcnt(0)
s_barrier
s_add_u32 m0, s62, 40960
s_add_u32 s63, s72, 0x190000
buffer_load_dwordx4 v11, s[12:15], s63 offen lds
s_add_u32 m0, s62, 45056
s_add_u32 s63, s69, 0x190000
buffer_load_dwordx4 v11, s[12:15], s63 offen lds
ds_read_b64_tr_b16 a[48:49], v8 offset:49152
ds_read_b64_tr_b16 a[50:51], v8 offset:49664
ds_read_b64_tr_b16 a[52:53], v8 offset:49160
ds_read_b64_tr_b16 a[54:55], v8 offset:49672
s_waitcnt vmcnt(36) lgkmcnt(0)
s_barrier
s_add_u32 m0, s62, 49152
s_add_u32 s63, s72, 0x1a0000
buffer_load_dwordx4 v11, s[12:15], s63 offen lds
s_add_u32 m0, s62, 53248
s_add_u32 s63, s69, 0x1a0000
buffer_load_dwordx4 v11, s[12:15], s63 offen lds
ds_read_b64_tr_b16 a[56:57], v8 offset:57344
ds_read_b64_tr_b16 a[58:59], v8 offset:57856
ds_read_b64_tr_b16 a[60:61], v8 offset:57352
ds_read_b64_tr_b16 a[62:63], v8 offset:57864
s_waitcnt vmcnt(36) lgkmcnt(0)
s_barrier
s_add_u32 m0, s62, 57344
s_add_u32 s63, s72, 0x1b0000
buffer_load_dwordx4 v11, s[12:15], s63 offen lds
s_add_u32 m0, s62, 61440
s_add_u32 s63, s69, 0x1b0000
buffer_load_dwordx4 v11, s[12:15], s63 offen lds
ds_read_b64_tr_b16 a[64:65], v9 offset:0
ds_read_b64_tr_b16 a[66:67], v9 offset:512
ds_read_b64_tr_b16 a[68:69], v9 offset:8
ds_read_b64_tr_b16 a[70:71], v9 offset:520
s_waitcnt vmcnt(36) lgkmcnt(0)
s_barrier
s_add_u32 m0, s62, 65536
s_add_u32 s63, s72, 0x1c0000
buffer_load_dwordx4 v11, s[12:15], s63 offen lds
s_add_u32 m0, s62, 69632
s_add_u32 s63, s69, 0x1c0000
buffer_load_dwordx4 v11, s[12:15], s63 offen lds
ds_read_b64_tr_b16 a[72:73], v9 offset:8192
ds_read_b64_tr_b16 a[74:75], v9 offset:8704
ds_read_b64_tr_b16 a[76:77], v9 offset:8200
ds_read_b64_tr_b16 a[78:79], v9 offset:8712
s_waitcnt vmcnt(36) lgkmcnt(0)
s_barrier
s_add_u32 m0, s62, 73728
s_add_u32 s63, s72, 0x1d0000
buffer_load_dwordx4 v11, s[12:15], s63 offen lds
s_add_u32 m0, s62, 77824
s_add_u32 s63, s69, 0x1d0000
buffer_load_dwordx4 v11, s[12:15], s63 offen lds
ds_read_b64_tr_b16 a[80:81], v9 offset:16384
ds_read_b64_tr_b16 a[82:83], v9 offset:16896
ds_read_b64_tr_b16 a[84:85], v9 offset:16392
ds_read_b64_tr_b16 a[86:87], v9 offset:16904
s_waitcnt vmcnt(36) lgkmcnt(0)
s_barrier
s_add_u32 m0, s62, 81920
s_add_u32 s63, s72, 0x1e0000
buffer_load_dwordx4 v11, s[12:15], s63 offen lds
s_add_u32 m0, s62, 86016
s_add_u32 s63, s69, 0x1e0000
buffer_load_dwordx4 v11, s[12:15], s63 offen lds
ds_read_b64_tr_b16 a[88:89], v9 offset:24576
ds_read_b64_tr_b16 a[90:91], v9 offset:25088
ds_read_b64_tr_b16 a[92:93], v9 offset:24584
ds_read_b64_tr_b16 a[94:95], v9 offset:25096
s_waitcnt vmcnt(36) lgkmcnt(0)
s_barrier
s_add_u32 m0, s62, 90112
s_add_u32 s63, s72, 0x1f0000
buffer_load_dwordx4 v11, s[12:15], s63 offen lds
s_add_u32 m0, s62, 94208
s_add_u32 s63, s69, 0x1f0000
buffer_load_dwordx4 v11, s[12:15], s63 offen lds
ds_read_b64_tr_b16 a[96:97], v9 offset:32768
ds_read_b64_tr_b16 a[98:99], v9 offset:33280
ds_read_b64_tr_b16 a[100:101], v9 offset:32776
ds_read_b64_tr_b16 a[102:103], v9 offset:33288
s_waitcnt vmcnt(36) lgkmcnt(0)
s_barrier
s_add_u32 m0, s62, 98304
s_add_u32 s63, s72, 0x200000
buffer_load_dwordx4 v11, s[12:15], s63 offen lds
s_add_u32 m0, s62, 102400
s_add_u32 s63, s69, 0x200000
buffer_load_dwordx4 v11, s[12:15], s63 offen lds
ds_read_b64_tr_b16 a[104:105], v9 offset:40960
ds_read_b64_tr_b16 a[106:107], v9 offset:41472
ds_read_b64_tr_b16 a[108:109], v9 offset:40968
ds_read_b64_tr_b16 a[110:111], v9 offset:41480
s_waitcnt vmcnt(36) lgkmcnt(0)
s_barrier
s_add_u32 m0, s62, 106496
s_add_u32 s63, s72, 0x210000
buffer_load_dwordx4 v11, s[12:15], s63 offen lds
s_add_u32 m0, s62, 110592
s_add_u32 s63, s69, 0x210000
buffer_load_dwordx4 v11, s[12:15], s63 offen lds
ds_read_b64_tr_b16 a[112:113], v9 offset:49152
ds_read_b64_tr_b16 a[114:115], v9 offset:49664
ds_read_b64_tr_b16 a[116:117], v9 offset:49160
ds_read_b64_tr_b16 a[118:119], v9 offset:49672
s_waitcnt vmcnt(36) lgkmcnt(0)
s_barrier
s_add_u32 m0, s62, 114688
s_add_u32 s63, s72, 0x220000
buffer_load_dwordx4 v11, s[12:15], s63 offen lds
s_add_u32 m0, s62, 118784
s_add_u32 s63, s69, 0x220000
buffer_load_dwordx4 v11, s[12:15], s63 offen lds
ds_read_b64_tr_b16 a[120:121], v9 offset:57344
ds_read_b64_tr_b16 a[122:123], v9 offset:57856
ds_read_b64_tr_b16 a[124:125], v9 offset:57352
ds_read_b64_tr_b16 a[126:127], v9 offset:57864
s_waitcnt vmcnt(36) lgkmcnt(0)
s_barrier
s_add_u32 m0, s62, 122880
s_add_u32 s63, s72, 0x230000
buffer_load_dwordx4 v11, s[12:15], s63 offen lds
s_add_u32 m0, s62, 126976
s_add_u32 s63, s69, 0x230000
buffer_load_dwordx4 v11, s[12:15], s63 offen lds
ds_read_b64_tr_b16 a[128:129], v10 offset:0
ds_read_b64_tr_b16 a[130:131], v10 offset:512
ds_read_b64_tr_b16 a[132:133], v10 offset:8
ds_read_b64_tr_b16 a[134:135], v10 offset:520
s_waitcnt vmcnt(36) lgkmcnt(0)
s_barrier
s_add_u32 m0, s62, 131072
s_add_u32 s63, s72, 0x240000
buffer_load_dwordx4 v11, s[12:15], s63 offen lds
s_add_u32 m0, s62, 135168
s_add_u32 s63, s69, 0x240000
buffer_load_dwordx4 v11, s[12:15], s63 offen lds
ds_read_b64_tr_b16 a[136:137], v10 offset:8192
ds_read_b64_tr_b16 a[138:139], v10 offset:8704
ds_read_b64_tr_b16 a[140:141], v10 offset:8200
ds_read_b64_tr_b16 a[142:143], v10 offset:8712
s_waitcnt vmcnt(36) lgkmcnt(0)
s_barrier
s_add_u32 m0, s62, 139264
s_add_u32 s63, s72, 0x250000
buffer_load_dwordx4 v11, s[12:15], s63 offen lds
s_add_u32 m0, s62, 143360
s_add_u32 s63, s69, 0x250000
buffer_load_dwordx4 v11, s[12:15], s63 offen lds
ds_read_b64_tr_b16 a[144:145], v10 offset:16384
ds_read_b64_tr_b16 a[146:147], v10 offset:16896
ds_read_b64_tr_b16 a[148:149], v10 offset:16392
ds_read_b64_tr_b16 a[150:151], v10 offset:16904
s_waitcnt vmcnt(36) lgkmcnt(0)
s_barrier
s_add_u32 m0, s62, 147456
s_add_u32 s63, s72, 0x260000
buffer_load_dwordx4 v11, s[12:15], s63 offen lds
s_add_u32 m0, s62, 151552
s_add_u32 s63, s69, 0x260000
buffer_load_dwordx4 v11, s[12:15], s63 offen lds
ds_read_b64_tr_b16 a[152:153], v10 offset:24576
ds_read_b64_tr_b16 a[154:155], v10 offset:25088
ds_read_b64_tr_b16 a[156:157], v10 offset:24584
ds_read_b64_tr_b16 a[158:159], v10 offset:25096
s_waitcnt vmcnt(36) lgkmcnt(0)
s_barrier
s_add_u32 m0, s62, 155648
s_add_u32 s63, s72, 0x270000
buffer_load_dwordx4 v11, s[12:15], s63 offen lds
s_add_u32 m0, s62, 159744
s_add_u32 s63, s69, 0x270000
buffer_load_dwordx4 v11, s[12:15], s63 offen lds
ds_read_b64_tr_b16 a[160:161], v8 offset:0
ds_read_b64_tr_b16 a[162:163], v8 offset:512
ds_read_b64_tr_b16 a[164:165], v8 offset:8
ds_read_b64_tr_b16 a[166:167], v8 offset:520
s_waitcnt vmcnt(36) lgkmcnt(0)
s_barrier
ds_read_b64_tr_b16 a[168:169], v8 offset:8192
ds_read_b64_tr_b16 a[170:171], v8 offset:8704
ds_read_b64_tr_b16 a[172:173], v8 offset:8200
ds_read_b64_tr_b16 a[174:175], v8 offset:8712
s_waitcnt vmcnt(34) lgkmcnt(0)
s_barrier
ds_read_b64_tr_b16 a[176:177], v8 offset:16384
ds_read_b64_tr_b16 a[178:179], v8 offset:16896
ds_read_b64_tr_b16 a[180:181], v8 offset:16392
ds_read_b64_tr_b16 a[182:183], v8 offset:16904
s_waitcnt vmcnt(32) lgkmcnt(0)
s_barrier
ds_read_b64_tr_b16 a[184:185], v8 offset:24576
ds_read_b64_tr_b16 a[186:187], v8 offset:25088
ds_read_b64_tr_b16 a[188:189], v8 offset:24584
ds_read_b64_tr_b16 a[190:191], v8 offset:25096
s_waitcnt vmcnt(30) lgkmcnt(0)
s_barrier
ds_read_b64_tr_b16 a[192:193], v8 offset:32768
ds_read_b64_tr_b16 a[194:195], v8 offset:33280
ds_read_b64_tr_b16 a[196:197], v8 offset:32776
ds_read_b64_tr_b16 a[198:199], v8 offset:33288
s_waitcnt vmcnt(28) lgkmcnt(0)
s_barrier
ds_read_b64_tr_b16 a[200:201], v8 offset:40960
ds_read_b64_tr_b16 a[202:203], v8 offset:41472
ds_read_b64_tr_b16 a[204:205], v8 offset:40968
ds_read_b64_tr_b16 a[206:207], v8 offset:41480
s_waitcnt vmcnt(26) lgkmcnt(0)
s_barrier
ds_read_b64_tr_b16 a[208:209], v8 offset:49152
ds_read_b64_tr_b16 a[210:211], v8 offset:49664
ds_read_b64_tr_b16 a[212:213], v8 offset:49160
ds_read_b64_tr_b16 a[214:215], v8 offset:49672
s_waitcnt vmcnt(24) lgkmcnt(0)
s_barrier
ds_read_b64_tr_b16 a[216:217], v8 offset:57344
ds_read_b64_tr_b16 a[218:219], v8 offset:57856
ds_read_b64_tr_b16 a[220:221], v8 offset:57352
ds_read_b64_tr_b16 a[222:223], v8 offset:57864
s_waitcnt vmcnt(22) lgkmcnt(0)
s_barrier
ds_read_b64_tr_b16 a[224:225], v9 offset:0
ds_read_b64_tr_b16 a[226:227], v9 offset:512
ds_read_b64_tr_b16 a[228:229], v9 offset:8
ds_read_b64_tr_b16 a[230:231], v9 offset:520
s_waitcnt vmcnt(20) lgkmcnt(0)
s_barrier
ds_read_b64_tr_b16 a[232:233], v9 offset:8192
ds_read_b64_tr_b16 a[234:235], v9 offset:8704
ds_read_b64_tr_b16 a[236:237], v9 offset:8200
ds_read_b64_tr_b16 a[238:239], v9 offset:8712
s_waitcnt vmcnt(18) lgkmcnt(0)
s_barrier
ds_read_b64_tr_b16 a[240:241], v9 offset:16384
ds_read_b64_tr_b16 a[242:243], v9 offset:16896
ds_read_b64_tr_b16 a[244:245], v9 offset:16392
ds_read_b64_tr_b16 a[246:247], v9 offset:16904
s_waitcnt vmcnt(16) lgkmcnt(0)
s_barrier
ds_read_b64_tr_b16 a[248:249], v9 offset:24576
ds_read_b64_tr_b16 a[250:251], v9 offset:25088
ds_read_b64_tr_b16 a[252:253], v9 offset:24584
ds_read_b64_tr_b16 a[254:255], v9 offset:25096
s_waitcnt vmcnt(14) lgkmcnt(0)
s_barrier
ds_read_b64_tr_b16 v[192:193], v9 offset:32768
ds_read_b64_tr_b16 v[194:195], v9 offset:33280
ds_read_b64_tr_b16 v[196:197], v9 offset:32776
ds_read_b64_tr_b16 v[198:199], v9 offset:33288
s_waitcnt vmcnt(12) lgkmcnt(0)
s_barrier
ds_read_b64_tr_b16 v[200:201], v9 offset:40960
ds_read_b64_tr_b16 v[202:203], v9 offset:41472
ds_read_b64_tr_b16 v[204:205], v9 offset:40968
ds_read_b64_tr_b16 v[206:207], v9 offset:41480
s_waitcnt vmcnt(10) lgkmcnt(0)
s_barrier
ds_read_b64_tr_b16 v[208:209], v9 offset:49152
ds_read_b64_tr_b16 v[210:211], v9 offset:49664
ds_read_b64_tr_b16 v[212:213], v9 offset:49160
ds_read_b64_tr_b16 v[214:215], v9 offset:49672
s_waitcnt vmcnt(8) lgkmcnt(0)
s_barrier
ds_read_b64_tr_b16 v[216:217], v9 offset:57344
ds_read_b64_tr_b16 v[218:219], v9 offset:57856
ds_read_b64_tr_b16 v[220:221], v9 offset:57352
ds_read_b64_tr_b16 v[222:223], v9 offset:57864
s_waitcnt vmcnt(6) lgkmcnt(0)
s_barrier
ds_read_b64_tr_b16 v[224:225], v10 offset:0
ds_read_b64_tr_b16 v[226:227], v10 offset:512
ds_read_b64_tr_b16 v[228:229], v10 offset:8
ds_read_b64_tr_b16 v[230:231], v10 offset:520
s_waitcnt vmcnt(4) lgkmcnt(0)
s_barrier
ds_read_b64_tr_b16 v[232:233], v10 offset:8192
ds_read_b64_tr_b16 v[234:235], v10 offset:8704
ds_read_b64_tr_b16 v[236:237], v10 offset:8200
ds_read_b64_tr_b16 v[238:239], v10 offset:8712
s_waitcnt vmcnt(2) lgkmcnt(0)
s_barrier
ds_read_b64_tr_b16 v[240:241], v10 offset:16384
ds_read_b64_tr_b16 v[242:243], v10 offset:16896
ds_read_b64_tr_b16 v[244:245], v10 offset:16392
ds_read_b64_tr_b16 v[246:247], v10 offset:16904
s_waitcnt vmcnt(0) lgkmcnt(0)
s_barrier
ds_read_b64_tr_b16 v[248:249], v10 offset:24576
ds_read_b64_tr_b16 v[250:251], v10 offset:25088
ds_read_b64_tr_b16 v[252:253], v10 offset:24584
ds_read_b64_tr_b16 v[254:255], v10 offset:25096
s_waitcnt lgkmcnt(0)
v_lshlrev_b32 v106, 4, v0
s_lshr_b32 s62, s70, 1
v_min_u32 v1, 19, v0
v_add_u32 v1, s62, v1
v_mul_u32_u24 v1, 256, v1
v_add_u32 v113, 69632, v1
v_and_b32 v1, 0xffffe000, v113
v_add_u32 v113, v1, v113
s_lshl_b32 s60, s68, 11
v_add_u32 v112, s60, v106
s_mul_i32 s73, s66, 0x10000
s_add_u32 s73, s73, 0xe800000
s_barrier
s_mov_b32 s62, 0
s_cmp_lg_u32 s100, 0
s_cbranch_scc1 Lnear2_144
s_cmp_lg_u32 s97, 0
s_cbranch_scc1 Lnear3_145
v_mov_b32 v1, 160
Lnear_143:
buffer_load_dword v1, v1, s[20:23], 0 offen sc1
s_waitcnt vmcnt(0)
v_readfirstlane_b32 s97, v1
v_mov_b32 v1, 160
s_cmp_eq_u32 s97, 0
s_cbranch_scc1 Lrt_146
Lnear3_145:
s_and_b32 s62, s97, 2
s_lshl_b32 s62, s62, 12
Lnear2_144:
s_xor_b32 s63, s62, 0x2000
v_add_u32 v110, s62, v110
v_add_u32 v113, s62, v113
s_add_u32 s71, s71, 0xb400000
s_mul_i32 s25, s48, 20480
v_add_u32 v107, s25, v106
s_add_u32 s65, s25, 81920
s_add_u32 s28, s49, 0
s_and_b32 s28, s28, 3
s_mul_i32 s28, s28, 4096
s_add_u32 s29, s49, 1
s_and_b32 s29, s29, 3
s_mul_i32 s29, s29, 4096
s_add_u32 s30, s49, 2
s_and_b32 s30, s30, 3
s_mul_i32 s30, s30, 4096
s_add_u32 s31, s49, 3
s_and_b32 s31, s31, 3
s_mul_i32 s31, s31, 4096
s_lshl_b32 s27, s48, 9
s_add_u32 s27, s27, 19456
v_lshrrev_b32 v120, 2, v106
v_add_u32 v120, 19456, v120
s_cmp_eq_u32 s48, 0
s_mov_b32 s41, 18432
s_cselect_b32 s41, 19456, s41
v_mov_b32 v121, v120
s_add_u32 s27, s41, 81920
v_add_u32 v120, 81920, v121
s_cmp_eq_u32 s48, 0
s_cselect_b32 s60, 0, 0x40000000
v_or_b32 v113, s60, v113
s_mov_b32 s53, 0
s_mov_b32 s54, 0
s_mov_b32 s52, 0
v_mov_b32 v104, v106
s_mov_b32 s59, 0x40000000
v_mov_b32 v111, 0
s_mov_b32 s98, 64
s_mov_b32 s99, 0xffffffee
s_mov_b32 s74, 0x40000000
s_add_u32 s60, s53, 1
s_add_u32 s99, s99, 1
s_cmp_lt_u32 s99, 93
s_cselect_b32 s24, s98, s60
s_cselect_b32 s98, s60, s98
s_branch LDNP_slow
.p2align 6
LDNP_top:
s_waitcnt lgkmcnt(4)
v_mfma_f32_16x16x32_bf16 v[8:11], a[0:3], v[32:35], 0
s_mov_b32 s52, s53
ds_read_b128 v[56:59], v104 offset:6144
s_mov_b32 s53, s24
v_mfma_f32_16x16x32_bf16 v[12:15], a[4:7], v[32:35], 0
s_mov_b32 s10, s51
ds_read_b128 v[60:63], v104 offset:7168
s_mul_i32 s55, s53, 0x38000
v_mfma_f32_16x16x32_bf16 v[20:23], a[4:7], v[36:39], 0
s_add_u32 s55, s55, s71
s_sub_u32 s56, s65, s54
v_add_u32 v105, 0x10000, v104
v_mfma_f32_16x16x32_bf16 v[16:19], a[0:3], v[36:39], 0
s_waitcnt lgkmcnt(4)
s_and_b32 s26, s52, 64
s_lshl_b32 s26, s26, 12
v_mfma_f32_16x16x32_bf16 v[8:11], a[8:11], v[40:43], v[8:11]
s_add_u32 s27, s41, s54
ds_read_b128 v[32:35], v104 offset:8192
v_add_u32 v120, s54, v121
v_mfma_f32_16x16x32_bf16 v[12:15], a[12:15], v[40:43], v[12:15]
ds_read_b128 v[36:39], v104 offset:9216
v_cvt_pk_bf16_f32 v156, v72, v73
v_mfma_f32_16x16x32_bf16 v[20:23], a[12:15], v[44:47], v[20:23]
v_cvt_pk_bf16_f32 v157, v74, v75
v_cvt_pk_bf16_f32 v158, v76, v77
v_mfma_f32_16x16x32_bf16 v[16:19], a[8:11], v[44:47], v[16:19]
s_waitcnt lgkmcnt(4)
v_cvt_pk_bf16_f32 v159, v78, v79
buffer_store_dwordx4 v[156:159], v112, s[4:7], s74 offen offset:0 sc1
v_mfma_f32_16x16x32_bf16 v[8:11], a[16:19], v[48:51], v[8:11]
ds_read_b128 v[40:43], v104 offset:10240
v_cvt_pk_bf16_f32 v160, v80, v81
v_mfma_f32_16x16x32_bf16 v[12:15], a[20:23], v[48:51], v[12:15]
ds_read_b128 v[44:47], v104 offset:11264
v_cvt_pk_bf16_f32 v161, v82, v83
v_mfma_f32_16x16x32_bf16 v[20:23], a[20:23], v[52:55], v[20:23]
v_cvt_pk_bf16_f32 v162, v84, v85
v_cvt_pk_bf16_f32 v163, v86, v87
v_mfma_f32_16x16x32_bf16 v[16:19], a[16:19], v[52:55], v[16:19]
s_waitcnt lgkmcnt(4)
v_mfma_f32_16x16x32_bf16 v[8:11], a[24:27], v[56:59], v[8:11]
ds_read_b128 v[48:51], v104 offset:12288
buffer_store_dwordx4 v[160:163], v112, s[4:7], s74 offen offset:1024 sc1
v_mfma_f32_16x16x32_bf16 v[12:15], a[28:31], v[56:59], v[12:15]
ds_read_b128 v[52:55], v104 offset:13312
v_mfma_f32_16x16x32_bf16 v[20:23], a[28:31], v[60:63], v[20:23]
v_mfma_f32_16x16x32_bf16 v[16:19], a[24:27], v[60:63], v[16:19]
s_waitcnt lgkmcnt(4)
v_mfma_f32_16x16x32_bf16 v[8:11], a[32:35], v[32:35], v[8:11]
ds_read_b128 v[56:59], v104 offset:14336
v_mfma_f32_16x16x32_bf16 v[12:15], a[36:39], v[32:35], v[12:15]
s_add_u32 m0, s56, s28
ds_read_b128 v[60:63], v104 offset:15360
s_add_u32 s32, s55, s28
v_mfma_f32_16x16x32_bf16 v[20:23], a[36:39], v[36:39], v[20:23]
buffer_load_dwordx4 v107, s[8:11], s32 offen offset:0 sc1 lds
v_mfma_f32_16x16x32_bf16 v[16:19], a[32:35], v[36:39], v[16:19]
s_waitcnt lgkmcnt(4)
v_mfma_f32_16x16x32_bf16 v[8:11], a[40:43], v[40:43], v[8:11]
ds_read_b128 v[32:35], v104 offset:16384
v_mfma_f32_16x16x32_bf16 v[12:15], a[44:47], v[40:43], v[12:15]
ds_read_b128 v[36:39], v104 offset:17408
v_mfma_f32_16x16x32_bf16 v[20:23], a[44:47], v[44:47], v[20:23]
buffer_load_dwordx4 v107, s[8:11], s32 offen offset:1024 sc1 lds
v_mfma_f32_16x16x32_bf16 v[16:19], a[40:43], v[44:47], v[16:19]
s_waitcnt lgkmcnt(4)
v_mfma_f32_16x16x32_bf16 v[8:11], a[48:51], v[48:51], v[8:11]
ds_read_b128 v[40:43], v104 offset:18432
v_mfma_f32_16x16x32_bf16 v[12:15], a[52:55], v[48:51], v[12:15]
ds_read_b128 v[44:47], v104 offset:19456
v_mfma_f32_16x16x32_bf16 v[20:23], a[52:55], v[52:55], v[20:23]
buffer_load_dwordx4 v107, s[8:11], s32 offen offset:2048 sc1 lds
v_mfma_f32_16x16x32_bf16 v[16:19], a[48:51], v[52:55], v[16:19]
s_waitcnt lgkmcnt(4)
v_mfma_f32_16x16x32_bf16 v[8:11], a[56:59], v[56:59], v[8:11]
ds_read_b128 v[48:51], v104 offset:20480
v_mfma_f32_16x16x32_bf16 v[12:15], a[60:63], v[56:59], v[12:15]
ds_read_b128 v[52:55], v104 offset:21504
v_mfma_f32_16x16x32_bf16 v[20:23], a[60:63], v[60:63], v[20:23]
buffer_load_dwordx4 v107, s[8:11], s32 offen offset:3072 sc1 lds
v_mfma_f32_16x16x32_bf16 v[16:19], a[56:59], v[60:63], v[16:19]
s_waitcnt lgkmcnt(4)
v_mfma_f32_16x16x32_bf16 v[8:11], a[64:67], v[32:35], v[8:11]
ds_read_b128 v[56:59], v104 offset:22528
v_mfma_f32_16x16x32_bf16 v[12:15], a[68:71], v[32:35], v[12:15]
ds_read_b128 v[60:63], v104 offset:23552
s_add_u32 m0, s56, s29
v_mfma_f32_16x16x32_bf16 v[20:23], a[68:71], v[36:39], v[20:23]
s_add_u32 s32, s55, s29
buffer_load_dwordx4 v107, s[8:11], s32 offen offset:0 sc1 lds
v_mfma_f32_16x16x32_bf16 v[16:19], a[64:67], v[36:39], v[16:19]
s_waitcnt lgkmcnt(4)
v_mfma_f32_16x16x32_bf16 v[8:11], a[72:75], v[40:43], v[8:11]
ds_read_b128 v[32:35], v104 offset:24576
v_mfma_f32_16x16x32_bf16 v[12:15], a[76:79], v[40:43], v[12:15]
ds_read_b128 v[36:39], v104 offset:25600
v_mfma_f32_16x16x32_bf16 v[20:23], a[76:79], v[44:47], v[20:23]
buffer_load_dwordx4 v107, s[8:11], s32 offen offset:1024 sc1 lds
v_mfma_f32_16x16x32_bf16 v[16:19], a[72:75], v[44:47], v[16:19]
s_waitcnt lgkmcnt(4)
v_mfma_f32_16x16x32_bf16 v[8:11], a[80:83], v[48:51], v[8:11]
ds_read_b128 v[40:43], v104 offset:26624
v_mfma_f32_16x16x32_bf16 v[12:15], a[84:87], v[48:51], v[12:15]
ds_read_b128 v[44:47], v104 offset:27648
v_mfma_f32_16x16x32_bf16 v[20:23], a[84:87], v[52:55], v[20:23]
buffer_load_dwordx4 v107, s[8:11], s32 offen offset:2048 sc1 lds
v_mfma_f32_16x16x32_bf16 v[16:19], a[80:83], v[52:55], v[16:19]
s_waitcnt lgkmcnt(4)
v_mfma_f32_16x16x32_bf16 v[8:11], a[88:91], v[56:59], v[8:11]
ds_read_b128 v[48:51], v104 offset:28672
v_mfma_f32_16x16x32_bf16 v[12:15], a[92:95], v[56:59], v[12:15]
ds_read_b128 v[52:55], v104 offset:29696
v_mfma_f32_16x16x32_bf16 v[20:23], a[92:95], v[60:63], v[20:23]
buffer_load_dwordx4 v107, s[8:11], s32 offen offset:3072 sc1 lds
v_mfma_f32_16x16x32_bf16 v[16:19], a[88:91], v[60:63], v[16:19]
s_waitcnt lgkmcnt(4)
v_mfma_f32_16x16x32_bf16 v[8:11], a[96:99], v[32:35], v[8:11]
ds_read_b128 v[56:59], v104 offset:30720
v_mfma_f32_16x16x32_bf16 v[12:15], a[100:103], v[32:35], v[12:15]
ds_read_b128 v[60:63], v104 offset:31744
s_add_u32 m0, s56, s30
v_mfma_f32_16x16x32_bf16 v[20:23], a[100:103], v[36:39], v[20:23]
s_add_u32 s32, s55, s30
buffer_load_dwordx4 v107, s[8:11], s32 offen offset:0 sc1 lds
v_mfma_f32_16x16x32_bf16 v[16:19], a[96:99], v[36:39], v[16:19]
s_waitcnt lgkmcnt(4)
v_mfma_f32_16x16x32_bf16 v[8:11], a[104:107], v[40:43], v[8:11]
ds_read_b128 v[32:35], v104 offset:32768
v_mfma_f32_16x16x32_bf16 v[12:15], a[108:111], v[40:43], v[12:15]
ds_read_b128 v[36:39], v104 offset:33792
v_mfma_f32_16x16x32_bf16 v[20:23], a[108:111], v[44:47], v[20:23]
buffer_load_dwordx4 v107, s[8:11], s32 offen offset:1024 sc1 lds
v_mfma_f32_16x16x32_bf16 v[16:19], a[104:107], v[44:47], v[16:19]
s_waitcnt lgkmcnt(4)
v_mfma_f32_16x16x32_bf16 v[8:11], a[112:115], v[48:51], v[8:11]
ds_read_b128 v[40:43], v104 offset:34816
v_mfma_f32_16x16x32_bf16 v[12:15], a[116:119], v[48:51], v[12:15]
ds_read_b128 v[44:47], v104 offset:35840
v_mfma_f32_16x16x32_bf16 v[20:23], a[116:119], v[52:55], v[20:23]
buffer_load_dwordx4 v107, s[8:11], s32 offen offset:2048 sc1 lds
v_mfma_f32_16x16x32_bf16 v[16:19], a[112:115], v[52:55], v[16:19]
s_waitcnt lgkmcnt(4)
v_mfma_f32_16x16x32_bf16 v[8:11], a[120:123], v[56:59], v[8:11]
ds_read_b128 v[48:51], v104 offset:36864
v_mfma_f32_16x16x32_bf16 v[12:15], a[124:127], v[56:59], v[12:15]
ds_read_b128 v[52:55], v104 offset:37888
v_mfma_f32_16x16x32_bf16 v[20:23], a[124:127], v[60:63], v[20:23]
buffer_load_dwordx4 v107, s[8:11], s32 offen offset:3072 sc1 lds
s_waitcnt vmcnt(12)
v_mfma_f32_16x16x32_bf16 v[16:19], a[120:123], v[60:63], v[16:19]
s_waitcnt lgkmcnt(4)
s_barrier
v_mfma_f32_16x16x32_bf16 v[8:11], a[128:131], v[32:35], v[8:11]
ds_read_b128 v[56:59], v104 offset:38912
v_mfma_f32_16x16x32_bf16 v[12:15], a[132:135], v[32:35], v[12:15]
ds_read_b128 v[60:63], v104 offset:39936
v_mfma_f32_16x16x32_bf16 v[20:23], a[132:135], v[36:39], v[20:23]
buffer_store_dword v111, v110, s[4:7], s59 offen sc1
v_mfma_f32_16x16x32_bf16 v[16:19], a[128:131], v[36:39], v[16:19]
s_waitcnt lgkmcnt(4)
v_mfma_f32_16x16x32_bf16 v[8:11], a[136:139], v[40:43], v[8:11]
ds_read_b128 v[32:35], v104 offset:40960
v_mfma_f32_16x16x32_bf16 v[12:15], a[140:143], v[40:43], v[12:15]
ds_read_b128 v[36:39], v104 offset:41984
s_add_u32 m0, s56, s31
v_mfma_f32_16x16x32_bf16 v[20:23], a[140:143], v[44:47], v[20:23]
s_add_u32 s32, s55, s31
buffer_load_dwordx4 v107, s[8:11], s32 offen offset:0 sc1 lds
v_mfma_f32_16x16x32_bf16 v[16:19], a[136:139], v[44:47], v[16:19]
s_waitcnt lgkmcnt(4)
v_mfma_f32_16x16x32_bf16 v[8:11], a[144:147], v[48:51], v[8:11]
ds_read_b128 v[40:43], v104 offset:43008
v_mfma_f32_16x16x32_bf16 v[12:15], a[148:151], v[48:51], v[12:15]
ds_read_b128 v[44:47], v104 offset:44032
v_mfma_f32_16x16x32_bf16 v[20:23], a[148:151], v[52:55], v[20:23]
buffer_load_dwordx4 v107, s[8:11], s32 offen offset:1024 sc1 lds
v_mfma_f32_16x16x32_bf16 v[16:19], a[144:147], v[52:55], v[16:19]
s_waitcnt lgkmcnt(4)
v_mfma_f32_16x16x32_bf16 v[8:11], a[152:155], v[56:59], v[8:11]
ds_read_b128 v[48:51], v104 offset:45056
v_mfma_f32_16x16x32_bf16 v[12:15], a[156:159], v[56:59], v[12:15]
ds_read_b128 v[52:55], v104 offset:46080
v_mfma_f32_16x16x32_bf16 v[20:23], a[156:159], v[60:63], v[20:23]
buffer_load_dwordx4 v107, s[8:11], s32 offen offset:2048 sc1 lds
v_mfma_f32_16x16x32_bf16 v[16:19], a[152:155], v[60:63], v[16:19]
s_waitcnt lgkmcnt(4)
v_mfma_f32_16x16x32_bf16 v[8:11], a[160:163], v[32:35], v[8:11]
ds_read_b128 v[56:59], v104 offset:47104
v_mfma_f32_16x16x32_bf16 v[12:15], a[164:167], v[32:35], v[12:15]
ds_read_b128 v[60:63], v104 offset:48128
v_mfma_f32_16x16x32_bf16 v[20:23], a[164:167], v[36:39], v[20:23]
buffer_load_dwordx4 v107, s[8:11], s32 offen offset:3072 sc1 lds
v_mfma_f32_16x16x32_bf16 v[16:19], a[160:163], v[36:39], v[16:19]
s_waitcnt lgkmcnt(4)
v_mfma_f32_16x16x32_bf16 v[8:11], a[168:171], v[40:43], v[8:11]
ds_read_b128 v[32:35], v104 offset:49152
v_mfma_f32_16x16x32_bf16 v[12:15], a[172:175], v[40:43], v[12:15]
ds_read_b128 v[36:39], v104 offset:50176
s_add_u32 m0, s56, 16384
v_mfma_f32_16x16x32_bf16 v[20:23], a[172:175], v[44:47], v[20:23]
s_add_u32 s32, s55, 16384
buffer_load_dwordx4 v107, s[8:11], s32 offen offset:0 sc1 lds
v_mfma_f32_16x16x32_bf16 v[16:19], a[168:171], v[44:47], v[16:19]
s_waitcnt lgkmcnt(4)
v_mfma_f32_16x16x32_bf16 v[8:11], a[176:179], v[48:51], v[8:11]
ds_read_b128 v[40:43], v104 offset:51200
v_mfma_f32_16x16x32_bf16 v[12:15], a[180:183], v[48:51], v[12:15]
ds_read_b128 v[44:47], v104 offset:52224
v_mfma_f32_16x16x32_bf16 v[20:23], a[180:183], v[52:55], v[20:23]
buffer_load_dwordx4 v107, s[8:11], s32 offen offset:1024 sc1 lds
v_mfma_f32_16x16x32_bf16 v[16:19], a[176:179], v[52:55], v[16:19]
s_waitcnt lgkmcnt(4)
v_mfma_f32_16x16x32_bf16 v[8:11], a[184:187], v[56:59], v[8:11]
ds_read_b128 v[48:51], v104 offset:53248
v_mfma_f32_16x16x32_bf16 v[12:15], a[188:191], v[56:59], v[12:15]
ds_read_b128 v[52:55], v104 offset:54272
v_mfma_f32_16x16x32_bf16 v[20:23], a[188:191], v[60:63], v[20:23]
buffer_load_dwordx4 v107, s[8:11], s32 offen offset:2048 sc1 lds
v_mfma_f32_16x16x32_bf16 v[16:19], a[184:187], v[60:63], v[16:19]
s_waitcnt lgkmcnt(4)
v_mfma_f32_16x16x32_bf16 v[8:11], a[192:195], v[32:35], v[8:11]
ds_read_b128 v[56:59], v104 offset:55296
v_mfma_f32_16x16x32_bf16 v[12:15], a[196:199], v[32:35], v[12:15]
ds_read_b128 v[60:63], v104 offset:56320
v_mfma_f32_16x16x32_bf16 v[20:23], a[196:199], v[36:39], v[20:23]
buffer_load_dwordx4 v107, s[8:11], s32 offen offset:3072 sc1 lds
v_mfma_f32_16x16x32_bf16 v[16:19], a[192:195], v[36:39], v[16:19]
s_waitcnt lgkmcnt(4)
v_mfma_f32_16x16x32_bf16 v[8:11], a[200:203], v[40:43], v[8:11]
ds_read_b128 v[32:35], v104 offset:57344
v_mfma_f32_16x16x32_bf16 v[12:15], a[204:207], v[40:43], v[12:15]
ds_read_b128 v[36:39], v104 offset:58368
v_mfma_f32_16x16x32_bf16 v[20:23], a[204:207], v[44:47], v[20:23]
v_mfma_f32_16x16x32_bf16 v[16:19], a[200:203], v[44:47], v[16:19]
s_waitcnt lgkmcnt(4)
s_add_u32 s60, s53, 1
s_add_u32 s99, s99, 1
v_mfma_f32_16x16x32_bf16 v[8:11], a[208:211], v[48:51], v[8:11]
s_cmp_lt_u32 s99, 93
ds_read_b128 v[40:43], v104 offset:59392
s_cselect_b32 s24, s98, s60
v_mfma_f32_16x16x32_bf16 v[12:15], a[212:215], v[48:51], v[12:15]
s_cselect_b32 s98, s60, s98
ds_read_b128 v[44:47], v104 offset:60416
s_mov_b32 m0, s27
v_mfma_f32_16x16x32_bf16 v[20:23], a[212:215], v[52:55], v[20:23]
s_cmp_lt_u32 s24, 64
s_cselect_b32 s58, 0, 0x40000
buffer_load_dword v113, s[4:7], s58 offen sc1 lds
v_mfma_f32_16x16x32_bf16 v[16:19], a[208:211], v[52:55], v[16:19]
s_waitcnt lgkmcnt(4)
v_mfma_f32_16x16x32_bf16 v[8:11], a[216:219], v[56:59], v[8:11]
ds_read_b128 v[48:51], v104 offset:61440
v_mfma_f32_16x16x32_bf16 v[12:15], a[220:223], v[56:59], v[12:15]
ds_read_b128 v[52:55], v104 offset:62464
v_mfma_f32_16x16x32_bf16 v[20:23], a[220:223], v[60:63], v[20:23]
v_mfma_f32_16x16x32_bf16 v[16:19], a[216:219], v[60:63], v[16:19]
s_waitcnt lgkmcnt(4)
v_mfma_f32_16x16x32_bf16 v[8:11], a[224:227], v[32:35], v[8:11]
ds_read_b128 v[56:59], v104 offset:63488
v_mfma_f32_16x16x32_bf16 v[12:15], a[228:231], v[32:35], v[12:15]
ds_read_b128 v[60:63], v104 offset:64512
v_mfma_f32_16x16x32_bf16 v[20:23], a[228:231], v[36:39], v[20:23]
v_mfma_f32_16x16x32_bf16 v[16:19], a[224:227], v[36:39], v[16:19]
s_waitcnt lgkmcnt(4)
v_mfma_f32_16x16x32_bf16 v[8:11], a[232:235], v[40:43], v[8:11]
ds_read_b128 v[32:35], v105 offset:0
v_mfma_f32_16x16x32_bf16 v[12:15], a[236:239], v[40:43], v[12:15]
ds_read_b128 v[36:39], v105 offset:1024
v_mfma_f32_16x16x32_bf16 v[20:23], a[236:239], v[44:47], v[20:23]
v_mfma_f32_16x16x32_bf16 v[16:19], a[232:235], v[44:47], v[16:19]
s_waitcnt lgkmcnt(4)
v_mfma_f32_16x16x32_bf16 v[8:11], a[240:243], v[48:51], v[8:11]
ds_read_b128 v[40:43], v105 offset:2048
v_mfma_f32_16x16x32_bf16 v[12:15], a[244:247], v[48:51], v[12:15]
ds_read_b128 v[44:47], v105 offset:3072
v_mfma_f32_16x16x32_bf16 v[20:23], a[244:247], v[52:55], v[20:23]
v_mfma_f32_16x16x32_bf16 v[16:19], a[240:243], v[52:55], v[16:19]
s_waitcnt lgkmcnt(4)
v_mfma_f32_16x16x32_bf16 v[8:11], a[248:251], v[56:59], v[8:11]
ds_read_b128 v[48:51], v105 offset:4096
v_mfma_f32_16x16x32_bf16 v[12:15], a[252:255], v[56:59], v[12:15]
ds_read_b128 v[52:55], v105 offset:5120
v_mfma_f32_16x16x32_bf16 v[20:23], a[252:255], v[60:63], v[20:23]
v_mfma_f32_16x16x32_bf16 v[16:19], a[248:251], v[60:63], v[16:19]
s_waitcnt lgkmcnt(4)
v_mfma_f32_16x16x32_bf16 v[8:11], v[192:195], v[32:35], v[8:11]
ds_read_b128 v[56:59], v105 offset:6144
v_mfma_f32_16x16x32_bf16 v[12:15], v[196:199], v[32:35], v[12:15]
ds_read_b128 v[60:63], v105 offset:7168
v_mfma_f32_16x16x32_bf16 v[20:23], v[196:199], v[36:39], v[20:23]
v_mfma_f32_16x16x32_bf16 v[16:19], v[192:195], v[36:39], v[16:19]
s_waitcnt lgkmcnt(4)
v_mfma_f32_16x16x32_bf16 v[8:11], v[200:203], v[40:43], v[8:11]
ds_read_b128 v[32:35], v105 offset:8192
v_mfma_f32_16x16x32_bf16 v[12:15], v[204:207], v[40:43], v[12:15]
ds_read_b128 v[36:39], v105 offset:9216
v_mfma_f32_16x16x32_bf16 v[20:23], v[204:207], v[44:47], v[20:23]
v_mfma_f32_16x16x32_bf16 v[16:19], v[200:203], v[44:47], v[16:19]
s_waitcnt lgkmcnt(4)
v_mfma_f32_16x16x32_bf16 v[8:11], v[208:211], v[48:51], v[8:11]
ds_read_b128 v[40:43], v105 offset:10240
v_mfma_f32_16x16x32_bf16 v[12:15], v[212:215], v[48:51], v[12:15]
ds_read_b128 v[44:47], v105 offset:11264
v_mfma_f32_16x16x32_bf16 v[20:23], v[212:215], v[52:55], v[20:23]
v_mfma_f32_16x16x32_bf16 v[16:19], v[208:211], v[52:55], v[16:19]
s_waitcnt lgkmcnt(4)
s_mul_i32 s74, s52, 0x20000
s_add_u32 s74, s74, s73
v_mfma_f32_16x16x32_bf16 v[8:11], v[216:219], v[56:59], v[8:11]
ds_read_b128 v[48:51], v105 offset:12288
v_mfma_f32_16x16x32_bf16 v[12:15], v[220:223], v[56:59], v[12:15]
s_add_u32 s60, s52, 1
ds_read_b128 v[52:55], v105 offset:13312
s_mov_b32 s59, s26
v_mfma_f32_16x16x32_bf16 v[20:23], v[220:223], v[60:63], v[20:23]
v_mov_b32 v111, s60
v_mfma_f32_16x16x32_bf16 v[16:19], v[216:219], v[60:63], v[16:19]
s_waitcnt lgkmcnt(4)
v_mfma_f32_16x16x32_bf16 v[8:11], v[224:227], v[32:35], v[8:11]
ds_read_b128 v[56:59], v105 offset:14336
v_mfma_f32_16x16x32_bf16 v[12:15], v[228:231], v[32:35], v[12:15]
ds_read_b128 v[60:63], v105 offset:15360
v_mfma_f32_16x16x32_bf16 v[20:23], v[228:231], v[36:39], v[20:23]
v_mfma_f32_16x16x32_bf16 v[16:19], v[224:227], v[36:39], v[16:19]
s_waitcnt lgkmcnt(4)
v_mfma_f32_16x16x32_bf16 v[8:11], v[232:235], v[40:43], v[8:11]
s_sub_u32 s54, 81920, s54
v_add_u32 v104, s54, v106
v_mfma_f32_16x16x32_bf16 v[12:15], v[236:239], v[40:43], v[12:15]
v_mfma_f32_16x16x32_bf16 v[20:23], v[236:239], v[44:47], v[20:23]
v_mfma_f32_16x16x32_bf16 v[16:19], v[232:235], v[44:47], v[16:19]
s_waitcnt lgkmcnt(0)
s_waitcnt vmcnt(0)
s_barrier
v_mfma_f32_16x16x32_bf16 v[8:11], v[240:243], v[48:51], v[8:11]
s_nop 0
ds_read_b32 v108, v120
ds_read_b128 v[32:35], v104 offset:0
v_mfma_f32_16x16x32_bf16 v[12:15], v[244:247], v[48:51], v[12:15]
ds_read_b128 v[36:39], v104 offset:1024
ds_read_b128 v[40:43], v104 offset:2048
v_mfma_f32_16x16x32_bf16 v[20:23], v[244:247], v[52:55], v[20:23]
ds_read_b128 v[44:47], v104 offset:3072
v_mfma_f32_16x16x32_bf16 v[16:19], v[240:243], v[52:55], v[16:19]
v_mfma_f32_16x16x32_bf16 v[72:75], v[248:251], v[56:59], v[8:11]
s_waitcnt lgkmcnt(4)
ds_read_b128 v[48:51], v104 offset:4096
v_cmp_lt_u32 vcc, s24, v108
v_mfma_f32_16x16x32_bf16 v[76:79], v[252:255], v[56:59], v[12:15]
s_cmp_eq_u64 vcc, -1
ds_read_b128 v[52:55], v104 offset:5120
s_cselect_b32 s51, 0x10000000, 0
v_mfma_f32_16x16x32_bf16 v[84:87], v[252:255], v[60:63], v[20:23]
s_add_u32 s61, s53, 1
s_cmp_eq_u32 s61, s24
s_cselect_b32 s57, -1, s51
v_mfma_f32_16x16x32_bf16 v[80:83], v[248:251], v[60:63], v[16:19]
s_and_b32 s57, s57, s10
s_cbranch_scc1 LDNP_top
v_cvt_pk_bf16_f32 v156, v72, v73
v_cvt_pk_bf16_f32 v157, v74, v75
v_cvt_pk_bf16_f32 v158, v76, v77
v_cvt_pk_bf16_f32 v159, v78, v79
buffer_store_dwordx4 v[156:159], v112, s[4:7], s74 offen offset:0 sc1
s_nop 0
v_cvt_pk_bf16_f32 v160, v80, v81
v_cvt_pk_bf16_f32 v161, v82, v83
v_cvt_pk_bf16_f32 v162, v84, v85
v_cvt_pk_bf16_f32 v163, v86, v87
buffer_store_dwordx4 v[160:163], v112, s[4:7], s74 offen offset:1024 sc1
s_mov_b32 s74, 0x40000000
s_cmp_lg_u32 s10, 0
s_cbranch_scc1 Lsc_148
s_add_u32 s27, s27, 256
v_add_u32 v120, 256, v120
s_min_u32 s61, s24, 127
s_xor_b32 s61, s61, s53
s_cmp_ge_u32 s61, 64
s_cbranch_scc1 Lnomed_155
v_cmp_lt_u32 vcc, s53, v108
s_nop 0
s_cmp_eq_u64 vcc, -1
s_cbranch_scc1 Lmed_154
Lnomed_155:
s_mov_b32 m0, s27
s_cmp_lt_u32 s53, 64
s_cselect_b32 s58, 0, 0x40000
buffer_load_dword v113, s[4:7], s58 offen sc1 lds
s_mul_i32 s55, s53, 0x38000
s_add_u32 s55, s55, s71
s_add_u32 s56, s25, s54
s_waitcnt vmcnt(0) lgkmcnt(0)
s_barrier
ds_read_b32 v108, v120
buffer_store_dword v111, v110, s[4:7], s59 offen sc1
s_cmp_ge_u32 s53, 128
s_cbranch_scc1 LDNP_exit
s_add_u32 s27, s27, 256
v_add_u32 v120, 256, v120
s_waitcnt lgkmcnt(0)
v_cmp_lt_u32 vcc, s53, v108
s_nop 0
s_cmp_eq_u64 vcc, -1
s_cbranch_scc1 Lgo_147
LDNP_slow:
s_and_b32 s58, s53, 64
s_lshl_b32 s58, s58, 12
s_mul_i32 s55, s53, 0x38000
s_add_u32 s55, s55, s71
s_add_u32 s56, s25, s54
s_cmp_lg_u32 s48, 0
s_cbranch_scc1 Lspd_157
Lsp_156:
buffer_load_dword v108, v113, s[4:7], s58 offen sc1
s_waitcnt vmcnt(0)
v_cmp_lt_u32 vcc, s53, v108
s_nop 0
s_cmp_eq_u64 vcc, -1
s_cbranch_scc0 Lrt_158
Lspd_157:
s_barrier
Lgo_147:
s_mov_b32 m0, s27
s_cmp_lt_u32 s24, 64
s_cselect_b32 s58, 0, 0x40000
buffer_load_dword v113, s[4:7], s58 offen sc1 lds
s_lshl_b32 s61, s48, 10
s_add_u32 s55, s55, s61
s_add_u32 s56, s54, s61
s_add_u32 m0, s56, 0
s_add_u32 s32, s55, 0
buffer_load_dwordx4 v106, s[4:7], s32 offen sc1 lds
s_add_u32 m0, s56, 4096
s_add_u32 s32, s55, 4096
buffer_load_dwordx4 v106, s[4:7], s32 offen sc1 lds
s_add_u32 m0, s56, 8192
s_add_u32 s32, s55, 8192
buffer_load_dwordx4 v106, s[4:7], s32 offen sc1 lds
s_add_u32 m0, s56, 12288
s_add_u32 s32, s55, 12288
buffer_load_dwordx4 v106, s[4:7], s32 offen sc1 lds
s_add_u32 m0, s56, 16384
s_add_u32 s32, s55, 16384
buffer_load_dwordx4 v106, s[4:7], s32 offen sc1 lds
s_add_u32 m0, s56, 20480
s_add_u32 s32, s55, 20480
buffer_load_dwordx4 v106, s[4:7], s32 offen sc1 lds
s_add_u32 m0, s56, 24576
s_add_u32 s32, s55, 24576
buffer_load_dwordx4 v106, s[4:7], s32 offen sc1 lds
s_add_u32 m0, s56, 28672
s_add_u32 s32, s55, 28672
buffer_load_dwordx4 v106, s[4:7], s32 offen sc1 lds
s_add_u32 m0, s56, 32768
s_add_u32 s32, s55, 32768
buffer_load_dwordx4 v106, s[4:7], s32 offen sc1 lds
s_add_u32 m0, s56, 36864
s_add_u32 s32, s55, 36864
buffer_load_dwordx4 v106, s[4:7], s32 offen sc1 lds
s_add_u32 m0, s56, 40960
s_add_u32 s32, s55, 40960
buffer_load_dwordx4 v106, s[4:7], s32 offen sc1 lds
s_add_u32 m0, s56, 45056
s_add_u32 s32, s55, 45056
buffer_load_dwordx4 v106, s[4:7], s32 offen sc1 lds
s_add_u32 m0, s56, 49152
s_add_u32 s32, s55, 49152
buffer_load_dwordx4 v106, s[4:7], s32 offen sc1 lds
s_add_u32 m0, s56, 53248
s_add_u32 s32, s55, 53248
buffer_load_dwordx4 v106, s[4:7], s32 offen sc1 lds
s_add_u32 m0, s56, 57344
s_add_u32 s32, s55, 57344
buffer_load_dwordx4 v106, s[4:7], s32 offen sc1 lds
s_add_u32 m0, s56, 61440
s_add_u32 s32, s55, 61440
buffer_load_dwordx4 v106, s[4:7], s32 offen sc1 lds
s_add_u32 m0, s56, 65536
s_add_u32 s32, s55, 65536
buffer_load_dwordx4 v106, s[4:7], s32 offen sc1 lds
s_add_u32 m0, s56, 69632
s_add_u32 s32, s55, 69632
buffer_load_dwordx4 v106, s[4:7], s32 offen sc1 lds
s_add_u32 m0, s56, 73728
s_add_u32 s32, s55, 73728
buffer_load_dwordx4 v106, s[4:7], s32 offen sc1 lds
s_add_u32 m0, s56, 77824
s_add_u32 s32, s55, 77824
buffer_load_dwordx4 v106, s[4:7], s32 offen sc1 lds
s_waitcnt vmcnt(10)
Lrd_152:
s_barrier
Lrd2_153:
ds_read_b32 v108, v120
ds_read_b128 v[32:35], v104 offset:0
ds_read_b128 v[36:39], v104 offset:1024
ds_read_b128 v[40:43], v104 offset:2048
ds_read_b128 v[44:47], v104 offset:3072
ds_read_b128 v[48:51], v104 offset:4096
ds_read_b128 v[52:55], v104 offset:5120
s_waitcnt lgkmcnt(6)
v_cmp_lt_u32 vcc, s24, v108
s_nop 0
s_cmp_eq_u64 vcc, -1
s_cselect_b32 s51, 0x10000000, 0
s_branch LDNP_top
LDNP_exit:
s_waitcnt vmcnt(0)
s_endpgm
Lrt_140:
s_add_u32 s96, s96, 1
s_cmp_lt_u32 s96, 1048576
s_cbranch_scc1 Lws_135
s_mov_b32 s97, 1
s_branch L_fail
Lrt_141:
s_add_u32 s96, s96, 1
s_cmp_lt_u32 s96, 1048576
s_cbranch_scc1 Lws1_136
s_mov_b32 s97, 1
s_branch L_fail
Lrt_142:
s_add_u32 s96, s96, 1
s_cmp_lt_u32 s96, 1048576
s_cbranch_scc1 Lwl_133
s_mov_b32 s97, 19
s_branch L_fail
Lrt_146:
s_add_u32 s96, s96, 1
s_cmp_lt_u32 s96, 1048576
s_cbranch_scc1 Lnear_143
s_mov_b32 s97, 24
s_branch L_fail
Lrt_151:
s_add_u32 s96, s96, 1
s_cmp_lt_u32 s96, 1048576
s_cbranch_scc1 Lsp_149
s_mov_b32 s97, 7
s_branch L_fail
Lsc_148:
s_add_u32 s27, s27, 256
v_add_u32 v120, 256, v120
s_mov_b32 m0, s27
s_cmp_lt_u32 s24, 64
s_cselect_b32 s58, 0, 0x40000
buffer_load_dword v113, s[4:7], s58 offen sc1 lds
s_waitcnt vmcnt(0) lgkmcnt(0)
s_barrier
ds_read_b32 v108, v120
buffer_store_dword v111, v110, s[4:7], s59 offen sc1
s_mov_b32 s51, 0x10000000
s_waitcnt lgkmcnt(0)
v_cmp_lt_u32 vcc, s24, v108
s_nop 0
s_cmp_eq_u64 vcc, -1
s_cbranch_scc1 LDNP_top
s_cmp_lg_u32 s48, 0
s_cbranch_scc1 Lspd_150
Lsp_149:
buffer_load_dword v108, v113, s[4:7], s58 offen sc1
s_waitcnt vmcnt(0)
v_cmp_lt_u32 vcc, s24, v108
s_nop 0
s_cmp_eq_u64 vcc, -1
s_cbranch_scc0 Lrt_151
Lspd_150:
s_barrier
s_branch LDNP_top
Lmed_154:
s_mul_i32 s55, s53, 0x38000
s_add_u32 s55, s55, s71
s_add_u32 s56, s25, s54
s_add_u32 m0, s56, s28
s_add_u32 s32, s55, s28
buffer_load_dwordx4 v107, s[4:7], s32 offen offset:0 sc1 lds
buffer_load_dwordx4 v107, s[4:7], s32 offen offset:1024 sc1 lds
buffer_load_dwordx4 v107, s[4:7], s32 offen offset:2048 sc1 lds
buffer_load_dwordx4 v107, s[4:7], s32 offen offset:3072 sc1 lds
s_add_u32 m0, s56, s29
s_add_u32 s32, s55, s29
buffer_load_dwordx4 v107, s[4:7], s32 offen offset:0 sc1 lds
buffer_load_dwordx4 v107, s[4:7], s32 offen offset:1024 sc1 lds
buffer_load_dwordx4 v107, s[4:7], s32 offen offset:2048 sc1 lds
buffer_load_dwordx4 v107, s[4:7], s32 offen offset:3072 sc1 lds
s_add_u32 m0, s56, s30
s_add_u32 s32, s55, s30
buffer_load_dwordx4 v107, s[4:7], s32 offen offset:0 sc1 lds
buffer_load_dwordx4 v107, s[4:7], s32 offen offset:1024 sc1 lds
buffer_load_dwordx4 v107, s[4:7], s32 offen offset:2048 sc1 lds
buffer_load_dwordx4 v107, s[4:7], s32 offen offset:3072 sc1 lds
s_add_u32 m0, s56, s31
s_add_u32 s32, s55, s31
buffer_load_dwordx4 v107, s[4:7], s32 offen offset:0 sc1 lds
buffer_load_dwordx4 v107, s[4:7], s32 offen offset:1024 sc1 lds
buffer_load_dwordx4 v107, s[4:7], s32 offen offset:2048 sc1 lds
buffer_load_dwordx4 v107, s[4:7], s32 offen offset:3072 sc1 lds
s_add_u32 m0, s56, 16384
s_add_u32 s32, s55, 16384
buffer_load_dwordx4 v107, s[4:7], s32 offen offset:0 sc1 lds
buffer_load_dwordx4 v107, s[4:7], s32 offen offset:1024 sc1 lds
buffer_load_dwordx4 v107, s[4:7], s32 offen offset:2048 sc1 lds
buffer_load_dwordx4 v107, s[4:7], s32 offen offset:3072 sc1 lds
s_mov_b32 m0, s27
s_cmp_lt_u32 s24, 64
s_cselect_b32 s58, 0, 0x40000
buffer_load_dword v113, s[4:7], s58 offen sc1 lds
s_waitcnt vmcnt(21) lgkmcnt(0)
s_barrier
buffer_store_dword v111, v110, s[4:7], s59 offen sc1
s_waitcnt vmcnt(1)
s_branch Lrd_152
Lrt_158:
s_add_u32 s96, s96, 1
s_cmp_lt_u32 s96, 1048576
s_cbranch_scc1 Lsp_156
s_mov_b32 s97, 7
s_branch L_fail
L_DNF:
s_lshl_b32 s62, s49, 3
s_lshr_b32 s60, s62, 3
s_mul_i32 s60, s60, 256
s_and_b32 s61, s62, 7
s_lshl_b32 s61, s61, 2
s_add_u32 s60, s60, s61
s_add_u32 s60, s60, 0
s_and_b32 s61, s60, 0xffffe000
s_add_u32 s60, s60, s61
v_mul_u32_u24 v110, 4, v0
v_add_u32 v110, s60, v110
v_mov_b32 v1, 0x40000000
v_cmp_gt_u32 vcc, 8, v0
s_nop 1
v_cndmask_b32 v110, v1, v110, vcc
s_cmp_eq_u32 s48, 1
s_cselect_b32 s60, 0, 0x40000000
v_or_b32 v110, s60, v110
v_mov_b32 v1, 0
s_mov_b32 s60, 0x40000
buffer_store_dword v1, v110, s[4:7], s60 offen sc1
s_mov_b32 s60, 0x42000
buffer_store_dword v1, v110, s[4:7], s60 offen sc1
s_mov_b32 s50, s49
s_add_i32 s61, s50, 0
s_cmp_ge_u32 s50, 0
s_cselect_b32 s49, s61, s49
s_mul_i32 s60, s49, 256
s_add_u32 s60, s60, 96256
s_and_b32 s61, s60, 0xffffe000
s_add_u32 s60, s60, s61
v_mov_b32 v117, s60
v_mov_b32 v1, 0x40000000
v_cmp_gt_u32 vcc, 1, v0
s_nop 1
v_cndmask_b32 v117, v1, v117, vcc
s_cmp_eq_u32 s48, 1
s_cselect_b32 s60, 0, 0x40000000
v_or_b32 v117, s60, v117
v_mov_b32 v1, 0
s_mov_b32 s60, 0x0
buffer_store_dword v1, v117, s[4:7], s60 offen sc1
s_mov_b32 s60, 0x2000
buffer_store_dword v1, v117, s[4:7], s60 offen sc1
s_waitcnt vmcnt(0)
s_barrier
s_cmp_lg_u32 s48, 0
s_cbranch_scc1 Larr_159
s_mov_b32 s60, 0
v_mov_b32 v2, s60
v_mov_b32 v1, 0x40000000
v_cmp_gt_u32 vcc, 1, v0
s_nop 1
v_cndmask_b32 v2, v1, v2, vcc
s_sub_u32 s61, s101, s2
s_and_b32 s61, s61, 7
s_lshl_b32 s61, s61, 2
s_add_u32 s61, s61, 128
s_cmp_eq_u32 s100, 0
s_cselect_b32 s61, s61, 0
v_mov_b32 v3, 1
buffer_atomic_add v3, v2, s[20:23], s61 offen sc1
Larr_159:
s_mov_b32 s3, 2
s_branch L_P2
L_DNF2:
s_mov_b32 s12, s40
s_and_b32 s13, s41, 0xffff
s_mov_b32 s14, 0x700000
s_mov_b32 s15, 0x20000
s_mov_b32 s66, 2
s_mov_b32 s67, s49
s_lshl_b32 s68, s67, 2
s_add_u32 s68, s68, s48
s_mul_i32 s70, s66, 40
s_lshl_b32 s71, s70, 11
s_lshl_b32 s62, s67, 3
s_lshr_b32 s60, s62, 3
s_mul_i32 s60, s60, 256
s_and_b32 s61, s62, 7
s_lshl_b32 s61, s61, 2
s_add_u32 s60, s60, s61
s_add_u32 s60, s60, 0
s_and_b32 s61, s60, 0xffffe000
s_add_u32 s60, s60, s61
v_mul_u32_u24 v110, 4, v0
v_add_u32 v110, s60, v110
v_mov_b32 v1, 0x40000000
v_cmp_gt_u32 vcc, 8, v0
s_nop 1
v_cndmask_b32 v110, v1, v110, vcc
s_cmp_eq_u32 s48, 1
s_cselect_b32 s60, 0, 0x40000000
v_or_b32 v110, s60, v110
s_lshr_b32 s61, s48, 1
s_lshl_b32 s61, s61, 12
s_and_b32 s60, s48, 1
s_lshl_b32 s60, s60, 6
s_add_u32 s61, s61, s60
v_lshrrev_b32 v1, 4, v0
v_bfe_u32 v2, v0, 2, 2
v_and_b32 v3, 3, v0
v_mul_u32_u24 v1, 8, v1
v_add_u32 v1, v1, v2
v_mul_u32_u24 v1, 128, v1
v_mul_u32_u24 v3, 16, v3
v_add3_u32 v8, v1, v3, s61
s_lshl_b32 s72, s70, 16
s_lshl_b32 s60, s67, 8
s_add_u32 s72, s72, s60
s_add_u32 s69, s72, 128
v_lshrrev_b32 v1, 3, v0
s_lshl_b32 s60, s48, 3
v_add_u32 v1, s60, v1
v_mul_u32_u24 v1, 2048, v1
v_and_b32 v2, 7, v0
v_lshlrev_b32 v2, 4, v2
v_add_u32 v11, v1, v2
v_add_u32 v9, 65536, v8
v_add_u32 v10, 131072, v8
s_lshl_b32 s62, s48, 10
s_add_u32 m0, s62, 0
s_add_u32 s63, s72, 0x0
buffer_load_dwordx4 v11, s[12:15], s63 offen lds
s_add_u32 m0, s62, 4096
s_add_u32 s63, s69, 0x0
buffer_load_dwordx4 v11, s[12:15], s63 offen lds
s_add_u32 m0, s62, 8192
s_add_u32 s63, s72, 0x10000
buffer_load_dwordx4 v11, s[12:15], s63 offen lds
s_add_u32 m0, s62, 12288
s_add_u32 s63, s69, 0x10000
buffer_load_dwordx4 v11, s[12:15], s63 offen lds
s_add_u32 m0, s62, 16384
s_add_u32 s63, s72, 0x20000
buffer_load_dwordx4 v11, s[12:15], s63 offen lds
s_add_u32 m0, s62, 20480
s_add_u32 s63, s69, 0x20000
buffer_load_dwordx4 v11, s[12:15], s63 offen lds
s_add_u32 m0, s62, 24576
s_add_u32 s63, s72, 0x30000
buffer_load_dwordx4 v11, s[12:15], s63 offen lds
s_add_u32 m0, s62, 28672
s_add_u32 s63, s69, 0x30000
buffer_load_dwordx4 v11, s[12:15], s63 offen lds
s_add_u32 m0, s62, 32768
s_add_u32 s63, s72, 0x40000
buffer_load_dwordx4 v11, s[12:15], s63 offen lds
s_add_u32 m0, s62, 36864
s_add_u32 s63, s69, 0x40000
buffer_load_dwordx4 v11, s[12:15], s63 offen lds
s_add_u32 m0, s62, 40960
s_add_u32 s63, s72, 0x50000
buffer_load_dwordx4 v11, s[12:15], s63 offen lds
s_add_u32 m0, s62, 45056
s_add_u32 s63, s69, 0x50000
buffer_load_dwordx4 v11, s[12:15], s63 offen lds
s_add_u32 m0, s62, 49152
s_add_u32 s63, s72, 0x60000
buffer_load_dwordx4 v11, s[12:15], s63 offen lds
s_add_u32 m0, s62, 53248
s_add_u32 s63, s69, 0x60000
buffer_load_dwordx4 v11, s[12:15], s63 offen lds
s_add_u32 m0, s62, 57344
s_add_u32 s63, s72, 0x70000
buffer_load_dwordx4 v11, s[12:15], s63 offen lds
s_add_u32 m0, s62, 61440
s_add_u32 s63, s69, 0x70000
buffer_load_dwordx4 v11, s[12:15], s63 offen lds
s_add_u32 m0, s62, 65536
s_add_u32 s63, s72, 0x80000
buffer_load_dwordx4 v11, s[12:15], s63 offen lds
s_add_u32 m0, s62, 69632
s_add_u32 s63, s69, 0x80000
buffer_load_dwordx4 v11, s[12:15], s63 offen lds
s_add_u32 m0, s62, 73728
s_add_u32 s63, s72, 0x90000
buffer_load_dwordx4 v11, s[12:15], s63 offen lds
s_add_u32 m0, s62, 77824
s_add_u32 s63, s69, 0x90000
buffer_load_dwordx4 v11, s[12:15], s63 offen lds
s_add_u32 m0, s62, 81920
s_add_u32 s63, s72, 0xa0000
buffer_load_dwordx4 v11, s[12:15], s63 offen lds
s_add_u32 m0, s62, 86016
s_add_u32 s63, s69, 0xa0000
buffer_load_dwordx4 v11, s[12:15], s63 offen lds
s_add_u32 m0, s62, 90112
s_add_u32 s63, s72, 0xb0000
buffer_load_dwordx4 v11, s[12:15], s63 offen lds
s_add_u32 m0, s62, 94208
s_add_u32 s63, s69, 0xb0000
buffer_load_dwordx4 v11, s[12:15], s63 offen lds
s_add_u32 m0, s62, 98304
s_add_u32 s63, s72, 0xc0000
buffer_load_dwordx4 v11, s[12:15], s63 offen lds
s_add_u32 m0, s62, 102400
s_add_u32 s63, s69, 0xc0000
buffer_load_dwordx4 v11, s[12:15], s63 offen lds
s_add_u32 m0, s62, 106496
s_add_u32 s63, s72, 0xd0000
buffer_load_dwordx4 v11, s[12:15], s63 offen lds
s_add_u32 m0, s62, 110592
s_add_u32 s63, s69, 0xd0000
buffer_load_dwordx4 v11, s[12:15], s63 offen lds
s_add_u32 m0, s62, 114688
s_add_u32 s63, s72, 0xe0000
buffer_load_dwordx4 v11, s[12:15], s63 offen lds
s_add_u32 m0, s62, 118784
s_add_u32 s63, s69, 0xe0000
buffer_load_dwordx4 v11, s[12:15], s63 offen lds
s_add_u32 m0, s62, 122880
s_add_u32 s63, s72, 0xf0000
buffer_load_dwordx4 v11, s[12:15], s63 offen lds
s_add_u32 m0, s62, 126976
s_add_u32 s63, s69, 0xf0000
buffer_load_dwordx4 v11, s[12:15], s63 offen lds
s_add_u32 m0, s62, 131072
s_add_u32 s63, s72, 0x100000
buffer_load_dwordx4 v11, s[12:15], s63 offen lds
s_add_u32 m0, s62, 135168
s_add_u32 s63, s69, 0x100000
buffer_load_dwordx4 v11, s[12:15], s63 offen lds
s_add_u32 m0, s62, 139264
s_add_u32 s63, s72, 0x110000
buffer_load_dwordx4 v11, s[12:15], s63 offen lds
s_add_u32 m0, s62, 143360
s_add_u32 s63, s69, 0x110000
buffer_load_dwordx4 v11, s[12:15], s63 offen lds
s_add_u32 m0, s62, 147456
s_add_u32 s63, s72, 0x120000
buffer_load_dwordx4 v11, s[12:15], s63 offen lds
s_add_u32 m0, s62, 151552
s_add_u32 s63, s69, 0x120000
buffer_load_dwordx4 v11, s[12:15], s63 offen lds
s_add_u32 m0, s62, 155648
s_add_u32 s63, s72, 0x130000
buffer_load_dwordx4 v11, s[12:15], s63 offen lds
s_add_u32 m0, s62, 159744
s_add_u32 s63, s69, 0x130000
buffer_load_dwordx4 v11, s[12:15], s63 offen lds
s_waitcnt vmcnt(38) lgkmcnt(0)
s_barrier
ds_read_b64_tr_b16 a[0:1], v8 offset:0
ds_read_b64_tr_b16 a[2:3], v8 offset:512
ds_read_b64_tr_b16 a[4:5], v8 offset:8
ds_read_b64_tr_b16 a[6:7], v8 offset:520
s_waitcnt vmcnt(36) lgkmcnt(0)
s_barrier
s_add_u32 m0, s62, 0
s_add_u32 s63, s72, 0x140000
buffer_load_dwordx4 v11, s[12:15], s63 offen lds
s_add_u32 m0, s62, 4096
s_add_u32 s63, s69, 0x140000
buffer_load_dwordx4 v11, s[12:15], s63 offen lds
ds_read_b64_tr_b16 a[8:9], v8 offset:8192
ds_read_b64_tr_b16 a[10:11], v8 offset:8704
ds_read_b64_tr_b16 a[12:13], v8 offset:8200
ds_read_b64_tr_b16 a[14:15], v8 offset:8712
s_waitcnt vmcnt(36) lgkmcnt(0)
s_barrier
s_add_u32 m0, s62, 8192
s_add_u32 s63, s72, 0x150000
buffer_load_dwordx4 v11, s[12:15], s63 offen lds
s_add_u32 m0, s62, 12288
s_add_u32 s63, s69, 0x150000
buffer_load_dwordx4 v11, s[12:15], s63 offen lds
ds_read_b64_tr_b16 a[16:17], v8 offset:16384
ds_read_b64_tr_b16 a[18:19], v8 offset:16896
ds_read_b64_tr_b16 a[20:21], v8 offset:16392
ds_read_b64_tr_b16 a[22:23], v8 offset:16904
s_waitcnt vmcnt(36) lgkmcnt(0)
s_barrier
s_add_u32 m0, s62, 16384
s_add_u32 s63, s72, 0x160000
buffer_load_dwordx4 v11, s[12:15], s63 offen lds
s_add_u32 m0, s62, 20480
s_add_u32 s63, s69, 0x160000
buffer_load_dwordx4 v11, s[12:15], s63 offen lds
ds_read_b64_tr_b16 a[24:25], v8 offset:24576
ds_read_b64_tr_b16 a[26:27], v8 offset:25088
ds_read_b64_tr_b16 a[28:29], v8 offset:24584
ds_read_b64_tr_b16 a[30:31], v8 offset:25096
s_waitcnt vmcnt(36) lgkmcnt(0)
s_barrier
s_add_u32 m0, s62, 24576
s_add_u32 s63, s72, 0x170000
buffer_load_dwordx4 v11, s[12:15], s63 offen lds
s_add_u32 m0, s62, 28672
s_add_u32 s63, s69, 0x170000
buffer_load_dwordx4 v11, s[12:15], s63 offen lds
ds_read_b64_tr_b16 a[32:33], v8 offset:32768
ds_read_b64_tr_b16 a[34:35], v8 offset:33280
ds_read_b64_tr_b16 a[36:37], v8 offset:32776
ds_read_b64_tr_b16 a[38:39], v8 offset:33288
s_waitcnt vmcnt(36) lgkmcnt(0)
s_barrier
s_add_u32 m0, s62, 32768
s_add_u32 s63, s72, 0x180000
buffer_load_dwordx4 v11, s[12:15], s63 offen lds
s_add_u32 m0, s62, 36864
s_add_u32 s63, s69, 0x180000
buffer_load_dwordx4 v11, s[12:15], s63 offen lds
ds_read_b64_tr_b16 a[40:41], v8 offset:40960
ds_read_b64_tr_b16 a[42:43], v8 offset:41472
ds_read_b64_tr_b16 a[44:45], v8 offset:40968
ds_read_b64_tr_b16 a[46:47], v8 offset:41480
s_waitcnt vmcnt(36) lgkmcnt(0)
s_barrier
s_add_u32 m0, s62, 40960
s_add_u32 s63, s72, 0x190000
buffer_load_dwordx4 v11, s[12:15], s63 offen lds
s_add_u32 m0, s62, 45056
s_add_u32 s63, s69, 0x190000
buffer_load_dwordx4 v11, s[12:15], s63 offen lds
ds_read_b64_tr_b16 a[48:49], v8 offset:49152
ds_read_b64_tr_b16 a[50:51], v8 offset:49664
ds_read_b64_tr_b16 a[52:53], v8 offset:49160
ds_read_b64_tr_b16 a[54:55], v8 offset:49672
s_waitcnt vmcnt(36) lgkmcnt(0)
s_barrier
s_add_u32 m0, s62, 49152
s_add_u32 s63, s72, 0x1a0000
buffer_load_dwordx4 v11, s[12:15], s63 offen lds
s_add_u32 m0, s62, 53248
s_add_u32 s63, s69, 0x1a0000
buffer_load_dwordx4 v11, s[12:15], s63 offen lds
ds_read_b64_tr_b16 a[56:57], v8 offset:57344
ds_read_b64_tr_b16 a[58:59], v8 offset:57856
ds_read_b64_tr_b16 a[60:61], v8 offset:57352
ds_read_b64_tr_b16 a[62:63], v8 offset:57864
s_waitcnt vmcnt(36) lgkmcnt(0)
s_barrier
s_add_u32 m0, s62, 57344
s_add_u32 s63, s72, 0x1b0000
buffer_load_dwordx4 v11, s[12:15], s63 offen lds
s_add_u32 m0, s62, 61440
s_add_u32 s63, s69, 0x1b0000
buffer_load_dwordx4 v11, s[12:15], s63 offen lds
ds_read_b64_tr_b16 a[64:65], v9 offset:0
ds_read_b64_tr_b16 a[66:67], v9 offset:512
ds_read_b64_tr_b16 a[68:69], v9 offset:8
ds_read_b64_tr_b16 a[70:71], v9 offset:520
s_waitcnt vmcnt(36) lgkmcnt(0)
s_barrier
s_add_u32 m0, s62, 65536
s_add_u32 s63, s72, 0x1c0000
buffer_load_dwordx4 v11, s[12:15], s63 offen lds
s_add_u32 m0, s62, 69632
s_add_u32 s63, s69, 0x1c0000
buffer_load_dwordx4 v11, s[12:15], s63 offen lds
ds_read_b64_tr_b16 a[72:73], v9 offset:8192
ds_read_b64_tr_b16 a[74:75], v9 offset:8704
ds_read_b64_tr_b16 a[76:77], v9 offset:8200
ds_read_b64_tr_b16 a[78:79], v9 offset:8712
s_waitcnt vmcnt(36) lgkmcnt(0)
s_barrier
s_add_u32 m0, s62, 73728
s_add_u32 s63, s72, 0x1d0000
buffer_load_dwordx4 v11, s[12:15], s63 offen lds
s_add_u32 m0, s62, 77824
s_add_u32 s63, s69, 0x1d0000
buffer_load_dwordx4 v11, s[12:15], s63 offen lds
ds_read_b64_tr_b16 a[80:81], v9 offset:16384
ds_read_b64_tr_b16 a[82:83], v9 offset:16896
ds_read_b64_tr_b16 a[84:85], v9 offset:16392
ds_read_b64_tr_b16 a[86:87], v9 offset:16904
s_waitcnt vmcnt(36) lgkmcnt(0)
s_barrier
s_add_u32 m0, s62, 81920
s_add_u32 s63, s72, 0x1e0000
buffer_load_dwordx4 v11, s[12:15], s63 offen lds
s_add_u32 m0, s62, 86016
s_add_u32 s63, s69, 0x1e0000
buffer_load_dwordx4 v11, s[12:15], s63 offen lds
ds_read_b64_tr_b16 a[88:89], v9 offset:24576
ds_read_b64_tr_b16 a[90:91], v9 offset:25088
ds_read_b64_tr_b16 a[92:93], v9 offset:24584
ds_read_b64_tr_b16 a[94:95], v9 offset:25096
s_waitcnt vmcnt(36) lgkmcnt(0)
s_barrier
s_add_u32 m0, s62, 90112
s_add_u32 s63, s72, 0x1f0000
buffer_load_dwordx4 v11, s[12:15], s63 offen lds
s_add_u32 m0, s62, 94208
s_add_u32 s63, s69, 0x1f0000
buffer_load_dwordx4 v11, s[12:15], s63 offen lds
ds_read_b64_tr_b16 a[96:97], v9 offset:32768
ds_read_b64_tr_b16 a[98:99], v9 offset:33280
ds_read_b64_tr_b16 a[100:101], v9 offset:32776
ds_read_b64_tr_b16 a[102:103], v9 offset:33288
s_waitcnt vmcnt(36) lgkmcnt(0)
s_barrier
ds_read_b64_tr_b16 a[104:105], v9 offset:40960
ds_read_b64_tr_b16 a[106:107], v9 offset:41472
ds_read_b64_tr_b16 a[108:109], v9 offset:40968
ds_read_b64_tr_b16 a[110:111], v9 offset:41480
s_waitcnt vmcnt(34) lgkmcnt(0)
s_barrier
ds_read_b64_tr_b16 a[112:113], v9 offset:49152
ds_read_b64_tr_b16 a[114:115], v9 offset:49664
ds_read_b64_tr_b16 a[116:117], v9 offset:49160
ds_read_b64_tr_b16 a[118:119], v9 offset:49672
s_waitcnt vmcnt(32) lgkmcnt(0)
s_barrier
ds_read_b64_tr_b16 a[120:121], v9 offset:57344
ds_read_b64_tr_b16 a[122:123], v9 offset:57856
ds_read_b64_tr_b16 a[124:125], v9 offset:57352
ds_read_b64_tr_b16 a[126:127], v9 offset:57864
s_waitcnt vmcnt(30) lgkmcnt(0)
s_barrier
ds_read_b64_tr_b16 a[128:129], v10 offset:0
ds_read_b64_tr_b16 a[130:131], v10 offset:512
ds_read_b64_tr_b16 a[132:133], v10 offset:8
ds_read_b64_tr_b16 a[134:135], v10 offset:520
s_waitcnt vmcnt(28) lgkmcnt(0)
s_barrier
ds_read_b64_tr_b16 a[136:137], v10 offset:8192
ds_read_b64_tr_b16 a[138:139], v10 offset:8704
ds_read_b64_tr_b16 a[140:141], v10 offset:8200
ds_read_b64_tr_b16 a[142:143], v10 offset:8712
s_waitcnt vmcnt(26) lgkmcnt(0)
s_barrier
ds_read_b64_tr_b16 a[144:145], v10 offset:16384
ds_read_b64_tr_b16 a[146:147], v10 offset:16896
ds_read_b64_tr_b16 a[148:149], v10 offset:16392
ds_read_b64_tr_b16 a[150:151], v10 offset:16904
s_waitcnt vmcnt(24) lgkmcnt(0)
s_barrier
ds_read_b64_tr_b16 a[152:153], v10 offset:24576
ds_read_b64_tr_b16 a[154:155], v10 offset:25088
ds_read_b64_tr_b16 a[156:157], v10 offset:24584
ds_read_b64_tr_b16 a[158:159], v10 offset:25096
s_waitcnt vmcnt(22) lgkmcnt(0)
s_barrier
ds_read_b64_tr_b16 a[160:161], v8 offset:0
ds_read_b64_tr_b16 a[162:163], v8 offset:512
ds_read_b64_tr_b16 a[164:165], v8 offset:8
ds_read_b64_tr_b16 a[166:167], v8 offset:520
s_waitcnt vmcnt(20) lgkmcnt(0)
s_barrier
ds_read_b64_tr_b16 a[168:169], v8 offset:8192
ds_read_b64_tr_b16 a[170:171], v8 offset:8704
ds_read_b64_tr_b16 a[172:173], v8 offset:8200
ds_read_b64_tr_b16 a[174:175], v8 offset:8712
s_waitcnt vmcnt(18) lgkmcnt(0)
s_barrier
ds_read_b64_tr_b16 a[176:177], v8 offset:16384
ds_read_b64_tr_b16 a[178:179], v8 offset:16896
ds_read_b64_tr_b16 a[180:181], v8 offset:16392
ds_read_b64_tr_b16 a[182:183], v8 offset:16904
s_waitcnt vmcnt(16) lgkmcnt(0)
s_barrier
ds_read_b64_tr_b16 a[184:185], v8 offset:24576
ds_read_b64_tr_b16 a[186:187], v8 offset:25088
ds_read_b64_tr_b16 a[188:189], v8 offset:24584
ds_read_b64_tr_b16 a[190:191], v8 offset:25096
s_waitcnt vmcnt(14) lgkmcnt(0)
s_barrier
ds_read_b64_tr_b16 a[192:193], v8 offset:32768
ds_read_b64_tr_b16 a[194:195], v8 offset:33280
ds_read_b64_tr_b16 a[196:197], v8 offset:32776
ds_read_b64_tr_b16 a[198:199], v8 offset:33288
s_waitcnt vmcnt(12) lgkmcnt(0)
s_barrier
ds_read_b64_tr_b16 a[200:201], v8 offset:40960
ds_read_b64_tr_b16 a[202:203], v8 offset:41472
ds_read_b64_tr_b16 a[204:205], v8 offset:40968
ds_read_b64_tr_b16 a[206:207], v8 offset:41480
s_waitcnt vmcnt(10) lgkmcnt(0)
s_barrier
ds_read_b64_tr_b16 a[208:209], v8 offset:49152
ds_read_b64_tr_b16 a[210:211], v8 offset:49664
ds_read_b64_tr_b16 a[212:213], v8 offset:49160
ds_read_b64_tr_b16 a[214:215], v8 offset:49672
s_waitcnt vmcnt(8) lgkmcnt(0)
s_barrier
ds_read_b64_tr_b16 a[216:217], v8 offset:57344
ds_read_b64_tr_b16 a[218:219], v8 offset:57856
ds_read_b64_tr_b16 a[220:221], v8 offset:57352
ds_read_b64_tr_b16 a[222:223], v8 offset:57864
s_waitcnt vmcnt(6) lgkmcnt(0)
s_barrier
ds_read_b64_tr_b16 a[224:225], v9 offset:0
ds_read_b64_tr_b16 a[226:227], v9 offset:512
ds_read_b64_tr_b16 a[228:229], v9 offset:8
ds_read_b64_tr_b16 a[230:231], v9 offset:520
s_waitcnt vmcnt(4) lgkmcnt(0)
s_barrier
ds_read_b64_tr_b16 a[232:233], v9 offset:8192
ds_read_b64_tr_b16 a[234:235], v9 offset:8704
ds_read_b64_tr_b16 a[236:237], v9 offset:8200
ds_read_b64_tr_b16 a[238:239], v9 offset:8712
s_waitcnt vmcnt(2) lgkmcnt(0)
s_barrier
ds_read_b64_tr_b16 a[240:241], v9 offset:16384
ds_read_b64_tr_b16 a[242:243], v9 offset:16896
ds_read_b64_tr_b16 a[244:245], v9 offset:16392
ds_read_b64_tr_b16 a[246:247], v9 offset:16904
s_waitcnt vmcnt(0) lgkmcnt(0)
s_barrier
ds_read_b64_tr_b16 a[248:249], v9 offset:24576
ds_read_b64_tr_b16 a[250:251], v9 offset:25088
ds_read_b64_tr_b16 a[252:253], v9 offset:24584
ds_read_b64_tr_b16 a[254:255], v9 offset:25096
s_waitcnt lgkmcnt(0)
v_lshlrev_b32 v106, 4, v0
s_lshr_b32 s62, s70, 1
v_min_u32 v1, 15, v0
v_add_u32 v1, s62, v1
v_mul_u32_u24 v1, 256, v1
v_add_u32 v113, 69632, v1
v_and_b32 v1, 0xffffe000, v113
v_add_u32 v113, v1, v113
s_lshl_b32 s60, s68, 11
v_add_u32 v112, s60, v106
s_lshl_b32 s62, s67, 1
v_min_u32 v1, 1, v0
v_add_u32 v1, s62, v1
v_mul_u32_u24 v1, 256, v1
v_add_u32 v119, 92160, v1
v_and_b32 v1, 0xffffe000, v119
v_add_u32 v119, v1, v119
v_lshrrev_b32 v1, 5, v0
v_lshlrev_b32 v1, 8, v1
v_and_b32 v2, 15, v0
v_lshlrev_b32 v2, 4, v2
v_add_u32 v1, v1, v2
v_bfe_u32 v2, v0, 4, 1
v_lshlrev_b32 v2, 2, v2
s_lshr_b32 s60, s67, 1
s_lshl_b32 s60, s60, 9
s_and_b32 s61, s67, 1
s_lshl_b32 s61, s61, 3
s_add_u32 s60, s60, s61
v_add3_u32 v114, v1, v2, s60
s_cmp_eq_u32 s48, 0
s_cselect_b32 s60, 0, 0x40000000
v_or_b32 v114, s60, v114
v_lshlrev_b32 v117, 2, v0
v_add_u32 v117, 135168, v117
s_lshl_b32 s60, s48, 8
v_add_u32 v118, s60, v117
s_mov_b32 s76, 0x3f803f80
v_bfe_u32 v1, v0, 2, 2
v_lshrrev_b32 v2, 4, v0
v_cmp_eq_u32 vcc, v1, v2
v_and_b32 v1, 1, v0
v_lshlrev_b32 v1, 4, v1
v_mov_b32 v2, 0x3f80
v_lshlrev_b32 v1, v1, v2
v_cndmask_b32 v1, 0, v1, vcc
v_and_b32 v2, 2, v0
v_cmp_eq_u32 vcc, 0, v2
s_nop 1
v_cndmask_b32 v24, 0, v1, vcc
v_sub_u32 v25, v1, v24
v_mov_b32 v26, 0
v_mov_b32 v27, 0
v_mov_b32 v28, 0
v_mov_b32 v29, 0
v_mov_b32 v30, v24
v_mov_b32 v31, v25
s_mov_b32 s16, s46
s_and_b32 s17, s47, 0xffff
s_mov_b32 s18, 0x10000000
s_mov_b32 s19, 0x20000
s_and_b32 s75, s43, 0xffff
s_mov_b32 s74, s42
v_and_b32 v1, 15, v0
v_lshlrev_b32 v1, 11, v1
v_lshrrev_b32 v2, 4, v0
v_lshlrev_b32 v2, 4, v2
s_lshl_b32 s60, s68, 6
v_add3_u32 v116, v1, v2, s60
v_add_u32 v115, 0x8000, v116
s_barrier
s_mov_b32 s62, 0
s_cmp_lg_u32 s100, 0
s_cbranch_scc1 Lnear2_161
s_cmp_lg_u32 s97, 0
s_cbranch_scc1 Lnear3_162
v_mov_b32 v1, 160
Lnear_160:
buffer_load_dword v1, v1, s[20:23], 0 offen sc1
s_waitcnt vmcnt(0)
v_readfirstlane_b32 s97, v1
v_mov_b32 v1, 160
s_cmp_eq_u32 s97, 0
s_cbranch_scc1 Lrt_163
Lnear3_162:
s_and_b32 s62, s97, 2
s_lshl_b32 s62, s62, 12
Lnear2_161:
s_xor_b32 s63, s62, 0x2000
v_add_u32 v113, s62, v113
v_add_u32 v119, s62, v119
s_mov_b32 s44, 0
s_mov_b32 s45, 0x40000000
s_add_u32 s71, s71, 0xb400000
s_mul_i32 s25, s48, 16384
v_add_u32 v107, s25, v106
s_add_u32 s65, s25, 65536
s_add_u32 s28, s49, 0
s_and_b32 s28, s28, 3
s_mul_i32 s28, s28, 4096
s_add_u32 s29, s49, 1
s_and_b32 s29, s29, 3
s_mul_i32 s29, s29, 4096
s_add_u32 s30, s49, 2
s_and_b32 s30, s30, 3
s_mul_i32 s30, s30, 4096
s_add_u32 s31, s49, 3
s_and_b32 s31, s31, 3
s_mul_i32 s31, s31, 4096
s_lshl_b32 s27, s48, 9
s_add_u32 s27, s27, 131072
v_lshrrev_b32 v120, 2, v106
v_add_u32 v120, 131072, v120
s_cmp_eq_u32 s48, 0
s_cselect_b32 s60, 0, 0x40000000
v_or_b32 v113, s60, v113
s_cmp_eq_u32 s48, 0
s_cselect_b32 s60, 0, 0x40000000
v_or_b32 v119, s60, v119
s_mov_b32 s53, 0
s_mov_b32 s54, 0
s_mov_b32 s52, 0
v_mov_b32 v104, v106
s_mov_b32 s59, 0x40000000
v_mov_b32 v111, 0
s_mov_b32 s98, 64
s_mov_b32 s99, 0xffffffed
s_mov_b32 s77, 0x40000000
s_mov_b32 s78, 0x40000000
s_mov_b32 s79, 0x40000000
s_mov_b32 s12, s46
s_and_b32 s13, s47, 0xffff
s_mov_b32 s14, 0x10000000
s_mov_b32 s15, 0x20000
s_mov_b32 s41, 0
s_add_u32 s60, s53, 1
s_add_u32 s99, s99, 1
s_cmp_lt_u32 s99, 91
s_cselect_b32 s24, s98, s60
s_cselect_b32 s98, s60, s98
s_branch LDNF_slow
.p2align 6
LDNF_top:
s_waitcnt lgkmcnt(4)
v_mfma_f32_16x16x32_bf16 v[8:11], a[0:3], v[32:35], 0
s_mov_b32 s52, s53
ds_read_b128 v[56:59], v104 offset:6144
s_mov_b32 s53, s24
v_mfma_f32_16x16x32_bf16 v[12:15], a[4:7], v[32:35], 0
s_mov_b32 s10, s51
ds_read_b128 v[60:63], v104 offset:7168
s_mul_i32 s55, s53, 0x38000
v_mfma_f32_16x16x32_bf16 v[20:23], a[4:7], v[36:39], 0
s_add_u32 s55, s55, s71
s_sub_u32 s56, s65, s54
s_add_u32 m0, s56, s28
v_mfma_f32_16x16x32_bf16 v[16:19], a[0:3], v[36:39], 0
s_waitcnt lgkmcnt(4)
s_add_u32 s32, s55, s28
buffer_load_dwordx4 v107, s[8:11], s32 offen offset:0 sc1 lds
v_mfma_f32_16x16x32_bf16 v[8:11], a[8:11], v[40:43], v[8:11]
ds_read_b128 v[32:35], v104 offset:8192
v_mfma_f32_16x16x32_bf16 v[12:15], a[12:15], v[40:43], v[12:15]
ds_read_b128 v[36:39], v104 offset:9216
v_mfma_f32_16x16x32_bf16 v[20:23], a[12:15], v[44:47], v[20:23]
v_mfma_f32_16x16x32_bf16 v[16:19], a[8:11], v[44:47], v[16:19]
s_waitcnt lgkmcnt(4)
buffer_load_dwordx4 v107, s[8:11], s32 offen offset:1024 sc1 lds
s_waitcnt vmcnt(8)
v_mfma_f32_16x16x32_bf16 v[8:11], a[16:19], v[48:51], v[8:11]
s_barrier
ds_read_b128 v[40:43], v104 offset:10240
buffer_store_dword v111, v110, s[4:7], s59 offen sc1
v_mfma_f32_16x16x32_bf16 v[12:15], a[20:23], v[48:51], v[12:15]
ds_read_b128 v[44:47], v104 offset:11264
v_mfma_f32_16x16x32_bf16 v[20:23], a[20:23], v[52:55], v[20:23]
v_mfma_f32_16x16x32_bf16 v[16:19], a[16:19], v[52:55], v[16:19]
s_waitcnt lgkmcnt(4)
v_mfma_f32_16x16x32_bf16 v[8:11], a[24:27], v[56:59], v[8:11]
ds_read_b128 v[48:51], v104 offset:12288
buffer_load_dwordx4 v107, s[8:11], s32 offen offset:2048 sc1 lds
v_mfma_f32_16x16x32_bf16 v[12:15], a[28:31], v[56:59], v[12:15]
s_and_b32 s26, s52, 64
ds_read_b128 v[52:55], v104 offset:13312
s_lshl_b32 s26, s26, 12
v_mfma_f32_16x16x32_bf16 v[20:23], a[28:31], v[60:63], v[20:23]
s_xor_b32 s27, s27, 2048
v_xor_b32 v120, 2048, v120
v_mfma_f32_16x16x32_bf16 v[16:19], a[24:27], v[60:63], v[16:19]
s_waitcnt lgkmcnt(4)
v_mfma_f32_16x16x32_bf16 v[8:11], a[32:35], v[32:35], v[8:11]
ds_read_b128 v[56:59], v104 offset:14336
buffer_load_dwordx4 v107, s[8:11], s32 offen offset:3072 sc1 lds
v_mfma_f32_16x16x32_bf16 v[12:15], a[36:39], v[32:35], v[12:15]
ds_read_b128 v[60:63], v104 offset:15360
v_mfma_f32_16x16x32_bf16 v[20:23], a[36:39], v[36:39], v[20:23]
v_mfma_f32_16x16x32_bf16 v[16:19], a[32:35], v[36:39], v[16:19]
s_waitcnt lgkmcnt(4)
s_add_u32 m0, s56, s29
s_add_u32 s32, s55, s29
v_mfma_f32_16x16x32_bf16 v[8:11], a[40:43], v[40:43], v[8:11]
ds_read_b128 v[32:35], v104 offset:16384
buffer_load_dwordx4 v107, s[8:11], s32 offen offset:0 sc1 lds
v_mfma_f32_16x16x32_bf16 v[12:15], a[44:47], v[40:43], v[12:15]
ds_read_b128 v[36:39], v104 offset:17408
v_mfma_f32_16x16x32_bf16 v[20:23], a[44:47], v[44:47], v[20:23]
v_mfma_f32_16x16x32_bf16 v[16:19], a[40:43], v[44:47], v[16:19]
s_waitcnt lgkmcnt(4)
v_mfma_f32_16x16x32_bf16 v[8:11], a[48:51], v[48:51], v[8:11]
ds_read_b128 v[40:43], v104 offset:18432
buffer_load_dwordx4 v107, s[8:11], s32 offen offset:1024 sc1 lds
v_mfma_f32_16x16x32_bf16 v[12:15], a[52:55], v[48:51], v[12:15]
ds_read_b128 v[44:47], v104 offset:19456
v_mfma_f32_16x16x32_bf16 v[20:23], a[52:55], v[52:55], v[20:23]
v_mfma_f32_16x16x32_bf16 v[16:19], a[48:51], v[52:55], v[16:19]
s_waitcnt lgkmcnt(4)
s_add_u32 m0, s27, 256
s_nop 0
v_mfma_f32_16x16x32_bf16 v[8:11], a[56:59], v[56:59], v[8:11]
ds_read_b128 v[48:51], v104 offset:20480
buffer_load_dword v119, s[4:7], s26 offen sc1 lds
v_mfma_f32_16x16x32_bf16 v[12:15], a[60:63], v[56:59], v[12:15]
ds_read_b128 v[52:55], v104 offset:21504
v_mfma_f32_16x16x32_bf16 v[20:23], a[60:63], v[60:63], v[20:23]
v_mfma_f32_16x16x32_bf16 v[16:19], a[56:59], v[60:63], v[16:19]
s_waitcnt lgkmcnt(4)
v_mfma_f32_16x16x32_bf16 v[8:11], a[64:67], v[32:35], v[8:11]
s_add_u32 m0, s56, s29
ds_read_b128 v[56:59], v104 offset:22528
buffer_load_dwordx4 v107, s[8:11], s32 offen offset:2048 sc1 lds
v_mfma_f32_16x16x32_bf16 v[12:15], a[68:71], v[32:35], v[12:15]
ds_read_b128 v[60:63], v104 offset:23552
v_mfma_f32_16x16x32_bf16 v[20:23], a[68:71], v[36:39], v[20:23]
v_mfma_f32_16x16x32_bf16 v[16:19], a[64:67], v[36:39], v[16:19]
s_waitcnt lgkmcnt(4)
v_mfma_f32_16x16x32_bf16 v[8:11], a[72:75], v[40:43], v[8:11]
ds_read_b128 v[32:35], v104 offset:24576
buffer_load_dwordx4 v107, s[8:11], s32 offen offset:3072 sc1 lds
v_mfma_f32_16x16x32_bf16 v[12:15], a[76:79], v[40:43], v[12:15]
ds_read_b128 v[36:39], v104 offset:25600
v_mfma_f32_16x16x32_bf16 v[20:23], a[76:79], v[44:47], v[20:23]
v_mfma_f32_16x16x32_bf16 v[16:19], a[72:75], v[44:47], v[16:19]
s_waitcnt lgkmcnt(4)
s_add_u32 m0, s56, s30
s_add_u32 s32, s55, s30
v_mfma_f32_16x16x32_bf16 v[8:11], a[80:83], v[48:51], v[8:11]
ds_read_b128 v[40:43], v104 offset:26624
buffer_load_dwordx4 v107, s[8:11], s32 offen offset:0 sc1 lds
v_mfma_f32_16x16x32_bf16 v[12:15], a[84:87], v[48:51], v[12:15]
ds_read_b128 v[44:47], v104 offset:27648
v_mfma_f32_16x16x32_bf16 v[20:23], a[84:87], v[52:55], v[20:23]
v_mfma_f32_16x16x32_bf16 v[16:19], a[80:83], v[52:55], v[16:19]
s_waitcnt lgkmcnt(4)
v_mfma_f32_16x16x32_bf16 v[8:11], a[88:91], v[56:59], v[8:11]
ds_read_b128 v[48:51], v104 offset:28672
buffer_load_dwordx4 v107, s[8:11], s32 offen offset:1024 sc1 lds
v_mfma_f32_16x16x32_bf16 v[12:15], a[92:95], v[56:59], v[12:15]
ds_read_b128 v[52:55], v104 offset:29696
v_mfma_f32_16x16x32_bf16 v[20:23], a[92:95], v[60:63], v[20:23]
v_mfma_f32_16x16x32_bf16 v[16:19], a[88:91], v[60:63], v[16:19]
s_waitcnt lgkmcnt(4)
v_mfma_f32_16x16x32_bf16 v[8:11], a[96:99], v[32:35], v[8:11]
ds_read_b128 v[56:59], v104 offset:30720
buffer_load_dwordx4 v107, s[8:11], s32 offen offset:2048 sc1 lds
v_mfma_f32_16x16x32_bf16 v[12:15], a[100:103], v[32:35], v[12:15]
ds_read_b128 v[60:63], v104 offset:31744
v_mfma_f32_16x16x32_bf16 v[20:23], a[100:103], v[36:39], v[20:23]
v_mfma_f32_16x16x32_bf16 v[16:19], a[96:99], v[36:39], v[16:19]
s_waitcnt lgkmcnt(4)
v_mfma_f32_16x16x32_bf16 v[8:11], a[104:107], v[40:43], v[8:11]
ds_read_b128 v[32:35], v104 offset:32768
buffer_load_dwordx4 v107, s[8:11], s32 offen offset:3072 sc1 lds
v_mfma_f32_16x16x32_bf16 v[12:15], a[108:111], v[40:43], v[12:15]
s_waitcnt vmcnt(14)
ds_read_b128 v[36:39], v104 offset:33792
v_mfma_f32_16x16x32_bf16 v[72:75], v[24:27], v[124:127], v[72:75]
v_mfma_f32_16x16x32_bf16 v[76:79], v[28:31], v[124:127], v[76:79]
v_mfma_f32_16x16x32_bf16 v[20:23], a[108:111], v[44:47], v[20:23]
s_add_u32 m0, s56, s31
s_add_u32 s32, s55, s31
buffer_load_dwordx4 v107, s[8:11], s32 offen offset:0 sc1 lds
v_mfma_f32_16x16x32_bf16 v[80:83], v[24:27], v[128:131], v[80:83]
v_mfma_f32_16x16x32_bf16 v[84:87], v[28:31], v[128:131], v[84:87]
v_mfma_f32_16x16x32_bf16 v[16:19], a[104:107], v[44:47], v[16:19]
s_waitcnt lgkmcnt(4)
v_mfma_f32_16x16x32_bf16 v[72:75], v[24:27], v[132:135], v[72:75]
buffer_load_dwordx4 v107, s[8:11], s32 offen offset:1024 sc1 lds
v_mfma_f32_16x16x32_bf16 v[76:79], v[28:31], v[132:135], v[76:79]
v_mfma_f32_16x16x32_bf16 v[80:83], v[24:27], v[136:139], v[80:83]
v_mfma_f32_16x16x32_bf16 v[8:11], a[112:115], v[48:51], v[8:11]
ds_read_b128 v[40:43], v104 offset:34816
buffer_load_dwordx4 v107, s[8:11], s32 offen offset:2048 sc1 lds
v_mfma_f32_16x16x32_bf16 v[84:87], v[28:31], v[136:139], v[84:87]
v_mfma_f32_16x16x32_bf16 v[72:75], v[24:27], v[140:143], v[72:75]
v_mfma_f32_16x16x32_bf16 v[12:15], a[116:119], v[48:51], v[12:15]
ds_read_b128 v[44:47], v104 offset:35840
v_mfma_f32_16x16x32_bf16 v[76:79], v[28:31], v[140:143], v[76:79]
buffer_load_dwordx4 v107, s[8:11], s32 offen offset:3072 sc1 lds
v_mfma_f32_16x16x32_bf16 v[80:83], v[24:27], v[144:147], v[80:83]
v_mfma_f32_16x16x32_bf16 v[84:87], v[28:31], v[144:147], v[84:87]
s_add_u32 s60, s53, 1
s_add_u32 s99, s99, 1
s_cmp_lt_u32 s99, 91
v_mfma_f32_16x16x32_bf16 v[20:23], a[116:119], v[52:55], v[20:23]
s_cselect_b32 s24, s98, s60
s_cselect_b32 s98, s60, s98
s_mov_b32 m0, s27
v_mfma_f32_16x16x32_bf16 v[16:19], a[112:115], v[52:55], v[16:19]
s_waitcnt lgkmcnt(4)
s_cmp_lt_u32 s24, 64
s_cselect_b32 s58, 0, 0x40000
v_mfma_f32_16x16x32_bf16 v[8:11], a[120:123], v[56:59], v[8:11]
ds_read_b128 v[48:51], v104 offset:36864
buffer_load_dword v113, s[4:7], s58 offen sc1 lds
v_mfma_f32_16x16x32_bf16 v[12:15], a[124:127], v[56:59], v[12:15]
ds_read_b128 v[52:55], v104 offset:37888
v_mfma_f32_16x16x32_bf16 v[20:23], a[124:127], v[60:63], v[20:23]
v_cvt_pk_bf16_f32 v156, v72, v73
v_cvt_pk_bf16_f32 v157, v74, v75
v_mfma_f32_16x16x32_bf16 v[16:19], a[120:123], v[60:63], v[16:19]
s_waitcnt lgkmcnt(4)
v_cvt_pk_bf16_f32 v158, v76, v77
v_cvt_pk_bf16_f32 v159, v78, v79
v_mfma_f32_16x16x32_bf16 v[8:11], a[128:131], v[32:35], v[8:11]
ds_read_b128 v[56:59], v104 offset:38912
buffer_store_dwordx4 v[156:159], v115, s[16:19], s77 offen sc1
v_mfma_f32_16x16x32_bf16 v[12:15], a[132:135], v[32:35], v[12:15]
ds_read_b128 v[60:63], v104 offset:39936
v_cvt_pk_bf16_f32 v160, v80, v81
v_mfma_f32_16x16x32_bf16 v[20:23], a[132:135], v[36:39], v[20:23]
v_cvt_pk_bf16_f32 v161, v82, v83
v_cvt_pk_bf16_f32 v162, v84, v85
v_mfma_f32_16x16x32_bf16 v[16:19], a[128:131], v[36:39], v[16:19]
s_waitcnt lgkmcnt(4)
v_cvt_pk_bf16_f32 v163, v86, v87
v_dot2_f32_bf16 v164, v156, s76, 0
v_dot2_f32_bf16 v166, v156, v156, 0
v_dot2_f32_bf16 v165, v160, s76, 0
v_dot2_f32_bf16 v167, v160, v160, 0
v_dot2_f32_bf16 v164, v157, s76, v164
v_dot2_f32_bf16 v166, v157, v157, v166
v_dot2_f32_bf16 v165, v161, s76, v165
v_dot2_f32_bf16 v167, v161, v161, v167
v_dot2_f32_bf16 v164, v158, s76, v164
v_dot2_f32_bf16 v166, v158, v158, v166
v_dot2_f32_bf16 v165, v162, s76, v165
v_dot2_f32_bf16 v167, v162, v162, v167
v_dot2_f32_bf16 v164, v159, s76, v164
v_dot2_f32_bf16 v166, v159, v159, v166
v_dot2_f32_bf16 v165, v163, s76, v165
v_dot2_f32_bf16 v167, v163, v163, v167
v_mfma_f32_16x16x32_bf16 v[8:11], a[136:139], v[40:43], v[8:11]
ds_read_b128 v[32:35], v104 offset:40960
buffer_store_dwordx4 v[160:163], v115, s[16:19], s78 offen sc1
v_mfma_f32_16x16x32_bf16 v[12:15], a[140:143], v[40:43], v[12:15]
ds_read_b128 v[36:39], v104 offset:41984
v_mfma_f32_16x16x32_bf16 v[20:23], a[140:143], v[44:47], v[20:23]
v_permlane32_swap_b32 v164, v165
v_mfma_f32_16x16x32_bf16 v[16:19], a[136:139], v[44:47], v[16:19]
s_waitcnt lgkmcnt(4)
v_permlane32_swap_b32 v166, v167
v_mfma_f32_16x16x32_bf16 v[8:11], a[144:147], v[48:51], v[8:11]
ds_read_b128 v[40:43], v104 offset:43008
v_add_f32 v164, v164, v165
v_mfma_f32_16x16x32_bf16 v[12:15], a[148:151], v[48:51], v[12:15]
ds_read_b128 v[44:47], v104 offset:44032
v_add_f32 v166, v166, v167
v_mfma_f32_16x16x32_bf16 v[20:23], a[148:151], v[52:55], v[20:23]
s_nop 0
v_permlane16_swap_b32 v164, v166
v_mfma_f32_16x16x32_bf16 v[16:19], a[144:147], v[52:55], v[16:19]
s_waitcnt lgkmcnt(4)
v_add_f32 v164, v164, v166
ds_write_b32 v118, v164
v_mfma_f32_16x16x32_bf16 v[8:11], a[152:155], v[56:59], v[8:11]
s_waitcnt lgkmcnt(0)
ds_read_b128 v[48:51], v104 offset:45056
s_waitcnt vmcnt(13)
v_mfma_f32_16x16x32_bf16 v[12:15], a[156:159], v[56:59], v[12:15]
s_barrier
ds_read_b128 v[52:55], v104 offset:46080
ds_read_b32 v109, v120 offset:256
v_mfma_f32_16x16x32_bf16 v[20:23], a[156:159], v[60:63], v[20:23]
ds_read2st64_b32 v[164:165], v117 offset0:0 offset1:1
ds_read2st64_b32 v[166:167], v117 offset0:2 offset1:3
v_mfma_f32_16x16x32_bf16 v[16:19], a[152:155], v[60:63], v[16:19]
v_mfma_f32_16x16x32_bf16 v[8:11], a[160:163], v[32:35], v[8:11]
ds_read_b128 v[56:59], v104 offset:47104
v_mfma_f32_16x16x32_bf16 v[12:15], a[164:167], v[32:35], v[12:15]
ds_read_b128 v[60:63], v104 offset:48128
v_mfma_f32_16x16x32_bf16 v[20:23], a[164:167], v[36:39], v[20:23]
s_waitcnt lgkmcnt(2)
v_add_f32 v164, v164, v165
v_add_f32 v166, v166, v167
v_mfma_f32_16x16x32_bf16 v[16:19], a[160:163], v[36:39], v[16:19]
v_add_f32 v164, v164, v166
buffer_store_dword v164, v114, s[4:7], s79 offen sc1
v_mfma_f32_16x16x32_bf16 v[8:11], a[168:171], v[40:43], v[8:11]
ds_read_b128 v[32:35], v104 offset:49152
v_cmp_lt_u32 vcc, s52, v109
v_mfma_f32_16x16x32_bf16 v[12:15], a[172:175], v[40:43], v[12:15]
s_cmp_eq_u64 vcc, -1
ds_read_b128 v[36:39], v104 offset:50176
s_cselect_b32 s14, 0x10000000, 0
v_mfma_f32_16x16x32_bf16 v[20:23], a[172:175], v[44:47], v[20:23]
v_mfma_f32_16x16x32_bf16 v[16:19], a[168:171], v[44:47], v[16:19]
s_lshl_b32 s73, s52, 16
s_add_u32 s73, s73, 0xc00000
v_mfma_f32_16x16x32_bf16 v[8:11], a[176:179], v[48:51], v[8:11]
ds_read_b128 v[40:43], v104 offset:51200
buffer_load_dwordx4 v[140:143], v112, s[12:15], s73 offen offset:0 sc1
v_mfma_f32_16x16x32_bf16 v[12:15], a[180:183], v[48:51], v[12:15]
ds_read_b128 v[44:47], v104 offset:52224
v_mfma_f32_16x16x32_bf16 v[20:23], a[180:183], v[52:55], v[20:23]
v_mfma_f32_16x16x32_bf16 v[16:19], a[176:179], v[52:55], v[16:19]
s_waitcnt lgkmcnt(4)
v_mfma_f32_16x16x32_bf16 v[8:11], a[184:187], v[56:59], v[8:11]
ds_read_b128 v[48:51], v104 offset:53248
buffer_load_dwordx4 v[144:147], v112, s[12:15], s73 offen offset:1024 sc1
v_mfma_f32_16x16x32_bf16 v[12:15], a[188:191], v[56:59], v[12:15]
ds_read_b128 v[52:55], v104 offset:54272
v_mfma_f32_16x16x32_bf16 v[20:23], a[188:191], v[60:63], v[20:23]
v_mfma_f32_16x16x32_bf16 v[16:19], a[184:187], v[60:63], v[16:19]
s_waitcnt lgkmcnt(4)
s_mul_i32 s73, s52, 0x20000
s_add_u32 s73, s73, 0xe800000
v_mfma_f32_16x16x32_bf16 v[8:11], a[192:195], v[32:35], v[8:11]
ds_read_b128 v[56:59], v104 offset:55296
buffer_load_dwordx4 v[124:127], v112, s[12:15], s73 offen offset:0 sc1
v_mfma_f32_16x16x32_bf16 v[12:15], a[196:199], v[32:35], v[12:15]
ds_read_b128 v[60:63], v104 offset:56320
v_mfma_f32_16x16x32_bf16 v[20:23], a[196:199], v[36:39], v[20:23]
v_mfma_f32_16x16x32_bf16 v[16:19], a[192:195], v[36:39], v[16:19]
s_waitcnt lgkmcnt(4)
v_mfma_f32_16x16x32_bf16 v[8:11], a[200:203], v[40:43], v[8:11]
ds_read_b128 v[32:35], v104 offset:57344
buffer_load_dwordx4 v[128:131], v112, s[12:15], s73 offen offset:1024 sc1
v_mfma_f32_16x16x32_bf16 v[12:15], a[204:207], v[40:43], v[12:15]
ds_read_b128 v[36:39], v104 offset:58368
v_mfma_f32_16x16x32_bf16 v[20:23], a[204:207], v[44:47], v[20:23]
v_mfma_f32_16x16x32_bf16 v[16:19], a[200:203], v[44:47], v[16:19]
s_waitcnt lgkmcnt(4)
v_mfma_f32_16x16x32_bf16 v[8:11], a[208:211], v[48:51], v[8:11]
s_add_u32 s73, s73, 0x10000
ds_read_b128 v[40:43], v104 offset:59392
buffer_load_dwordx4 v[132:135], v112, s[12:15], s73 offen offset:0 sc1
v_mfma_f32_16x16x32_bf16 v[12:15], a[212:215], v[48:51], v[12:15]
ds_read_b128 v[44:47], v104 offset:60416
v_mfma_f32_16x16x32_bf16 v[20:23], a[212:215], v[52:55], v[20:23]
v_mfma_f32_16x16x32_bf16 v[16:19], a[208:211], v[52:55], v[16:19]
s_waitcnt lgkmcnt(4)
s_and_b32 s77, s52, 63
s_lshl_b32 s77, s77, 16
v_mfma_f32_16x16x32_bf16 v[8:11], a[216:219], v[56:59], v[8:11]
s_lshl_b32 s79, s52, 11
ds_read_b128 v[48:51], v104 offset:61440
s_add_u32 s79, s79, 0x1a0000
v_mfma_f32_16x16x32_bf16 v[12:15], a[220:223], v[56:59], v[12:15]
s_mov_b32 s78, 0x8000
ds_read_b128 v[52:55], v104 offset:62464
s_cmp_lt_u32 s52, 64
v_mfma_f32_16x16x32_bf16 v[20:23], a[220:223], v[60:63], v[20:23]
s_cselect_b32 s16, s4, s74
s_cselect_b32 s17, s5, s75
s_cselect_b32 s18, s6, 0x400000
v_mfma_f32_16x16x32_bf16 v[16:19], a[216:219], v[60:63], v[16:19]
s_waitcnt lgkmcnt(4)
s_cselect_b32 s79, s79, 0x40000000
s_cselect_b32 s78, 0x400, s78
v_mfma_f32_16x16x32_bf16 v[8:11], a[224:227], v[32:35], v[8:11]
s_cselect_b32 s61, 0x800000, 0
ds_read_b128 v[56:59], v104 offset:63488
s_cselect_b64 vcc, -1, 0
v_mfma_f32_16x16x32_bf16 v[12:15], a[228:231], v[32:35], v[12:15]
s_add_u32 s77, s77, s61
ds_read_b128 v[60:63], v104 offset:64512
s_add_u32 s78, s78, s77
v_mfma_f32_16x16x32_bf16 v[20:23], a[228:231], v[36:39], v[20:23]
v_cndmask_b32 v115, v116, v112, vcc
buffer_load_dwordx4 v[136:139], v112, s[12:15], s73 offen offset:1024 sc1
v_mfma_f32_16x16x32_bf16 v[16:19], a[224:227], v[36:39], v[16:19]
s_waitcnt lgkmcnt(4)
v_mfma_f32_16x16x32_bf16 v[8:11], a[232:235], v[40:43], v[8:11]
s_sub_u32 s54, 65536, s54
v_add_u32 v104, s54, v106
v_mfma_f32_16x16x32_bf16 v[12:15], a[236:239], v[40:43], v[12:15]
v_mfma_f32_16x16x32_bf16 v[20:23], a[236:239], v[44:47], v[20:23]
v_mfma_f32_16x16x32_bf16 v[16:19], a[232:235], v[44:47], v[16:19]
s_waitcnt lgkmcnt(0)
s_waitcnt vmcnt(9)
s_barrier
v_mfma_f32_16x16x32_bf16 v[8:11], a[240:243], v[48:51], v[8:11]
ds_read_b32 v108, v120
ds_read_b128 v[32:35], v104 offset:0
v_mfma_f32_16x16x32_bf16 v[12:15], a[244:247], v[48:51], v[12:15]
ds_read_b128 v[36:39], v104 offset:1024
ds_read_b128 v[40:43], v104 offset:2048
v_mfma_f32_16x16x32_bf16 v[20:23], a[244:247], v[52:55], v[20:23]
ds_read_b128 v[44:47], v104 offset:3072
v_mov_b32 v111, s44
v_mfma_f32_16x16x32_bf16 v[16:19], a[240:243], v[52:55], v[16:19]
s_mov_b32 s59, s45
s_add_u32 s44, s52, 65
v_mfma_f32_16x16x32_bf16 v[72:75], a[248:251], v[56:59], v[8:11]
s_cmp_lt_u32 s52, 64
ds_read_b128 v[48:51], v104 offset:4096
s_mov_b32 s45, 0x40000000
v_mfma_f32_16x16x32_bf16 v[76:79], a[252:255], v[56:59], v[12:15]
s_cselect_b32 s45, 0x40000, s45
ds_read_b128 v[52:55], v104 offset:5120
s_nop 0
v_mfma_f32_16x16x32_bf16 v[84:87], a[252:255], v[60:63], v[20:23]
s_waitcnt lgkmcnt(6)
v_cmp_lt_u32 vcc, s24, v108
s_nop 0
s_cmp_eq_u64 vcc, -1
v_mfma_f32_16x16x32_bf16 v[80:83], a[248:251], v[60:63], v[16:19]
s_cselect_b32 s51, 0x10000000, 0
s_and_b32 s64, s10, s14
s_cbranch_scc1 LDNF_top
s_cmp_lg_u32 s14, 0
s_cbranch_scc1 Llw_164
s_xor_b32 s27, s27, 2048
v_xor_b32 v120, 2048, v120
s_mov_b32 m0, s27
s_cmp_lt_u32 s24, 64
s_cselect_b32 s58, 0, 0x40000
buffer_load_dword v113, s[4:7], s58 offen sc1 lds
s_add_u32 m0, s27, 256
s_nop 0
buffer_load_dword v119, s[4:7], s26 offen sc1 lds
s_waitcnt vmcnt(0) lgkmcnt(0)
s_barrier
ds_read2st64_b32 v[108:109], v120 offset0:0 offset1:1
buffer_store_dword v111, v110, s[4:7], s59 offen sc1
s_waitcnt lgkmcnt(0)
v_cmp_lt_u32 vcc, s52, v109
s_nop 0
s_cmp_eq_u64 vcc, -1
s_cbranch_scc1 Llg_165
s_xor_b32 s27, s27, 2048
v_xor_b32 v120, 2048, v120
s_cmp_lg_u32 s48, 0
s_cbranch_scc1 Lspd_167
Lsp_166:
s_mov_b32 m0, s27
s_cmp_lt_u32 s24, 64
s_cselect_b32 s58, 0, 0x40000
buffer_load_dword v113, s[4:7], s58 offen sc1 lds
buffer_load_dword v109, v119, s[4:7], s26 offen sc1
s_waitcnt vmcnt(0)
v_cmp_lt_u32 vcc, s52, v109
s_nop 0
s_cmp_eq_u64 vcc, -1
s_cbranch_scc0 Lrt_168
Lspd_167:
s_barrier
ds_read_b32 v108, v120
Llg_165:
s_lshl_b32 s73, s52, 16
s_add_u32 s73, s73, 0xc00000
buffer_load_dwordx4 v[140:143], v112, s[4:7], s73 offen offset:0 sc1
buffer_load_dwordx4 v[144:147], v112, s[4:7], s73 offen offset:1024 sc1
s_mul_i32 s73, s52, 0x20000
s_add_u32 s73, s73, 0xe800000
buffer_load_dwordx4 v[124:127], v112, s[4:7], s73 offen offset:0 sc1
buffer_load_dwordx4 v[128:131], v112, s[4:7], s73 offen offset:1024 sc1
s_add_u32 s73, s73, 0x10000
buffer_load_dwordx4 v[132:135], v112, s[4:7], s73 offen offset:0 sc1
buffer_load_dwordx4 v[136:139], v112, s[4:7], s73 offen offset:1024 sc1
s_waitcnt lgkmcnt(0)
v_cmp_lt_u32 vcc, s24, v108
s_nop 0
s_cmp_eq_u64 vcc, -1
s_cselect_b32 s51, 0x10000000, 0
s_mov_b32 s61, 0x40000000
s_cmp_lg_u32 s10, 0
s_cbranch_scc1 LDNF_top
v_cmp_lt_u32 vcc, s53, v108
s_min_u32 s61, s24, 127
s_xor_b32 s61, s61, s53
s_cmp_eq_u64 vcc, -1
s_cselect_b32 s10, 0x10000000, 0
s_cmp_lt_u32 s61, 64
s_cselect_b32 s10, s10, 0
s_cmp_eq_u32 s10, 0
s_cbranch_scc1 Lfen_171
s_mul_i32 s55, s53, 0x38000
s_add_u32 s55, s55, s71
s_add_u32 s56, s25, s54
s_add_u32 m0, s56, s28
s_add_u32 s32, s55, s28
buffer_load_dwordx4 v107, s[4:7], s32 offen offset:0 sc1 lds
buffer_load_dwordx4 v107, s[4:7], s32 offen offset:1024 sc1 lds
buffer_load_dwordx4 v107, s[4:7], s32 offen offset:2048 sc1 lds
buffer_load_dwordx4 v107, s[4:7], s32 offen offset:3072 sc1 lds
s_add_u32 m0, s56, s29
s_add_u32 s32, s55, s29
buffer_load_dwordx4 v107, s[4:7], s32 offen offset:0 sc1 lds
buffer_load_dwordx4 v107, s[4:7], s32 offen offset:1024 sc1 lds
buffer_load_dwordx4 v107, s[4:7], s32 offen offset:2048 sc1 lds
buffer_load_dwordx4 v107, s[4:7], s32 offen offset:3072 sc1 lds
s_add_u32 m0, s56, s30
s_add_u32 s32, s55, s30
buffer_load_dwordx4 v107, s[4:7], s32 offen offset:0 sc1 lds
buffer_load_dwordx4 v107, s[4:7], s32 offen offset:1024 sc1 lds
buffer_load_dwordx4 v107, s[4:7], s32 offen offset:2048 sc1 lds
buffer_load_dwordx4 v107, s[4:7], s32 offen offset:3072 sc1 lds
s_add_u32 m0, s56, s31
s_add_u32 s32, s55, s31
buffer_load_dwordx4 v107, s[4:7], s32 offen offset:0 sc1 lds
buffer_load_dwordx4 v107, s[4:7], s32 offen offset:1024 sc1 lds
buffer_load_dwordx4 v107, s[4:7], s32 offen offset:2048 sc1 lds
buffer_load_dwordx4 v107, s[4:7], s32 offen offset:3072 sc1 lds
s_waitcnt vmcnt(16)
s_branch Lfe_169
Lfen_171:
s_waitcnt vmcnt(0)
s_branch Lfe_169
Llw_164:
s_waitcnt vmcnt(0)
s_barrier
buffer_store_dword v111, v110, s[4:7], s59 offen sc1
Lfe_169:
v_mfma_f32_16x16x32_bf16 v[72:75], v[24:27], v[124:127], v[72:75]
v_mfma_f32_16x16x32_bf16 v[76:79], v[28:31], v[124:127], v[76:79]
v_mfma_f32_16x16x32_bf16 v[80:83], v[24:27], v[128:131], v[80:83]
v_mfma_f32_16x16x32_bf16 v[84:87], v[28:31], v[128:131], v[84:87]
v_mfma_f32_16x16x32_bf16 v[72:75], v[24:27], v[132:135], v[72:75]
v_mfma_f32_16x16x32_bf16 v[76:79], v[28:31], v[132:135], v[76:79]
v_mfma_f32_16x16x32_bf16 v[80:83], v[24:27], v[136:139], v[80:83]
v_mfma_f32_16x16x32_bf16 v[84:87], v[28:31], v[136:139], v[84:87]
v_mfma_f32_16x16x32_bf16 v[72:75], v[24:27], v[140:143], v[72:75]
v_mfma_f32_16x16x32_bf16 v[76:79], v[28:31], v[140:143], v[76:79]
v_mfma_f32_16x16x32_bf16 v[80:83], v[24:27], v[144:147], v[80:83]
v_mfma_f32_16x16x32_bf16 v[84:87], v[28:31], v[144:147], v[84:87]
s_nop 4
v_cvt_pk_bf16_f32 v156, v72, v73
v_cvt_pk_bf16_f32 v157, v74, v75
v_cvt_pk_bf16_f32 v158, v76, v77
v_cvt_pk_bf16_f32 v159, v78, v79
buffer_store_dwordx4 v[156:159], v115, s[16:19], s77 offen sc1
v_cvt_pk_bf16_f32 v160, v80, v81
v_cvt_pk_bf16_f32 v161, v82, v83
v_cvt_pk_bf16_f32 v162, v84, v85
v_cvt_pk_bf16_f32 v163, v86, v87
buffer_store_dwordx4 v[160:163], v115, s[16:19], s78 offen sc1
v_dot2_f32_bf16 v164, v156, s76, 0
v_dot2_f32_bf16 v166, v156, v156, 0
v_dot2_f32_bf16 v165, v160, s76, 0
v_dot2_f32_bf16 v167, v160, v160, 0
v_dot2_f32_bf16 v164, v157, s76, v164
v_dot2_f32_bf16 v166, v157, v157, v166
v_dot2_f32_bf16 v165, v161, s76, v165
v_dot2_f32_bf16 v167, v161, v161, v167
v_dot2_f32_bf16 v164, v158, s76, v164
v_dot2_f32_bf16 v166, v158, v158, v166
v_dot2_f32_bf16 v165, v162, s76, v165
v_dot2_f32_bf16 v167, v162, v162, v167
v_dot2_f32_bf16 v164, v159, s76, v164
v_dot2_f32_bf16 v166, v159, v159, v166
v_dot2_f32_bf16 v165, v163, s76, v165
v_dot2_f32_bf16 v167, v163, v163, v167
s_nop 1
v_permlane32_swap_b32 v164, v165
v_permlane32_swap_b32 v166, v167
v_add_f32 v164, v164, v165
v_add_f32 v166, v166, v167
s_nop 1
v_permlane16_swap_b32 v164, v166
v_add_f32 v164, v164, v166
ds_write_b32 v118, v164
s_waitcnt lgkmcnt(0)
s_barrier
ds_read2st64_b32 v[164:165], v117 offset0:0 offset1:1
ds_read2st64_b32 v[166:167], v117 offset0:2 offset1:3
s_waitcnt lgkmcnt(0)
v_add_f32 v164, v164, v165
v_add_f32 v166, v166, v167
v_add_f32 v164, v164, v166
buffer_store_dword v164, v114, s[4:7], s79 offen sc1
s_mov_b32 s77, 0x40000000
s_mov_b32 s78, 0x40000000
s_mov_b32 s79, 0x40000000
v_mov_b32 v111, s44
s_mov_b32 s59, s45
s_xor_b32 s27, s27, 2048
v_xor_b32 v120, 2048, v120
s_cmp_lg_u32 s10, 0
s_cbranch_scc1 Lfef_170
s_min_u32 s61, s24, 127
s_xor_b32 s61, s61, s53
s_cmp_ge_u32 s61, 64
s_cbranch_scc1 Lnomed_176
v_cmp_lt_u32 vcc, s53, v108
s_nop 0
s_cmp_eq_u64 vcc, -1
s_cbranch_scc1 Lmed_175
Lnomed_176:
s_mov_b32 m0, s27
s_cmp_lt_u32 s53, 64
s_cselect_b32 s58, 0, 0x40000
buffer_load_dword v113, s[4:7], s58 offen sc1 lds
s_mul_i32 s55, s53, 0x38000
s_add_u32 s55, s55, s71
s_add_u32 s56, s25, s54
s_waitcnt vmcnt(0) lgkmcnt(0)
s_barrier
ds_read_b32 v108, v120
buffer_store_dword v111, v110, s[4:7], s59 offen sc1
s_cmp_ge_u32 s53, 128
s_cbranch_scc1 LDNF_exit
s_xor_b32 s27, s27, 2048
v_xor_b32 v120, 2048, v120
s_waitcnt lgkmcnt(0)
v_cmp_lt_u32 vcc, s53, v108
s_nop 0
s_cmp_eq_u64 vcc, -1
s_cbranch_scc1 Lgo_172
LDNF_slow:
s_and_b32 s58, s53, 64
s_lshl_b32 s58, s58, 12
s_mul_i32 s55, s53, 0x38000
s_add_u32 s55, s55, s71
s_add_u32 s56, s25, s54
s_cmp_lg_u32 s48, 0
s_cbranch_scc1 Lspd_178
Lsp_177:
buffer_load_dword v108, v113, s[4:7], s58 offen sc1
s_waitcnt vmcnt(0)
v_cmp_lt_u32 vcc, s53, v108
s_nop 0
s_cmp_eq_u64 vcc, -1
s_cbranch_scc0 Lrt_179
Lspd_178:
s_barrier
Lgo_172:
s_add_u32 m0, s56, s28
s_add_u32 s32, s55, s28
buffer_load_dwordx4 v107, s[4:7], s32 offen offset:0 sc1 lds
buffer_load_dwordx4 v107, s[4:7], s32 offen offset:1024 sc1 lds
buffer_load_dwordx4 v107, s[4:7], s32 offen offset:2048 sc1 lds
buffer_load_dwordx4 v107, s[4:7], s32 offen offset:3072 sc1 lds
s_add_u32 m0, s56, s29
s_add_u32 s32, s55, s29
buffer_load_dwordx4 v107, s[4:7], s32 offen offset:0 sc1 lds
buffer_load_dwordx4 v107, s[4:7], s32 offen offset:1024 sc1 lds
buffer_load_dwordx4 v107, s[4:7], s32 offen offset:2048 sc1 lds
buffer_load_dwordx4 v107, s[4:7], s32 offen offset:3072 sc1 lds
s_add_u32 m0, s56, s30
s_add_u32 s32, s55, s30
buffer_load_dwordx4 v107, s[4:7], s32 offen offset:0 sc1 lds
buffer_load_dwordx4 v107, s[4:7], s32 offen offset:1024 sc1 lds
buffer_load_dwordx4 v107, s[4:7], s32 offen offset:2048 sc1 lds
buffer_load_dwordx4 v107, s[4:7], s32 offen offset:3072 sc1 lds
s_add_u32 m0, s56, s31
s_add_u32 s32, s55, s31
buffer_load_dwordx4 v107, s[4:7], s32 offen offset:0 sc1 lds
buffer_load_dwordx4 v107, s[4:7], s32 offen offset:1024 sc1 lds
buffer_load_dwordx4 v107, s[4:7], s32 offen offset:2048 sc1 lds
buffer_load_dwordx4 v107, s[4:7], s32 offen offset:3072 sc1 lds
s_mov_b32 m0, s27
s_cmp_lt_u32 s24, 64
s_cselect_b32 s58, 0, 0x40000
buffer_load_dword v113, s[4:7], s58 offen sc1 lds
s_waitcnt vmcnt(0)
Lrd_173:
s_barrier
Lrd2_174:
ds_read_b32 v108, v120
ds_read_b128 v[32:35], v104 offset:0
ds_read_b128 v[36:39], v104 offset:1024
ds_read_b128 v[40:43], v104 offset:2048
ds_read_b128 v[44:47], v104 offset:3072
ds_read_b128 v[48:51], v104 offset:4096
ds_read_b128 v[52:55], v104 offset:5120
s_waitcnt lgkmcnt(6)
v_cmp_lt_u32 vcc, s24, v108
s_nop 0
s_cmp_eq_u64 vcc, -1
s_cselect_b32 s51, 0x10000000, 0
s_branch LDNF_top
LDNF_exit:
s_waitcnt vmcnt(0)
s_endpgm
Lrt_163:
s_add_u32 s96, s96, 1
s_cmp_lt_u32 s96, 1048576
s_cbranch_scc1 Lnear_160
s_mov_b32 s97, 24
s_branch L_fail
Lrt_168:
s_add_u32 s96, s96, 1
s_cmp_lt_u32 s96, 1048576
s_cbranch_scc1 Lsp_166
s_mov_b32 s97, 21
s_branch L_fail
Lfef_170:
s_mov_b32 m0, s27
s_cmp_lt_u32 s24, 64
s_cselect_b32 s58, 0, 0x40000
buffer_load_dword v113, s[4:7], s58 offen sc1 lds
s_waitcnt vmcnt(0) lgkmcnt(0)
s_barrier
buffer_store_dword v111, v110, s[4:7], s59 offen sc1
s_branch Lrd2_174
Lmed_175:
s_mul_i32 s55, s53, 0x38000
s_add_u32 s55, s55, s71
s_add_u32 s56, s25, s54
s_add_u32 m0, s56, s28
s_add_u32 s32, s55, s28
buffer_load_dwordx4 v107, s[4:7], s32 offen offset:0 sc1 lds
buffer_load_dwordx4 v107, s[4:7], s32 offen offset:1024 sc1 lds
buffer_load_dwordx4 v107, s[4:7], s32 offen offset:2048 sc1 lds
buffer_load_dwordx4 v107, s[4:7], s32 offen offset:3072 sc1 lds
s_add_u32 m0, s56, s29
s_add_u32 s32, s55, s29
buffer_load_dwordx4 v107, s[4:7], s32 offen offset:0 sc1 lds
buffer_load_dwordx4 v107, s[4:7], s32 offen offset:1024 sc1 lds
buffer_load_dwordx4 v107, s[4:7], s32 offen offset:2048 sc1 lds
buffer_load_dwordx4 v107, s[4:7], s32 offen offset:3072 sc1 lds
s_add_u32 m0, s56, s30
s_add_u32 s32, s55, s30
buffer_load_dwordx4 v107, s[4:7], s32 offen offset:0 sc1 lds
buffer_load_dwordx4 v107, s[4:7], s32 offen offset:1024 sc1 lds
buffer_load_dwordx4 v107, s[4:7], s32 offen offset:2048 sc1 lds
buffer_load_dwordx4 v107, s[4:7], s32 offen offset:3072 sc1 lds
s_add_u32 m0, s56, s31
s_add_u32 s32, s55, s31
buffer_load_dwordx4 v107, s[4:7], s32 offen offset:0 sc1 lds
buffer_load_dwordx4 v107, s[4:7], s32 offen offset:1024 sc1 lds
buffer_load_dwordx4 v107, s[4:7], s32 offen offset:2048 sc1 lds
buffer_load_dwordx4 v107, s[4:7], s32 offen offset:3072 sc1 lds
s_mov_b32 m0, s27
s_cmp_lt_u32 s24, 64
s_cselect_b32 s58, 0, 0x40000
buffer_load_dword v113, s[4:7], s58 offen sc1 lds
s_waitcnt vmcnt(17) lgkmcnt(0)
s_barrier
buffer_store_dword v111, v110, s[4:7], s59 offen sc1
s_waitcnt vmcnt(1)
s_branch Lrd_173
Lrt_179:
s_add_u32 s96, s96, 1
s_cmp_lt_u32 s96, 1048576
s_cbranch_scc1 Lsp_177
s_mov_b32 s97, 8
s_branch L_fail
L_AT:
s_lshl_b32 s66, s49, 2
s_add_u32 s66, s66, s48
s_and_b32 s67, s48, 1
s_lshr_b32 s68, s66, 1
s_mul_i32 s60, s66, 256
s_add_u32 s60, s60, 53248
s_and_b32 s61, s60, 0xffffe000
s_add_u32 s60, s60, s61
v_mov_b32 v4, s60
v_mov_b32 v1, 0x40000000
v_cmp_gt_u32 vcc, 1, v0
s_nop 1
v_cndmask_b32 v4, v1, v4, vcc
v_mov_b32 v1, 0
s_mov_b32 s60, 0x0
buffer_store_dword v1, v4, s[4:7], s60 offen sc1
s_mov_b32 s60, 0x2000
buffer_store_dword v1, v4, s[4:7], s60 offen sc1
s_mov_b32 s60, 0x40000
buffer_store_dword v1, v4, s[4:7], s60 offen sc1
s_mov_b32 s60, 0x42000
buffer_store_dword v1, v4, s[4:7], s60 offen sc1
s_and_b32 s69, s66, 7
s_lshr_b32 s70, s66, 3
s_lshl_b32 s62, s69, 3
s_add_u32 s62, s62, s70
s_lshr_b32 s60, s62, 3
s_mul_i32 s60, s60, 256
s_and_b32 s61, s62, 7
s_lshl_b32 s61, s61, 2
s_add_u32 s60, s60, s61
s_add_u32 s60, s60, 0
s_and_b32 s61, s60, 0xffffe000
s_add_u32 s60, s60, s61
v_mov_b32 v5, s60
v_mov_b32 v1, 0x40000000
v_cmp_gt_u32 vcc, 1, v0
s_nop 1
v_cndmask_b32 v5, v1, v5, vcc
v_mov_b32 v1, s70
buffer_store_dword v1, v5, s[4:7], 0 offen sc1
s_mov_b32 s12, s24
s_and_b32 s13, s25, 0xffff
s_mov_b32 s14, 0x400000
s_mov_b32 s15, 0x20000
v_and_b32 v1, 15, v0
v_lshlrev_b32 v1, 11, v1
v_lshrrev_b32 v2, 4, v0
v_lshlrev_b32 v2, 4, v2
s_lshl_b32 s60, s69, 8
v_add3_u32 v6, v1, v2, s60
s_mov_b32 s52, s70
s_lshl_b32 s60, s52, 16
s_add_u32 s60, s60, 0
buffer_load_dwordx4 v[32:35], v6, s[12:15], s60 offen offset:0
buffer_load_dwordx4 v[40:43], v6, s[12:15], s60 offen offset:64
buffer_load_dwordx4 v[48:51], v6, s[12:15], s60 offen offset:128
buffer_load_dwordx4 v[56:59], v6, s[12:15], s60 offen offset:192
s_lshl_b32 s60, s52, 16
s_add_u32 s60, s60, 32768
buffer_load_dwordx4 v[36:39], v6, s[12:15], s60 offen offset:0
buffer_load_dwordx4 v[44:47], v6, s[12:15], s60 offen offset:64
buffer_load_dwordx4 v[52:55], v6, s[12:15], s60 offen offset:128
buffer_load_dwordx4 v[60:63], v6, s[12:15], s60 offen offset:192
s_lshl_b32 s60, s69, 13
v_lshlrev_b32 v1, 4, v0
v_add_u32 v7, s60, v1
v_lshrrev_b32 v1, 5, v0
v_lshlrev_b32 v1, 8, v1
v_and_b32 v2, 15, v0
v_lshlrev_b32 v2, 4, v2
v_add_u32 v1, v1, v2
v_bfe_u32 v2, v0, 4, 1
v_lshlrev_b32 v2, 2, v2
s_lshr_b32 s60, s69, 1
s_lshl_b32 s60, s60, 9
s_and_b32 s61, s69, 1
s_lshl_b32 s61, s61, 3
s_add_u32 s60, s60, s61
v_add3_u32 v20, v1, v2, s60
v_mov_b32 v28, 0x3f803f80
s_waitcnt vmcnt(0)
s_barrier
s_cmp_lg_u32 s48, 0
s_cbranch_scc1 Larr_180
s_mov_b32 s60, 0
v_mov_b32 v2, s60
v_mov_b32 v1, 0x40000000
v_cmp_gt_u32 vcc, 1, v0
s_nop 1
v_cndmask_b32 v2, v1, v2, vcc
s_sub_u32 s61, s101, s2
s_and_b32 s61, s61, 7
s_lshl_b32 s61, s61, 2
s_add_u32 s61, s61, 128
s_cmp_eq_u32 s100, 0
s_cselect_b32 s61, s61, 0
v_mov_b32 v3, 1
buffer_atomic_add v3, v2, s[20:23], s61 offen sc1
Larr_180:
s_lshl_b32 s60, s52, 16
s_add_u32 s60, s60, 0x400000
buffer_store_dwordx4 v[32:35], v7, s[4:7], s60 offen offset:0 sc1
buffer_store_dwordx4 v[36:39], v7, s[4:7], s60 offen offset:1024 sc1
buffer_store_dwordx4 v[40:43], v7, s[4:7], s60 offen offset:2048 sc1
buffer_store_dwordx4 v[44:47], v7, s[4:7], s60 offen offset:3072 sc1
s_lshl_b32 s60, s52, 16
s_add_u32 s60, s60, 0x401000
buffer_store_dwordx4 v[48:51], v7, s[4:7], s60 offen offset:0 sc1
buffer_store_dwordx4 v[52:55], v7, s[4:7], s60 offen offset:1024 sc1
buffer_store_dwordx4 v[56:59], v7, s[4:7], s60 offen offset:2048 sc1
buffer_store_dwordx4 v[60:63], v7, s[4:7], s60 offen offset:3072 sc1
v_dot2_f32_bf16 v24, v32, v28, 0
v_dot2_f32_bf16 v26, v32, v32, 0
v_dot2_f32_bf16 v25, v36, v28, 0
v_dot2_f32_bf16 v27, v36, v36, 0
v_dot2_f32_bf16 v24, v33, v28, v24
v_dot2_f32_bf16 v26, v33, v33, v26
v_dot2_f32_bf16 v25, v37, v28, v25
v_dot2_f32_bf16 v27, v37, v37, v27
v_dot2_f32_bf16 v24, v34, v28, v24
v_dot2_f32_bf16 v26, v34, v34, v26
v_dot2_f32_bf16 v25, v38, v28, v25
v_dot2_f32_bf16 v27, v38, v38, v27
v_dot2_f32_bf16 v24, v35, v28, v24
v_dot2_f32_bf16 v26, v35, v35, v26
v_dot2_f32_bf16 v25, v39, v28, v25
v_dot2_f32_bf16 v27, v39, v39, v27
v_dot2_f32_bf16 v24, v40, v28, v24
v_dot2_f32_bf16 v26, v40, v40, v26
v_dot2_f32_bf16 v25, v44, v28, v25
v_dot2_f32_bf16 v27, v44, v44, v27
v_dot2_f32_bf16 v24, v41, v28, v24
v_dot2_f32_bf16 v26, v41, v41, v26
v_dot2_f32_bf16 v25, v45, v28, v25
v_dot2_f32_bf16 v27, v45, v45, v27
v_dot2_f32_bf16 v24, v42, v28, v24
v_dot2_f32_bf16 v26, v42, v42, v26
v_dot2_f32_bf16 v25, v46, v28, v25
v_dot2_f32_bf16 v27, v46, v46, v27
v_dot2_f32_bf16 v24, v43, v28, v24
v_dot2_f32_bf16 v26, v43, v43, v26
v_dot2_f32_bf16 v25, v47, v28, v25
v_dot2_f32_bf16 v27, v47, v47, v27
v_dot2_f32_bf16 v24, v48, v28, v24
v_dot2_f32_bf16 v26, v48, v48, v26
v_dot2_f32_bf16 v25, v52, v28, v25
v_dot2_f32_bf16 v27, v52, v52, v27
v_dot2_f32_bf16 v24, v49, v28, v24
v_dot2_f32_bf16 v26, v49, v49, v26
v_dot2_f32_bf16 v25, v53, v28, v25
v_dot2_f32_bf16 v27, v53, v53, v27
v_dot2_f32_bf16 v24, v50, v28, v24
v_dot2_f32_bf16 v26, v50, v50, v26
v_dot2_f32_bf16 v25, v54, v28, v25
v_dot2_f32_bf16 v27, v54, v54, v27
v_dot2_f32_bf16 v24, v51, v28, v24
v_dot2_f32_bf16 v26, v51, v51, v26
v_dot2_f32_bf16 v25, v55, v28, v25
v_dot2_f32_bf16 v27, v55, v55, v27
v_dot2_f32_bf16 v24, v56, v28, v24
v_dot2_f32_bf16 v26, v56, v56, v26
v_dot2_f32_bf16 v25, v60, v28, v25
v_dot2_f32_bf16 v27, v60, v60, v27
v_dot2_f32_bf16 v24, v57, v28, v24
v_dot2_f32_bf16 v26, v57, v57, v26
v_dot2_f32_bf16 v25, v61, v28, v25
v_dot2_f32_bf16 v27, v61, v61, v27
v_dot2_f32_bf16 v24, v58, v28, v24
v_dot2_f32_bf16 v26, v58, v58, v26
v_dot2_f32_bf16 v25, v62, v28, v25
v_dot2_f32_bf16 v27, v62, v62, v27
v_dot2_f32_bf16 v24, v59, v28, v24
v_dot2_f32_bf16 v26, v59, v59, v26
v_dot2_f32_bf16 v25, v63, v28, v25
v_dot2_f32_bf16 v27, v63, v63, v27
s_nop 1
v_permlane32_swap_b32 v24, v25
v_permlane32_swap_b32 v26, v27
v_add_f32 v24, v24, v25
v_add_f32 v26, v26, v27
s_nop 1
v_permlane16_swap_b32 v24, v26
v_add_f32 v24, v24, v26
s_lshl_b32 s60, s52, 11
s_add_u32 s60, s60, 0x180000
buffer_store_dword v24, v20, s[4:7], s60 offen sc1
s_lshl_b32 s60, s52, 16
s_add_u32 s60, s60, 524288
buffer_load_dwordx4 v[64:67], v6, s[12:15], s60 offen offset:0
buffer_load_dwordx4 v[72:75], v6, s[12:15], s60 offen offset:64
buffer_load_dwordx4 v[80:83], v6, s[12:15], s60 offen offset:128
buffer_load_dwordx4 v[88:91], v6, s[12:15], s60 offen offset:192
s_lshl_b32 s60, s52, 16
s_add_u32 s60, s60, 557056
buffer_load_dwordx4 v[68:71], v6, s[12:15], s60 offen offset:0
buffer_load_dwordx4 v[76:79], v6, s[12:15], s60 offen offset:64
buffer_load_dwordx4 v[84:87], v6, s[12:15], s60 offen offset:128
buffer_load_dwordx4 v[92:95], v6, s[12:15], s60 offen offset:192
s_lshl_b32 s60, s52, 16
s_add_u32 s60, s60, 1048576
buffer_load_dwordx4 v[96:99], v6, s[12:15], s60 offen offset:0
buffer_load_dwordx4 v[104:107], v6, s[12:15], s60 offen offset:64
buffer_load_dwordx4 v[112:115], v6, s[12:15], s60 offen offset:128
buffer_load_dwordx4 v[120:123], v6, s[12:15], s60 offen offset:192
s_lshl_b32 s60, s52, 16
s_add_u32 s60, s60, 1081344
buffer_load_dwordx4 v[100:103], v6, s[12:15], s60 offen offset:0
buffer_load_dwordx4 v[108:111], v6, s[12:15], s60 offen offset:64
buffer_load_dwordx4 v[116:119], v6, s[12:15], s60 offen offset:128
buffer_load_dwordx4 v[124:127], v6, s[12:15], s60 offen offset:192
s_lshl_b32 s60, s52, 16
s_add_u32 s60, s60, 1572864
buffer_load_dwordx4 v[128:131], v6, s[12:15], s60 offen offset:0
buffer_load_dwordx4 v[136:139], v6, s[12:15], s60 offen offset:64
buffer_load_dwordx4 v[144:147], v6, s[12:15], s60 offen offset:128
buffer_load_dwordx4 v[152:155], v6, s[12:15], s60 offen offset:192
s_lshl_b32 s60, s52, 16
s_add_u32 s60, s60, 1605632
buffer_load_dwordx4 v[132:135], v6, s[12:15], s60 offen offset:0
buffer_load_dwordx4 v[140:143], v6, s[12:15], s60 offen offset:64
buffer_load_dwordx4 v[148:151], v6, s[12:15], s60 offen offset:128
buffer_load_dwordx4 v[156:159], v6, s[12:15], s60 offen offset:192
s_lshl_b32 s60, s52, 16
s_add_u32 s60, s60, 2097152
buffer_load_dwordx4 v[160:163], v6, s[12:15], s60 offen offset:0
buffer_load_dwordx4 v[168:171], v6, s[12:15], s60 offen offset:64
buffer_load_dwordx4 v[176:179], v6, s[12:15], s60 offen offset:128
buffer_load_dwordx4 v[184:187], v6, s[12:15], s60 offen offset:192
s_lshl_b32 s60, s52, 16
s_add_u32 s60, s60, 2129920
buffer_load_dwordx4 v[164:167], v6, s[12:15], s60 offen offset:0
buffer_load_dwordx4 v[172:175], v6, s[12:15], s60 offen offset:64
buffer_load_dwordx4 v[180:183], v6, s[12:15], s60 offen offset:128
buffer_load_dwordx4 v[188:191], v6, s[12:15], s60 offen offset:192
s_waitcnt vmcnt(32)
s_add_u32 s60, s52, 8
s_min_u32 s60, s60, 64
v_mov_b32 v29, s60
buffer_store_dword v29, v5, s[4:7], 0 offen sc1
s_waitcnt vmcnt(25)
s_lshl_b32 s60, s52, 16
s_add_u32 s60, s60, 0x480000
buffer_store_dwordx4 v[64:67], v7, s[4:7], s60 offen offset:0 sc1
buffer_store_dwordx4 v[68:71], v7, s[4:7], s60 offen offset:1024 sc1
buffer_store_dwordx4 v[72:75], v7, s[4:7], s60 offen offset:2048 sc1
buffer_store_dwordx4 v[76:79], v7, s[4:7], s60 offen offset:3072 sc1
s_lshl_b32 s60, s52, 16
s_add_u32 s60, s60, 0x481000
buffer_store_dwordx4 v[80:83], v7, s[4:7], s60 offen offset:0 sc1
buffer_store_dwordx4 v[84:87], v7, s[4:7], s60 offen offset:1024 sc1
buffer_store_dwordx4 v[88:91], v7, s[4:7], s60 offen offset:2048 sc1
buffer_store_dwordx4 v[92:95], v7, s[4:7], s60 offen offset:3072 sc1
v_dot2_f32_bf16 v24, v64, v28, 0
v_dot2_f32_bf16 v26, v64, v64, 0
v_dot2_f32_bf16 v25, v68, v28, 0
v_dot2_f32_bf16 v27, v68, v68, 0
v_dot2_f32_bf16 v24, v65, v28, v24
v_dot2_f32_bf16 v26, v65, v65, v26
v_dot2_f32_bf16 v25, v69, v28, v25
v_dot2_f32_bf16 v27, v69, v69, v27
v_dot2_f32_bf16 v24, v66, v28, v24
v_dot2_f32_bf16 v26, v66, v66, v26
v_dot2_f32_bf16 v25, v70, v28, v25
v_dot2_f32_bf16 v27, v70, v70, v27
v_dot2_f32_bf16 v24, v67, v28, v24
v_dot2_f32_bf16 v26, v67, v67, v26
v_dot2_f32_bf16 v25, v71, v28, v25
v_dot2_f32_bf16 v27, v71, v71, v27
v_dot2_f32_bf16 v24, v72, v28, v24
v_dot2_f32_bf16 v26, v72, v72, v26
v_dot2_f32_bf16 v25, v76, v28, v25
v_dot2_f32_bf16 v27, v76, v76, v27
v_dot2_f32_bf16 v24, v73, v28, v24
v_dot2_f32_bf16 v26, v73, v73, v26
v_dot2_f32_bf16 v25, v77, v28, v25
v_dot2_f32_bf16 v27, v77, v77, v27
v_dot2_f32_bf16 v24, v74, v28, v24
v_dot2_f32_bf16 v26, v74, v74, v26
v_dot2_f32_bf16 v25, v78, v28, v25
v_dot2_f32_bf16 v27, v78, v78, v27
v_dot2_f32_bf16 v24, v75, v28, v24
v_dot2_f32_bf16 v26, v75, v75, v26
v_dot2_f32_bf16 v25, v79, v28, v25
v_dot2_f32_bf16 v27, v79, v79, v27
v_dot2_f32_bf16 v24, v80, v28, v24
v_dot2_f32_bf16 v26, v80, v80, v26
v_dot2_f32_bf16 v25, v84, v28, v25
v_dot2_f32_bf16 v27, v84, v84, v27
v_dot2_f32_bf16 v24, v81, v28, v24
v_dot2_f32_bf16 v26, v81, v81, v26
v_dot2_f32_bf16 v25, v85, v28, v25
v_dot2_f32_bf16 v27, v85, v85, v27
v_dot2_f32_bf16 v24, v82, v28, v24
v_dot2_f32_bf16 v26, v82, v82, v26
v_dot2_f32_bf16 v25, v86, v28, v25
v_dot2_f32_bf16 v27, v86, v86, v27
v_dot2_f32_bf16 v24, v83, v28, v24
v_dot2_f32_bf16 v26, v83, v83, v26
v_dot2_f32_bf16 v25, v87, v28, v25
v_dot2_f32_bf16 v27, v87, v87, v27
v_dot2_f32_bf16 v24, v88, v28, v24
v_dot2_f32_bf16 v26, v88, v88, v26
v_dot2_f32_bf16 v25, v92, v28, v25
v_dot2_f32_bf16 v27, v92, v92, v27
v_dot2_f32_bf16 v24, v89, v28, v24
v_dot2_f32_bf16 v26, v89, v89, v26
v_dot2_f32_bf16 v25, v93, v28, v25
v_dot2_f32_bf16 v27, v93, v93, v27
v_dot2_f32_bf16 v24, v90, v28, v24
v_dot2_f32_bf16 v26, v90, v90, v26
v_dot2_f32_bf16 v25, v94, v28, v25
v_dot2_f32_bf16 v27, v94, v94, v27
v_dot2_f32_bf16 v24, v91, v28, v24
v_dot2_f32_bf16 v26, v91, v91, v26
v_dot2_f32_bf16 v25, v95, v28, v25
v_dot2_f32_bf16 v27, v95, v95, v27
s_nop 1
v_permlane32_swap_b32 v24, v25
v_permlane32_swap_b32 v26, v27
v_add_f32 v24, v24, v25
v_add_f32 v26, v26, v27
s_nop 1
v_permlane16_swap_b32 v24, v26
v_add_f32 v24, v24, v26
s_lshl_b32 s60, s52, 11
s_add_u32 s60, s60, 0x184000
buffer_store_dword v24, v20, s[4:7], s60 offen sc1
s_waitcnt vmcnt(26)
s_lshl_b32 s60, s52, 16
s_add_u32 s60, s60, 0x500000
buffer_store_dwordx4 v[96:99], v7, s[4:7], s60 offen offset:0 sc1
buffer_store_dwordx4 v[100:103], v7, s[4:7], s60 offen offset:1024 sc1
buffer_store_dwordx4 v[104:107], v7, s[4:7], s60 offen offset:2048 sc1
buffer_store_dwordx4 v[108:111], v7, s[4:7], s60 offen offset:3072 sc1
s_lshl_b32 s60, s52, 16
s_add_u32 s60, s60, 0x501000
buffer_store_dwordx4 v[112:115], v7, s[4:7], s60 offen offset:0 sc1
buffer_store_dwordx4 v[116:119], v7, s[4:7], s60 offen offset:1024 sc1
buffer_store_dwordx4 v[120:123], v7, s[4:7], s60 offen offset:2048 sc1
buffer_store_dwordx4 v[124:127], v7, s[4:7], s60 offen offset:3072 sc1
v_dot2_f32_bf16 v24, v96, v28, 0
v_dot2_f32_bf16 v26, v96, v96, 0
v_dot2_f32_bf16 v25, v100, v28, 0
v_dot2_f32_bf16 v27, v100, v100, 0
v_dot2_f32_bf16 v24, v97, v28, v24
v_dot2_f32_bf16 v26, v97, v97, v26
v_dot2_f32_bf16 v25, v101, v28, v25
v_dot2_f32_bf16 v27, v101, v101, v27
v_dot2_f32_bf16 v24, v98, v28, v24
v_dot2_f32_bf16 v26, v98, v98, v26
v_dot2_f32_bf16 v25, v102, v28, v25
v_dot2_f32_bf16 v27, v102, v102, v27
v_dot2_f32_bf16 v24, v99, v28, v24
v_dot2_f32_bf16 v26, v99, v99, v26
v_dot2_f32_bf16 v25, v103, v28, v25
v_dot2_f32_bf16 v27, v103, v103, v27
v_dot2_f32_bf16 v24, v104, v28, v24
v_dot2_f32_bf16 v26, v104, v104, v26
v_dot2_f32_bf16 v25, v108, v28, v25
v_dot2_f32_bf16 v27, v108, v108, v27
v_dot2_f32_bf16 v24, v105, v28, v24
v_dot2_f32_bf16 v26, v105, v105, v26
v_dot2_f32_bf16 v25, v109, v28, v25
v_dot2_f32_bf16 v27, v109, v109, v27
v_dot2_f32_bf16 v24, v106, v28, v24
v_dot2_f32_bf16 v26, v106, v106, v26
v_dot2_f32_bf16 v25, v110, v28, v25
v_dot2_f32_bf16 v27, v110, v110, v27
v_dot2_f32_bf16 v24, v107, v28, v24
v_dot2_f32_bf16 v26, v107, v107, v26
v_dot2_f32_bf16 v25, v111, v28, v25
v_dot2_f32_bf16 v27, v111, v111, v27
v_dot2_f32_bf16 v24, v112, v28, v24
v_dot2_f32_bf16 v26, v112, v112, v26
v_dot2_f32_bf16 v25, v116, v28, v25
v_dot2_f32_bf16 v27, v116, v116, v27
v_dot2_f32_bf16 v24, v113, v28, v24
v_dot2_f32_bf16 v26, v113, v113, v26
v_dot2_f32_bf16 v25, v117, v28, v25
v_dot2_f32_bf16 v27, v117, v117, v27
v_dot2_f32_bf16 v24, v114, v28, v24
v_dot2_f32_bf16 v26, v114, v114, v26
v_dot2_f32_bf16 v25, v118, v28, v25
v_dot2_f32_bf16 v27, v118, v118, v27
v_dot2_f32_bf16 v24, v115, v28, v24
v_dot2_f32_bf16 v26, v115, v115, v26
v_dot2_f32_bf16 v25, v119, v28, v25
v_dot2_f32_bf16 v27, v119, v119, v27
v_dot2_f32_bf16 v24, v120, v28, v24
v_dot2_f32_bf16 v26, v120, v120, v26
v_dot2_f32_bf16 v25, v124, v28, v25
v_dot2_f32_bf16 v27, v124, v124, v27
v_dot2_f32_bf16 v24, v121, v28, v24
v_dot2_f32_bf16 v26, v121, v121, v26
v_dot2_f32_bf16 v25, v125, v28, v25
v_dot2_f32_bf16 v27, v125, v125, v27
v_dot2_f32_bf16 v24, v122, v28, v24
v_dot2_f32_bf16 v26, v122, v122, v26
v_dot2_f32_bf16 v25, v126, v28, v25
v_dot2_f32_bf16 v27, v126, v126, v27
v_dot2_f32_bf16 v24, v123, v28, v24
v_dot2_f32_bf16 v26, v123, v123, v26
v_dot2_f32_bf16 v25, v127, v28, v25
v_dot2_f32_bf16 v27, v127, v127, v27
s_nop 1
v_permlane32_swap_b32 v24, v25
v_permlane32_swap_b32 v26, v27
v_add_f32 v24, v24, v25
v_add_f32 v26, v26, v27
s_nop 1
v_permlane16_swap_b32 v24, v26
v_add_f32 v24, v24, v26
s_lshl_b32 s60, s52, 11
s_add_u32 s60, s60, 0x188000
buffer_store_dword v24, v20, s[4:7], s60 offen sc1
s_lshl_b32 s60, s52, 16
s_add_u32 s60, s60, 2621440
buffer_load_dwordx4 v[192:195], v6, s[12:15], s60 offen offset:0
buffer_load_dwordx4 v[200:203], v6, s[12:15], s60 offen offset:64
buffer_load_dwordx4 v[208:211], v6, s[12:15], s60 offen offset:128
buffer_load_dwordx4 v[216:219], v6, s[12:15], s60 offen offset:192
s_lshl_b32 s60, s52, 16
s_add_u32 s60, s60, 2654208
buffer_load_dwordx4 v[196:199], v6, s[12:15], s60 offen offset:0
buffer_load_dwordx4 v[204:207], v6, s[12:15], s60 offen offset:64
buffer_load_dwordx4 v[212:215], v6, s[12:15], s60 offen offset:128
buffer_load_dwordx4 v[220:223], v6, s[12:15], s60 offen offset:192
s_lshl_b32 s60, s52, 16
s_add_u32 s60, s60, 3145728
buffer_load_dwordx4 v[224:227], v6, s[12:15], s60 offen offset:0
buffer_load_dwordx4 v[232:235], v6, s[12:15], s60 offen offset:64
buffer_load_dwordx4 v[240:243], v6, s[12:15], s60 offen offset:128
buffer_load_dwordx4 v[248:251], v6, s[12:15], s60 offen offset:192
s_lshl_b32 s60, s52, 16
s_add_u32 s60, s60, 3178496
buffer_load_dwordx4 v[228:231], v6, s[12:15], s60 offen offset:0
buffer_load_dwordx4 v[236:239], v6, s[12:15], s60 offen offset:64
buffer_load_dwordx4 v[244:247], v6, s[12:15], s60 offen offset:128
buffer_load_dwordx4 v[252:255], v6, s[12:15], s60 offen offset:192
s_lshl_b32 s60, s52, 16
s_add_u32 s60, s60, 3670016
buffer_load_dwordx4 v[32:35], v6, s[12:15], s60 offen offset:0
buffer_load_dwordx4 v[40:43], v6, s[12:15], s60 offen offset:64
buffer_load_dwordx4 v[48:51], v6, s[12:15], s60 offen offset:128
buffer_load_dwordx4 v[56:59], v6, s[12:15], s60 offen offset:192
s_lshl_b32 s60, s52, 16
s_add_u32 s60, s60, 3702784
buffer_load_dwordx4 v[36:39], v6, s[12:15], s60 offen offset:0
buffer_load_dwordx4 v[44:47], v6, s[12:15], s60 offen offset:64
buffer_load_dwordx4 v[52:55], v6, s[12:15], s60 offen offset:128
buffer_load_dwordx4 v[60:63], v6, s[12:15], s60 offen offset:192
s_waitcnt vmcnt(24)
s_add_u32 s60, s52, 24
s_min_u32 s60, s60, 64
v_mov_b32 v29, s60
buffer_store_dword v29, v5, s[4:7], 0 offen sc1
s_lshl_b32 s60, s52, 16
s_add_u32 s60, s60, 0x580000
buffer_store_dwordx4 v[128:131], v7, s[4:7], s60 offen offset:0 sc1
buffer_store_dwordx4 v[132:135], v7, s[4:7], s60 offen offset:1024 sc1
buffer_store_dwordx4 v[136:139], v7, s[4:7], s60 offen offset:2048 sc1
buffer_store_dwordx4 v[140:143], v7, s[4:7], s60 offen offset:3072 sc1
s_lshl_b32 s60, s52, 16
s_add_u32 s60, s60, 0x581000
buffer_store_dwordx4 v[144:147], v7, s[4:7], s60 offen offset:0 sc1
buffer_store_dwordx4 v[148:151], v7, s[4:7], s60 offen offset:1024 sc1
buffer_store_dwordx4 v[152:155], v7, s[4:7], s60 offen offset:2048 sc1
buffer_store_dwordx4 v[156:159], v7, s[4:7], s60 offen offset:3072 sc1
v_dot2_f32_bf16 v24, v128, v28, 0
v_dot2_f32_bf16 v26, v128, v128, 0
v_dot2_f32_bf16 v25, v132, v28, 0
v_dot2_f32_bf16 v27, v132, v132, 0
v_dot2_f32_bf16 v24, v129, v28, v24
v_dot2_f32_bf16 v26, v129, v129, v26
v_dot2_f32_bf16 v25, v133, v28, v25
v_dot2_f32_bf16 v27, v133, v133, v27
v_dot2_f32_bf16 v24, v130, v28, v24
v_dot2_f32_bf16 v26, v130, v130, v26
v_dot2_f32_bf16 v25, v134, v28, v25
v_dot2_f32_bf16 v27, v134, v134, v27
v_dot2_f32_bf16 v24, v131, v28, v24
v_dot2_f32_bf16 v26, v131, v131, v26
v_dot2_f32_bf16 v25, v135, v28, v25
v_dot2_f32_bf16 v27, v135, v135, v27
v_dot2_f32_bf16 v24, v136, v28, v24
v_dot2_f32_bf16 v26, v136, v136, v26
v_dot2_f32_bf16 v25, v140, v28, v25
v_dot2_f32_bf16 v27, v140, v140, v27
v_dot2_f32_bf16 v24, v137, v28, v24
v_dot2_f32_bf16 v26, v137, v137, v26
v_dot2_f32_bf16 v25, v141, v28, v25
v_dot2_f32_bf16 v27, v141, v141, v27
v_dot2_f32_bf16 v24, v138, v28, v24
v_dot2_f32_bf16 v26, v138, v138, v26
v_dot2_f32_bf16 v25, v142, v28, v25
v_dot2_f32_bf16 v27, v142, v142, v27
v_dot2_f32_bf16 v24, v139, v28, v24
v_dot2_f32_bf16 v26, v139, v139, v26
v_dot2_f32_bf16 v25, v143, v28, v25
v_dot2_f32_bf16 v27, v143, v143, v27
v_dot2_f32_bf16 v24, v144, v28, v24
v_dot2_f32_bf16 v26, v144, v144, v26
v_dot2_f32_bf16 v25, v148, v28, v25
v_dot2_f32_bf16 v27, v148, v148, v27
v_dot2_f32_bf16 v24, v145, v28, v24
v_dot2_f32_bf16 v26, v145, v145, v26
v_dot2_f32_bf16 v25, v149, v28, v25
v_dot2_f32_bf16 v27, v149, v149, v27
v_dot2_f32_bf16 v24, v146, v28, v24
v_dot2_f32_bf16 v26, v146, v146, v26
v_dot2_f32_bf16 v25, v150, v28, v25
v_dot2_f32_bf16 v27, v150, v150, v27
v_dot2_f32_bf16 v24, v147, v28, v24
v_dot2_f32_bf16 v26, v147, v147, v26
v_dot2_f32_bf16 v25, v151, v28, v25
v_dot2_f32_bf16 v27, v151, v151, v27
v_dot2_f32_bf16 v24, v152, v28, v24
v_dot2_f32_bf16 v26, v152, v152, v26
v_dot2_f32_bf16 v25, v156, v28, v25
v_dot2_f32_bf16 v27, v156, v156, v27
v_dot2_f32_bf16 v24, v153, v28, v24
v_dot2_f32_bf16 v26, v153, v153, v26
v_dot2_f32_bf16 v25, v157, v28, v25
v_dot2_f32_bf16 v27, v157, v157, v27
v_dot2_f32_bf16 v24, v154, v28, v24
v_dot2_f32_bf16 v26, v154, v154, v26
v_dot2_f32_bf16 v25, v158, v28, v25
v_dot2_f32_bf16 v27, v158, v158, v27
v_dot2_f32_bf16 v24, v155, v28, v24
v_dot2_f32_bf16 v26, v155, v155, v26
v_dot2_f32_bf16 v25, v159, v28, v25
v_dot2_f32_bf16 v27, v159, v159, v27
s_nop 1
v_permlane32_swap_b32 v24, v25
v_permlane32_swap_b32 v26, v27
v_add_f32 v24, v24, v25
v_add_f32 v26, v26, v27
s_nop 1
v_permlane16_swap_b32 v24, v26
v_add_f32 v24, v24, v26
s_lshl_b32 s60, s52, 11
s_add_u32 s60, s60, 0x18c000
buffer_store_dword v24, v20, s[4:7], s60 offen sc1
s_lshl_b32 s60, s52, 16
s_add_u32 s60, s60, 0x600000
buffer_store_dwordx4 v[160:163], v7, s[4:7], s60 offen offset:0 sc1
buffer_store_dwordx4 v[164:167], v7, s[4:7], s60 offen offset:1024 sc1
buffer_store_dwordx4 v[168:171], v7, s[4:7], s60 offen offset:2048 sc1
buffer_store_dwordx4 v[172:175], v7, s[4:7], s60 offen offset:3072 sc1
s_lshl_b32 s60, s52, 16
s_add_u32 s60, s60, 0x601000
buffer_store_dwordx4 v[176:179], v7, s[4:7], s60 offen offset:0 sc1
buffer_store_dwordx4 v[180:183], v7, s[4:7], s60 offen offset:1024 sc1
buffer_store_dwordx4 v[184:187], v7, s[4:7], s60 offen offset:2048 sc1
buffer_store_dwordx4 v[188:191], v7, s[4:7], s60 offen offset:3072 sc1
v_dot2_f32_bf16 v24, v160, v28, 0
v_dot2_f32_bf16 v26, v160, v160, 0
v_dot2_f32_bf16 v25, v164, v28, 0
v_dot2_f32_bf16 v27, v164, v164, 0
v_dot2_f32_bf16 v24, v161, v28, v24
v_dot2_f32_bf16 v26, v161, v161, v26
v_dot2_f32_bf16 v25, v165, v28, v25
v_dot2_f32_bf16 v27, v165, v165, v27
v_dot2_f32_bf16 v24, v162, v28, v24
v_dot2_f32_bf16 v26, v162, v162, v26
v_dot2_f32_bf16 v25, v166, v28, v25
v_dot2_f32_bf16 v27, v166, v166, v27
v_dot2_f32_bf16 v24, v163, v28, v24
v_dot2_f32_bf16 v26, v163, v163, v26
v_dot2_f32_bf16 v25, v167, v28, v25
v_dot2_f32_bf16 v27, v167, v167, v27
v_dot2_f32_bf16 v24, v168, v28, v24
v_dot2_f32_bf16 v26, v168, v168, v26
v_dot2_f32_bf16 v25, v172, v28, v25
v_dot2_f32_bf16 v27, v172, v172, v27
v_dot2_f32_bf16 v24, v169, v28, v24
v_dot2_f32_bf16 v26, v169, v169, v26
v_dot2_f32_bf16 v25, v173, v28, v25
v_dot2_f32_bf16 v27, v173, v173, v27
v_dot2_f32_bf16 v24, v170, v28, v24
v_dot2_f32_bf16 v26, v170, v170, v26
v_dot2_f32_bf16 v25, v174, v28, v25
v_dot2_f32_bf16 v27, v174, v174, v27
v_dot2_f32_bf16 v24, v171, v28, v24
v_dot2_f32_bf16 v26, v171, v171, v26
v_dot2_f32_bf16 v25, v175, v28, v25
v_dot2_f32_bf16 v27, v175, v175, v27
v_dot2_f32_bf16 v24, v176, v28, v24
v_dot2_f32_bf16 v26, v176, v176, v26
v_dot2_f32_bf16 v25, v180, v28, v25
v_dot2_f32_bf16 v27, v180, v180, v27
v_dot2_f32_bf16 v24, v177, v28, v24
v_dot2_f32_bf16 v26, v177, v177, v26
v_dot2_f32_bf16 v25, v181, v28, v25
v_dot2_f32_bf16 v27, v181, v181, v27
v_dot2_f32_bf16 v24, v178, v28, v24
v_dot2_f32_bf16 v26, v178, v178, v26
v_dot2_f32_bf16 v25, v182, v28, v25
v_dot2_f32_bf16 v27, v182, v182, v27
v_dot2_f32_bf16 v24, v179, v28, v24
v_dot2_f32_bf16 v26, v179, v179, v26
v_dot2_f32_bf16 v25, v183, v28, v25
v_dot2_f32_bf16 v27, v183, v183, v27
v_dot2_f32_bf16 v24, v184, v28, v24
v_dot2_f32_bf16 v26, v184, v184, v26
v_dot2_f32_bf16 v25, v188, v28, v25
v_dot2_f32_bf16 v27, v188, v188, v27
v_dot2_f32_bf16 v24, v185, v28, v24
v_dot2_f32_bf16 v26, v185, v185, v26
v_dot2_f32_bf16 v25, v189, v28, v25
v_dot2_f32_bf16 v27, v189, v189, v27
v_dot2_f32_bf16 v24, v186, v28, v24
v_dot2_f32_bf16 v26, v186, v186, v26
v_dot2_f32_bf16 v25, v190, v28, v25
v_dot2_f32_bf16 v27, v190, v190, v27
v_dot2_f32_bf16 v24, v187, v28, v24
v_dot2_f32_bf16 v26, v187, v187, v26
v_dot2_f32_bf16 v25, v191, v28, v25
v_dot2_f32_bf16 v27, v191, v191, v27
s_nop 1
v_permlane32_swap_b32 v24, v25
v_permlane32_swap_b32 v26, v27
v_add_f32 v24, v24, v25
v_add_f32 v26, v26, v27
s_nop 1
v_permlane16_swap_b32 v24, v26
v_add_f32 v24, v24, v26
s_lshl_b32 s60, s52, 11
s_add_u32 s60, s60, 0x190000
buffer_store_dword v24, v20, s[4:7], s60 offen sc1
s_waitcnt vmcnt(19)
s_lshl_b32 s60, s52, 16
s_add_u32 s60, s60, 0x680000
buffer_store_dwordx4 v[192:195], v7, s[4:7], s60 offen offset:0 sc1
buffer_store_dwordx4 v[196:199], v7, s[4:7], s60 offen offset:1024 sc1
buffer_store_dwordx4 v[200:203], v7, s[4:7], s60 offen offset:2048 sc1
buffer_store_dwordx4 v[204:207], v7, s[4:7], s60 offen offset:3072 sc1
s_lshl_b32 s60, s52, 16
s_add_u32 s60, s60, 0x681000
buffer_store_dwordx4 v[208:211], v7, s[4:7], s60 offen offset:0 sc1
buffer_store_dwordx4 v[212:215], v7, s[4:7], s60 offen offset:1024 sc1
buffer_store_dwordx4 v[216:219], v7, s[4:7], s60 offen offset:2048 sc1
buffer_store_dwordx4 v[220:223], v7, s[4:7], s60 offen offset:3072 sc1
v_dot2_f32_bf16 v24, v192, v28, 0
v_dot2_f32_bf16 v26, v192, v192, 0
v_dot2_f32_bf16 v25, v196, v28, 0
v_dot2_f32_bf16 v27, v196, v196, 0
v_dot2_f32_bf16 v24, v193, v28, v24
v_dot2_f32_bf16 v26, v193, v193, v26
v_dot2_f32_bf16 v25, v197, v28, v25
v_dot2_f32_bf16 v27, v197, v197, v27
v_dot2_f32_bf16 v24, v194, v28, v24
v_dot2_f32_bf16 v26, v194, v194, v26
v_dot2_f32_bf16 v25, v198, v28, v25
v_dot2_f32_bf16 v27, v198, v198, v27
v_dot2_f32_bf16 v24, v195, v28, v24
v_dot2_f32_bf16 v26, v195, v195, v26
v_dot2_f32_bf16 v25, v199, v28, v25
v_dot2_f32_bf16 v27, v199, v199, v27
v_dot2_f32_bf16 v24, v200, v28, v24
v_dot2_f32_bf16 v26, v200, v200, v26
v_dot2_f32_bf16 v25, v204, v28, v25
v_dot2_f32_bf16 v27, v204, v204, v27
v_dot2_f32_bf16 v24, v201, v28, v24
v_dot2_f32_bf16 v26, v201, v201, v26
v_dot2_f32_bf16 v25, v205, v28, v25
v_dot2_f32_bf16 v27, v205, v205, v27
v_dot2_f32_bf16 v24, v202, v28, v24
v_dot2_f32_bf16 v26, v202, v202, v26
v_dot2_f32_bf16 v25, v206, v28, v25
v_dot2_f32_bf16 v27, v206, v206, v27
v_dot2_f32_bf16 v24, v203, v28, v24
v_dot2_f32_bf16 v26, v203, v203, v26
v_dot2_f32_bf16 v25, v207, v28, v25
v_dot2_f32_bf16 v27, v207, v207, v27
v_dot2_f32_bf16 v24, v208, v28, v24
v_dot2_f32_bf16 v26, v208, v208, v26
v_dot2_f32_bf16 v25, v212, v28, v25
v_dot2_f32_bf16 v27, v212, v212, v27
v_dot2_f32_bf16 v24, v209, v28, v24
v_dot2_f32_bf16 v26, v209, v209, v26
v_dot2_f32_bf16 v25, v213, v28, v25
v_dot2_f32_bf16 v27, v213, v213, v27
v_dot2_f32_bf16 v24, v210, v28, v24
v_dot2_f32_bf16 v26, v210, v210, v26
v_dot2_f32_bf16 v25, v214, v28, v25
v_dot2_f32_bf16 v27, v214, v214, v27
v_dot2_f32_bf16 v24, v211, v28, v24
v_dot2_f32_bf16 v26, v211, v211, v26
v_dot2_f32_bf16 v25, v215, v28, v25
v_dot2_f32_bf16 v27, v215, v215, v27
v_dot2_f32_bf16 v24, v216, v28, v24
v_dot2_f32_bf16 v26, v216, v216, v26
v_dot2_f32_bf16 v25, v220, v28, v25
v_dot2_f32_bf16 v27, v220, v220, v27
v_dot2_f32_bf16 v24, v217, v28, v24
v_dot2_f32_bf16 v26, v217, v217, v26
v_dot2_f32_bf16 v25, v221, v28, v25
v_dot2_f32_bf16 v27, v221, v221, v27
v_dot2_f32_bf16 v24, v218, v28, v24
v_dot2_f32_bf16 v26, v218, v218, v26
v_dot2_f32_bf16 v25, v222, v28, v25
v_dot2_f32_bf16 v27, v222, v222, v27
v_dot2_f32_bf16 v24, v219, v28, v24
v_dot2_f32_bf16 v26, v219, v219, v26
v_dot2_f32_bf16 v25, v223, v28, v25
v_dot2_f32_bf16 v27, v223, v223, v27
s_nop 1
v_permlane32_swap_b32 v24, v25
v_permlane32_swap_b32 v26, v27
v_add_f32 v24, v24, v25
v_add_f32 v26, v26, v27
s_nop 1
v_permlane16_swap_b32 v24, v26
v_add_f32 v24, v24, v26
s_lshl_b32 s60, s52, 11
s_add_u32 s60, s60, 0x194000
buffer_store_dword v24, v20, s[4:7], s60 offen sc1
s_waitcnt vmcnt(9)
s_add_u32 s60, s52, 40
s_min_u32 s60, s60, 64
v_mov_b32 v29, s60
buffer_store_dword v29, v5, s[4:7], 0 offen sc1
s_lshl_b32 s60, s52, 16
s_add_u32 s60, s60, 0x700000
buffer_store_dwordx4 v[224:227], v7, s[4:7], s60 offen offset:0 sc1
buffer_store_dwordx4 v[228:231], v7, s[4:7], s60 offen offset:1024 sc1
buffer_store_dwordx4 v[232:235], v7, s[4:7], s60 offen offset:2048 sc1
buffer_store_dwordx4 v[236:239], v7, s[4:7], s60 offen offset:3072 sc1
s_lshl_b32 s60, s52, 16
s_add_u32 s60, s60, 0x701000
buffer_store_dwordx4 v[240:243], v7, s[4:7], s60 offen offset:0 sc1
buffer_store_dwordx4 v[244:247], v7, s[4:7], s60 offen offset:1024 sc1
buffer_store_dwordx4 v[248:251], v7, s[4:7], s60 offen offset:2048 sc1
buffer_store_dwordx4 v[252:255], v7, s[4:7], s60 offen offset:3072 sc1
v_dot2_f32_bf16 v24, v224, v28, 0
v_dot2_f32_bf16 v26, v224, v224, 0
v_dot2_f32_bf16 v25, v228, v28, 0
v_dot2_f32_bf16 v27, v228, v228, 0
v_dot2_f32_bf16 v24, v225, v28, v24
v_dot2_f32_bf16 v26, v225, v225, v26
v_dot2_f32_bf16 v25, v229, v28, v25
v_dot2_f32_bf16 v27, v229, v229, v27
v_dot2_f32_bf16 v24, v226, v28, v24
v_dot2_f32_bf16 v26, v226, v226, v26
v_dot2_f32_bf16 v25, v230, v28, v25
v_dot2_f32_bf16 v27, v230, v230, v27
v_dot2_f32_bf16 v24, v227, v28, v24
v_dot2_f32_bf16 v26, v227, v227, v26
v_dot2_f32_bf16 v25, v231, v28, v25
v_dot2_f32_bf16 v27, v231, v231, v27
v_dot2_f32_bf16 v24, v232, v28, v24
v_dot2_f32_bf16 v26, v232, v232, v26
v_dot2_f32_bf16 v25, v236, v28, v25
v_dot2_f32_bf16 v27, v236, v236, v27
v_dot2_f32_bf16 v24, v233, v28, v24
v_dot2_f32_bf16 v26, v233, v233, v26
v_dot2_f32_bf16 v25, v237, v28, v25
v_dot2_f32_bf16 v27, v237, v237, v27
v_dot2_f32_bf16 v24, v234, v28, v24
v_dot2_f32_bf16 v26, v234, v234, v26
v_dot2_f32_bf16 v25, v238, v28, v25
v_dot2_f32_bf16 v27, v238, v238, v27
v_dot2_f32_bf16 v24, v235, v28, v24
v_dot2_f32_bf16 v26, v235, v235, v26
v_dot2_f32_bf16 v25, v239, v28, v25
v_dot2_f32_bf16 v27, v239, v239, v27
v_dot2_f32_bf16 v24, v240, v28, v24
v_dot2_f32_bf16 v26, v240, v240, v26
v_dot2_f32_bf16 v25, v244, v28, v25
v_dot2_f32_bf16 v27, v244, v244, v27
v_dot2_f32_bf16 v24, v241, v28, v24
v_dot2_f32_bf16 v26, v241, v241, v26
v_dot2_f32_bf16 v25, v245, v28, v25
v_dot2_f32_bf16 v27, v245, v245, v27
v_dot2_f32_bf16 v24, v242, v28, v24
v_dot2_f32_bf16 v26, v242, v242, v26
v_dot2_f32_bf16 v25, v246, v28, v25
v_dot2_f32_bf16 v27, v246, v246, v27
v_dot2_f32_bf16 v24, v243, v28, v24
v_dot2_f32_bf16 v26, v243, v243, v26
v_dot2_f32_bf16 v25, v247, v28, v25
v_dot2_f32_bf16 v27, v247, v247, v27
v_dot2_f32_bf16 v24, v248, v28, v24
v_dot2_f32_bf16 v26, v248, v248, v26
v_dot2_f32_bf16 v25, v252, v28, v25
v_dot2_f32_bf16 v27, v252, v252, v27
v_dot2_f32_bf16 v24, v249, v28, v24
v_dot2_f32_bf16 v26, v249, v249, v26
v_dot2_f32_bf16 v25, v253, v28, v25
v_dot2_f32_bf16 v27, v253, v253, v27
v_dot2_f32_bf16 v24, v250, v28, v24
v_dot2_f32_bf16 v26, v250, v250, v26
v_dot2_f32_bf16 v25, v254, v28, v25
v_dot2_f32_bf16 v27, v254, v254, v27
v_dot2_f32_bf16 v24, v251, v28, v24
v_dot2_f32_bf16 v26, v251, v251, v26
v_dot2_f32_bf16 v25, v255, v28, v25
v_dot2_f32_bf16 v27, v255, v255, v27
s_nop 1
v_permlane32_swap_b32 v24, v25
v_permlane32_swap_b32 v26, v27
v_add_f32 v24, v24, v25
v_add_f32 v26, v26, v27
s_nop 1
v_permlane16_swap_b32 v24, v26
v_add_f32 v24, v24, v26
s_lshl_b32 s60, s52, 11
s_add_u32 s60, s60, 0x198000
buffer_store_dword v24, v20, s[4:7], s60 offen sc1
s_lshl_b32 s60, s52, 16
s_add_u32 s60, s60, 0x780000
buffer_store_dwordx4 v[32:35], v7, s[4:7], s60 offen offset:0 sc1
buffer_store_dwordx4 v[36:39], v7, s[4:7], s60 offen offset:1024 sc1
buffer_store_dwordx4 v[40:43], v7, s[4:7], s60 offen offset:2048 sc1
buffer_store_dwordx4 v[44:47], v7, s[4:7], s60 offen offset:3072 sc1
s_lshl_b32 s60, s52, 16
s_add_u32 s60, s60, 0x781000
buffer_store_dwordx4 v[48:51], v7, s[4:7], s60 offen offset:0 sc1
buffer_store_dwordx4 v[52:55], v7, s[4:7], s60 offen offset:1024 sc1
buffer_store_dwordx4 v[56:59], v7, s[4:7], s60 offen offset:2048 sc1
buffer_store_dwordx4 v[60:63], v7, s[4:7], s60 offen offset:3072 sc1
v_dot2_f32_bf16 v24, v32, v28, 0
v_dot2_f32_bf16 v26, v32, v32, 0
v_dot2_f32_bf16 v25, v36, v28, 0
v_dot2_f32_bf16 v27, v36, v36, 0
v_dot2_f32_bf16 v24, v33, v28, v24
v_dot2_f32_bf16 v26, v33, v33, v26
v_dot2_f32_bf16 v25, v37, v28, v25
v_dot2_f32_bf16 v27, v37, v37, v27
v_dot2_f32_bf16 v24, v34, v28, v24
v_dot2_f32_bf16 v26, v34, v34, v26
v_dot2_f32_bf16 v25, v38, v28, v25
v_dot2_f32_bf16 v27, v38, v38, v27
v_dot2_f32_bf16 v24, v35, v28, v24
v_dot2_f32_bf16 v26, v35, v35, v26
v_dot2_f32_bf16 v25, v39, v28, v25
v_dot2_f32_bf16 v27, v39, v39, v27
v_dot2_f32_bf16 v24, v40, v28, v24
v_dot2_f32_bf16 v26, v40, v40, v26
v_dot2_f32_bf16 v25, v44, v28, v25
v_dot2_f32_bf16 v27, v44, v44, v27
v_dot2_f32_bf16 v24, v41, v28, v24
v_dot2_f32_bf16 v26, v41, v41, v26
v_dot2_f32_bf16 v25, v45, v28, v25
v_dot2_f32_bf16 v27, v45, v45, v27
v_dot2_f32_bf16 v24, v42, v28, v24
v_dot2_f32_bf16 v26, v42, v42, v26
v_dot2_f32_bf16 v25, v46, v28, v25
v_dot2_f32_bf16 v27, v46, v46, v27
v_dot2_f32_bf16 v24, v43, v28, v24
v_dot2_f32_bf16 v26, v43, v43, v26
v_dot2_f32_bf16 v25, v47, v28, v25
v_dot2_f32_bf16 v27, v47, v47, v27
v_dot2_f32_bf16 v24, v48, v28, v24
v_dot2_f32_bf16 v26, v48, v48, v26
v_dot2_f32_bf16 v25, v52, v28, v25
v_dot2_f32_bf16 v27, v52, v52, v27
v_dot2_f32_bf16 v24, v49, v28, v24
v_dot2_f32_bf16 v26, v49, v49, v26
v_dot2_f32_bf16 v25, v53, v28, v25
v_dot2_f32_bf16 v27, v53, v53, v27
v_dot2_f32_bf16 v24, v50, v28, v24
v_dot2_f32_bf16 v26, v50, v50, v26
v_dot2_f32_bf16 v25, v54, v28, v25
v_dot2_f32_bf16 v27, v54, v54, v27
v_dot2_f32_bf16 v24, v51, v28, v24
v_dot2_f32_bf16 v26, v51, v51, v26
v_dot2_f32_bf16 v25, v55, v28, v25
v_dot2_f32_bf16 v27, v55, v55, v27
v_dot2_f32_bf16 v24, v56, v28, v24
v_dot2_f32_bf16 v26, v56, v56, v26
v_dot2_f32_bf16 v25, v60, v28, v25
v_dot2_f32_bf16 v27, v60, v60, v27
v_dot2_f32_bf16 v24, v57, v28, v24
v_dot2_f32_bf16 v26, v57, v57, v26
v_dot2_f32_bf16 v25, v61, v28, v25
v_dot2_f32_bf16 v27, v61, v61, v27
v_dot2_f32_bf16 v24, v58, v28, v24
v_dot2_f32_bf16 v26, v58, v58, v26
v_dot2_f32_bf16 v25, v62, v28, v25
v_dot2_f32_bf16 v27, v62, v62, v27
v_dot2_f32_bf16 v24, v59, v28, v24
v_dot2_f32_bf16 v26, v59, v59, v26
v_dot2_f32_bf16 v25, v63, v28, v25
v_dot2_f32_bf16 v27, v63, v63, v27
s_nop 1
v_permlane32_swap_b32 v24, v25
v_permlane32_swap_b32 v26, v27
v_add_f32 v24, v24, v25
v_add_f32 v26, v26, v27
s_nop 1
v_permlane16_swap_b32 v24, v26
v_add_f32 v24, v24, v26
s_lshl_b32 s60, s52, 11
s_add_u32 s60, s60, 0x19c000
buffer_store_dword v24, v20, s[4:7], s60 offen sc1
v_mov_b32 v16, 0
buffer_load_dwordx4 v[8:11], v16, s[20:23], 0 offen offset:128 sc1
buffer_load_dwordx4 v[12:15], v16, s[20:23], 0 offen offset:144 sc1
buffer_load_dword v18, v16, s[20:23], 0 offen offset:160 sc1
s_waitcnt vmcnt(0)
s_add_u32 s60, s52, 64
s_min_u32 s60, s60, 64
v_mov_b32 v29, s60
buffer_store_dword v29, v5, s[4:7], 0 offen sc1
v_mov_b32 v16, 0
s_cmp_lg_u32 s100, 0
s_cbranch_scc1 Lws1_182
s_branch Lwsw1_185
Lws_181:
v_mov_b32 v16, 0
buffer_load_dwordx4 v[8:11], v16, s[20:23], 0 offen offset:128 sc1
buffer_load_dwordx4 v[12:15], v16, s[20:23], 0 offen offset:144 sc1
buffer_load_dword v18, v16, s[20:23], 0 offen offset:160 sc1
Lwsw1_185:
s_waitcnt vmcnt(0)
v_readfirstlane_b32 s97, v18
v_add3_u32 v17, v8, v9, v10
v_add3_u32 v17, v17, v11, v12
v_add3_u32 v17, v17, v13, v14
v_add_u32 v17, v17, v15
v_cmp_le_u32 vcc, 0x100, v17
s_nop 0
s_cmp_eq_u64 vcc, -1
s_cbranch_scc0 Lrt_186
v_or3_b32 v17, v8, v9, v10
v_or3_b32 v17, v17, v11, v12
v_or3_b32 v17, v17, v13, v14
v_or_b32 v17, v17, v15
v_cmp_eq_u32 vcc, 256, v17
s_nop 0
s_cmp_eq_u64 vcc, -1
s_cbranch_scc1 Lws2_183
s_branch L_restart
Lws1_182:
buffer_load_dword v8, v16, s[20:23], 0 offen sc1
s_waitcnt vmcnt(0)
v_cmp_le_u32 vcc, 0x100, v8
s_nop 0
s_cmp_eq_u64 vcc, -1
s_cbranch_scc0 Lrt_187
Lws2_183:
s_waitcnt vmcnt(0)
v_lshlrev_b32 v6, 4, v0
s_cmp_eq_u32 s67, 0
s_cselect_b32 s60, 0x40000000, 0
v_add_u32 v7, s60, v6
v_mov_b32 v3, v4
v_bfe_u32 v2, v0, 2, 2
v_lshlrev_b32 v2, 5, v2
v_and_b32 v4, 1, v0
v_lshlrev_b32 v4, 4, v4
v_add_u32 v2, v2, v4
v_mov_b32 v4, v3
v_lshrrev_b32 v1, 4, v0
v_lshlrev_b32 v1, 7, v1
v_add_u32 v8, v1, v2
v_mov_b32 v173, 0
v_mov_b32 v174, 0
s_lshl_b32 s76, s48, 13
v_bfe_u32 v1, v0, 1, 1
v_lshlrev_b32 v1, 8, v1
v_lshrrev_b32 v2, 2, v0
v_lshlrev_b32 v2, 4, v2
v_add_u32 v1, v1, v2
v_and_b32 v2, 1, v0
v_lshlrev_b32 v2, 3, v2
v_add_u32 v10, v1, v2
v_add_u32 v10, s76, v10
s_lshl_b32 s62, s68, 2
v_min_u32 v1, 3, v0
v_add_u32 v1, s62, v1
v_mul_u32_u24 v1, 256, v1
v_add_u32 v11, 20480, v1
v_and_b32 v1, 0xffffe000, v11
v_add_u32 v11, v1, v11
v_and_b32 v1, 1, v0
s_lshl_b32 s60, s68, 1
v_add_u32 v1, s60, v1
v_mul_u32_u24 v1, 256, v1
v_add_u32 v2, 112640, v1
v_and_b32 v1, 0xffffe000, v2
v_add_u32 v2, v1, v2
v_cmp_gt_u32 vcc, 4, v0
s_nop 1
v_cndmask_b32 v11, v2, v11, vcc
v_bfe_u32 v1, v0, 1, 2
v_min_u32 v1, 2, v1
v_lshlrev_b32 v1, 6, v1
v_and_b32 v2, 1, v0
v_add_u32 v1, v1, v2
s_lshl_b32 s60, s68, 1
v_add_u32 v1, s60, v1
v_mul_u32_u24 v1, 683, v1
v_lshrrev_b32 v1, 11, v1
v_mul_u32_u24 v1, 256, v1
v_add_u32 v2, 4096, v1
v_and_b32 v1, 0xffffe000, v2
v_add_u32 v2, v1, v2
v_cmp_gt_u32 vcc, 32, v0
s_nop 1
v_cndmask_b32 v11, v2, v11, vcc
s_mov_b32 s62, 0
s_cmp_lg_u32 s100, 0
s_cbranch_scc1 Lnear2_189
s_cmp_lg_u32 s97, 0
s_cbranch_scc1 Lnear3_190
v_mov_b32 v1, 160
Lnear_188:
buffer_load_dword v1, v1, s[20:23], 0 offen sc1
s_waitcnt vmcnt(0)
v_readfirstlane_b32 s97, v1
v_mov_b32 v1, 160
s_cmp_eq_u32 s97, 0
s_cbranch_scc1 Lrt_191
Lnear3_190:
s_and_b32 s62, s97, 2
s_lshl_b32 s62, s62, 12
Lnear2_189:
s_xor_b32 s63, s62, 0x2000
v_add_u32 v4, s63, v4
v_add_u32 v11, s62, v11
s_lshl_b32 s72, s68, 13
s_lshr_b32 s60, s68, 1
s_lshl_b32 s60, s60, 14
s_and_b32 s73, s68, 1
s_lshl_b32 s73, s73, 12
s_add_u32 s73, s73, s60
s_add_u32 s73, s73, 0x7400000
s_mov_b32 s62, 0
s_cmp_lg_u32 s100, 0
s_cbranch_scc1 Lnear2_193
s_cmp_lg_u32 s97, 0
s_cbranch_scc1 Lnear3_194
v_mov_b32 v1, 160
Lnear_192:
buffer_load_dword v1, v1, s[20:23], 0 offen sc1
s_waitcnt vmcnt(0)
v_readfirstlane_b32 s97, v1
v_mov_b32 v1, 160
s_cmp_eq_u32 s97, 0
s_cbranch_scc1 Lrt_195
Lnear3_194:
s_and_b32 s62, s97, 2
s_lshl_b32 s62, s62, 12
Lnear2_193:
s_add_u32 s73, s73, s62
v_and_b32 v1, 15, v0
s_lshl_b32 s60, s67, 4
v_add_u32 v1, s60, v1
v_lshrrev_b32 v2, 4, v0
v_lshlrev_b32 v2, 2, v2
v_mov_b32 v14, 0xf149f2ca
v_add_u32 v3, 0, v2
v_cmp_gt_u32 vcc, v3, v1
s_nop 1
v_cndmask_b32 v16, 0, v14, vcc
v_add_u32 v3, 1, v2
v_cmp_gt_u32 vcc, v3, v1
s_nop 1
v_cndmask_b32 v17, 0, v14, vcc
v_add_u32 v3, 2, v2
v_cmp_gt_u32 vcc, v3, v1
s_nop 1
v_cndmask_b32 v18, 0, v14, vcc
v_add_u32 v3, 3, v2
v_cmp_gt_u32 vcc, v3, v1
s_nop 1
v_cndmask_b32 v19, 0, v14, vcc
v_add_u32 v3, 16, v2
v_cmp_gt_u32 vcc, v3, v1
s_nop 1
v_cndmask_b32 v20, 0, v14, vcc
v_add_u32 v3, 17, v2
v_cmp_gt_u32 vcc, v3, v1
s_nop 1
v_cndmask_b32 v21, 0, v14, vcc
v_add_u32 v3, 18, v2
v_cmp_gt_u32 vcc, v3, v1
s_nop 1
v_cndmask_b32 v22, 0, v14, vcc
v_add_u32 v3, 19, v2
v_cmp_gt_u32 vcc, v3, v1
s_nop 1
v_cndmask_b32 v23, 0, v14, vcc
v_mov_b32 v180, 0x3f803f80
v_mov_b32 v181, 0x3f803f80
v_mov_b32 v182, 0x3f803f80
v_mov_b32 v183, 0x3f803f80
s_mov_b32 s71, 0x3e0293ee
s_lshl_b32 s67, s67, 10
s_mov_b32 s98, 64
s_mov_b32 s99, 0xfffffff2
s_mov_b32 s52, 0
s_mov_b32 s53, 0
s_mov_b32 s59, 0x40000000
v_mov_b32 v15, 0
s_add_u32 s60, s53, 1
s_add_u32 s99, s99, 1
s_cmp_lt_u32 s99, 101
s_cselect_b32 s24, s98, s60
s_cselect_b32 s98, s60, s98
LAT_slow:
s_and_b32 s58, s53, 64
s_lshl_b32 s58, s58, 12
s_and_b32 s77, s53, 64
s_lshl_b32 s77, s77, 12
s_mov_b32 vcc_lo, -1
s_mov_b32 vcc_hi, 0
v_mov_b32 v1, s77
v_mov_b32 v2, s58
v_cndmask_b32 v1, v1, v2, vcc
v_add_u32 v12, v1, v11
v_mov_b32 v1, s53
v_mov_b32 v2, s53
v_cndmask_b32 v14, v1, v2, vcc
LAT_slow2:
buffer_load_dword v13, v12, s[4:7], 0 offen sc1
s_waitcnt vmcnt(0)
v_cmp_lt_u32 vcc, v14, v13
s_nop 0
s_cmp_eq_u32 vcc_hi, -1
s_cbranch_scc0 Lrt_196
s_lshl_b32 s74, s53, 18
s_add_u32 s74, s74, s72
s_add_u32 s74, s74, 0x3400000
s_add_u32 s75, s74, 4096
buffer_load_dwordx4 v[60:63], v6, s[4:7], s74 offen offset:0 sc1
buffer_load_dwordx4 v[64:67], v7, s[4:7], s74 offen offset:1024 sc1
buffer_load_dwordx4 v[68:71], v6, s[4:7], s74 offen offset:2048 sc1
buffer_load_dwordx4 v[72:75], v7, s[4:7], s74 offen offset:3072 sc1
buffer_load_dwordx4 v[76:79], v6, s[4:7], s75 offen offset:0 sc1
buffer_load_dwordx4 v[80:83], v7, s[4:7], s75 offen offset:1024 sc1
buffer_load_dwordx4 v[84:87], v6, s[4:7], s75 offen offset:2048 sc1
buffer_load_dwordx4 v[88:91], v7, s[4:7], s75 offen offset:3072 sc1
s_sub_u32 s75, s74, 0x2000000
s_add_u32 s75, s75, s67
buffer_load_dwordx4 v[28:31], v6, s[4:7], s75 offen offset:0 sc1
buffer_load_dwordx4 v[32:35], v6, s[4:7], s75 offen offset:2048 sc1
s_add_u32 s75, s75, 4096
buffer_load_dwordx4 v[36:39], v6, s[4:7], s75 offen offset:0 sc1
buffer_load_dwordx4 v[40:43], v6, s[4:7], s75 offen offset:2048 sc1
s_add_u32 m0, s76, 0
s_add_u32 s75, s74, 0x2000000
buffer_load_dwordx4 v6, s[4:7], s75 offen offset:0 sc1 lds
buffer_load_dwordx4 v7, s[4:7], s75 offen offset:1024 sc1 lds
buffer_load_dwordx4 v6, s[4:7], s75 offen offset:2048 sc1 lds
buffer_load_dwordx4 v7, s[4:7], s75 offen offset:3072 sc1 lds
s_add_u32 m0, s76, 4096
s_add_u32 s75, s74, 0x2001000
buffer_load_dwordx4 v6, s[4:7], s75 offen offset:0 sc1 lds
buffer_load_dwordx4 v7, s[4:7], s75 offen offset:1024 sc1 lds
buffer_load_dwordx4 v6, s[4:7], s75 offen offset:2048 sc1 lds
buffer_load_dwordx4 v7, s[4:7], s75 offen offset:3072 sc1 lds
s_and_b32 s58, s53, 64
s_lshl_b32 s58, s58, 12
s_and_b32 s77, s24, 64
s_lshl_b32 s77, s77, 12
s_mov_b32 vcc_lo, -1
s_mov_b32 vcc_hi, 0
v_mov_b32 v1, s77
v_mov_b32 v2, s58
v_cndmask_b32 v1, v1, v2, vcc
v_add_u32 v12, v1, v11
v_mov_b32 v1, s24
v_mov_b32 v2, s53
v_cndmask_b32 v14, v1, v2, vcc
buffer_load_dword v13, v12, s[4:7], 0 offen sc1
s_waitcnt vmcnt(0)
.p2align 6
LAT_top:
s_mov_b32 s52, s53
s_mov_b32 s53, s24
s_and_b32 s62, s52, 8
s_lshl_b32 s62, s62, 10
s_xor_b32 s62, s62, s73
s_lshl_b32 s61, s52, 18
s_add_u32 s62, s62, s61
v_cmp_lt_u32 vcc, v14, v13
s_nop 0
s_cmp_eq_u64 vcc, -1
s_cbranch_scc0 LAT_look
buffer_load_dwordx4 v[92:95], v8, s[4:7], s62 offen offset:0 sc1
buffer_load_dwordx4 v[96:99], v8, s[4:7], s62 offen offset:512 sc1
buffer_load_dwordx4 v[100:103], v8, s[4:7], s62 offen offset:1024 sc1
buffer_load_dwordx4 v[104:107], v8, s[4:7], s62 offen offset:1536 sc1
buffer_load_dwordx4 v[140:143], v6, s[4:7], s62 offen offset:2048 sc1
buffer_load_dwordx4 v[144:147], v6, s[4:7], s62 offen offset:3072 sc1
s_waitcnt vmcnt(10)
ds_read_b64_tr_b16 v[108:109], v10 offset:0
ds_read_b64_tr_b16 v[110:111], v10 offset:1024
v_mfma_f32_16x16x32_bf16 v[156:159], v[60:63], v[28:31], v[16:19]
ds_read_b64_tr_b16 v[112:113], v10 offset:512
ds_read_b64_tr_b16 v[114:115], v10 offset:1536
v_mfma_f32_16x16x32_bf16 v[160:163], v[64:67], v[28:31], v[20:23]
ds_read_b64_tr_b16 v[116:117], v10 offset:2048
ds_read_b64_tr_b16 v[118:119], v10 offset:3072
v_mfma_f32_16x16x32_bf16 v[156:159], v[68:71], v[32:35], v[156:159]
ds_read_b64_tr_b16 v[120:121], v10 offset:2560
ds_read_b64_tr_b16 v[122:123], v10 offset:3584
v_mfma_f32_16x16x32_bf16 v[160:163], v[72:75], v[32:35], v[160:163]
ds_read_b64_tr_b16 v[124:125], v10 offset:4096
ds_read_b64_tr_b16 v[126:127], v10 offset:5120
v_mfma_f32_16x16x32_bf16 v[156:159], v[76:79], v[36:39], v[156:159]
ds_read_b64_tr_b16 v[128:129], v10 offset:4608
ds_read_b64_tr_b16 v[130:131], v10 offset:5632
v_mfma_f32_16x16x32_bf16 v[160:163], v[80:83], v[36:39], v[160:163]
ds_read_b64_tr_b16 v[132:133], v10 offset:6144
ds_read_b64_tr_b16 v[134:135], v10 offset:7168
v_mfma_f32_16x16x32_bf16 v[156:159], v[84:87], v[40:43], v[156:159]
ds_read_b64_tr_b16 v[136:137], v10 offset:6656
ds_read_b64_tr_b16 v[138:139], v10 offset:7680
v_mfma_f32_16x16x32_bf16 v[160:163], v[88:91], v[40:43], v[160:163]
v_mov_b32 v44, v28
v_mov_b32 v45, v29
v_mov_b32 v46, v30
v_mov_b32 v47, v31
v_mov_b32 v48, v32
v_mov_b32 v49, v33
v_mov_b32 v50, v34
v_mov_b32 v51, v35
v_mov_b32 v52, v36
v_mov_b32 v53, v37
v_mov_b32 v54, v38
v_mov_b32 v55, v39
v_mov_b32 v56, v40
v_mov_b32 v57, v41
v_mov_b32 v58, v42
v_mov_b32 v59, v43
s_waitcnt lgkmcnt(0)
s_branch LAT_go
LAT_look:
buffer_load_dword v13, v12, s[4:7], 0 offen sc1
s_waitcnt vmcnt(5)
ds_read_b64_tr_b16 v[108:109], v10 offset:0
ds_read_b64_tr_b16 v[110:111], v10 offset:1024
v_mfma_f32_16x16x32_bf16 v[156:159], v[60:63], v[28:31], v[16:19]
ds_read_b64_tr_b16 v[112:113], v10 offset:512
ds_read_b64_tr_b16 v[114:115], v10 offset:1536
v_mfma_f32_16x16x32_bf16 v[160:163], v[64:67], v[28:31], v[20:23]
ds_read_b64_tr_b16 v[116:117], v10 offset:2048
ds_read_b64_tr_b16 v[118:119], v10 offset:3072
v_mfma_f32_16x16x32_bf16 v[156:159], v[68:71], v[32:35], v[156:159]
ds_read_b64_tr_b16 v[120:121], v10 offset:2560
ds_read_b64_tr_b16 v[122:123], v10 offset:3584
v_mfma_f32_16x16x32_bf16 v[160:163], v[72:75], v[32:35], v[160:163]
ds_read_b64_tr_b16 v[124:125], v10 offset:4096
ds_read_b64_tr_b16 v[126:127], v10 offset:5120
v_mfma_f32_16x16x32_bf16 v[156:159], v[76:79], v[36:39], v[156:159]
ds_read_b64_tr_b16 v[128:129], v10 offset:4608
ds_read_b64_tr_b16 v[130:131], v10 offset:5632
v_mfma_f32_16x16x32_bf16 v[160:163], v[80:83], v[36:39], v[160:163]
ds_read_b64_tr_b16 v[132:133], v10 offset:6144
ds_read_b64_tr_b16 v[134:135], v10 offset:7168
v_mfma_f32_16x16x32_bf16 v[156:159], v[84:87], v[40:43], v[156:159]
ds_read_b64_tr_b16 v[136:137], v10 offset:6656
ds_read_b64_tr_b16 v[138:139], v10 offset:7680
v_mfma_f32_16x16x32_bf16 v[160:163], v[88:91], v[40:43], v[160:163]
v_mov_b32 v44, v28
v_mov_b32 v45, v29
v_mov_b32 v46, v30
v_mov_b32 v47, v31
v_mov_b32 v48, v32
v_mov_b32 v49, v33
v_mov_b32 v50, v34
v_mov_b32 v51, v35
v_mov_b32 v52, v36
v_mov_b32 v53, v37
v_mov_b32 v54, v38
v_mov_b32 v55, v39
v_mov_b32 v56, v40
v_mov_b32 v57, v41
v_mov_b32 v58, v42
v_mov_b32 v59, v43
s_waitcnt vmcnt(0) lgkmcnt(0)
buffer_store_dword v15, v4, s[4:7], s59 offen sc1
v_cmp_lt_u32 vcc, v14, v13
s_nop 0
s_cmp_eq_u32 vcc_lo, -1
s_cbranch_scc1 LAT_seen
LAT_spin:
buffer_load_dword v13, v12, s[4:7], 0 offen sc1
s_waitcnt vmcnt(0)
v_cmp_lt_u32 vcc, v14, v13
s_nop 0
s_cmp_eq_u32 vcc_lo, -1
s_cbranch_scc0 Lrt_197
LAT_seen:
buffer_load_dwordx4 v[92:95], v8, s[4:7], s62 offen offset:0 sc1
buffer_load_dwordx4 v[96:99], v8, s[4:7], s62 offen offset:512 sc1
buffer_load_dwordx4 v[100:103], v8, s[4:7], s62 offen offset:1024 sc1
buffer_load_dwordx4 v[104:107], v8, s[4:7], s62 offen offset:1536 sc1
buffer_load_dwordx4 v[140:143], v6, s[4:7], s62 offen offset:2048 sc1
buffer_load_dwordx4 v[144:147], v6, s[4:7], s62 offen offset:3072 sc1
LAT_go:
s_cmp_eq_u32 vcc_hi, -1
s_cselect_b32 s10, 0x10000000, 0
s_mov_b32 s63, s58
s_add_u32 s60, s53, 1
s_add_u32 s99, s99, 1
s_cmp_lt_u32 s99, 101
s_cselect_b32 s24, s98, s60
s_cselect_b32 s98, s60, s98
s_and_b32 s58, s53, 64
s_lshl_b32 s58, s58, 12
s_and_b32 s77, s24, 64
s_lshl_b32 s77, s77, 12
s_mov_b32 vcc_lo, -1
s_mov_b32 vcc_hi, 0
v_mov_b32 v1, s77
v_mov_b32 v2, s58
v_cndmask_b32 v1, v1, v2, vcc
v_add_u32 v12, v1, v11
v_mov_b32 v1, s24
v_mov_b32 v2, s53
v_cndmask_b32 v14, v1, v2, vcc
s_lshl_b32 s78, s52, 18
s_add_u32 s78, s78, s72
s_add_u32 s78, s78, s67
s_add_u32 s78, s78, 0x9400000
s_lshl_b32 s74, s53, 18
s_add_u32 s74, s74, s72
s_add_u32 s74, s74, 0x3400000
s_add_u32 s75, s74, 4096
buffer_load_dwordx4 v[60:63], v6, s[8:11], s74 offen offset:0 sc1
buffer_load_dwordx4 v[64:67], v7, s[8:11], s74 offen offset:1024 sc1
buffer_load_dwordx4 v[68:71], v6, s[8:11], s74 offen offset:2048 sc1
buffer_load_dwordx4 v[72:75], v7, s[8:11], s74 offen offset:3072 sc1
buffer_load_dwordx4 v[76:79], v6, s[8:11], s75 offen offset:0 sc1
buffer_load_dwordx4 v[80:83], v7, s[8:11], s75 offen offset:1024 sc1
buffer_load_dwordx4 v[84:87], v6, s[8:11], s75 offen offset:2048 sc1
buffer_load_dwordx4 v[88:91], v7, s[8:11], s75 offen offset:3072 sc1
s_waitcnt vmcnt(10)
buffer_store_dword v15, v4, s[4:7], s59 offen sc1
buffer_load_dword v13, v12, s[4:7], 0 offen sc1
s_add_u32 s60, s52, 1
v_mov_b32 v15, s60
s_mov_b32 s59, s63
s_add_u32 s61, s78, 4096
v_mfma_f32_16x16x32_bf16 v[164:167], v[92:95], v[44:47], 0
s_sub_u32 s75, s74, 0x2000000
s_add_u32 s75, s75, s67
buffer_load_dwordx4 v[28:31], v6, s[8:11], s75 offen offset:0 sc1
v_mfma_f32_16x16x32_bf16 v[164:167], v[96:99], v[48:51], v[164:167]
v_mfma_f32_16x16x32_bf16 v[164:167], v[100:103], v[52:55], v[164:167]
v_mfma_f32_16x16x32_bf16 v[164:167], v[104:107], v[56:59], v[164:167]
buffer_load_dwordx4 v[32:35], v6, s[8:11], s75 offen offset:2048 sc1
v_max3_f32 v176, v156, v157, v158
v_max3_f32 v177, v159, v160, v161
s_nop 4
v_max3_f32 v178, v162, v163, v164
v_max3_f32 v176, v176, v177, v165
v_max_f32 v176, v176, v178
v_mov_b32 v177, v176
s_nop 1
v_permlane16_swap_b32 v176, v177
v_max_f32 v176, v176, v177
v_mov_b32 v177, v176
s_nop 1
v_permlane32_swap_b32 v176, v177
s_add_u32 s75, s75, 4096
buffer_load_dwordx4 v[36:39], v6, s[8:11], s75 offen offset:0 sc1
v_max_f32 v176, v176, v177
v_mul_f32 v176, s71, v176
v_fma_f32 v156, v156, s71, -v176
v_fma_f32 v157, v157, s71, -v176
v_fma_f32 v158, v158, s71, -v176
v_fma_f32 v159, v159, s71, -v176
v_fma_f32 v160, v160, s71, -v176
v_fma_f32 v161, v161, s71, -v176
v_fma_f32 v162, v162, s71, -v176
v_fma_f32 v163, v163, s71, -v176
v_fma_f32 v164, v164, s71, -v176
v_fma_f32 v165, v165, s71, -v176
buffer_load_dwordx4 v[40:43], v6, s[8:11], s75 offen offset:2048 sc1
v_exp_f32 v156, v156
v_exp_f32 v157, v157
v_exp_f32 v158, v158
v_cvt_pk_bf16_f32 v168, v156, v157
v_exp_f32 v159, v159
v_exp_f32 v160, v160
v_cvt_pk_bf16_f32 v169, v158, v159
v_exp_f32 v161, v161
s_add_u32 m0, s76, 0
s_add_u32 s75, s74, 0x2000000
buffer_load_dwordx4 v6, s[8:11], s75 offen offset:0 sc1 lds
v_exp_f32 v162, v162
v_cvt_pk_bf16_f32 v170, v160, v161
v_exp_f32 v163, v163
v_exp_f32 v164, v164
v_cvt_pk_bf16_f32 v171, v162, v163
v_exp_f32 v165, v165
s_nop 0
v_cvt_pk_bf16_f32 v172, v164, v165
v_cvt_pk_bf16_f32 v175, v164, v165
v_mfma_f32_16x16x32_bf16 v[184:187], v[180:183], v[168:171], 0
buffer_load_dwordx4 v7, s[8:11], s75 offen offset:1024 sc1 lds
v_mfma_f32_16x16x32_bf16 v[188:191], v[108:111], v[168:171], 0
v_mfma_f32_16x16x32_bf16 v[192:195], v[112:115], v[168:171], 0
v_mfma_f32_16x16x32_bf16 v[196:199], v[116:119], v[168:171], 0
buffer_load_dwordx4 v6, s[8:11], s75 offen offset:2048 sc1 lds
v_mfma_f32_16x16x32_bf16 v[200:203], v[120:123], v[168:171], 0
v_mfma_f32_16x16x32_bf16 v[204:207], v[124:127], v[168:171], 0
v_mfma_f32_16x16x32_bf16 v[208:211], v[128:131], v[168:171], 0
buffer_load_dwordx4 v7, s[8:11], s75 offen offset:3072 sc1 lds
v_mfma_f32_16x16x32_bf16 v[212:215], v[132:135], v[168:171], 0
v_mfma_f32_16x16x32_bf16 v[216:219], v[136:139], v[168:171], 0
s_waitcnt vmcnt(18)
v_mfma_f32_16x16x16_bf16 v[184:187], v[180:181], v[172:173], v[184:187]
s_add_u32 m0, s76, 4096
s_add_u32 s75, s74, 0x2001000
buffer_load_dwordx4 v6, s[8:11], s75 offen offset:0 sc1 lds
v_mfma_f32_16x16x16_bf16 v[188:191], v[140:141], v[172:173], v[188:191]
v_mfma_f32_16x16x16_bf16 v[192:195], v[140:141], v[174:175], v[192:195]
v_mfma_f32_16x16x16_bf16 v[196:199], v[142:143], v[172:173], v[196:199]
v_mfma_f32_16x16x16_bf16 v[200:203], v[142:143], v[174:175], v[200:203]
buffer_load_dwordx4 v7, s[8:11], s75 offen offset:1024 sc1 lds
v_mfma_f32_16x16x16_bf16 v[204:207], v[144:145], v[172:173], v[204:207]
v_mfma_f32_16x16x16_bf16 v[208:211], v[144:145], v[174:175], v[208:211]
v_mfma_f32_16x16x16_bf16 v[212:215], v[146:147], v[172:173], v[212:215]
buffer_load_dwordx4 v6, s[8:11], s75 offen offset:2048 sc1 lds
v_mfma_f32_16x16x16_bf16 v[216:219], v[146:147], v[174:175], v[216:219]
buffer_load_dwordx4 v7, s[8:11], s75 offen offset:3072 sc1 lds
v_rcp_f32 v176, v184
s_nop 0
v_pk_mul_f32 v[188:189], v[188:189], v[176:177] op_sel_hi:[1,0]
v_pk_mul_f32 v[190:191], v[190:191], v[176:177] op_sel_hi:[1,0]
v_pk_mul_f32 v[192:193], v[192:193], v[176:177] op_sel_hi:[1,0]
v_pk_mul_f32 v[194:195], v[194:195], v[176:177] op_sel_hi:[1,0]
v_cvt_pk_bf16_f32 v220, v188, v189
v_cvt_pk_bf16_f32 v221, v190, v191
v_cvt_pk_bf16_f32 v222, v192, v193
v_cvt_pk_bf16_f32 v223, v194, v195
buffer_store_dwordx4 v[220:223], v6, s[4:7], s78 offen offset:0 sc1
v_pk_mul_f32 v[196:197], v[196:197], v[176:177] op_sel_hi:[1,0]
v_pk_mul_f32 v[198:199], v[198:199], v[176:177] op_sel_hi:[1,0]
v_pk_mul_f32 v[200:201], v[200:201], v[176:177] op_sel_hi:[1,0]
v_pk_mul_f32 v[202:203], v[202:203], v[176:177] op_sel_hi:[1,0]
v_cvt_pk_bf16_f32 v224, v196, v197
v_cvt_pk_bf16_f32 v225, v198, v199
v_cvt_pk_bf16_f32 v226, v200, v201
v_cvt_pk_bf16_f32 v227, v202, v203
buffer_store_dwordx4 v[224:227], v6, s[4:7], s78 offen offset:2048 sc1
v_pk_mul_f32 v[204:205], v[204:205], v[176:177] op_sel_hi:[1,0]
v_pk_mul_f32 v[206:207], v[206:207], v[176:177] op_sel_hi:[1,0]
v_pk_mul_f32 v[208:209], v[208:209], v[176:177] op_sel_hi:[1,0]
v_pk_mul_f32 v[210:211], v[210:211], v[176:177] op_sel_hi:[1,0]
v_cvt_pk_bf16_f32 v228, v204, v205
v_cvt_pk_bf16_f32 v229, v206, v207
v_cvt_pk_bf16_f32 v230, v208, v209
v_cvt_pk_bf16_f32 v231, v210, v211
buffer_store_dwordx4 v[228:231], v6, s[4:7], s61 offen offset:0 sc1
v_pk_mul_f32 v[212:213], v[212:213], v[176:177] op_sel_hi:[1,0]
v_pk_mul_f32 v[214:215], v[214:215], v[176:177] op_sel_hi:[1,0]
v_pk_mul_f32 v[216:217], v[216:217], v[176:177] op_sel_hi:[1,0]
v_pk_mul_f32 v[218:219], v[218:219], v[176:177] op_sel_hi:[1,0]
v_cvt_pk_bf16_f32 v232, v212, v213
v_cvt_pk_bf16_f32 v233, v214, v215
v_cvt_pk_bf16_f32 v234, v216, v217
v_cvt_pk_bf16_f32 v235, v218, v219
buffer_store_dwordx4 v[232:235], v6, s[4:7], s61 offen offset:2048 sc1
s_waitcnt vmcnt(16)
s_cmp_lg_u32 s10, 0
s_cbranch_scc1 LAT_top
s_waitcnt vmcnt(0)
buffer_store_dword v15, v4, s[4:7], s59 offen sc1
s_cmp_lt_u32 s53, 128
s_cbranch_scc1 LAT_slow
s_waitcnt vmcnt(0)
s_endpgm
Lrt_186:
s_add_u32 s96, s96, 1
s_cmp_lt_u32 s96, 1048576
s_cbranch_scc1 Lws_181
s_mov_b32 s97, 1
s_branch L_fail
Lrt_187:
s_add_u32 s96, s96, 1
s_cmp_lt_u32 s96, 1048576
s_cbranch_scc1 Lws1_182
s_mov_b32 s97, 1
s_branch L_fail
Lrt_191:
s_add_u32 s96, s96, 1
s_cmp_lt_u32 s96, 1048576
s_cbranch_scc1 Lnear_188
s_mov_b32 s97, 24
s_branch L_fail
Lrt_195:
s_add_u32 s96, s96, 1
s_cmp_lt_u32 s96, 1048576
s_cbranch_scc1 Lnear_192
s_mov_b32 s97, 24
s_branch L_fail
Lrt_196:
s_add_u32 s96, s96, 1
s_cmp_lt_u32 s96, 1048576
s_cbranch_scc1 LAT_slow2
s_mov_b32 s97, 9
s_branch L_fail
Lrt_197:
s_add_u32 s96, s96, 1
s_cmp_lt_u32 s96, 1048576
s_cbranch_scc1 LAT_spin
s_mov_b32 s97, 10
s_branch L_fail
L_QK:
s_cmp_lt_u32 s48, 2
s_cselect_b32 s28, s28, s30
s_cselect_b32 s29, s29, s31
s_mov_b32 s12, s28
s_and_b32 s13, s29, 0xffff
s_mov_b32 s14, 0x800000
s_mov_b32 s15, 0x20000
s_mul_i32 s66, s50, 0x50000
s_add_u32 s66, s66, 0x200000
s_lshl_b32 s67, s48, 14
s_add_u32 s67, s67, 98304
s_lshl_b32 s65, s50, 8
s_add_u32 s65, s65, 0x340000
v_lshlrev_b32 v6, 4, v0
s_mul_i32 s60, s48, 24576
v_add_u32 v8, s60, v6
v_mov_b32 v1, 0x4444
v_mov_b32 v2, 0xeeee
v_and_b32 v3, 2, v0
v_cmp_eq_u32 vcc, 0, v3
s_nop 1
v_cndmask_b32 v5, v2, v1, vcc
s_lshl_b32 s70, s50, 4
s_add_u32 s70, s70, s49
s_lshl_b32 s70, s70, 2
s_add_u32 s70, s70, s48
s_mul_i32 s60, s70, 256
s_add_u32 s60, s60, 20480
s_and_b32 s61, s60, 0xffffe000
s_add_u32 s60, s60, s61
v_mov_b32 v15, s60
v_mov_b32 v1, 0x40000000
v_cmp_gt_u32 vcc, 1, v0
s_nop 1
v_cndmask_b32 v15, v1, v15, vcc
v_mov_b32 v1, 0
s_mov_b32 s60, 0x0
buffer_store_dword v1, v15, s[4:7], s60 offen sc1
s_mov_b32 s60, 0x2000
buffer_store_dword v1, v15, s[4:7], s60 offen sc1
s_mov_b32 s60, 0x40000
buffer_store_dword v1, v15, s[4:7], s60 offen sc1
s_mov_b32 s60, 0x42000
buffer_store_dword v1, v15, s[4:7], s60 offen sc1
v_and_b32 v1, 13, v0
v_lshlrev_b32 v1, 4, v1
v_and_b32 v2, 16, v0
v_lshlrev_b32 v2, 1, v2
v_add_u32 v1, v1, v2
v_and_b32 v2, 32, v0
v_lshlrev_b32 v2, 3, v2
v_add_u32 v1, v1, v2
v_bfe_u32 v2, v0, 2, 2
v_lshlrev_b32 v2, 5, v2
v_and_b32 v4, 1, v0
v_lshlrev_b32 v4, 4, v4
v_add_u32 v2, v2, v4
v_mov_b32 v3, 0x40000000
v_and_b32 v4, 2, v0
v_cmp_eq_u32 vcc, 0, v4
s_nop 1
v_cndmask_b32 v11, v1, v3, vcc
v_lshrrev_b32 v1, 4, v0
v_lshlrev_b32 v1, 7, v1
v_add_u32 v1, v1, v2
v_cndmask_b32 v12, v3, v1, vcc
s_lshl_b32 s71, s49, 11
s_lshl_b32 s60, s48, 9
s_add_u32 s71, s71, s60
v_mov_b32 v16, -1
v_mov_b32 v17, -1
v_mov_b32 v18, -1
v_mov_b32 v19, -1
s_add_u32 s60, s66, 0x10000
s_add_u32 s60, s60, s71
buffer_store_dwordx4 v[16:19], v11, s[4:7], s60 offen sc1
s_add_u32 s60, s66, 0x18000
s_add_u32 s60, s60, s71
buffer_store_dwordx4 v[16:19], v11, s[4:7], s60 offen sc1
s_add_u32 s60, s66, 0x20000
s_add_u32 s60, s60, s71
buffer_store_dwordx4 v[16:19], v11, s[4:7], s60 offen sc1
s_add_u32 s60, s66, 0x28000
s_add_u32 s60, s60, s71
buffer_store_dwordx4 v[16:19], v11, s[4:7], s60 offen sc1
s_add_u32 s60, s66, 0xb0000
s_add_u32 s60, s60, s71
buffer_store_dwordx4 v[16:19], v11, s[4:7], s60 offen sc1
s_add_u32 s60, s66, 0xb8000
s_add_u32 s60, s60, s71
buffer_store_dwordx4 v[16:19], v11, s[4:7], s60 offen sc1
s_add_u32 s60, s66, 0xc0000
s_add_u32 s60, s60, s71
buffer_store_dwordx4 v[16:19], v11, s[4:7], s60 offen sc1
s_add_u32 s60, s66, 0xc8000
s_add_u32 s60, s60, s71
buffer_store_dwordx4 v[16:19], v11, s[4:7], s60 offen sc1
s_waitcnt vmcnt(0)
s_barrier
s_cmp_lg_u32 s48, 0
s_cbranch_scc1 Larr_198
s_mov_b32 s60, 0
v_mov_b32 v2, s60
v_mov_b32 v1, 0x40000000
v_cmp_gt_u32 vcc, 1, v0
s_nop 1
v_cndmask_b32 v2, v1, v2, vcc
s_sub_u32 s61, s101, s2
s_and_b32 s61, s61, 7
s_lshl_b32 s61, s61, 2
s_add_u32 s61, s61, 128
s_cmp_eq_u32 s100, 0
s_cselect_b32 s61, s61, 0
v_mov_b32 v3, 1
buffer_atomic_add v3, v2, s[20:23], s61 offen sc1
Larr_198:
s_add_u32 s71, s71, 0x10000
s_lshr_b32 s77, s70, 2
s_lshl_b32 s77, s77, 8
s_and_b32 s60, s48, 1
s_lshl_b32 s60, s60, 7
s_add_u32 s77, s77, s60
v_lshrrev_b32 v1, 3, v0
v_mul_u32_u24 v1, 8192, v1
v_and_b32 v2, 7, v0
v_lshlrev_b32 v2, 4, v2
v_add_u32 v20, v1, v2
v_lshrrev_b32 v1, 4, v0
v_bfe_u32 v2, v0, 2, 2
v_and_b32 v3, 3, v0
v_lshrrev_b32 v4, 1, v1
v_mul_u32_u24 v4, 16, v4
v_and_b32 v1, 1, v1
v_mul_u32_u24 v1, 4, v1
v_add_u32 v1, v1, v4
v_lshrrev_b32 v4, 1, v2
v_mul_u32_u24 v4, 8, v4
v_add_u32 v1, v1, v4
v_and_b32 v2, 1, v2
v_add_u32 v1, v1, v2
v_mul_u32_u24 v1, 128, v1
v_mul_u32_u24 v3, 8, v3
v_add3_u32 v21, v1, v3, s67
s_xor_b32 s68, s48, 0
s_lshl_b32 s68, s68, 21
s_add_u32 s68, s68, s77
s_add_u32 m0, s67, 0
s_add_u32 s63, s68, 0x0
buffer_load_dwordx4 v20, s[12:15], s63 offen lds
s_add_u32 m0, s67, 1024
s_add_u32 s63, s68, 0x10000
buffer_load_dwordx4 v20, s[12:15], s63 offen lds
s_add_u32 m0, s67, 2048
s_add_u32 s63, s68, 0x20000
buffer_load_dwordx4 v20, s[12:15], s63 offen lds
s_add_u32 m0, s67, 3072
s_add_u32 s63, s68, 0x30000
buffer_load_dwordx4 v20, s[12:15], s63 offen lds
s_add_u32 m0, s67, 4096
s_add_u32 s63, s68, 0x40000
buffer_load_dwordx4 v20, s[12:15], s63 offen lds
s_add_u32 m0, s67, 5120
s_add_u32 s63, s68, 0x50000
buffer_load_dwordx4 v20, s[12:15], s63 offen lds
s_add_u32 m0, s67, 6144
s_add_u32 s63, s68, 0x60000
buffer_load_dwordx4 v20, s[12:15], s63 offen lds
s_add_u32 m0, s67, 7168
s_add_u32 s63, s68, 0x70000
buffer_load_dwordx4 v20, s[12:15], s63 offen lds
s_xor_b32 s68, s48, 0
s_lshl_b32 s68, s68, 21
s_add_u32 s68, s68, s77
s_add_u32 m0, s67, 8192
s_add_u32 s63, s68, 0x80000
buffer_load_dwordx4 v20, s[12:15], s63 offen lds
s_add_u32 m0, s67, 9216
s_add_u32 s63, s68, 0x90000
buffer_load_dwordx4 v20, s[12:15], s63 offen lds
s_add_u32 m0, s67, 10240
s_add_u32 s63, s68, 0xa0000
buffer_load_dwordx4 v20, s[12:15], s63 offen lds
s_add_u32 m0, s67, 11264
s_add_u32 s63, s68, 0xb0000
buffer_load_dwordx4 v20, s[12:15], s63 offen lds
s_add_u32 m0, s67, 12288
s_add_u32 s63, s68, 0xc0000
buffer_load_dwordx4 v20, s[12:15], s63 offen lds
s_add_u32 m0, s67, 13312
s_add_u32 s63, s68, 0xd0000
buffer_load_dwordx4 v20, s[12:15], s63 offen lds
s_add_u32 m0, s67, 14336
s_add_u32 s63, s68, 0xe0000
buffer_load_dwordx4 v20, s[12:15], s63 offen lds
s_add_u32 m0, s67, 15360
s_add_u32 s63, s68, 0xf0000
buffer_load_dwordx4 v20, s[12:15], s63 offen lds
s_waitcnt vmcnt(12)
ds_read_b64_tr_b16 a[0:1], v21 offset:0
ds_read_b64_tr_b16 a[2:3], v21 offset:256
ds_read_b64_tr_b16 a[8:9], v21 offset:32
ds_read_b64_tr_b16 a[10:11], v21 offset:288
ds_read_b64_tr_b16 a[16:17], v21 offset:64
ds_read_b64_tr_b16 a[18:19], v21 offset:320
ds_read_b64_tr_b16 a[24:25], v21 offset:96
ds_read_b64_tr_b16 a[26:27], v21 offset:352
s_waitcnt lgkmcnt(0)
s_xor_b32 s68, s48, 0
s_lshl_b32 s68, s68, 21
s_add_u32 s68, s68, s77
s_add_u32 m0, s67, 0
s_add_u32 s63, s68, 0x100000
buffer_load_dwordx4 v20, s[12:15], s63 offen lds
s_add_u32 m0, s67, 1024
s_add_u32 s63, s68, 0x110000
buffer_load_dwordx4 v20, s[12:15], s63 offen lds
s_add_u32 m0, s67, 2048
s_add_u32 s63, s68, 0x120000
buffer_load_dwordx4 v20, s[12:15], s63 offen lds
s_add_u32 m0, s67, 3072
s_add_u32 s63, s68, 0x130000
buffer_load_dwordx4 v20, s[12:15], s63 offen lds
s_waitcnt vmcnt(12)
ds_read_b64_tr_b16 a[4:5], v21 offset:4096
ds_read_b64_tr_b16 a[6:7], v21 offset:4352
ds_read_b64_tr_b16 a[12:13], v21 offset:4128
ds_read_b64_tr_b16 a[14:15], v21 offset:4384
ds_read_b64_tr_b16 a[20:21], v21 offset:4160
ds_read_b64_tr_b16 a[22:23], v21 offset:4416
ds_read_b64_tr_b16 a[28:29], v21 offset:4192
ds_read_b64_tr_b16 a[30:31], v21 offset:4448
s_waitcnt lgkmcnt(0)
s_add_u32 m0, s67, 4096
s_add_u32 s63, s68, 0x140000
buffer_load_dwordx4 v20, s[12:15], s63 offen lds
s_add_u32 m0, s67, 5120
s_add_u32 s63, s68, 0x150000
buffer_load_dwordx4 v20, s[12:15], s63 offen lds
s_add_u32 m0, s67, 6144
s_add_u32 s63, s68, 0x160000
buffer_load_dwordx4 v20, s[12:15], s63 offen lds
s_add_u32 m0, s67, 7168
s_add_u32 s63, s68, 0x170000
buffer_load_dwordx4 v20, s[12:15], s63 offen lds
s_waitcnt vmcnt(12)
ds_read_b64_tr_b16 a[32:33], v21 offset:8192
ds_read_b64_tr_b16 a[34:35], v21 offset:8448
ds_read_b64_tr_b16 a[40:41], v21 offset:8224
ds_read_b64_tr_b16 a[42:43], v21 offset:8480
ds_read_b64_tr_b16 a[48:49], v21 offset:8256
ds_read_b64_tr_b16 a[50:51], v21 offset:8512
ds_read_b64_tr_b16 v[36:37], v21 offset:8288
ds_read_b64_tr_b16 v[38:39], v21 offset:8544
s_waitcnt lgkmcnt(0)
ds_write_b128 v8, v[36:39] offset:0
s_waitcnt lgkmcnt(0)
s_xor_b32 s68, s48, 0
s_lshl_b32 s68, s68, 21
s_add_u32 s68, s68, s77
s_add_u32 m0, s67, 8192
s_add_u32 s63, s68, 0x180000
buffer_load_dwordx4 v20, s[12:15], s63 offen lds
s_add_u32 m0, s67, 9216
s_add_u32 s63, s68, 0x190000
buffer_load_dwordx4 v20, s[12:15], s63 offen lds
s_add_u32 m0, s67, 10240
s_add_u32 s63, s68, 0x1a0000
buffer_load_dwordx4 v20, s[12:15], s63 offen lds
s_add_u32 m0, s67, 11264
s_add_u32 s63, s68, 0x1b0000
buffer_load_dwordx4 v20, s[12:15], s63 offen lds
s_waitcnt vmcnt(12)
ds_read_b64_tr_b16 a[36:37], v21 offset:12288
ds_read_b64_tr_b16 a[38:39], v21 offset:12544
ds_read_b64_tr_b16 a[44:45], v21 offset:12320
ds_read_b64_tr_b16 a[46:47], v21 offset:12576
ds_read_b64_tr_b16 a[52:53], v21 offset:12352
ds_read_b64_tr_b16 a[54:55], v21 offset:12608
ds_read_b64_tr_b16 v[36:37], v21 offset:12384
ds_read_b64_tr_b16 v[38:39], v21 offset:12640
s_waitcnt lgkmcnt(0)
ds_write_b128 v8, v[36:39] offset:1024
s_waitcnt lgkmcnt(0)
s_add_u32 m0, s67, 12288
s_add_u32 s63, s68, 0x1c0000
buffer_load_dwordx4 v20, s[12:15], s63 offen lds
s_add_u32 m0, s67, 13312
s_add_u32 s63, s68, 0x1d0000
buffer_load_dwordx4 v20, s[12:15], s63 offen lds
s_add_u32 m0, s67, 14336
s_add_u32 s63, s68, 0x1e0000
buffer_load_dwordx4 v20, s[12:15], s63 offen lds
s_add_u32 m0, s67, 15360
s_add_u32 s63, s68, 0x1f0000
buffer_load_dwordx4 v20, s[12:15], s63 offen lds
s_waitcnt vmcnt(12)
ds_read_b64_tr_b16 a[56:57], v21 offset:0
ds_read_b64_tr_b16 a[58:59], v21 offset:256
ds_read_b64_tr_b16 a[64:65], v21 offset:32
ds_read_b64_tr_b16 a[66:67], v21 offset:288
ds_read_b64_tr_b16 a[72:73], v21 offset:64
ds_read_b64_tr_b16 a[74:75], v21 offset:320
ds_read_b64_tr_b16 v[36:37], v21 offset:96
ds_read_b64_tr_b16 v[38:39], v21 offset:352
s_waitcnt lgkmcnt(0)
ds_write_b128 v8, v[36:39] offset:2048
s_waitcnt lgkmcnt(0)
s_xor_b32 s68, s48, 1
s_lshl_b32 s68, s68, 21
s_add_u32 s68, s68, s77
s_add_u32 m0, s67, 0
s_add_u32 s63, s68, 0x0
buffer_load_dwordx4 v20, s[12:15], s63 offen lds
s_add_u32 m0, s67, 1024
s_add_u32 s63, s68, 0x10000
buffer_load_dwordx4 v20, s[12:15], s63 offen lds
s_add_u32 m0, s67, 2048
s_add_u32 s63, s68, 0x20000
buffer_load_dwordx4 v20, s[12:15], s63 offen lds
s_add_u32 m0, s67, 3072
s_add_u32 s63, s68, 0x30000
buffer_load_dwordx4 v20, s[12:15], s63 offen lds
s_waitcnt vmcnt(12)
ds_read_b64_tr_b16 a[60:61], v21 offset:4096
ds_read_b64_tr_b16 a[62:63], v21 offset:4352
ds_read_b64_tr_b16 a[68:69], v21 offset:4128
ds_read_b64_tr_b16 a[70:71], v21 offset:4384
ds_read_b64_tr_b16 a[76:77], v21 offset:4160
ds_read_b64_tr_b16 a[78:79], v21 offset:4416
ds_read_b64_tr_b16 v[36:37], v21 offset:4192
ds_read_b64_tr_b16 v[38:39], v21 offset:4448
s_waitcnt lgkmcnt(0)
ds_write_b128 v8, v[36:39] offset:3072
s_waitcnt lgkmcnt(0)
s_add_u32 m0, s67, 4096
s_add_u32 s63, s68, 0x40000
buffer_load_dwordx4 v20, s[12:15], s63 offen lds
s_add_u32 m0, s67, 5120
s_add_u32 s63, s68, 0x50000
buffer_load_dwordx4 v20, s[12:15], s63 offen lds
s_add_u32 m0, s67, 6144
s_add_u32 s63, s68, 0x60000
buffer_load_dwordx4 v20, s[12:15], s63 offen lds
s_add_u32 m0, s67, 7168
s_add_u32 s63, s68, 0x70000
buffer_load_dwordx4 v20, s[12:15], s63 offen lds
s_waitcnt vmcnt(12)
ds_read_b64_tr_b16 a[80:81], v21 offset:8192
ds_read_b64_tr_b16 a[82:83], v21 offset:8448
ds_read_b64_tr_b16 a[88:89], v21 offset:8224
ds_read_b64_tr_b16 a[90:91], v21 offset:8480
ds_read_b64_tr_b16 a[96:97], v21 offset:8256
ds_read_b64_tr_b16 a[98:99], v21 offset:8512
ds_read_b64_tr_b16 v[36:37], v21 offset:8288
ds_read_b64_tr_b16 v[38:39], v21 offset:8544
s_waitcnt lgkmcnt(0)
ds_write_b128 v8, v[36:39] offset:4096
s_waitcnt lgkmcnt(0)
s_xor_b32 s68, s48, 1
s_lshl_b32 s68, s68, 21
s_add_u32 s68, s68, s77
s_add_u32 m0, s67, 8192
s_add_u32 s63, s68, 0x80000
buffer_load_dwordx4 v20, s[12:15], s63 offen lds
s_add_u32 m0, s67, 9216
s_add_u32 s63, s68, 0x90000
buffer_load_dwordx4 v20, s[12:15], s63 offen lds
s_add_u32 m0, s67, 10240
s_add_u32 s63, s68, 0xa0000
buffer_load_dwordx4 v20, s[12:15], s63 offen lds
s_add_u32 m0, s67, 11264
s_add_u32 s63, s68, 0xb0000
buffer_load_dwordx4 v20, s[12:15], s63 offen lds
s_waitcnt vmcnt(12)
ds_read_b64_tr_b16 a[84:85], v21 offset:12288
ds_read_b64_tr_b16 a[86:87], v21 offset:12544
ds_read_b64_tr_b16 a[92:93], v21 offset:12320
ds_read_b64_tr_b16 a[94:95], v21 offset:12576
ds_read_b64_tr_b16 a[100:101], v21 offset:12352
ds_read_b64_tr_b16 a[102:103], v21 offset:12608
ds_read_b64_tr_b16 v[36:37], v21 offset:12384
ds_read_b64_tr_b16 v[38:39], v21 offset:12640
s_waitcnt lgkmcnt(0)
ds_write_b128 v8, v[36:39] offset:5120
s_waitcnt lgkmcnt(0)
s_add_u32 m0, s67, 12288
s_add_u32 s63, s68, 0xc0000
buffer_load_dwordx4 v20, s[12:15], s63 offen lds
s_add_u32 m0, s67, 13312
s_add_u32 s63, s68, 0xd0000
buffer_load_dwordx4 v20, s[12:15], s63 offen lds
s_add_u32 m0, s67, 14336
s_add_u32 s63, s68, 0xe0000
buffer_load_dwordx4 v20, s[12:15], s63 offen lds
s_add_u32 m0, s67, 15360
s_add_u32 s63, s68, 0xf0000
buffer_load_dwordx4 v20, s[12:15], s63 offen lds
s_waitcnt vmcnt(12)
ds_read_b64_tr_b16 a[104:105], v21 offset:0
ds_read_b64_tr_b16 a[106:107], v21 offset:256
ds_read_b64_tr_b16 a[112:113], v21 offset:32
ds_read_b64_tr_b16 a[114:115], v21 offset:288
ds_read_b64_tr_b16 a[120:121], v21 offset:64
ds_read_b64_tr_b16 a[122:123], v21 offset:320
ds_read_b64_tr_b16 v[36:37], v21 offset:96
ds_read_b64_tr_b16 v[38:39], v21 offset:352
s_waitcnt lgkmcnt(0)
ds_write_b128 v8, v[36:39] offset:6144
s_waitcnt lgkmcnt(0)
s_xor_b32 s68, s48, 1
s_lshl_b32 s68, s68, 21
s_add_u32 s68, s68, s77
s_add_u32 m0, s67, 0
s_add_u32 s63, s68, 0x100000
buffer_load_dwordx4 v20, s[12:15], s63 offen lds
s_add_u32 m0, s67, 1024
s_add_u32 s63, s68, 0x110000
buffer_load_dwordx4 v20, s[12:15], s63 offen lds
s_add_u32 m0, s67, 2048
s_add_u32 s63, s68, 0x120000
buffer_load_dwordx4 v20, s[12:15], s63 offen lds
s_add_u32 m0, s67, 3072
s_add_u32 s63, s68, 0x130000
buffer_load_dwordx4 v20, s[12:15], s63 offen lds
s_waitcnt vmcnt(12)
ds_read_b64_tr_b16 a[108:109], v21 offset:4096
ds_read_b64_tr_b16 a[110:111], v21 offset:4352
ds_read_b64_tr_b16 a[116:117], v21 offset:4128
ds_read_b64_tr_b16 a[118:119], v21 offset:4384
ds_read_b64_tr_b16 a[124:125], v21 offset:4160
ds_read_b64_tr_b16 a[126:127], v21 offset:4416
ds_read_b64_tr_b16 v[36:37], v21 offset:4192
ds_read_b64_tr_b16 v[38:39], v21 offset:4448
s_waitcnt lgkmcnt(0)
ds_write_b128 v8, v[36:39] offset:7168
s_waitcnt lgkmcnt(0)
s_add_u32 m0, s67, 4096
s_add_u32 s63, s68, 0x140000
buffer_load_dwordx4 v20, s[12:15], s63 offen lds
s_add_u32 m0, s67, 5120
s_add_u32 s63, s68, 0x150000
buffer_load_dwordx4 v20, s[12:15], s63 offen lds
s_add_u32 m0, s67, 6144
s_add_u32 s63, s68, 0x160000
buffer_load_dwordx4 v20, s[12:15], s63 offen lds
s_add_u32 m0, s67, 7168
s_add_u32 s63, s68, 0x170000
buffer_load_dwordx4 v20, s[12:15], s63 offen lds
s_waitcnt vmcnt(12)
ds_read_b64_tr_b16 a[128:129], v21 offset:8192
ds_read_b64_tr_b16 a[130:131], v21 offset:8448
ds_read_b64_tr_b16 a[136:137], v21 offset:8224
ds_read_b64_tr_b16 a[138:139], v21 offset:8480
ds_read_b64_tr_b16 a[144:145], v21 offset:8256
ds_read_b64_tr_b16 a[146:147], v21 offset:8512
ds_read_b64_tr_b16 v[36:37], v21 offset:8288
ds_read_b64_tr_b16 v[38:39], v21 offset:8544
s_waitcnt lgkmcnt(0)
ds_write_b128 v8, v[36:39] offset:8192
s_waitcnt lgkmcnt(0)
s_xor_b32 s68, s48, 1
s_lshl_b32 s68, s68, 21
s_add_u32 s68, s68, s77
s_add_u32 m0, s67, 8192
s_add_u32 s63, s68, 0x180000
buffer_load_dwordx4 v20, s[12:15], s63 offen lds
s_add_u32 m0, s67, 9216
s_add_u32 s63, s68, 0x190000
buffer_load_dwordx4 v20, s[12:15], s63 offen lds
s_add_u32 m0, s67, 10240
s_add_u32 s63, s68, 0x1a0000
buffer_load_dwordx4 v20, s[12:15], s63 offen lds
s_add_u32 m0, s67, 11264
s_add_u32 s63, s68, 0x1b0000
buffer_load_dwordx4 v20, s[12:15], s63 offen lds
s_waitcnt vmcnt(12)
ds_read_b64_tr_b16 a[132:133], v21 offset:12288
ds_read_b64_tr_b16 a[134:135], v21 offset:12544
ds_read_b64_tr_b16 a[140:141], v21 offset:12320
ds_read_b64_tr_b16 a[142:143], v21 offset:12576
ds_read_b64_tr_b16 a[148:149], v21 offset:12352
ds_read_b64_tr_b16 a[150:151], v21 offset:12608
ds_read_b64_tr_b16 v[36:37], v21 offset:12384
ds_read_b64_tr_b16 v[38:39], v21 offset:12640
s_waitcnt lgkmcnt(0)
ds_write_b128 v8, v[36:39] offset:9216
s_waitcnt lgkmcnt(0)
s_add_u32 m0, s67, 12288
s_add_u32 s63, s68, 0x1c0000
buffer_load_dwordx4 v20, s[12:15], s63 offen lds
s_add_u32 m0, s67, 13312
s_add_u32 s63, s68, 0x1d0000
buffer_load_dwordx4 v20, s[12:15], s63 offen lds
s_add_u32 m0, s67, 14336
s_add_u32 s63, s68, 0x1e0000
buffer_load_dwordx4 v20, s[12:15], s63 offen lds
s_add_u32 m0, s67, 15360
s_add_u32 s63, s68, 0x1f0000
buffer_load_dwordx4 v20, s[12:15], s63 offen lds
s_waitcnt vmcnt(12)
ds_read_b64_tr_b16 a[152:153], v21 offset:0
ds_read_b64_tr_b16 a[154:155], v21 offset:256
ds_read_b64_tr_b16 a[160:161], v21 offset:32
ds_read_b64_tr_b16 a[162:163], v21 offset:288
ds_read_b64_tr_b16 a[168:169], v21 offset:64
ds_read_b64_tr_b16 a[170:171], v21 offset:320
ds_read_b64_tr_b16 v[36:37], v21 offset:96
ds_read_b64_tr_b16 v[38:39], v21 offset:352
s_waitcnt lgkmcnt(0)
ds_write_b128 v8, v[36:39] offset:10240
s_waitcnt lgkmcnt(0)
s_xor_b32 s68, s48, 2
s_lshl_b32 s68, s68, 21
s_add_u32 s68, s68, s77
s_add_u32 m0, s67, 0
s_add_u32 s63, s68, 0x0
buffer_load_dwordx4 v20, s[12:15], s63 offen lds
s_add_u32 m0, s67, 1024
s_add_u32 s63, s68, 0x10000
buffer_load_dwordx4 v20, s[12:15], s63 offen lds
s_add_u32 m0, s67, 2048
s_add_u32 s63, s68, 0x20000
buffer_load_dwordx4 v20, s[12:15], s63 offen lds
s_add_u32 m0, s67, 3072
s_add_u32 s63, s68, 0x30000
buffer_load_dwordx4 v20, s[12:15], s63 offen lds
s_waitcnt vmcnt(12)
ds_read_b64_tr_b16 a[156:157], v21 offset:4096
ds_read_b64_tr_b16 a[158:159], v21 offset:4352
ds_read_b64_tr_b16 a[164:165], v21 offset:4128
ds_read_b64_tr_b16 a[166:167], v21 offset:4384
ds_read_b64_tr_b16 a[172:173], v21 offset:4160
ds_read_b64_tr_b16 a[174:175], v21 offset:4416
ds_read_b64_tr_b16 v[36:37], v21 offset:4192
ds_read_b64_tr_b16 v[38:39], v21 offset:4448
s_waitcnt lgkmcnt(0)
ds_write_b128 v8, v[36:39] offset:11264
s_waitcnt lgkmcnt(0)
s_add_u32 m0, s67, 4096
s_add_u32 s63, s68, 0x40000
buffer_load_dwordx4 v20, s[12:15], s63 offen lds
s_add_u32 m0, s67, 5120
s_add_u32 s63, s68, 0x50000
buffer_load_dwordx4 v20, s[12:15], s63 offen lds
s_add_u32 m0, s67, 6144
s_add_u32 s63, s68, 0x60000
buffer_load_dwordx4 v20, s[12:15], s63 offen lds
s_add_u32 m0, s67, 7168
s_add_u32 s63, s68, 0x70000
buffer_load_dwordx4 v20, s[12:15], s63 offen lds
s_waitcnt vmcnt(12)
ds_read_b64_tr_b16 a[176:177], v21 offset:8192
ds_read_b64_tr_b16 a[178:179], v21 offset:8448
ds_read_b64_tr_b16 a[184:185], v21 offset:8224
ds_read_b64_tr_b16 a[186:187], v21 offset:8480
ds_read_b64_tr_b16 a[192:193], v21 offset:8256
ds_read_b64_tr_b16 a[194:195], v21 offset:8512
ds_read_b64_tr_b16 v[36:37], v21 offset:8288
ds_read_b64_tr_b16 v[38:39], v21 offset:8544
s_waitcnt lgkmcnt(0)
ds_write_b128 v8, v[36:39] offset:12288
s_waitcnt lgkmcnt(0)
s_xor_b32 s68, s48, 2
s_lshl_b32 s68, s68, 21
s_add_u32 s68, s68, s77
s_add_u32 m0, s67, 8192
s_add_u32 s63, s68, 0x80000
buffer_load_dwordx4 v20, s[12:15], s63 offen lds
s_add_u32 m0, s67, 9216
s_add_u32 s63, s68, 0x90000
buffer_load_dwordx4 v20, s[12:15], s63 offen lds
s_add_u32 m0, s67, 10240
s_add_u32 s63, s68, 0xa0000
buffer_load_dwordx4 v20, s[12:15], s63 offen lds
s_add_u32 m0, s67, 11264
s_add_u32 s63, s68, 0xb0000
buffer_load_dwordx4 v20, s[12:15], s63 offen lds
s_waitcnt vmcnt(12)
ds_read_b64_tr_b16 a[180:181], v21 offset:12288
ds_read_b64_tr_b16 a[182:183], v21 offset:12544
ds_read_b64_tr_b16 a[188:189], v21 offset:12320
ds_read_b64_tr_b16 a[190:191], v21 offset:12576
ds_read_b64_tr_b16 a[196:197], v21 offset:12352
ds_read_b64_tr_b16 a[198:199], v21 offset:12608
ds_read_b64_tr_b16 v[36:37], v21 offset:12384
ds_read_b64_tr_b16 v[38:39], v21 offset:12640
s_waitcnt lgkmcnt(0)
ds_write_b128 v8, v[36:39] offset:13312
s_waitcnt lgkmcnt(0)
s_add_u32 m0, s67, 12288
s_add_u32 s63, s68, 0xc0000
buffer_load_dwordx4 v20, s[12:15], s63 offen lds
s_add_u32 m0, s67, 13312
s_add_u32 s63, s68, 0xd0000
buffer_load_dwordx4 v20, s[12:15], s63 offen lds
s_add_u32 m0, s67, 14336
s_add_u32 s63, s68, 0xe0000
buffer_load_dwordx4 v20, s[12:15], s63 offen lds
s_add_u32 m0, s67, 15360
s_add_u32 s63, s68, 0xf0000
buffer_load_dwordx4 v20, s[12:15], s63 offen lds
s_waitcnt vmcnt(12)
ds_read_b64_tr_b16 a[200:201], v21 offset:0
ds_read_b64_tr_b16 a[202:203], v21 offset:256
ds_read_b64_tr_b16 a[208:209], v21 offset:32
ds_read_b64_tr_b16 a[210:211], v21 offset:288
ds_read_b64_tr_b16 a[216:217], v21 offset:64
ds_read_b64_tr_b16 a[218:219], v21 offset:320
ds_read_b64_tr_b16 v[36:37], v21 offset:96
ds_read_b64_tr_b16 v[38:39], v21 offset:352
s_waitcnt lgkmcnt(0)
ds_write_b128 v8, v[36:39] offset:14336
s_waitcnt lgkmcnt(0)
s_xor_b32 s68, s48, 2
s_lshl_b32 s68, s68, 21
s_add_u32 s68, s68, s77
s_add_u32 m0, s67, 0
s_add_u32 s63, s68, 0x100000
buffer_load_dwordx4 v20, s[12:15], s63 offen lds
s_add_u32 m0, s67, 1024
s_add_u32 s63, s68, 0x110000
buffer_load_dwordx4 v20, s[12:15], s63 offen lds
s_add_u32 m0, s67, 2048
s_add_u32 s63, s68, 0x120000
buffer_load_dwordx4 v20, s[12:15], s63 offen lds
s_add_u32 m0, s67, 3072
s_add_u32 s63, s68, 0x130000
buffer_load_dwordx4 v20, s[12:15], s63 offen lds
s_waitcnt vmcnt(12)
ds_read_b64_tr_b16 a[204:205], v21 offset:4096
ds_read_b64_tr_b16 a[206:207], v21 offset:4352
ds_read_b64_tr_b16 a[212:213], v21 offset:4128
ds_read_b64_tr_b16 a[214:215], v21 offset:4384
ds_read_b64_tr_b16 a[220:221], v21 offset:4160
ds_read_b64_tr_b16 a[222:223], v21 offset:4416
ds_read_b64_tr_b16 v[36:37], v21 offset:4192
ds_read_b64_tr_b16 v[38:39], v21 offset:4448
s_waitcnt lgkmcnt(0)
ds_write_b128 v8, v[36:39] offset:15360
s_waitcnt lgkmcnt(0)
s_add_u32 m0, s67, 4096
s_add_u32 s63, s68, 0x140000
buffer_load_dwordx4 v20, s[12:15], s63 offen lds
s_add_u32 m0, s67, 5120
s_add_u32 s63, s68, 0x150000
buffer_load_dwordx4 v20, s[12:15], s63 offen lds
s_add_u32 m0, s67, 6144
s_add_u32 s63, s68, 0x160000
buffer_load_dwordx4 v20, s[12:15], s63 offen lds
s_add_u32 m0, s67, 7168
s_add_u32 s63, s68, 0x170000
buffer_load_dwordx4 v20, s[12:15], s63 offen lds
s_waitcnt vmcnt(12)
ds_read_b64_tr_b16 a[224:225], v21 offset:8192
ds_read_b64_tr_b16 a[226:227], v21 offset:8448
ds_read_b64_tr_b16 a[232:233], v21 offset:8224
ds_read_b64_tr_b16 a[234:235], v21 offset:8480
ds_read_b64_tr_b16 a[240:241], v21 offset:8256
ds_read_b64_tr_b16 a[242:243], v21 offset:8512
ds_read_b64_tr_b16 v[36:37], v21 offset:8288
ds_read_b64_tr_b16 v[38:39], v21 offset:8544
s_waitcnt lgkmcnt(0)
ds_write_b128 v8, v[36:39] offset:16384
s_waitcnt lgkmcnt(0)
s_xor_b32 s68, s48, 2
s_lshl_b32 s68, s68, 21
s_add_u32 s68, s68, s77
s_add_u32 m0, s67, 8192
s_add_u32 s63, s68, 0x180000
buffer_load_dwordx4 v20, s[12:15], s63 offen lds
s_add_u32 m0, s67, 9216
s_add_u32 s63, s68, 0x190000
buffer_load_dwordx4 v20, s[12:15], s63 offen lds
s_add_u32 m0, s67, 10240
s_add_u32 s63, s68, 0x1a0000
buffer_load_dwordx4 v20, s[12:15], s63 offen lds
s_add_u32 m0, s67, 11264
s_add_u32 s63, s68, 0x1b0000
buffer_load_dwordx4 v20, s[12:15], s63 offen lds
s_waitcnt vmcnt(12)
ds_read_b64_tr_b16 a[228:229], v21 offset:12288
ds_read_b64_tr_b16 a[230:231], v21 offset:12544
ds_read_b64_tr_b16 a[236:237], v21 offset:12320
ds_read_b64_tr_b16 a[238:239], v21 offset:12576
ds_read_b64_tr_b16 a[244:245], v21 offset:12352
ds_read_b64_tr_b16 a[246:247], v21 offset:12608
ds_read_b64_tr_b16 v[36:37], v21 offset:12384
ds_read_b64_tr_b16 v[38:39], v21 offset:12640
s_waitcnt lgkmcnt(0)
ds_write_b128 v8, v[36:39] offset:17408
s_waitcnt lgkmcnt(0)
s_add_u32 m0, s67, 12288
s_add_u32 s63, s68, 0x1c0000
buffer_load_dwordx4 v20, s[12:15], s63 offen lds
s_add_u32 m0, s67, 13312
s_add_u32 s63, s68, 0x1d0000
buffer_load_dwordx4 v20, s[12:15], s63 offen lds
s_add_u32 m0, s67, 14336
s_add_u32 s63, s68, 0x1e0000
buffer_load_dwordx4 v20, s[12:15], s63 offen lds
s_add_u32 m0, s67, 15360
s_add_u32 s63, s68, 0x1f0000
buffer_load_dwordx4 v20, s[12:15], s63 offen lds
s_waitcnt vmcnt(12)
ds_read_b64_tr_b16 a[248:249], v21 offset:0
ds_read_b64_tr_b16 a[250:251], v21 offset:256
ds_read_b64_tr_b16 v[96:97], v21 offset:32
ds_read_b64_tr_b16 v[98:99], v21 offset:288
ds_read_b64_tr_b16 v[104:105], v21 offset:64
ds_read_b64_tr_b16 v[106:107], v21 offset:320
ds_read_b64_tr_b16 v[36:37], v21 offset:96
ds_read_b64_tr_b16 v[38:39], v21 offset:352
s_waitcnt lgkmcnt(0)
ds_write_b128 v8, v[36:39] offset:18432
s_waitcnt lgkmcnt(0)
s_xor_b32 s68, s48, 3
s_lshl_b32 s68, s68, 21
s_add_u32 s68, s68, s77
s_add_u32 m0, s67, 0
s_add_u32 s63, s68, 0x0
buffer_load_dwordx4 v20, s[12:15], s63 offen lds
s_add_u32 m0, s67, 1024
s_add_u32 s63, s68, 0x10000
buffer_load_dwordx4 v20, s[12:15], s63 offen lds
s_add_u32 m0, s67, 2048
s_add_u32 s63, s68, 0x20000
buffer_load_dwordx4 v20, s[12:15], s63 offen lds
s_add_u32 m0, s67, 3072
s_add_u32 s63, s68, 0x30000
buffer_load_dwordx4 v20, s[12:15], s63 offen lds
s_waitcnt vmcnt(12)
ds_read_b64_tr_b16 a[252:253], v21 offset:4096
ds_read_b64_tr_b16 a[254:255], v21 offset:4352
ds_read_b64_tr_b16 v[100:101], v21 offset:4128
ds_read_b64_tr_b16 v[102:103], v21 offset:4384
ds_read_b64_tr_b16 v[108:109], v21 offset:4160
ds_read_b64_tr_b16 v[110:111], v21 offset:4416
ds_read_b64_tr_b16 v[36:37], v21 offset:4192
ds_read_b64_tr_b16 v[38:39], v21 offset:4448
s_waitcnt lgkmcnt(0)
ds_write_b128 v8, v[36:39] offset:19456
s_waitcnt lgkmcnt(0)
s_add_u32 m0, s67, 4096
s_add_u32 s63, s68, 0x40000
buffer_load_dwordx4 v20, s[12:15], s63 offen lds
s_add_u32 m0, s67, 5120
s_add_u32 s63, s68, 0x50000
buffer_load_dwordx4 v20, s[12:15], s63 offen lds
s_add_u32 m0, s67, 6144
s_add_u32 s63, s68, 0x60000
buffer_load_dwordx4 v20, s[12:15], s63 offen lds
s_add_u32 m0, s67, 7168
s_add_u32 s63, s68, 0x70000
buffer_load_dwordx4 v20, s[12:15], s63 offen lds
s_waitcnt vmcnt(12)
ds_read_b64_tr_b16 v[112:113], v21 offset:8192
ds_read_b64_tr_b16 v[114:115], v21 offset:8448
ds_read_b64_tr_b16 v[120:121], v21 offset:8224
ds_read_b64_tr_b16 v[122:123], v21 offset:8480
ds_read_b64_tr_b16 v[128:129], v21 offset:8256
ds_read_b64_tr_b16 v[130:131], v21 offset:8512
ds_read_b64_tr_b16 v[36:37], v21 offset:8288
ds_read_b64_tr_b16 v[38:39], v21 offset:8544
s_waitcnt lgkmcnt(0)
ds_write_b128 v8, v[36:39] offset:20480
s_waitcnt lgkmcnt(0)
s_xor_b32 s68, s48, 3
s_lshl_b32 s68, s68, 21
s_add_u32 s68, s68, s77
s_add_u32 m0, s67, 8192
s_add_u32 s63, s68, 0x80000
buffer_load_dwordx4 v20, s[12:15], s63 offen lds
s_add_u32 m0, s67, 9216
s_add_u32 s63, s68, 0x90000
buffer_load_dwordx4 v20, s[12:15], s63 offen lds
s_add_u32 m0, s67, 10240
s_add_u32 s63, s68, 0xa0000
buffer_load_dwordx4 v20, s[12:15], s63 offen lds
s_add_u32 m0, s67, 11264
s_add_u32 s63, s68, 0xb0000
buffer_load_dwordx4 v20, s[12:15], s63 offen lds
s_waitcnt vmcnt(12)
ds_read_b64_tr_b16 v[116:117], v21 offset:12288
ds_read_b64_tr_b16 v[118:119], v21 offset:12544
ds_read_b64_tr_b16 v[124:125], v21 offset:12320
ds_read_b64_tr_b16 v[126:127], v21 offset:12576
ds_read_b64_tr_b16 v[132:133], v21 offset:12352
ds_read_b64_tr_b16 v[134:135], v21 offset:12608
ds_read_b64_tr_b16 v[36:37], v21 offset:12384
ds_read_b64_tr_b16 v[38:39], v21 offset:12640
s_waitcnt lgkmcnt(0)
ds_write_b128 v8, v[36:39] offset:21504
s_waitcnt lgkmcnt(0)
s_add_u32 m0, s67, 12288
s_add_u32 s63, s68, 0xc0000
buffer_load_dwordx4 v20, s[12:15], s63 offen lds
s_add_u32 m0, s67, 13312
s_add_u32 s63, s68, 0xd0000
buffer_load_dwordx4 v20, s[12:15], s63 offen lds
s_add_u32 m0, s67, 14336
s_add_u32 s63, s68, 0xe0000
buffer_load_dwordx4 v20, s[12:15], s63 offen lds
s_add_u32 m0, s67, 15360
s_add_u32 s63, s68, 0xf0000
buffer_load_dwordx4 v20, s[12:15], s63 offen lds
s_waitcnt vmcnt(12)
ds_read_b64_tr_b16 v[136:137], v21 offset:0
ds_read_b64_tr_b16 v[138:139], v21 offset:256
ds_read_b64_tr_b16 v[144:145], v21 offset:32
ds_read_b64_tr_b16 v[146:147], v21 offset:288
ds_read_b64_tr_b16 v[152:153], v21 offset:64
ds_read_b64_tr_b16 v[154:155], v21 offset:320
ds_read_b64_tr_b16 v[36:37], v21 offset:96
ds_read_b64_tr_b16 v[38:39], v21 offset:352
s_waitcnt lgkmcnt(0)
ds_write_b128 v8, v[36:39] offset:22528
s_waitcnt lgkmcnt(0)
s_xor_b32 s68, s48, 3
s_lshl_b32 s68, s68, 21
s_add_u32 s68, s68, s77
s_add_u32 m0, s67, 0
s_add_u32 s63, s68, 0x100000
buffer_load_dwordx4 v20, s[12:15], s63 offen lds
s_add_u32 m0, s67, 1024
s_add_u32 s63, s68, 0x110000
buffer_load_dwordx4 v20, s[12:15], s63 offen lds
s_add_u32 m0, s67, 2048
s_add_u32 s63, s68, 0x120000
buffer_load_dwordx4 v20, s[12:15], s63 offen lds
s_add_u32 m0, s67, 3072
s_add_u32 s63, s68, 0x130000
buffer_load_dwordx4 v20, s[12:15], s63 offen lds
s_waitcnt vmcnt(12)
ds_read_b64_tr_b16 v[140:141], v21 offset:4096
ds_read_b64_tr_b16 v[142:143], v21 offset:4352
ds_read_b64_tr_b16 v[148:149], v21 offset:4128
ds_read_b64_tr_b16 v[150:151], v21 offset:4384
ds_read_b64_tr_b16 v[156:157], v21 offset:4160
ds_read_b64_tr_b16 v[158:159], v21 offset:4416
ds_read_b64_tr_b16 v[36:37], v21 offset:4192
ds_read_b64_tr_b16 v[38:39], v21 offset:4448
s_waitcnt lgkmcnt(0)
ds_write_b128 v8, v[36:39] offset:23552
s_waitcnt lgkmcnt(0)
s_add_u32 m0, s67, 4096
s_add_u32 s63, s68, 0x140000
buffer_load_dwordx4 v20, s[12:15], s63 offen lds
s_add_u32 m0, s67, 5120
s_add_u32 s63, s68, 0x150000
buffer_load_dwordx4 v20, s[12:15], s63 offen lds
s_add_u32 m0, s67, 6144
s_add_u32 s63, s68, 0x160000
buffer_load_dwordx4 v20, s[12:15], s63 offen lds
s_add_u32 m0, s67, 7168
s_add_u32 s63, s68, 0x170000
buffer_load_dwordx4 v20, s[12:15], s63 offen lds
s_waitcnt vmcnt(12)
ds_read_b64_tr_b16 v[160:161], v21 offset:8192
ds_read_b64_tr_b16 v[162:163], v21 offset:8448
ds_read_b64_tr_b16 v[168:169], v21 offset:8224
ds_read_b64_tr_b16 v[170:171], v21 offset:8480
ds_read_b64_tr_b16 v[176:177], v21 offset:8256
ds_read_b64_tr_b16 v[178:179], v21 offset:8512
ds_read_b64_tr_b16 v[184:185], v21 offset:8288
ds_read_b64_tr_b16 v[186:187], v21 offset:8544
s_waitcnt lgkmcnt(0)
s_xor_b32 s68, s48, 3
s_lshl_b32 s68, s68, 21
s_add_u32 s68, s68, s77
s_add_u32 m0, s67, 8192
s_add_u32 s63, s68, 0x180000
buffer_load_dwordx4 v20, s[12:15], s63 offen lds
s_add_u32 m0, s67, 9216
s_add_u32 s63, s68, 0x190000
buffer_load_dwordx4 v20, s[12:15], s63 offen lds
s_add_u32 m0, s67, 10240
s_add_u32 s63, s68, 0x1a0000
buffer_load_dwordx4 v20, s[12:15], s63 offen lds
s_add_u32 m0, s67, 11264
s_add_u32 s63, s68, 0x1b0000
buffer_load_dwordx4 v20, s[12:15], s63 offen lds
s_waitcnt vmcnt(12)
ds_read_b64_tr_b16 v[164:165], v21 offset:12288
ds_read_b64_tr_b16 v[166:167], v21 offset:12544
ds_read_b64_tr_b16 v[172:173], v21 offset:12320
ds_read_b64_tr_b16 v[174:175], v21 offset:12576
ds_read_b64_tr_b16 v[180:181], v21 offset:12352
ds_read_b64_tr_b16 v[182:183], v21 offset:12608
ds_read_b64_tr_b16 v[188:189], v21 offset:12384
ds_read_b64_tr_b16 v[190:191], v21 offset:12640
s_waitcnt lgkmcnt(0)
s_add_u32 m0, s67, 12288
s_add_u32 s63, s68, 0x1c0000
buffer_load_dwordx4 v20, s[12:15], s63 offen lds
s_add_u32 m0, s67, 13312
s_add_u32 s63, s68, 0x1d0000
buffer_load_dwordx4 v20, s[12:15], s63 offen lds
s_add_u32 m0, s67, 14336
s_add_u32 s63, s68, 0x1e0000
buffer_load_dwordx4 v20, s[12:15], s63 offen lds
s_add_u32 m0, s67, 15360
s_add_u32 s63, s68, 0x1f0000
buffer_load_dwordx4 v20, s[12:15], s63 offen lds
v_mov_b32 v56, 0
buffer_load_dwordx4 v[48:51], v56, s[20:23], 0 offen offset:128 sc1
buffer_load_dwordx4 v[52:55], v56, s[20:23], 0 offen offset:144 sc1
buffer_load_dword v58, v56, s[20:23], 0 offen offset:160 sc1
s_waitcnt vmcnt(12)
ds_read_b64_tr_b16 v[192:193], v21 offset:0
ds_read_b64_tr_b16 v[194:195], v21 offset:256
ds_read_b64_tr_b16 v[200:201], v21 offset:32
ds_read_b64_tr_b16 v[202:203], v21 offset:288
ds_read_b64_tr_b16 v[208:209], v21 offset:64
ds_read_b64_tr_b16 v[210:211], v21 offset:320
ds_read_b64_tr_b16 v[216:217], v21 offset:96
ds_read_b64_tr_b16 v[218:219], v21 offset:352
s_waitcnt lgkmcnt(0)
s_waitcnt vmcnt(8)
ds_read_b64_tr_b16 v[196:197], v21 offset:4096
ds_read_b64_tr_b16 v[198:199], v21 offset:4352
ds_read_b64_tr_b16 v[204:205], v21 offset:4128
ds_read_b64_tr_b16 v[206:207], v21 offset:4384
ds_read_b64_tr_b16 v[212:213], v21 offset:4160
ds_read_b64_tr_b16 v[214:215], v21 offset:4416
ds_read_b64_tr_b16 v[220:221], v21 offset:4192
ds_read_b64_tr_b16 v[222:223], v21 offset:4448
s_waitcnt lgkmcnt(0)
s_waitcnt vmcnt(4)
ds_read_b64_tr_b16 v[224:225], v21 offset:8192
ds_read_b64_tr_b16 v[226:227], v21 offset:8448
ds_read_b64_tr_b16 v[232:233], v21 offset:8224
ds_read_b64_tr_b16 v[234:235], v21 offset:8480
ds_read_b64_tr_b16 v[240:241], v21 offset:8256
ds_read_b64_tr_b16 v[242:243], v21 offset:8512
ds_read_b64_tr_b16 v[248:249], v21 offset:8288
ds_read_b64_tr_b16 v[250:251], v21 offset:8544
s_waitcnt lgkmcnt(0)
s_waitcnt vmcnt(0)
ds_read_b64_tr_b16 v[228:229], v21 offset:12288
ds_read_b64_tr_b16 v[230:231], v21 offset:12544
ds_read_b64_tr_b16 v[236:237], v21 offset:12320
ds_read_b64_tr_b16 v[238:239], v21 offset:12576
ds_read_b64_tr_b16 v[244:245], v21 offset:12352
ds_read_b64_tr_b16 v[246:247], v21 offset:12608
ds_read_b64_tr_b16 v[252:253], v21 offset:12384
ds_read_b64_tr_b16 v[254:255], v21 offset:12640
s_waitcnt lgkmcnt(0)
s_waitcnt lgkmcnt(0)
s_cmp_lg_u32 s48, 0
s_cbranch_scc1 Lldd_199
s_mov_b32 s60, 12
v_mov_b32 v2, s60
v_mov_b32 v1, 0x40000000
v_cmp_gt_u32 vcc, 1, v0
s_nop 1
v_cndmask_b32 v2, v1, v2, vcc
v_mov_b32 v3, 1
buffer_atomic_add v3, v2, s[20:23], 0 offen sc1
Lldd_199:
s_lshl_b32 s75, s48, 12
s_lshl_b32 s79, s48, 11
s_add_u32 s60, s75, 98304
v_add_u32 v7, s60, v6
v_lshrrev_b32 v2, 4, v0
v_lshlrev_b32 v1, 10, v2
v_and_b32 v3, 1, v2
v_lshlrev_b32 v3, 5, v3
v_add_u32 v1, v1, v3
v_lshrrev_b32 v3, 1, v2
v_lshlrev_b32 v3, 7, v3
v_add_u32 v1, v1, v3
v_and_b32 v2, 15, v0
v_lshlrev_b32 v2, 3, v2
s_and_b32 s60, s48, 1
s_lshl_b32 s60, s60, 9
s_and_b32 s61, s48, 2
s_xor_b32 s61, s61, 2
s_lshl_b32 s61, s61, 1
s_add_u32 s60, s60, s61
s_add_u32 s60, s60, 147456
v_add3_u32 v9, v1, v2, s60
v_and_b32 v2, 3, v0
v_lshlrev_b32 v1, 10, v2
v_and_b32 v3, 1, v2
v_lshlrev_b32 v3, 5, v3
v_add_u32 v1, v1, v3
v_lshrrev_b32 v3, 1, v2
v_lshlrev_b32 v3, 7, v3
v_add_u32 v1, v1, v3
v_lshrrev_b32 v2, 4, v0
v_lshlrev_b32 v2, 6, v2
v_add_u32 v1, v1, v2
v_bfe_u32 v2, v0, 2, 2
v_lshlrev_b32 v2, 3, v2
v_add_u32 v1, v1, v2
v_add_u32 v10, 147456, v1
s_lshl_b32 s72, s49, 1
s_lshr_b32 s60, s48, 1
s_add_u32 s72, s72, s60
s_lshl_b32 s72, s72, 10
s_and_b32 s60, s48, 1
s_lshl_b32 s60, s60, 3
s_add_u32 s72, s72, s60
s_add_u32 s72, s72, 0x30000
s_lshl_b32 s77, s70, 11
s_add_u32 s77, s77, 0x3400000
s_lshr_b32 s78, s70, 2
s_lshr_b32 s60, s78, 1
s_lshl_b32 s60, s60, 14
s_and_b32 s78, s78, 1
s_lshl_b32 s78, s78, 12
s_add_u32 s78, s78, s60
s_add_u32 s78, s78, 0x7400000
s_lshl_b32 s60, s48, 9
s_add_u32 s78, s78, s60
v_and_b32 v1, 1, v0
v_lshlrev_b32 v1, 6, v1
s_lshr_b32 s60, s70, 1
s_add_u32 s60, s60, 64
v_add_u32 v1, s60, v1
v_mul_u32_u24 v1, 683, v1
v_lshrrev_b32 v1, 11, v1
v_mul_u32_u24 v1, 256, v1
v_add_u32 v14, 4096, v1
v_and_b32 v1, 0xffffe000, v14
v_add_u32 v14, v1, v14
v_bfe_u32 v1, v0, 1, 1
v_lshlrev_b32 v1, 8, v1
v_lshrrev_b32 v2, 2, v0
v_lshlrev_b32 v2, 4, v2
v_add_u32 v1, v1, v2
v_and_b32 v2, 1, v0
v_lshlrev_b32 v2, 3, v2
v_add_u32 v2, v1, v2
v_add_u32 v2, s79, v2
s_mov_b32 s34, 0x3e0293ee
s_mov_b32 s35, s34
s_lshl_b32 s74, s48, 8
v_mov_b32 v56, 0
s_cmp_lg_u32 s100, 0
s_cbranch_scc1 Lws1_201
s_branch Lwsw1_204
Lws_200:
v_mov_b32 v56, 0
buffer_load_dwordx4 v[48:51], v56, s[20:23], 0 offen offset:128 sc1
buffer_load_dwordx4 v[52:55], v56, s[20:23], 0 offen offset:144 sc1
buffer_load_dword v58, v56, s[20:23], 0 offen offset:160 sc1
Lwsw1_204:
s_waitcnt vmcnt(0)
v_readfirstlane_b32 s97, v58
v_add3_u32 v57, v48, v49, v50
v_add3_u32 v57, v57, v51, v52
v_add3_u32 v57, v57, v53, v54
v_add_u32 v57, v57, v55
v_cmp_le_u32 vcc, 0x100, v57
s_nop 0
s_cmp_eq_u64 vcc, -1
s_cbranch_scc0 Lrt_205
v_or3_b32 v57, v48, v49, v50
v_or3_b32 v57, v57, v51, v52
v_or3_b32 v57, v57, v53, v54
v_or_b32 v57, v57, v55
v_cmp_eq_u32 vcc, 256, v57
s_nop 0
s_cmp_eq_u64 vcc, -1
s_cbranch_scc1 Lws2_202
s_branch L_restart
Lws1_201:
buffer_load_dword v48, v56, s[20:23], 0 offen sc1
s_waitcnt vmcnt(0)
v_cmp_le_u32 vcc, 0x100, v48
s_nop 0
s_cmp_eq_u64 vcc, -1
s_cbranch_scc0 Lrt_206
Lws2_202:
s_add_u32 s64, s100, 1
s_mov_b32 s98, 64
s_mov_b32 s99, 0xfffffff3
s_barrier
s_mov_b32 s62, 0
s_cmp_lg_u32 s100, 0
s_cbranch_scc1 Lnear2_208
s_cmp_lg_u32 s97, 0
s_cbranch_scc1 Lnear3_209
v_mov_b32 v1, 160
Lnear_207:
buffer_load_dword v1, v1, s[20:23], 0 offen sc1
s_waitcnt vmcnt(0)
v_readfirstlane_b32 s97, v1
v_mov_b32 v1, 160
s_cmp_eq_u32 s97, 0
s_cbranch_scc1 Lrt_210
Lnear3_209:
s_and_b32 s62, s97, 2
s_lshl_b32 s62, s62, 12
Lnear2_208:
s_xor_b32 s63, s62, 0x2000
v_add_u32 v15, s62, v15
v_add_u32 v14, s62, v14
s_mov_b32 s62, 0
s_cmp_lg_u32 s100, 0
s_cbranch_scc1 Lnear2_212
s_cmp_lg_u32 s97, 0
s_cbranch_scc1 Lnear3_213
v_mov_b32 v1, 160
Lnear_211:
buffer_load_dword v1, v1, s[20:23], 0 offen sc1
s_waitcnt vmcnt(0)
v_readfirstlane_b32 s97, v1
v_mov_b32 v1, 160
s_cmp_eq_u32 s97, 0
s_cbranch_scc1 Lrt_214
Lnear3_213:
s_and_b32 s62, s97, 2
s_lshl_b32 s62, s62, 12
Lnear2_212:
s_add_u32 s78, s78, s62
s_mov_b32 s52, 0
s_mov_b32 s73, 131072
s_and_b32 s58, s52, 64
s_lshl_b32 s58, s58, 12
s_cmp_lt_u32 s52, 128
s_cselect_b32 s57, s52, 0
Lspin_215:
buffer_load_dword v4, v14, s[4:7], s58 offen sc1
s_waitcnt vmcnt(0)
v_cmp_lt_u32 vcc, s57, v4
s_nop 0
s_cmp_eq_u64 vcc, -1
s_cbranch_scc0 Lrt_216
s_lshl_b32 s29, s52, 18
s_add_u32 s29, s29, s77
s_cmp_lt_u32 s52, 128
s_cselect_b32 s29, s29, 0x40000000
s_add_u32 s30, s29, 0x2000000
s_sub_u32 s31, 245760, s73
s_add_u32 s31, s31, s79
s_mov_b32 m0, s31
s_nop 0
buffer_load_dwordx4 v6, s[4:7], s29 offen sc1 lds
buffer_load_dwordx4 v6, s[4:7], s29 offen offset:1024 sc1 lds
s_add_u32 m0, s31, 8192
s_nop 0
buffer_load_dwordx4 v6, s[4:7], s30 offen sc1 lds
buffer_load_dwordx4 v6, s[4:7], s30 offen offset:1024 sc1 lds
s_mov_b32 s73, 114688
s_add_u32 s60, s52, 1
s_add_u32 s99, s99, 1
s_cmp_lt_u32 s99, 103
s_cselect_b32 s53, s98, s60
s_cselect_b32 s98, s60, s98
s_mov_b32 s59, 0x40000000
s_mov_b32 s38, 0x40000000
s_mov_b32 s28, 0x40000000
s_mov_b32 s76, 0
ds_read_b128 v[60:63], v8 offset:0
ds_read_b128 v[64:67], v8 offset:1024
ds_read_b128 v[68:71], v8 offset:2048
ds_read_b128 v[72:75], v8 offset:3072
v_mov_b32 v16, 0
v_mov_b32 v17, 0
v_mov_b32 v18, 0
v_mov_b32 v19, 0
v_mov_b32 v20, 0
v_mov_b32 v21, 0
v_mov_b32 v22, 0
v_mov_b32 v23, 0
v_mov_b32 v24, 0
v_mov_b32 v25, 0
v_mov_b32 v26, 0
v_mov_b32 v27, 0
v_mov_b32 v28, 0
v_mov_b32 v29, 0
v_mov_b32 v30, 0
v_mov_b32 v31, 0
s_cmp_lt_u32 s52, 64
s_cselect_b32 s32, 0, 0xa0000
s_add_u32 s32, s32, s66
s_and_b32 s26, s52, 3
s_lshl_b32 s26, s26, 15
s_xor_b32 s27, s26, 0x10000
s_add_u32 s27, s27, s32
s_add_u32 s26, s26, s32
s_add_u32 s25, s26, s72
s_add_u32 s26, s26, s71
s_add_u32 s27, s27, s71
s_and_b32 s28, s52, 8
s_lshl_b32 s28, s28, 10
s_xor_b32 s28, s28, s78
s_lshl_b32 s61, s52, 18
s_add_u32 s28, s28, s61
s_lshl_b32 s29, s53, 18
s_add_u32 s29, s29, s77
s_cmp_lt_u32 s53, 128
s_cselect_b32 s29, s29, 0x40000000
s_add_u32 s30, s29, 0x2000000
s_sub_u32 s31, 245760, s73
s_add_u32 s31, s31, s79
s_and_b32 s58, s53, 64
s_lshl_b32 s58, s58, 12
s_cmp_lt_u32 s53, 128
s_cselect_b32 s57, s53, 0
s_add_u32 s60, s53, 1
s_add_u32 s99, s99, 1
s_cmp_lt_u32 s99, 103
s_cselect_b32 s69, s98, s60
s_cselect_b32 s98, s60, s98
s_and_b32 s37, s69, 64
s_lshl_b32 s37, s37, 12
s_cmp_lt_u32 s53, 64
s_cselect_b32 s32, 0, 0xa0000
s_add_u32 s32, s32, s66
s_and_b32 s36, s53, 3
s_lshl_b32 s36, s36, 14
s_add_u32 s36, s36, s32
s_add_u32 s36, s36, s75
v_add_u32 v1, s73, v6
buffer_load_dword v4, v14, s[4:7], s58 offen sc1
s_add_u32 s24, s66, s75
s_mov_b32 s39, 0
s_mov_b32 s10, 0
s_cmp_lg_u32 s64, 1
s_cbranch_scc1 LQK_poll_s
.p2align 6
LQK_poll_f:
buffer_load_dwordx4 v[32:35], v6, s[4:7], s24 offen offset:0 sc1
buffer_load_dwordx4 v[36:39], v6, s[4:7], s24 offen offset:1024 sc1
buffer_load_dwordx4 v[40:43], v6, s[4:7], s24 offen offset:2048 sc1
buffer_load_dwordx4 v[44:47], v6, s[4:7], s24 offen offset:3072 sc1
s_add_u32 s96, s96, 1
s_cmp_ge_u32 s96, 1048576
s_cbranch_scc1 Lto_217
s_waitcnt vmcnt(3)
v_max3_u32 v0, v32, v33, v34
v_max_u32 v0, v0, v35
s_waitcnt vmcnt(2)
v_max3_u32 v0, v0, v36, v37
v_max3_u32 v0, v0, v38, v39
s_waitcnt vmcnt(1)
v_max3_u32 v0, v0, v40, v41
v_max3_u32 v0, v0, v42, v43
s_waitcnt vmcnt(0)
v_max3_u32 v0, v0, v44, v45
v_max3_u32 v0, v0, v46, v47
v_cmp_eq_u32 vcc, -1, v0
s_nop 0
s_cbranch_vccnz LQK_poll_f
LQK_go_f:
v_smfmac_f32_16x16x64_bf16 v[16:19], v[32:35], a[0:7], v5
ds_write_b128 v7, v[32:35] offset:0
v_smfmac_f32_16x16x64_bf16 v[24:27], v[32:35], a[16:23], v5
s_cmp_eq_u32 s10, 0
s_cbranch_scc1 Lkve_220
Lkvec_221:
ds_write_b128 v7, v[36:39] offset:1024
v_smfmac_f32_16x16x64_bf16 v[20:23], v[32:35], a[8:15], v5
s_mov_b32 m0, s31
ds_write_b128 v7, v[40:43] offset:2048
v_smfmac_f32_16x16x64_bf16 v[28:31], v[32:35], a[24:31], v5
ds_write_b128 v7, v[44:47] offset:3072
v_smfmac_f32_16x16x64_bf16 v[16:19], v[36:39], a[32:39], v5
v_smfmac_f32_16x16x64_bf16 v[24:27], v[36:39], a[48:55], v5
v_xor_b32 v0, 4096, v7
v_smfmac_f32_16x16x64_bf16 v[20:23], v[36:39], a[40:47], v5
s_waitcnt lgkmcnt(0)
v_smfmac_f32_16x16x64_bf16 v[28:31], v[36:39], v[60:67], v5
s_barrier
ds_read_b128 v[52:55], v0 offset:0
v_smfmac_f32_16x16x64_bf16 v[16:19], v[40:43], a[56:63], v5
ds_read_b128 v[60:63], v8 offset:4096
v_smfmac_f32_16x16x64_bf16 v[24:27], v[40:43], a[72:79], v5
ds_read_b128 v[64:67], v8 offset:5120
v_smfmac_f32_16x16x64_bf16 v[20:23], v[40:43], a[64:71], v5
ds_read_b128 v[56:59], v0 offset:1024
v_smfmac_f32_16x16x64_bf16 v[28:31], v[40:43], v[68:75], v5
ds_read_b128 v[48:51], v0 offset:2048
v_smfmac_f32_16x16x64_bf16 v[16:19], v[44:47], a[80:87], v5
ds_read_b128 v[68:71], v8 offset:6144
v_smfmac_f32_16x16x64_bf16 v[24:27], v[44:47], a[96:103], v5
ds_read_b128 v[72:75], v8 offset:7168
v_smfmac_f32_16x16x64_bf16 v[20:23], v[44:47], a[88:95], v5
s_waitcnt lgkmcnt(4)
buffer_store_dword v81, v15, s[4:7], s59 offen sc1
v_smfmac_f32_16x16x64_bf16 v[28:31], v[44:47], v[60:67], v5
buffer_load_dwordx4 v6, s[8:11], s29 offen sc1 lds
v_smfmac_f32_16x16x64_bf16 v[16:19], v[52:55], a[104:111], v5
ds_read_b128 v[60:63], v8 offset:8192
v_smfmac_f32_16x16x64_bf16 v[24:27], v[52:55], a[120:127], v5
ds_read_b128 v[64:67], v8 offset:9216
v_smfmac_f32_16x16x64_bf16 v[20:23], v[52:55], a[112:119], v5
s_waitcnt lgkmcnt(2)
buffer_load_dwordx4 v6, s[8:11], s29 offen offset:1024 sc1 lds
v_smfmac_f32_16x16x64_bf16 v[28:31], v[52:55], v[68:75], v5
s_add_u32 m0, s31, 8192
ds_read_b128 v[52:55], v0 offset:3072
v_smfmac_f32_16x16x64_bf16 v[16:19], v[56:59], a[128:135], v5
ds_read_b128 v[68:71], v8 offset:10240
v_smfmac_f32_16x16x64_bf16 v[24:27], v[56:59], a[144:151], v5
ds_read_b128 v[72:75], v8 offset:11264
v_smfmac_f32_16x16x64_bf16 v[20:23], v[56:59], a[136:143], v5
s_waitcnt lgkmcnt(3)
v_xor_b32 v0, 8192, v7
v_smfmac_f32_16x16x64_bf16 v[28:31], v[56:59], v[60:67], v5
ds_read_b128 v[56:59], v0 offset:0
v_smfmac_f32_16x16x64_bf16 v[16:19], v[48:51], a[152:159], v5
ds_read_b128 v[60:63], v8 offset:12288
v_smfmac_f32_16x16x64_bf16 v[24:27], v[48:51], a[168:175], v5
ds_read_b128 v[64:67], v8 offset:13312
v_smfmac_f32_16x16x64_bf16 v[20:23], v[48:51], a[160:167], v5
s_waitcnt lgkmcnt(3)
buffer_load_dwordx4 v6, s[8:11], s30 offen sc1 lds
v_smfmac_f32_16x16x64_bf16 v[28:31], v[48:51], v[68:75], v5
ds_read_b128 v[48:51], v0 offset:1024
v_smfmac_f32_16x16x64_bf16 v[16:19], v[52:55], a[176:183], v5
ds_read_b128 v[68:71], v8 offset:14336
v_smfmac_f32_16x16x64_bf16 v[24:27], v[52:55], a[192:199], v5
ds_read_b128 v[72:75], v8 offset:15360
v_smfmac_f32_16x16x64_bf16 v[20:23], v[52:55], a[184:191], v5
s_waitcnt lgkmcnt(3)
buffer_load_dwordx4 v6, s[8:11], s30 offen offset:1024 sc1 lds
v_smfmac_f32_16x16x64_bf16 v[28:31], v[52:55], v[60:67], v5
ds_read_b128 v[52:55], v0 offset:2048
v_smfmac_f32_16x16x64_bf16 v[16:19], v[56:59], a[200:207], v5
ds_read_b128 v[60:63], v8 offset:16384
v_smfmac_f32_16x16x64_bf16 v[24:27], v[56:59], a[216:223], v5
ds_read_b128 v[64:67], v8 offset:17408
v_smfmac_f32_16x16x64_bf16 v[20:23], v[56:59], a[208:215], v5
s_waitcnt lgkmcnt(3)
buffer_load_dword v4, v14, s[4:7], s37 offen sc1
v_smfmac_f32_16x16x64_bf16 v[28:31], v[56:59], v[68:75], v5
ds_read_b128 v[56:59], v0 offset:3072
v_smfmac_f32_16x16x64_bf16 v[16:19], v[48:51], a[224:231], v5
ds_read_b128 v[68:71], v8 offset:18432
v_smfmac_f32_16x16x64_bf16 v[24:27], v[48:51], a[240:247], v5
ds_read_b128 v[72:75], v8 offset:19456
v_smfmac_f32_16x16x64_bf16 v[20:23], v[48:51], a[232:239], v5
s_waitcnt lgkmcnt(3)
v_xor_b32 v0, 12288, v7
v_smfmac_f32_16x16x64_bf16 v[28:31], v[48:51], v[60:67], v5
ds_read_b128 v[48:51], v0 offset:0
v_smfmac_f32_16x16x64_bf16 v[16:19], v[52:55], a[248:255], v5
ds_read_b128 v[60:63], v8 offset:20480
v_smfmac_f32_16x16x64_bf16 v[24:27], v[52:55], v[104:111], v5
ds_read_b128 v[64:67], v8 offset:21504
v_smfmac_f32_16x16x64_bf16 v[20:23], v[52:55], v[96:103], v5
s_waitcnt lgkmcnt(3)
ds_read_b128 v[32:35], v1 offset:0
v_smfmac_f32_16x16x64_bf16 v[28:31], v[52:55], v[68:75], v5
ds_read_b128 v[52:55], v0 offset:1024
v_smfmac_f32_16x16x64_bf16 v[16:19], v[56:59], v[112:119], v5
ds_read_b128 v[68:71], v8 offset:22528
v_smfmac_f32_16x16x64_bf16 v[24:27], v[56:59], v[128:135], v5
ds_read_b128 v[72:75], v8 offset:23552
v_smfmac_f32_16x16x64_bf16 v[20:23], v[56:59], v[120:127], v5
s_waitcnt lgkmcnt(4)
ds_read_b128 v[36:39], v1 offset:1024
v_smfmac_f32_16x16x64_bf16 v[28:31], v[56:59], v[60:67], v5
ds_read_b128 v[56:59], v0 offset:2048
v_smfmac_f32_16x16x64_bf16 v[16:19], v[48:51], v[136:143], v5
ds_read_b128 v[40:43], v1 offset:2048
v_smfmac_f32_16x16x64_bf16 v[24:27], v[48:51], v[152:159], v5
ds_read_b128 v[44:47], v1 offset:3072
v_smfmac_f32_16x16x64_bf16 v[20:23], v[48:51], v[144:151], v5
s_waitcnt lgkmcnt(4)
ds_read_b128 v[76:79], v1 offset:4096
v_smfmac_f32_16x16x64_bf16 v[28:31], v[48:51], v[68:75], v5
ds_read_b128 v[48:51], v0 offset:3072
v_smfmac_f32_16x16x64_bf16 v[16:19], v[52:55], v[160:167], v5
ds_read_b128 v[80:83], v1 offset:5120
v_smfmac_f32_16x16x64_bf16 v[24:27], v[52:55], v[176:183], v5
s_waitcnt lgkmcnt(5)
ds_read_b128 v[84:87], v1 offset:6144
v_smfmac_f32_16x16x64_bf16 v[16:19], v[56:59], v[192:199], v5
ds_read_b128 v[88:91], v1 offset:7168
v_smfmac_f32_16x16x64_bf16 v[24:27], v[56:59], v[208:215], v5
s_waitcnt lgkmcnt(3)
v_add_u32 v1, s73, v2
v_smfmac_f32_16x16x64_bf16 v[16:19], v[48:51], v[224:231], v5
v_smfmac_f32_16x16x64_bf16 v[24:27], v[48:51], v[240:247], v5
s_nop 0
v_smfmac_f32_16x16x64_bf16 v[20:23], v[52:55], v[168:175], v5
s_nop 0
v_smfmac_f32_16x16x64_bf16 v[28:31], v[52:55], v[184:191], v5
s_nop 0
v_smfmac_f32_16x16x64_bf16 v[20:23], v[56:59], v[200:207], v5
s_nop 0
v_add_f32 v16, v16, v18
v_smfmac_f32_16x16x64_bf16 v[28:31], v[56:59], v[216:223], v5
v_add_f32 v17, v17, v19
v_smfmac_f32_16x16x64_bf16 v[20:23], v[48:51], v[232:239], v5
v_add_f32 v24, v24, v26
v_smfmac_f32_16x16x64_bf16 v[28:31], v[48:51], v[248:255], v5
v_add_f32 v25, v25, v27
v_cvt_pk_bf16_f32 v16, v16, v17
v_cvt_pk_bf16_f32 v24, v24, v25
ds_write2_b32 v9, v16, v24 offset0:0 offset1:64
s_nop 1
v_pk_add_f32 v[20:21], v[20:21], v[22:23]
s_nop 0
v_pk_add_f32 v[28:29], v[28:29], v[30:31]
v_cvt_pk_bf16_f32 v20, v20, v21
v_cvt_pk_bf16_f32 v28, v28, v29
ds_write2_b32 v9, v20, v28 offset0:32 offset1:96
s_waitcnt lgkmcnt(0)
s_barrier
ds_read_b64_tr_b16 v[48:49], v10 offset:0
ds_read_b64_tr_b16 v[50:51], v10 offset:32
ds_read_b64_tr_b16 v[52:53], v10 offset:256
ds_read_b64_tr_b16 v[54:55], v10 offset:288
ds_read_b64_tr_b16 v[56:57], v10 offset:512
ds_read_b64_tr_b16 v[58:59], v10 offset:544
ds_read_b64_tr_b16 v[60:61], v10 offset:768
ds_read_b64_tr_b16 v[62:63], v10 offset:800
ds_read_b64_tr_b16 v[16:17], v1 offset:8192
ds_read_b64_tr_b16 v[18:19], v1 offset:9216
ds_read_b64_tr_b16 v[20:21], v1 offset:8704
ds_read_b64_tr_b16 v[22:23], v1 offset:9728
s_waitcnt lgkmcnt(10)
v_mfma_f32_16x16x32_bf16 v[64:67], v[32:35], v[48:51], 0
v_mfma_f32_16x16x32_bf16 v[68:71], v[36:39], v[48:51], 0
v_mfma_f32_16x16x32_bf16 v[72:75], v[48:51], v[48:51], 0
s_waitcnt lgkmcnt(8)
v_mfma_f32_16x16x32_bf16 v[64:67], v[40:43], v[52:55], v[64:67]
v_mfma_f32_16x16x32_bf16 v[68:71], v[44:47], v[52:55], v[68:71]
v_mfma_f32_16x16x32_bf16 v[72:75], v[52:55], v[52:55], v[72:75]
s_waitcnt lgkmcnt(6)
v_mfma_f32_16x16x32_bf16 v[64:67], v[76:79], v[56:59], v[64:67]
v_mfma_f32_16x16x32_bf16 v[68:71], v[80:83], v[56:59], v[68:71]
v_mfma_f32_16x16x32_bf16 v[72:75], v[56:59], v[56:59], v[72:75]
s_waitcnt lgkmcnt(4)
v_mfma_f32_16x16x32_bf16 v[64:67], v[84:87], v[60:63], v[64:67]
v_mfma_f32_16x16x32_bf16 v[68:71], v[88:91], v[60:63], v[68:71]
v_mfma_f32_16x16x32_bf16 v[72:75], v[60:63], v[60:63], v[72:75]
buffer_load_dwordx2 v[92:93], v6, s[4:7], s25 offen sc1
v_add_u32 v1, s74, v10
ds_read_b64_tr_b16 v[76:77], v1 offset:0
ds_read_b64_tr_b16 v[78:79], v1 offset:32
v_mov_b32 v36, 0x3f803f80
v_mov_b32 v37, 0x3f803f80
v_max3_f32 v44, v64, v65, v66
v_max3_f32 v45, v67, v68, v69
v_max3_f32 v46, v70, v71, v72
v_max3_f32 v44, v44, v45, v73
v_max_f32 v45, v44, v46
v_max_f32 v44, v44, v46
v_mov_b32 v38, 0x3f803f80
v_mov_b32 v39, 0x3f803f80
v_permlane16_swap_b32 v44, v45
v_max_f32 v46, v44, v45
v_max_f32 v44, v44, v45
v_mov_b32 v29, 0
v_mov_b32 v30, 0
v_permlane32_swap_b32 v44, v46
s_waitcnt lgkmcnt(0)
buffer_load_dwordx2 v[92:93], v6, s[4:7], s25 offen sc1
buffer_store_dwordx4 v[76:79], v12, s[4:7], s28 offen sc1
v_max_f32 v44, v44, v46
v_mul_f32 v44, s34, v44
v_pk_fma_f32 v[64:65], v[64:65], s[34:35], v[44:45] op_sel_hi:[1,1,0] neg_lo:[0,0,1] neg_hi:[0,0,1]
v_pk_fma_f32 v[66:67], v[66:67], s[34:35], v[44:45] op_sel_hi:[1,1,0] neg_lo:[0,0,1] neg_hi:[0,0,1]
v_pk_fma_f32 v[68:69], v[68:69], s[34:35], v[44:45] op_sel_hi:[1,1,0] neg_lo:[0,0,1] neg_hi:[0,0,1]
v_pk_fma_f32 v[70:71], v[70:71], s[34:35], v[44:45] op_sel_hi:[1,1,0] neg_lo:[0,0,1] neg_hi:[0,0,1]
v_pk_fma_f32 v[72:73], v[72:73], s[34:35], v[44:45] op_sel_hi:[1,1,0] neg_lo:[0,0,1] neg_hi:[0,0,1]
v_exp_f32 v64, v64
v_exp_f32 v65, v65
v_exp_f32 v66, v66
v_cvt_pk_bf16_f32 v24, v64, v65
v_exp_f32 v67, v67
v_exp_f32 v68, v68
v_cvt_pk_bf16_f32 v25, v66, v67
v_exp_f32 v69, v69
v_exp_f32 v70, v70
v_cvt_pk_bf16_f32 v26, v68, v69
v_exp_f32 v71, v71
v_exp_f32 v72, v72
v_cvt_pk_bf16_f32 v27, v70, v71
v_exp_f32 v73, v73
s_nop 0
v_mfma_f32_16x16x32_bf16 v[40:43], v[36:39], v[24:27], 0
v_cvt_pk_bf16_f32 v28, v72, v73
v_cvt_pk_bf16_f32 v31, v72, v73
v_mfma_f32_16x16x32_bf16 v[48:51], v[16:19], v[24:27], 0
s_waitcnt vmcnt(2)
v_max_u32 v0, v92, v93
v_cmp_eq_u32 vcc, -1, v0
v_mfma_f32_16x16x32_bf16 v[52:55], v[20:23], v[24:27], 0
v_mfma_f32_16x16x16_bf16 v[40:43], v[36:37], v[28:29], v[40:43]
s_cbranch_vccnz Lvmr_228
Lvm_227:
v_mfma_f32_16x16x16_bf16 v[48:51], v[92:93], v[28:29], v[48:51]
s_nop 0
v_mov_b32 v60, -1
v_mov_b32 v61, -1
v_mfma_f32_16x16x16_bf16 v[52:55], v[92:93], v[30:31], v[52:55]
v_mov_b32 v62, -1
v_mov_b32 v63, -1
v_rcp_f32 v44, v40
s_nop 0
v_pk_mul_f32 v[48:49], v[48:49], v[44:45] op_sel_hi:[1,0]
v_pk_mul_f32 v[50:51], v[50:51], v[44:45] op_sel_hi:[1,0]
s_nop 1
v_pk_mul_f32 v[52:53], v[52:53], v[44:45] op_sel_hi:[1,0]
v_pk_mul_f32 v[54:55], v[54:55], v[44:45] op_sel_hi:[1,0]
v_cvt_pk_bf16_f32 v56, v48, v49
v_cvt_pk_bf16_f32 v57, v50, v51
v_cvt_pk_bf16_f32 v58, v52, v53
v_cvt_pk_bf16_f32 v59, v54, v55
buffer_store_dwordx4 v[56:59], v11, s[4:7], s26 offen
s_mov_b32 s24, s36
buffer_load_dwordx4 v[32:35], v6, s[4:7], s24 offen offset:0 sc1
buffer_load_dwordx4 v[36:39], v6, s[4:7], s24 offen offset:1024 sc1
buffer_load_dwordx4 v[40:43], v6, s[4:7], s24 offen offset:2048 sc1
buffer_load_dwordx4 v[44:47], v6, s[4:7], s24 offen offset:3072 sc1
buffer_store_dwordx4 v[60:63], v11, s[4:7], s27 offen
s_nop 1
ds_read_b128 v[60:63], v8 offset:0
ds_read_b128 v[64:67], v8 offset:1024
ds_read_b128 v[68:71], v8 offset:2048
ds_read_b128 v[72:75], v8 offset:3072
v_mov_b32 v81, s76
s_mov_b32 s59, s38
s_add_u32 s76, s52, 1
s_and_b32 s38, s52, 64
s_lshl_b32 s38, s38, 12
s_and_b32 s28, s52, 8
s_lshl_b32 s28, s28, 10
s_xor_b32 s28, s28, s78
s_lshl_b32 s61, s52, 18
s_add_u32 s28, s28, s61
v_mov_b32 v81, s76
s_mov_b32 s59, s38
s_mov_b32 s39, s10
s_cmp_eq_u32 s10, 0
s_cbranch_scc1 Lkvs_218
Lkvc_219:
s_sub_u32 s73, 245760, s73
s_mov_b32 s52, s53
s_mov_b32 s53, s69
s_cmp_lt_u32 s52, 64
s_cselect_b32 s32, 0, 0xa0000
s_add_u32 s32, s32, s66
s_and_b32 s26, s52, 3
s_lshl_b32 s26, s26, 15
s_xor_b32 s27, s26, 0x10000
s_add_u32 s27, s27, s32
s_add_u32 s26, s26, s32
s_add_u32 s25, s26, s72
s_add_u32 s26, s26, s71
s_add_u32 s27, s27, s71
s_and_b32 s28, s52, 8
s_lshl_b32 s28, s28, 10
s_xor_b32 s28, s28, s78
s_lshl_b32 s61, s52, 18
s_add_u32 s28, s28, s61
s_lshl_b32 s29, s53, 18
s_add_u32 s29, s29, s77
s_cmp_lt_u32 s53, 128
s_cselect_b32 s29, s29, 0x40000000
s_add_u32 s30, s29, 0x2000000
s_sub_u32 s31, 245760, s73
s_add_u32 s31, s31, s79
s_and_b32 s58, s53, 64
s_lshl_b32 s58, s58, 12
s_cmp_lt_u32 s53, 128
s_cselect_b32 s57, s53, 0
s_add_u32 s60, s53, 1
s_add_u32 s99, s99, 1
s_cmp_lt_u32 s99, 103
s_cselect_b32 s69, s98, s60
s_cselect_b32 s98, s60, s98
s_and_b32 s37, s69, 64
s_lshl_b32 s37, s37, 12
s_cmp_lt_u32 s53, 64
s_cselect_b32 s32, 0, 0xa0000
s_add_u32 s32, s32, s66
s_and_b32 s36, s53, 3
s_lshl_b32 s36, s36, 14
s_add_u32 s36, s36, s32
s_add_u32 s36, s36, s75
v_add_u32 v1, s73, v6
v_mov_b32 v16, 0
v_mov_b32 v17, 0
v_mov_b32 v18, 0
v_mov_b32 v19, 0
v_mov_b32 v20, 0
v_mov_b32 v21, 0
v_mov_b32 v22, 0
v_mov_b32 v23, 0
v_mov_b32 v24, 0
v_mov_b32 v25, 0
v_mov_b32 v26, 0
v_mov_b32 v27, 0
v_mov_b32 v28, 0
v_mov_b32 v29, 0
v_mov_b32 v30, 0
v_mov_b32 v31, 0
v_cmp_lt_u32 vcc, s57, v4
s_nop 0
s_cmp_eq_u64 vcc, -1
s_cselect_b32 s10, 0x10000000, 0
s_cmp_eq_u32 s76, s52
s_cbranch_scc1 Lqkn_231
s_cmp_eq_u32 s39, 0
s_cbranch_scc1 LQK_poll_f
s_waitcnt vmcnt(4)
v_max3_u32 v0, v32, v33, v34
v_max_u32 v0, v0, v35
s_waitcnt vmcnt(3)
v_max3_u32 v0, v0, v36, v37
v_max3_u32 v0, v0, v38, v39
s_waitcnt vmcnt(2)
v_max3_u32 v0, v0, v40, v41
v_max3_u32 v0, v0, v42, v43
s_waitcnt vmcnt(1)
v_max3_u32 v0, v0, v44, v45
v_max3_u32 v0, v0, v46, v47
v_cmp_eq_u32 vcc, -1, v0
s_nop 0
s_cbranch_vccz LQK_go_f
s_branch LQK_poll_f
Lqkn_231:
s_waitcnt vmcnt(0)
buffer_store_dword v81, v15, s[4:7], s59 offen sc1
s_cmp_lt_u32 s52, 128
s_cbranch_scc1 LQK_poll_f
s_waitcnt vmcnt(0)
s_endpgm
Lrt_205:
s_add_u32 s96, s96, 1
s_cmp_lt_u32 s96, 1048576
s_cbranch_scc1 Lws_200
s_mov_b32 s97, 1
s_branch L_fail
Lrt_206:
s_add_u32 s96, s96, 1
s_cmp_lt_u32 s96, 1048576
s_cbranch_scc1 Lws1_201
s_mov_b32 s97, 1
s_branch L_fail
Lrt_210:
s_add_u32 s96, s96, 1
s_cmp_lt_u32 s96, 1048576
s_cbranch_scc1 Lnear_207
s_mov_b32 s97, 24
s_branch L_fail
Lrt_214:
s_add_u32 s96, s96, 1
s_cmp_lt_u32 s96, 1048576
s_cbranch_scc1 Lnear_211
s_mov_b32 s97, 24
s_branch L_fail
Lrt_216:
s_add_u32 s96, s96, 1
s_cmp_lt_u32 s96, 1048576
s_cbranch_scc1 Lspin_215
s_mov_b32 s97, 11
s_branch L_fail
Lto_217:
s_mov_b32 s97, 12
s_branch L_fail
Lrt_223:
s_add_u32 s96, s96, 1
s_cmp_lt_u32 s96, 1048576
s_cbranch_scc1 Lkvel_222
s_mov_b32 s97, 13
s_branch L_fail
Lkve_220:
s_add_u32 s60, s52, 1
s_cmp_eq_u32 s60, s53
s_cbranch_scc1 Lkvec_221
Lkvel_222:
buffer_load_dword v4, v14, s[4:7], s58 offen sc1
s_waitcnt vmcnt(0)
v_cmp_lt_u32 vcc, s57, v4
s_nop 0
s_cmp_eq_u64 vcc, -1
s_cbranch_scc0 Lrt_223
s_mov_b32 s10, 0x10000000
s_branch Lkvec_221
Lrt_226:
s_add_u32 s96, s96, 1
s_cmp_lt_u32 s96, 1048576
s_cbranch_scc1 Lkvs2_224
s_mov_b32 s97, 13
s_branch L_fail
Lkvs_218:
buffer_load_dword v0, v14, s[4:7], s58 offen sc1
s_waitcnt vmcnt(0)
v_cmp_lt_u32 vcc, s57, v0
s_nop 0
s_cmp_eq_u64 vcc, -1
s_cbranch_scc1 Lkvs3_225
buffer_store_dword v81, v15, s[4:7], s59 offen sc1
Lkvs2_224:
buffer_load_dword v0, v14, s[4:7], s58 offen sc1
s_waitcnt vmcnt(0)
v_cmp_lt_u32 vcc, s57, v0
s_nop 0
s_cmp_eq_u64 vcc, -1
s_cbranch_scc0 Lrt_226
Lkvs3_225:
s_mov_b32 m0, s31
s_nop 0
buffer_load_dwordx4 v6, s[4:7], s29 offen sc1 lds
buffer_load_dwordx4 v6, s[4:7], s29 offen offset:1024 sc1 lds
s_add_u32 m0, s31, 8192
s_nop 0
buffer_load_dwordx4 v6, s[4:7], s30 offen sc1 lds
buffer_load_dwordx4 v6, s[4:7], s30 offen offset:1024 sc1 lds
s_branch Lkvc_219
Lto_230:
s_mov_b32 s97, 14
s_branch L_fail
Lvmr_228:
s_waitcnt vmcnt(1)
v_max_u32 v0, v92, v93
v_cmp_eq_u32 vcc, -1, v0
s_nop 0
s_cbranch_vccz Lvm_227
Lvmr2_229:
buffer_load_dwordx2 v[92:93], v6, s[4:7], s25 offen sc1
s_add_u32 s96, s96, 1
s_cmp_ge_u32 s96, 1048576
s_cbranch_scc1 Lto_230
s_waitcnt vmcnt(0)
v_max_u32 v0, v92, v93
v_cmp_eq_u32 vcc, -1, v0
s_nop 0
s_cbranch_vccz Lvm_227
s_branch Lvmr2_229
.p2align 6
LQK_poll_s:
buffer_load_dwordx4 v[32:35], v6, s[4:7], s24 offen offset:0 sc1
buffer_load_dwordx4 v[36:39], v6, s[4:7], s24 offen offset:1024 sc1
buffer_load_dwordx4 v[40:43], v6, s[4:7], s24 offen offset:2048 sc1
buffer_load_dwordx4 v[44:47], v6, s[4:7], s24 offen offset:3072 sc1
s_add_u32 s96, s96, 1
s_cmp_ge_u32 s96, 1048576
s_cbranch_scc1 Lto_232
s_waitcnt vmcnt(3)
v_max3_u32 v0, v32, v33, v34
v_max_u32 v0, v0, v35
s_waitcnt vmcnt(2)
v_max3_u32 v0, v0, v36, v37
v_max3_u32 v0, v0, v38, v39
s_waitcnt vmcnt(1)
v_max3_u32 v0, v0, v40, v41
v_max3_u32 v0, v0, v42, v43
s_waitcnt vmcnt(0)
v_max3_u32 v0, v0, v44, v45
v_max3_u32 v0, v0, v46, v47
v_cmp_eq_u32 vcc, -1, v0
s_nop 0
s_cbranch_vccnz LQK_poll_s
LQK_go_s:
v_smfmac_f32_16x16x64_bf16 v[16:19], v[32:35], a[0:7], v5
ds_write_b128 v7, v[32:35] offset:0
v_smfmac_f32_16x16x64_bf16 v[24:27], v[32:35], a[16:23], v5
s_cmp_eq_u32 s10, 0
s_cbranch_scc1 Lkve_235
Lkvec_236:
ds_write_b128 v7, v[36:39] offset:1024
v_smfmac_f32_16x16x64_bf16 v[20:23], v[32:35], a[8:15], v5
s_mov_b32 m0, s31
ds_write_b128 v7, v[40:43] offset:2048
v_smfmac_f32_16x16x64_bf16 v[28:31], v[32:35], a[24:31], v5
ds_write_b128 v7, v[44:47] offset:3072
v_smfmac_f32_16x16x64_bf16 v[16:19], v[36:39], a[32:39], v5
v_smfmac_f32_16x16x64_bf16 v[24:27], v[36:39], a[48:55], v5
v_xor_b32 v0, 4096, v7
v_smfmac_f32_16x16x64_bf16 v[20:23], v[36:39], a[40:47], v5
s_waitcnt lgkmcnt(0)
v_smfmac_f32_16x16x64_bf16 v[28:31], v[36:39], v[60:67], v5
s_barrier
ds_read_b128 v[52:55], v0 offset:0
v_smfmac_f32_16x16x64_bf16 v[16:19], v[40:43], a[56:63], v5
ds_read_b128 v[60:63], v8 offset:4096
v_smfmac_f32_16x16x64_bf16 v[24:27], v[40:43], a[72:79], v5
ds_read_b128 v[64:67], v8 offset:5120
v_smfmac_f32_16x16x64_bf16 v[20:23], v[40:43], a[64:71], v5
ds_read_b128 v[56:59], v0 offset:1024
v_smfmac_f32_16x16x64_bf16 v[28:31], v[40:43], v[68:75], v5
ds_read_b128 v[48:51], v0 offset:2048
v_smfmac_f32_16x16x64_bf16 v[16:19], v[44:47], a[80:87], v5
ds_read_b128 v[68:71], v8 offset:6144
v_smfmac_f32_16x16x64_bf16 v[24:27], v[44:47], a[96:103], v5
ds_read_b128 v[72:75], v8 offset:7168
v_smfmac_f32_16x16x64_bf16 v[20:23], v[44:47], a[88:95], v5
s_waitcnt lgkmcnt(4)
buffer_store_dword v81, v15, s[4:7], s59 offen sc1
v_smfmac_f32_16x16x64_bf16 v[28:31], v[44:47], v[60:67], v5
buffer_load_dwordx4 v6, s[8:11], s29 offen sc1 lds
v_smfmac_f32_16x16x64_bf16 v[16:19], v[52:55], a[104:111], v5
ds_read_b128 v[60:63], v8 offset:8192
v_smfmac_f32_16x16x64_bf16 v[24:27], v[52:55], a[120:127], v5
ds_read_b128 v[64:67], v8 offset:9216
v_smfmac_f32_16x16x64_bf16 v[20:23], v[52:55], a[112:119], v5
s_waitcnt lgkmcnt(2)
buffer_load_dwordx4 v6, s[8:11], s29 offen offset:1024 sc1 lds
v_smfmac_f32_16x16x64_bf16 v[28:31], v[52:55], v[68:75], v5
s_add_u32 m0, s31, 8192
ds_read_b128 v[52:55], v0 offset:3072
v_smfmac_f32_16x16x64_bf16 v[16:19], v[56:59], a[128:135], v5
ds_read_b128 v[68:71], v8 offset:10240
v_smfmac_f32_16x16x64_bf16 v[24:27], v[56:59], a[144:151], v5
ds_read_b128 v[72:75], v8 offset:11264
v_smfmac_f32_16x16x64_bf16 v[20:23], v[56:59], a[136:143], v5
s_waitcnt lgkmcnt(3)
v_xor_b32 v0, 8192, v7
v_smfmac_f32_16x16x64_bf16 v[28:31], v[56:59], v[60:67], v5
ds_read_b128 v[56:59], v0 offset:0
v_smfmac_f32_16x16x64_bf16 v[16:19], v[48:51], a[152:159], v5
ds_read_b128 v[60:63], v8 offset:12288
v_smfmac_f32_16x16x64_bf16 v[24:27], v[48:51], a[168:175], v5
ds_read_b128 v[64:67], v8 offset:13312
v_smfmac_f32_16x16x64_bf16 v[20:23], v[48:51], a[160:167], v5
s_waitcnt lgkmcnt(3)
buffer_load_dwordx4 v6, s[8:11], s30 offen sc1 lds
v_smfmac_f32_16x16x64_bf16 v[28:31], v[48:51], v[68:75], v5
ds_read_b128 v[48:51], v0 offset:1024
v_smfmac_f32_16x16x64_bf16 v[16:19], v[52:55], a[176:183], v5
ds_read_b128 v[68:71], v8 offset:14336
v_smfmac_f32_16x16x64_bf16 v[24:27], v[52:55], a[192:199], v5
ds_read_b128 v[72:75], v8 offset:15360
v_smfmac_f32_16x16x64_bf16 v[20:23], v[52:55], a[184:191], v5
s_waitcnt lgkmcnt(3)
buffer_load_dwordx4 v6, s[8:11], s30 offen offset:1024 sc1 lds
v_smfmac_f32_16x16x64_bf16 v[28:31], v[52:55], v[60:67], v5
ds_read_b128 v[52:55], v0 offset:2048
v_smfmac_f32_16x16x64_bf16 v[16:19], v[56:59], a[200:207], v5
ds_read_b128 v[60:63], v8 offset:16384
v_smfmac_f32_16x16x64_bf16 v[24:27], v[56:59], a[216:223], v5
ds_read_b128 v[64:67], v8 offset:17408
v_smfmac_f32_16x16x64_bf16 v[20:23], v[56:59], a[208:215], v5
s_waitcnt lgkmcnt(3)
buffer_load_dword v4, v14, s[4:7], s37 offen sc1
v_smfmac_f32_16x16x64_bf16 v[28:31], v[56:59], v[68:75], v5
ds_read_b128 v[56:59], v0 offset:3072
v_smfmac_f32_16x16x64_bf16 v[16:19], v[48:51], a[224:231], v5
ds_read_b128 v[68:71], v8 offset:18432
v_smfmac_f32_16x16x64_bf16 v[24:27], v[48:51], a[240:247], v5
ds_read_b128 v[72:75], v8 offset:19456
v_smfmac_f32_16x16x64_bf16 v[20:23], v[48:51], a[232:239], v5
s_waitcnt lgkmcnt(3)
v_xor_b32 v0, 12288, v7
v_smfmac_f32_16x16x64_bf16 v[28:31], v[48:51], v[60:67], v5
ds_read_b128 v[48:51], v0 offset:0
v_smfmac_f32_16x16x64_bf16 v[16:19], v[52:55], a[248:255], v5
ds_read_b128 v[60:63], v8 offset:20480
v_smfmac_f32_16x16x64_bf16 v[24:27], v[52:55], v[104:111], v5
ds_read_b128 v[64:67], v8 offset:21504
v_smfmac_f32_16x16x64_bf16 v[20:23], v[52:55], v[96:103], v5
s_waitcnt lgkmcnt(3)
ds_read_b128 v[32:35], v1 offset:0
v_smfmac_f32_16x16x64_bf16 v[28:31], v[52:55], v[68:75], v5
ds_read_b128 v[52:55], v0 offset:1024
v_smfmac_f32_16x16x64_bf16 v[16:19], v[56:59], v[112:119], v5
ds_read_b128 v[68:71], v8 offset:22528
v_smfmac_f32_16x16x64_bf16 v[24:27], v[56:59], v[128:135], v5
ds_read_b128 v[72:75], v8 offset:23552
v_smfmac_f32_16x16x64_bf16 v[20:23], v[56:59], v[120:127], v5
s_waitcnt lgkmcnt(4)
ds_read_b128 v[36:39], v1 offset:1024
v_smfmac_f32_16x16x64_bf16 v[28:31], v[56:59], v[60:67], v5
ds_read_b128 v[56:59], v0 offset:2048
v_smfmac_f32_16x16x64_bf16 v[16:19], v[48:51], v[136:143], v5
ds_read_b128 v[40:43], v1 offset:2048
v_smfmac_f32_16x16x64_bf16 v[24:27], v[48:51], v[152:159], v5
ds_read_b128 v[44:47], v1 offset:3072
v_smfmac_f32_16x16x64_bf16 v[20:23], v[48:51], v[144:151], v5
s_waitcnt lgkmcnt(4)
ds_read_b128 v[76:79], v1 offset:4096
v_smfmac_f32_16x16x64_bf16 v[28:31], v[48:51], v[68:75], v5
ds_read_b128 v[48:51], v0 offset:3072
v_smfmac_f32_16x16x64_bf16 v[16:19], v[52:55], v[160:167], v5
ds_read_b128 v[80:83], v1 offset:5120
v_smfmac_f32_16x16x64_bf16 v[24:27], v[52:55], v[176:183], v5
s_waitcnt lgkmcnt(5)
ds_read_b128 v[84:87], v1 offset:6144
v_smfmac_f32_16x16x64_bf16 v[16:19], v[56:59], v[192:199], v5
ds_read_b128 v[88:91], v1 offset:7168
v_smfmac_f32_16x16x64_bf16 v[24:27], v[56:59], v[208:215], v5
s_waitcnt lgkmcnt(3)
v_add_u32 v1, s73, v2
v_smfmac_f32_16x16x64_bf16 v[16:19], v[48:51], v[224:231], v5
v_smfmac_f32_16x16x64_bf16 v[24:27], v[48:51], v[240:247], v5
s_nop 0
v_smfmac_f32_16x16x64_bf16 v[20:23], v[52:55], v[168:175], v5
s_nop 0
v_smfmac_f32_16x16x64_bf16 v[28:31], v[52:55], v[184:191], v5
s_nop 0
v_smfmac_f32_16x16x64_bf16 v[20:23], v[56:59], v[200:207], v5
s_nop 0
v_add_f32 v16, v16, v18
v_smfmac_f32_16x16x64_bf16 v[28:31], v[56:59], v[216:223], v5
v_add_f32 v17, v17, v19
v_smfmac_f32_16x16x64_bf16 v[20:23], v[48:51], v[232:239], v5
v_add_f32 v24, v24, v26
v_smfmac_f32_16x16x64_bf16 v[28:31], v[48:51], v[248:255], v5
v_add_f32 v25, v25, v27
v_cvt_pk_bf16_f32 v16, v16, v17
v_cvt_pk_bf16_f32 v24, v24, v25
ds_write2_b32 v9, v16, v24 offset0:0 offset1:64
s_nop 1
v_pk_add_f32 v[20:21], v[20:21], v[22:23]
s_nop 0
v_pk_add_f32 v[28:29], v[28:29], v[30:31]
v_cvt_pk_bf16_f32 v20, v20, v21
v_cvt_pk_bf16_f32 v28, v28, v29
ds_write2_b32 v9, v20, v28 offset0:32 offset1:96
s_waitcnt lgkmcnt(0)
s_barrier
ds_read_b64_tr_b16 v[48:49], v10 offset:0
ds_read_b64_tr_b16 v[50:51], v10 offset:32
ds_read_b64_tr_b16 v[52:53], v10 offset:256
ds_read_b64_tr_b16 v[54:55], v10 offset:288
ds_read_b64_tr_b16 v[56:57], v10 offset:512
ds_read_b64_tr_b16 v[58:59], v10 offset:544
ds_read_b64_tr_b16 v[60:61], v10 offset:768
ds_read_b64_tr_b16 v[62:63], v10 offset:800
ds_read_b64_tr_b16 v[16:17], v1 offset:8192
ds_read_b64_tr_b16 v[18:19], v1 offset:9216
ds_read_b64_tr_b16 v[20:21], v1 offset:8704
ds_read_b64_tr_b16 v[22:23], v1 offset:9728
s_waitcnt lgkmcnt(10)
v_mfma_f32_16x16x32_bf16 v[64:67], v[32:35], v[48:51], 0
v_mfma_f32_16x16x32_bf16 v[68:71], v[36:39], v[48:51], 0
v_mfma_f32_16x16x32_bf16 v[72:75], v[48:51], v[48:51], 0
s_waitcnt lgkmcnt(8)
v_mfma_f32_16x16x32_bf16 v[64:67], v[40:43], v[52:55], v[64:67]
v_mfma_f32_16x16x32_bf16 v[68:71], v[44:47], v[52:55], v[68:71]
v_mfma_f32_16x16x32_bf16 v[72:75], v[52:55], v[52:55], v[72:75]
s_waitcnt lgkmcnt(6)
v_mfma_f32_16x16x32_bf16 v[64:67], v[76:79], v[56:59], v[64:67]
v_mfma_f32_16x16x32_bf16 v[68:71], v[80:83], v[56:59], v[68:71]
v_mfma_f32_16x16x32_bf16 v[72:75], v[56:59], v[56:59], v[72:75]
s_waitcnt lgkmcnt(4)
v_mfma_f32_16x16x32_bf16 v[64:67], v[84:87], v[60:63], v[64:67]
v_mfma_f32_16x16x32_bf16 v[68:71], v[88:91], v[60:63], v[68:71]
v_mfma_f32_16x16x32_bf16 v[72:75], v[60:63], v[60:63], v[72:75]
buffer_load_dwordx2 v[92:93], v6, s[4:7], s25 offen sc1
v_add_u32 v1, s74, v10
ds_read_b64_tr_b16 v[76:77], v1 offset:0
ds_read_b64_tr_b16 v[78:79], v1 offset:32
v_mov_b32 v36, 0x3f803f80
v_mov_b32 v37, 0x3f803f80
v_max3_f32 v44, v64, v65, v66
v_max3_f32 v45, v67, v68, v69
v_max3_f32 v46, v70, v71, v72
v_max3_f32 v44, v44, v45, v73
v_max_f32 v45, v44, v46
v_max_f32 v44, v44, v46
v_mov_b32 v38, 0x3f803f80
v_mov_b32 v39, 0x3f803f80
v_permlane16_swap_b32 v44, v45
v_max_f32 v46, v44, v45
v_max_f32 v44, v44, v45
v_mov_b32 v29, 0
v_mov_b32 v30, 0
v_permlane32_swap_b32 v44, v46
s_waitcnt lgkmcnt(0)
buffer_load_dwordx2 v[92:93], v6, s[4:7], s25 offen sc1
buffer_store_dwordx4 v[76:79], v12, s[4:7], s28 offen sc1
v_max_f32 v44, v44, v46
v_mul_f32 v44, s34, v44
v_pk_fma_f32 v[64:65], v[64:65], s[34:35], v[44:45] op_sel_hi:[1,1,0] neg_lo:[0,0,1] neg_hi:[0,0,1]
v_pk_fma_f32 v[66:67], v[66:67], s[34:35], v[44:45] op_sel_hi:[1,1,0] neg_lo:[0,0,1] neg_hi:[0,0,1]
v_pk_fma_f32 v[68:69], v[68:69], s[34:35], v[44:45] op_sel_hi:[1,1,0] neg_lo:[0,0,1] neg_hi:[0,0,1]
v_pk_fma_f32 v[70:71], v[70:71], s[34:35], v[44:45] op_sel_hi:[1,1,0] neg_lo:[0,0,1] neg_hi:[0,0,1]
v_pk_fma_f32 v[72:73], v[72:73], s[34:35], v[44:45] op_sel_hi:[1,1,0] neg_lo:[0,0,1] neg_hi:[0,0,1]
v_exp_f32 v64, v64
v_exp_f32 v65, v65
v_exp_f32 v66, v66
v_cvt_pk_bf16_f32 v24, v64, v65
v_exp_f32 v67, v67
v_exp_f32 v68, v68
v_cvt_pk_bf16_f32 v25, v66, v67
v_exp_f32 v69, v69
v_exp_f32 v70, v70
v_cvt_pk_bf16_f32 v26, v68, v69
v_exp_f32 v71, v71
v_exp_f32 v72, v72
v_cvt_pk_bf16_f32 v27, v70, v71
v_exp_f32 v73, v73
s_nop 0
v_mfma_f32_16x16x32_bf16 v[40:43], v[36:39], v[24:27], 0
v_cvt_pk_bf16_f32 v28, v72, v73
v_cvt_pk_bf16_f32 v31, v72, v73
v_mfma_f32_16x16x32_bf16 v[48:51], v[16:19], v[24:27], 0
s_waitcnt vmcnt(2)
v_max_u32 v0, v92, v93
v_cmp_eq_u32 vcc, -1, v0
v_mfma_f32_16x16x32_bf16 v[52:55], v[20:23], v[24:27], 0
v_mfma_f32_16x16x16_bf16 v[40:43], v[36:37], v[28:29], v[40:43]
s_cbranch_vccnz Lvmr_243
Lvm_242:
v_mfma_f32_16x16x16_bf16 v[48:51], v[92:93], v[28:29], v[48:51]
s_nop 0
v_mov_b32 v60, -1
v_mov_b32 v61, -1
v_mfma_f32_16x16x16_bf16 v[52:55], v[92:93], v[30:31], v[52:55]
v_mov_b32 v62, -1
v_mov_b32 v63, -1
v_rcp_f32 v44, v40
s_nop 0
v_pk_mul_f32 v[48:49], v[48:49], v[44:45] op_sel_hi:[1,0]
v_pk_mul_f32 v[50:51], v[50:51], v[44:45] op_sel_hi:[1,0]
s_nop 1
v_pk_mul_f32 v[52:53], v[52:53], v[44:45] op_sel_hi:[1,0]
v_pk_mul_f32 v[54:55], v[54:55], v[44:45] op_sel_hi:[1,0]
v_cvt_pk_bf16_f32 v56, v48, v49
v_cvt_pk_bf16_f32 v57, v50, v51
v_cvt_pk_bf16_f32 v58, v52, v53
v_cvt_pk_bf16_f32 v59, v54, v55
buffer_store_dwordx4 v[56:59], v11, s[4:7], s26 offen sc1
s_mov_b32 s24, s36
buffer_load_dwordx4 v[32:35], v6, s[4:7], s24 offen offset:0 sc1
buffer_load_dwordx4 v[36:39], v6, s[4:7], s24 offen offset:1024 sc1
buffer_load_dwordx4 v[40:43], v6, s[4:7], s24 offen offset:2048 sc1
buffer_load_dwordx4 v[44:47], v6, s[4:7], s24 offen offset:3072 sc1
buffer_store_dwordx4 v[60:63], v11, s[4:7], s27 offen sc1
s_nop 1
ds_read_b128 v[60:63], v8 offset:0
ds_read_b128 v[64:67], v8 offset:1024
ds_read_b128 v[68:71], v8 offset:2048
ds_read_b128 v[72:75], v8 offset:3072
v_mov_b32 v81, s76
s_mov_b32 s59, s38
s_add_u32 s76, s52, 1
s_and_b32 s38, s52, 64
s_lshl_b32 s38, s38, 12
s_and_b32 s28, s52, 8
s_lshl_b32 s28, s28, 10
s_xor_b32 s28, s28, s78
s_lshl_b32 s61, s52, 18
s_add_u32 s28, s28, s61
v_mov_b32 v81, s76
s_mov_b32 s59, s38
s_mov_b32 s39, s10
s_cmp_eq_u32 s10, 0
s_cbranch_scc1 Lkvs_233
Lkvc_234:
s_sub_u32 s73, 245760, s73
s_mov_b32 s52, s53
s_mov_b32 s53, s69
s_cmp_lt_u32 s52, 64
s_cselect_b32 s32, 0, 0xa0000
s_add_u32 s32, s32, s66
s_and_b32 s26, s52, 3
s_lshl_b32 s26, s26, 15
s_xor_b32 s27, s26, 0x10000
s_add_u32 s27, s27, s32
s_add_u32 s26, s26, s32
s_add_u32 s25, s26, s72
s_add_u32 s26, s26, s71
s_add_u32 s27, s27, s71
s_and_b32 s28, s52, 8
s_lshl_b32 s28, s28, 10
s_xor_b32 s28, s28, s78
s_lshl_b32 s61, s52, 18
s_add_u32 s28, s28, s61
s_lshl_b32 s29, s53, 18
s_add_u32 s29, s29, s77
s_cmp_lt_u32 s53, 128
s_cselect_b32 s29, s29, 0x40000000
s_add_u32 s30, s29, 0x2000000
s_sub_u32 s31, 245760, s73
s_add_u32 s31, s31, s79
s_and_b32 s58, s53, 64
s_lshl_b32 s58, s58, 12
s_cmp_lt_u32 s53, 128
s_cselect_b32 s57, s53, 0
s_add_u32 s60, s53, 1
s_add_u32 s99, s99, 1
s_cmp_lt_u32 s99, 103
s_cselect_b32 s69, s98, s60
s_cselect_b32 s98, s60, s98
s_and_b32 s37, s69, 64
s_lshl_b32 s37, s37, 12
s_cmp_lt_u32 s53, 64
s_cselect_b32 s32, 0, 0xa0000
s_add_u32 s32, s32, s66
s_and_b32 s36, s53, 3
s_lshl_b32 s36, s36, 14
s_add_u32 s36, s36, s32
s_add_u32 s36, s36, s75
v_add_u32 v1, s73, v6
v_mov_b32 v16, 0
v_mov_b32 v17, 0
v_mov_b32 v18, 0
v_mov_b32 v19, 0
v_mov_b32 v20, 0
v_mov_b32 v21, 0
v_mov_b32 v22, 0
v_mov_b32 v23, 0
v_mov_b32 v24, 0
v_mov_b32 v25, 0
v_mov_b32 v26, 0
v_mov_b32 v27, 0
v_mov_b32 v28, 0
v_mov_b32 v29, 0
v_mov_b32 v30, 0
v_mov_b32 v31, 0
v_cmp_lt_u32 vcc, s57, v4
s_nop 0
s_cmp_eq_u64 vcc, -1
s_cselect_b32 s10, 0x10000000, 0
s_cmp_eq_u32 s76, s52
s_cbranch_scc1 Lqkn_246
s_cmp_eq_u32 s39, 0
s_cbranch_scc1 LQK_poll_s
s_waitcnt vmcnt(4)
v_max3_u32 v0, v32, v33, v34
v_max_u32 v0, v0, v35
s_waitcnt vmcnt(3)
v_max3_u32 v0, v0, v36, v37
v_max3_u32 v0, v0, v38, v39
s_waitcnt vmcnt(2)
v_max3_u32 v0, v0, v40, v41
v_max3_u32 v0, v0, v42, v43
s_waitcnt vmcnt(1)
v_max3_u32 v0, v0, v44, v45
v_max3_u32 v0, v0, v46, v47
v_cmp_eq_u32 vcc, -1, v0
s_nop 0
s_cbranch_vccz LQK_go_s
s_branch LQK_poll_s
Lqkn_246:
s_waitcnt vmcnt(0)
buffer_store_dword v81, v15, s[4:7], s59 offen sc1
s_cmp_lt_u32 s52, 128
s_cbranch_scc1 LQK_poll_s
s_waitcnt vmcnt(0)
s_endpgm
Lto_232:
s_mov_b32 s97, 12
s_branch L_fail
Lrt_238:
s_add_u32 s96, s96, 1
s_cmp_lt_u32 s96, 1048576
s_cbranch_scc1 Lkvel_237
s_mov_b32 s97, 13
s_branch L_fail
Lkve_235:
s_add_u32 s60, s52, 1
s_cmp_eq_u32 s60, s53
s_cbranch_scc1 Lkvec_236
Lkvel_237:
buffer_load_dword v4, v14, s[4:7], s58 offen sc1
s_waitcnt vmcnt(0)
v_cmp_lt_u32 vcc, s57, v4
s_nop 0
s_cmp_eq_u64 vcc, -1
s_cbranch_scc0 Lrt_238
s_mov_b32 s10, 0x10000000
s_branch Lkvec_236
Lrt_241:
s_add_u32 s96, s96, 1
s_cmp_lt_u32 s96, 1048576
s_cbranch_scc1 Lkvs2_239
s_mov_b32 s97, 13
s_branch L_fail
Lkvs_233:
buffer_load_dword v0, v14, s[4:7], s58 offen sc1
s_waitcnt vmcnt(0)
v_cmp_lt_u32 vcc, s57, v0
s_nop 0
s_cmp_eq_u64 vcc, -1
s_cbranch_scc1 Lkvs3_240
buffer_store_dword v81, v15, s[4:7], s59 offen sc1
Lkvs2_239:
buffer_load_dword v0, v14, s[4:7], s58 offen sc1
s_waitcnt vmcnt(0)
v_cmp_lt_u32 vcc, s57, v0
s_nop 0
s_cmp_eq_u64 vcc, -1
s_cbranch_scc0 Lrt_241
Lkvs3_240:
s_mov_b32 m0, s31
s_nop 0
buffer_load_dwordx4 v6, s[4:7], s29 offen sc1 lds
buffer_load_dwordx4 v6, s[4:7], s29 offen offset:1024 sc1 lds
s_add_u32 m0, s31, 8192
s_nop 0
buffer_load_dwordx4 v6, s[4:7], s30 offen sc1 lds
buffer_load_dwordx4 v6, s[4:7], s30 offen offset:1024 sc1 lds
s_branch Lkvc_234
Lto_245:
s_mov_b32 s97, 14
s_branch L_fail
Lvmr_243:
s_waitcnt vmcnt(1)
v_max_u32 v0, v92, v93
v_cmp_eq_u32 vcc, -1, v0
s_nop 0
s_cbranch_vccz Lvm_242
Lvmr2_244:
buffer_load_dwordx2 v[92:93], v6, s[4:7], s25 offen sc1
s_add_u32 s96, s96, 1
s_cmp_ge_u32 s96, 1048576
s_cbranch_scc1 Lto_245
s_waitcnt vmcnt(0)
v_max_u32 v0, v92, v93
v_cmp_eq_u32 vcc, -1, v0
s_nop 0
s_cbranch_vccz Lvm_242
s_branch Lvmr2_244
L_VM:
s_mov_b32 s12, s32
s_and_b32 s13, s33, 0xffff
s_mov_b32 s14, 0x800000
s_mov_b32 s15, 0x20000
s_mul_i32 s66, s50, 0x50000
s_add_u32 s66, s66, 0x200000
s_lshl_b32 s67, s48, 14
s_add_u32 s67, s67, 98304
s_lshl_b32 s65, s50, 8
s_add_u32 s65, s65, 0x340000
v_lshlrev_b32 v6, 4, v0
s_mul_i32 s60, s48, 24576
v_add_u32 v8, s60, v6
v_mov_b32 v1, 0x4444
v_mov_b32 v2, 0xeeee
v_and_b32 v3, 2, v0
v_cmp_eq_u32 vcc, 0, v3
s_nop 1
v_cndmask_b32 v5, v2, v1, vcc
s_lshl_b32 s70, s49, 2
s_add_u32 s70, s70, s48
s_lshl_b32 s72, s50, 5
s_add_u32 s72, s72, s70
s_lshl_b32 s72, s72, 7
s_lshl_b32 s70, s70, 10
s_lshr_b32 s62, s72, 7
s_mul_i32 s60, s62, 256
s_add_u32 s60, s60, 112640
s_and_b32 s61, s60, 0xffffe000
s_add_u32 s60, s60, s61
v_mov_b32 v9, s60
v_mov_b32 v1, 0x40000000
v_cmp_gt_u32 vcc, 1, v0
s_nop 1
v_cndmask_b32 v9, v1, v9, vcc
v_mov_b32 v1, 0
s_mov_b32 s60, 0x0
buffer_store_dword v1, v9, s[4:7], s60 offen sc1
s_mov_b32 s60, 0x2000
buffer_store_dword v1, v9, s[4:7], s60 offen sc1
s_mov_b32 s60, 0x40000
buffer_store_dword v1, v9, s[4:7], s60 offen sc1
s_mov_b32 s60, 0x42000
buffer_store_dword v1, v9, s[4:7], s60 offen sc1
s_lshr_b32 s73, s72, 8
s_lshr_b32 s60, s73, 1
s_lshl_b32 s60, s60, 14
s_and_b32 s73, s73, 1
s_lshl_b32 s73, s73, 12
s_add_u32 s73, s73, s60
s_add_u32 s73, s73, 0x7400000
s_and_b32 s60, s48, 1
s_lshl_b32 s60, s60, 10
s_add_u32 s73, s73, s60
s_add_u32 s73, s73, 2048
v_mov_b32 v16, -1
v_mov_b32 v17, -1
v_mov_b32 v18, -1
v_mov_b32 v19, -1
s_add_u32 s60, s66, 0x30000
s_add_u32 s60, s60, s70
buffer_store_dwordx4 v[16:19], v6, s[4:7], s60 offen sc1
s_add_u32 s60, s66, 0x38000
s_add_u32 s60, s60, s70
buffer_store_dwordx4 v[16:19], v6, s[4:7], s60 offen sc1
s_add_u32 s60, s66, 0x40000
s_add_u32 s60, s60, s70
buffer_store_dwordx4 v[16:19], v6, s[4:7], s60 offen sc1
s_add_u32 s60, s66, 0x48000
s_add_u32 s60, s60, s70
buffer_store_dwordx4 v[16:19], v6, s[4:7], s60 offen sc1
s_add_u32 s60, s66, 0xd0000
s_add_u32 s60, s60, s70
buffer_store_dwordx4 v[16:19], v6, s[4:7], s60 offen sc1
s_add_u32 s60, s66, 0xd8000
s_add_u32 s60, s60, s70
buffer_store_dwordx4 v[16:19], v6, s[4:7], s60 offen sc1
s_add_u32 s60, s66, 0xe0000
s_add_u32 s60, s60, s70
buffer_store_dwordx4 v[16:19], v6, s[4:7], s60 offen sc1
s_add_u32 s60, s66, 0xe8000
s_add_u32 s60, s60, s70
buffer_store_dwordx4 v[16:19], v6, s[4:7], s60 offen sc1
s_waitcnt vmcnt(0)
s_barrier
s_cmp_lg_u32 s48, 0
s_cbranch_scc1 Larr_247
s_mov_b32 s60, 0
v_mov_b32 v2, s60
v_mov_b32 v1, 0x40000000
v_cmp_gt_u32 vcc, 1, v0
s_nop 1
v_cndmask_b32 v2, v1, v2, vcc
s_sub_u32 s61, s101, s2
s_and_b32 s61, s61, 7
s_lshl_b32 s61, s61, 2
s_add_u32 s61, s61, 128
s_cmp_eq_u32 s100, 0
s_cselect_b32 s61, s61, 0
v_mov_b32 v3, 1
buffer_atomic_add v3, v2, s[20:23], s61 offen sc1
Larr_247:
s_add_u32 s70, s70, 0x30000
v_lshrrev_b32 v1, 3, v0
v_mul_u32_u24 v1, 8192, v1
v_and_b32 v2, 7, v0
v_lshlrev_b32 v2, 4, v2
v_add_u32 v20, v1, v2
v_lshrrev_b32 v1, 4, v0
v_bfe_u32 v2, v0, 2, 2
v_and_b32 v3, 3, v0
v_lshrrev_b32 v4, 1, v1
v_mul_u32_u24 v4, 16, v4
v_and_b32 v1, 1, v1
v_mul_u32_u24 v1, 4, v1
v_add_u32 v1, v1, v4
v_lshrrev_b32 v4, 1, v2
v_mul_u32_u24 v4, 8, v4
v_add_u32 v1, v1, v4
v_and_b32 v2, 1, v2
v_add_u32 v1, v1, v2
v_mul_u32_u24 v1, 128, v1
v_mul_u32_u24 v3, 8, v3
v_add3_u32 v21, v1, v3, s67
s_xor_b32 s68, s48, 0
s_lshl_b32 s68, s68, 21
s_add_u32 s68, s68, s72
s_add_u32 m0, s67, 0
s_add_u32 s63, s68, 0x0
buffer_load_dwordx4 v20, s[12:15], s63 offen lds
s_add_u32 m0, s67, 1024
s_add_u32 s63, s68, 0x10000
buffer_load_dwordx4 v20, s[12:15], s63 offen lds
s_add_u32 m0, s67, 2048
s_add_u32 s63, s68, 0x20000
buffer_load_dwordx4 v20, s[12:15], s63 offen lds
s_add_u32 m0, s67, 3072
s_add_u32 s63, s68, 0x30000
buffer_load_dwordx4 v20, s[12:15], s63 offen lds
s_add_u32 m0, s67, 4096
s_add_u32 s63, s68, 0x40000
buffer_load_dwordx4 v20, s[12:15], s63 offen lds
s_add_u32 m0, s67, 5120
s_add_u32 s63, s68, 0x50000
buffer_load_dwordx4 v20, s[12:15], s63 offen lds
s_add_u32 m0, s67, 6144
s_add_u32 s63, s68, 0x60000
buffer_load_dwordx4 v20, s[12:15], s63 offen lds
s_add_u32 m0, s67, 7168
s_add_u32 s63, s68, 0x70000
buffer_load_dwordx4 v20, s[12:15], s63 offen lds
s_xor_b32 s68, s48, 0
s_lshl_b32 s68, s68, 21
s_add_u32 s68, s68, s72
s_add_u32 m0, s67, 8192
s_add_u32 s63, s68, 0x80000
buffer_load_dwordx4 v20, s[12:15], s63 offen lds
s_add_u32 m0, s67, 9216
s_add_u32 s63, s68, 0x90000
buffer_load_dwordx4 v20, s[12:15], s63 offen lds
s_add_u32 m0, s67, 10240
s_add_u32 s63, s68, 0xa0000
buffer_load_dwordx4 v20, s[12:15], s63 offen lds
s_add_u32 m0, s67, 11264
s_add_u32 s63, s68, 0xb0000
buffer_load_dwordx4 v20, s[12:15], s63 offen lds
s_add_u32 m0, s67, 12288
s_add_u32 s63, s68, 0xc0000
buffer_load_dwordx4 v20, s[12:15], s63 offen lds
s_add_u32 m0, s67, 13312
s_add_u32 s63, s68, 0xd0000
buffer_load_dwordx4 v20, s[12:15], s63 offen lds
s_add_u32 m0, s67, 14336
s_add_u32 s63, s68, 0xe0000
buffer_load_dwordx4 v20, s[12:15], s63 offen lds
s_add_u32 m0, s67, 15360
s_add_u32 s63, s68, 0xf0000
buffer_load_dwordx4 v20, s[12:15], s63 offen lds
s_waitcnt vmcnt(12)
ds_read_b64_tr_b16 a[0:1], v21 offset:0
ds_read_b64_tr_b16 a[2:3], v21 offset:256
ds_read_b64_tr_b16 a[8:9], v21 offset:32
ds_read_b64_tr_b16 a[10:11], v21 offset:288
ds_read_b64_tr_b16 a[16:17], v21 offset:64
ds_read_b64_tr_b16 a[18:19], v21 offset:320
ds_read_b64_tr_b16 a[24:25], v21 offset:96
ds_read_b64_tr_b16 a[26:27], v21 offset:352
s_waitcnt lgkmcnt(0)
s_xor_b32 s68, s48, 0
s_lshl_b32 s68, s68, 21
s_add_u32 s68, s68, s72
s_add_u32 m0, s67, 0
s_add_u32 s63, s68, 0x100000
buffer_load_dwordx4 v20, s[12:15], s63 offen lds
s_add_u32 m0, s67, 1024
s_add_u32 s63, s68, 0x110000
buffer_load_dwordx4 v20, s[12:15], s63 offen lds
s_add_u32 m0, s67, 2048
s_add_u32 s63, s68, 0x120000
buffer_load_dwordx4 v20, s[12:15], s63 offen lds
s_add_u32 m0, s67, 3072
s_add_u32 s63, s68, 0x130000
buffer_load_dwordx4 v20, s[12:15], s63 offen lds
s_waitcnt vmcnt(12)
ds_read_b64_tr_b16 a[4:5], v21 offset:4096
ds_read_b64_tr_b16 a[6:7], v21 offset:4352
ds_read_b64_tr_b16 a[12:13], v21 offset:4128
ds_read_b64_tr_b16 a[14:15], v21 offset:4384
ds_read_b64_tr_b16 a[20:21], v21 offset:4160
ds_read_b64_tr_b16 a[22:23], v21 offset:4416
ds_read_b64_tr_b16 a[28:29], v21 offset:4192
ds_read_b64_tr_b16 a[30:31], v21 offset:4448
s_waitcnt lgkmcnt(0)
s_add_u32 m0, s67, 4096
s_add_u32 s63, s68, 0x140000
buffer_load_dwordx4 v20, s[12:15], s63 offen lds
s_add_u32 m0, s67, 5120
s_add_u32 s63, s68, 0x150000
buffer_load_dwordx4 v20, s[12:15], s63 offen lds
s_add_u32 m0, s67, 6144
s_add_u32 s63, s68, 0x160000
buffer_load_dwordx4 v20, s[12:15], s63 offen lds
s_add_u32 m0, s67, 7168
s_add_u32 s63, s68, 0x170000
buffer_load_dwordx4 v20, s[12:15], s63 offen lds
s_waitcnt vmcnt(12)
ds_read_b64_tr_b16 a[32:33], v21 offset:8192
ds_read_b64_tr_b16 a[34:35], v21 offset:8448
ds_read_b64_tr_b16 a[40:41], v21 offset:8224
ds_read_b64_tr_b16 a[42:43], v21 offset:8480
ds_read_b64_tr_b16 a[48:49], v21 offset:8256
ds_read_b64_tr_b16 a[50:51], v21 offset:8512
ds_read_b64_tr_b16 v[36:37], v21 offset:8288
ds_read_b64_tr_b16 v[38:39], v21 offset:8544
s_waitcnt lgkmcnt(0)
ds_write_b128 v8, v[36:39] offset:0
s_waitcnt lgkmcnt(0)
s_xor_b32 s68, s48, 0
s_lshl_b32 s68, s68, 21
s_add_u32 s68, s68, s72
s_add_u32 m0, s67, 8192
s_add_u32 s63, s68, 0x180000
buffer_load_dwordx4 v20, s[12:15], s63 offen lds
s_add_u32 m0, s67, 9216
s_add_u32 s63, s68, 0x190000
buffer_load_dwordx4 v20, s[12:15], s63 offen lds
s_add_u32 m0, s67, 10240
s_add_u32 s63, s68, 0x1a0000
buffer_load_dwordx4 v20, s[12:15], s63 offen lds
s_add_u32 m0, s67, 11264
s_add_u32 s63, s68, 0x1b0000
buffer_load_dwordx4 v20, s[12:15], s63 offen lds
s_waitcnt vmcnt(12)
ds_read_b64_tr_b16 a[36:37], v21 offset:12288
ds_read_b64_tr_b16 a[38:39], v21 offset:12544
ds_read_b64_tr_b16 a[44:45], v21 offset:12320
ds_read_b64_tr_b16 a[46:47], v21 offset:12576
ds_read_b64_tr_b16 a[52:53], v21 offset:12352
ds_read_b64_tr_b16 a[54:55], v21 offset:12608
ds_read_b64_tr_b16 v[36:37], v21 offset:12384
ds_read_b64_tr_b16 v[38:39], v21 offset:12640
s_waitcnt lgkmcnt(0)
ds_write_b128 v8, v[36:39] offset:1024
s_waitcnt lgkmcnt(0)
s_add_u32 m0, s67, 12288
s_add_u32 s63, s68, 0x1c0000
buffer_load_dwordx4 v20, s[12:15], s63 offen lds
s_add_u32 m0, s67, 13312
s_add_u32 s63, s68, 0x1d0000
buffer_load_dwordx4 v20, s[12:15], s63 offen lds
s_add_u32 m0, s67, 14336
s_add_u32 s63, s68, 0x1e0000
buffer_load_dwordx4 v20, s[12:15], s63 offen lds
s_add_u32 m0, s67, 15360
s_add_u32 s63, s68, 0x1f0000
buffer_load_dwordx4 v20, s[12:15], s63 offen lds
s_waitcnt vmcnt(12)
ds_read_b64_tr_b16 a[56:57], v21 offset:0
ds_read_b64_tr_b16 a[58:59], v21 offset:256
ds_read_b64_tr_b16 a[64:65], v21 offset:32
ds_read_b64_tr_b16 a[66:67], v21 offset:288
ds_read_b64_tr_b16 a[72:73], v21 offset:64
ds_read_b64_tr_b16 a[74:75], v21 offset:320
ds_read_b64_tr_b16 v[36:37], v21 offset:96
ds_read_b64_tr_b16 v[38:39], v21 offset:352
s_waitcnt lgkmcnt(0)
ds_write_b128 v8, v[36:39] offset:2048
s_waitcnt lgkmcnt(0)
s_xor_b32 s68, s48, 1
s_lshl_b32 s68, s68, 21
s_add_u32 s68, s68, s72
s_add_u32 m0, s67, 0
s_add_u32 s63, s68, 0x0
buffer_load_dwordx4 v20, s[12:15], s63 offen lds
s_add_u32 m0, s67, 1024
s_add_u32 s63, s68, 0x10000
buffer_load_dwordx4 v20, s[12:15], s63 offen lds
s_add_u32 m0, s67, 2048
s_add_u32 s63, s68, 0x20000
buffer_load_dwordx4 v20, s[12:15], s63 offen lds
s_add_u32 m0, s67, 3072
s_add_u32 s63, s68, 0x30000
buffer_load_dwordx4 v20, s[12:15], s63 offen lds
s_waitcnt vmcnt(12)
ds_read_b64_tr_b16 a[60:61], v21 offset:4096
ds_read_b64_tr_b16 a[62:63], v21 offset:4352
ds_read_b64_tr_b16 a[68:69], v21 offset:4128
ds_read_b64_tr_b16 a[70:71], v21 offset:4384
ds_read_b64_tr_b16 a[76:77], v21 offset:4160
ds_read_b64_tr_b16 a[78:79], v21 offset:4416
ds_read_b64_tr_b16 v[36:37], v21 offset:4192
ds_read_b64_tr_b16 v[38:39], v21 offset:4448
s_waitcnt lgkmcnt(0)
ds_write_b128 v8, v[36:39] offset:3072
s_waitcnt lgkmcnt(0)
s_add_u32 m0, s67, 4096
s_add_u32 s63, s68, 0x40000
buffer_load_dwordx4 v20, s[12:15], s63 offen lds
s_add_u32 m0, s67, 5120
s_add_u32 s63, s68, 0x50000
buffer_load_dwordx4 v20, s[12:15], s63 offen lds
s_add_u32 m0, s67, 6144
s_add_u32 s63, s68, 0x60000
buffer_load_dwordx4 v20, s[12:15], s63 offen lds
s_add_u32 m0, s67, 7168
s_add_u32 s63, s68, 0x70000
buffer_load_dwordx4 v20, s[12:15], s63 offen lds
s_waitcnt vmcnt(12)
ds_read_b64_tr_b16 a[80:81], v21 offset:8192
ds_read_b64_tr_b16 a[82:83], v21 offset:8448
ds_read_b64_tr_b16 a[88:89], v21 offset:8224
ds_read_b64_tr_b16 a[90:91], v21 offset:8480
ds_read_b64_tr_b16 a[96:97], v21 offset:8256
ds_read_b64_tr_b16 a[98:99], v21 offset:8512
ds_read_b64_tr_b16 v[36:37], v21 offset:8288
ds_read_b64_tr_b16 v[38:39], v21 offset:8544
s_waitcnt lgkmcnt(0)
ds_write_b128 v8, v[36:39] offset:4096
s_waitcnt lgkmcnt(0)
s_xor_b32 s68, s48, 1
s_lshl_b32 s68, s68, 21
s_add_u32 s68, s68, s72
s_add_u32 m0, s67, 8192
s_add_u32 s63, s68, 0x80000
buffer_load_dwordx4 v20, s[12:15], s63 offen lds
s_add_u32 m0, s67, 9216
s_add_u32 s63, s68, 0x90000
buffer_load_dwordx4 v20, s[12:15], s63 offen lds
s_add_u32 m0, s67, 10240
s_add_u32 s63, s68, 0xa0000
buffer_load_dwordx4 v20, s[12:15], s63 offen lds
s_add_u32 m0, s67, 11264
s_add_u32 s63, s68, 0xb0000
buffer_load_dwordx4 v20, s[12:15], s63 offen lds
s_waitcnt vmcnt(12)
ds_read_b64_tr_b16 a[84:85], v21 offset:12288
ds_read_b64_tr_b16 a[86:87], v21 offset:12544
ds_read_b64_tr_b16 a[92:93], v21 offset:12320
ds_read_b64_tr_b16 a[94:95], v21 offset:12576
ds_read_b64_tr_b16 a[100:101], v21 offset:12352
ds_read_b64_tr_b16 a[102:103], v21 offset:12608
ds_read_b64_tr_b16 v[36:37], v21 offset:12384
ds_read_b64_tr_b16 v[38:39], v21 offset:12640
s_waitcnt lgkmcnt(0)
ds_write_b128 v8, v[36:39] offset:5120
s_waitcnt lgkmcnt(0)
s_add_u32 m0, s67, 12288
s_add_u32 s63, s68, 0xc0000
buffer_load_dwordx4 v20, s[12:15], s63 offen lds
s_add_u32 m0, s67, 13312
s_add_u32 s63, s68, 0xd0000
buffer_load_dwordx4 v20, s[12:15], s63 offen lds
s_add_u32 m0, s67, 14336
s_add_u32 s63, s68, 0xe0000
buffer_load_dwordx4 v20, s[12:15], s63 offen lds
s_add_u32 m0, s67, 15360
s_add_u32 s63, s68, 0xf0000
buffer_load_dwordx4 v20, s[12:15], s63 offen lds
s_waitcnt vmcnt(12)
ds_read_b64_tr_b16 a[104:105], v21 offset:0
ds_read_b64_tr_b16 a[106:107], v21 offset:256
ds_read_b64_tr_b16 a[112:113], v21 offset:32
ds_read_b64_tr_b16 a[114:115], v21 offset:288
ds_read_b64_tr_b16 a[120:121], v21 offset:64
ds_read_b64_tr_b16 a[122:123], v21 offset:320
ds_read_b64_tr_b16 v[36:37], v21 offset:96
ds_read_b64_tr_b16 v[38:39], v21 offset:352
s_waitcnt lgkmcnt(0)
ds_write_b128 v8, v[36:39] offset:6144
s_waitcnt lgkmcnt(0)
s_xor_b32 s68, s48, 1
s_lshl_b32 s68, s68, 21
s_add_u32 s68, s68, s72
s_add_u32 m0, s67, 0
s_add_u32 s63, s68, 0x100000
buffer_load_dwordx4 v20, s[12:15], s63 offen lds
s_add_u32 m0, s67, 1024
s_add_u32 s63, s68, 0x110000
buffer_load_dwordx4 v20, s[12:15], s63 offen lds
s_add_u32 m0, s67, 2048
s_add_u32 s63, s68, 0x120000
buffer_load_dwordx4 v20, s[12:15], s63 offen lds
s_add_u32 m0, s67, 3072
s_add_u32 s63, s68, 0x130000
buffer_load_dwordx4 v20, s[12:15], s63 offen lds
s_waitcnt vmcnt(12)
ds_read_b64_tr_b16 a[108:109], v21 offset:4096
ds_read_b64_tr_b16 a[110:111], v21 offset:4352
ds_read_b64_tr_b16 a[116:117], v21 offset:4128
ds_read_b64_tr_b16 a[118:119], v21 offset:4384
ds_read_b64_tr_b16 a[124:125], v21 offset:4160
ds_read_b64_tr_b16 a[126:127], v21 offset:4416
ds_read_b64_tr_b16 v[36:37], v21 offset:4192
ds_read_b64_tr_b16 v[38:39], v21 offset:4448
s_waitcnt lgkmcnt(0)
ds_write_b128 v8, v[36:39] offset:7168
s_waitcnt lgkmcnt(0)
s_add_u32 m0, s67, 4096
s_add_u32 s63, s68, 0x140000
buffer_load_dwordx4 v20, s[12:15], s63 offen lds
s_add_u32 m0, s67, 5120
s_add_u32 s63, s68, 0x150000
buffer_load_dwordx4 v20, s[12:15], s63 offen lds
s_add_u32 m0, s67, 6144
s_add_u32 s63, s68, 0x160000
buffer_load_dwordx4 v20, s[12:15], s63 offen lds
s_add_u32 m0, s67, 7168
s_add_u32 s63, s68, 0x170000
buffer_load_dwordx4 v20, s[12:15], s63 offen lds
s_waitcnt vmcnt(12)
ds_read_b64_tr_b16 a[128:129], v21 offset:8192
ds_read_b64_tr_b16 a[130:131], v21 offset:8448
ds_read_b64_tr_b16 a[136:137], v21 offset:8224
ds_read_b64_tr_b16 a[138:139], v21 offset:8480
ds_read_b64_tr_b16 a[144:145], v21 offset:8256
ds_read_b64_tr_b16 a[146:147], v21 offset:8512
ds_read_b64_tr_b16 v[36:37], v21 offset:8288
ds_read_b64_tr_b16 v[38:39], v21 offset:8544
s_waitcnt lgkmcnt(0)
ds_write_b128 v8, v[36:39] offset:8192
s_waitcnt lgkmcnt(0)
s_xor_b32 s68, s48, 1
s_lshl_b32 s68, s68, 21
s_add_u32 s68, s68, s72
s_add_u32 m0, s67, 8192
s_add_u32 s63, s68, 0x180000
buffer_load_dwordx4 v20, s[12:15], s63 offen lds
s_add_u32 m0, s67, 9216
s_add_u32 s63, s68, 0x190000
buffer_load_dwordx4 v20, s[12:15], s63 offen lds
s_add_u32 m0, s67, 10240
s_add_u32 s63, s68, 0x1a0000
buffer_load_dwordx4 v20, s[12:15], s63 offen lds
s_add_u32 m0, s67, 11264
s_add_u32 s63, s68, 0x1b0000
buffer_load_dwordx4 v20, s[12:15], s63 offen lds
s_waitcnt vmcnt(12)
ds_read_b64_tr_b16 a[132:133], v21 offset:12288
ds_read_b64_tr_b16 a[134:135], v21 offset:12544
ds_read_b64_tr_b16 a[140:141], v21 offset:12320
ds_read_b64_tr_b16 a[142:143], v21 offset:12576
ds_read_b64_tr_b16 a[148:149], v21 offset:12352
ds_read_b64_tr_b16 a[150:151], v21 offset:12608
ds_read_b64_tr_b16 v[36:37], v21 offset:12384
ds_read_b64_tr_b16 v[38:39], v21 offset:12640
s_waitcnt lgkmcnt(0)
ds_write_b128 v8, v[36:39] offset:9216
s_waitcnt lgkmcnt(0)
s_add_u32 m0, s67, 12288
s_add_u32 s63, s68, 0x1c0000
buffer_load_dwordx4 v20, s[12:15], s63 offen lds
s_add_u32 m0, s67, 13312
s_add_u32 s63, s68, 0x1d0000
buffer_load_dwordx4 v20, s[12:15], s63 offen lds
s_add_u32 m0, s67, 14336
s_add_u32 s63, s68, 0x1e0000
buffer_load_dwordx4 v20, s[12:15], s63 offen lds
s_add_u32 m0, s67, 15360
s_add_u32 s63, s68, 0x1f0000
buffer_load_dwordx4 v20, s[12:15], s63 offen lds
s_waitcnt vmcnt(12)
ds_read_b64_tr_b16 a[152:153], v21 offset:0
ds_read_b64_tr_b16 a[154:155], v21 offset:256
ds_read_b64_tr_b16 a[160:161], v21 offset:32
ds_read_b64_tr_b16 a[162:163], v21 offset:288
ds_read_b64_tr_b16 a[168:169], v21 offset:64
ds_read_b64_tr_b16 a[170:171], v21 offset:320
ds_read_b64_tr_b16 v[36:37], v21 offset:96
ds_read_b64_tr_b16 v[38:39], v21 offset:352
s_waitcnt lgkmcnt(0)
ds_write_b128 v8, v[36:39] offset:10240
s_waitcnt lgkmcnt(0)
s_xor_b32 s68, s48, 2
s_lshl_b32 s68, s68, 21
s_add_u32 s68, s68, s72
s_add_u32 m0, s67, 0
s_add_u32 s63, s68, 0x0
buffer_load_dwordx4 v20, s[12:15], s63 offen lds
s_add_u32 m0, s67, 1024
s_add_u32 s63, s68, 0x10000
buffer_load_dwordx4 v20, s[12:15], s63 offen lds
s_add_u32 m0, s67, 2048
s_add_u32 s63, s68, 0x20000
buffer_load_dwordx4 v20, s[12:15], s63 offen lds
s_add_u32 m0, s67, 3072
s_add_u32 s63, s68, 0x30000
buffer_load_dwordx4 v20, s[12:15], s63 offen lds
s_waitcnt vmcnt(12)
ds_read_b64_tr_b16 a[156:157], v21 offset:4096
ds_read_b64_tr_b16 a[158:159], v21 offset:4352
ds_read_b64_tr_b16 a[164:165], v21 offset:4128
ds_read_b64_tr_b16 a[166:167], v21 offset:4384
ds_read_b64_tr_b16 a[172:173], v21 offset:4160
ds_read_b64_tr_b16 a[174:175], v21 offset:4416
ds_read_b64_tr_b16 v[36:37], v21 offset:4192
ds_read_b64_tr_b16 v[38:39], v21 offset:4448
s_waitcnt lgkmcnt(0)
ds_write_b128 v8, v[36:39] offset:11264
s_waitcnt lgkmcnt(0)
s_add_u32 m0, s67, 4096
s_add_u32 s63, s68, 0x40000
buffer_load_dwordx4 v20, s[12:15], s63 offen lds
s_add_u32 m0, s67, 5120
s_add_u32 s63, s68, 0x50000
buffer_load_dwordx4 v20, s[12:15], s63 offen lds
s_add_u32 m0, s67, 6144
s_add_u32 s63, s68, 0x60000
buffer_load_dwordx4 v20, s[12:15], s63 offen lds
s_add_u32 m0, s67, 7168
s_add_u32 s63, s68, 0x70000
buffer_load_dwordx4 v20, s[12:15], s63 offen lds
s_waitcnt vmcnt(12)
ds_read_b64_tr_b16 a[176:177], v21 offset:8192
ds_read_b64_tr_b16 a[178:179], v21 offset:8448
ds_read_b64_tr_b16 a[184:185], v21 offset:8224
ds_read_b64_tr_b16 a[186:187], v21 offset:8480
ds_read_b64_tr_b16 a[192:193], v21 offset:8256
ds_read_b64_tr_b16 a[194:195], v21 offset:8512
ds_read_b64_tr_b16 v[36:37], v21 offset:8288
ds_read_b64_tr_b16 v[38:39], v21 offset:8544
s_waitcnt lgkmcnt(0)
ds_write_b128 v8, v[36:39] offset:12288
s_waitcnt lgkmcnt(0)
s_xor_b32 s68, s48, 2
s_lshl_b32 s68, s68, 21
s_add_u32 s68, s68, s72
s_add_u32 m0, s67, 8192
s_add_u32 s63, s68, 0x80000
buffer_load_dwordx4 v20, s[12:15], s63 offen lds
s_add_u32 m0, s67, 9216
s_add_u32 s63, s68, 0x90000
buffer_load_dwordx4 v20, s[12:15], s63 offen lds
s_add_u32 m0, s67, 10240
s_add_u32 s63, s68, 0xa0000
buffer_load_dwordx4 v20, s[12:15], s63 offen lds
s_add_u32 m0, s67, 11264
s_add_u32 s63, s68, 0xb0000
buffer_load_dwordx4 v20, s[12:15], s63 offen lds
s_waitcnt vmcnt(12)
ds_read_b64_tr_b16 a[180:181], v21 offset:12288
ds_read_b64_tr_b16 a[182:183], v21 offset:12544
ds_read_b64_tr_b16 a[188:189], v21 offset:12320
ds_read_b64_tr_b16 a[190:191], v21 offset:12576
ds_read_b64_tr_b16 a[196:197], v21 offset:12352
ds_read_b64_tr_b16 a[198:199], v21 offset:12608
ds_read_b64_tr_b16 v[36:37], v21 offset:12384
ds_read_b64_tr_b16 v[38:39], v21 offset:12640
s_waitcnt lgkmcnt(0)
ds_write_b128 v8, v[36:39] offset:13312
s_waitcnt lgkmcnt(0)
s_add_u32 m0, s67, 12288
s_add_u32 s63, s68, 0xc0000
buffer_load_dwordx4 v20, s[12:15], s63 offen lds
s_add_u32 m0, s67, 13312
s_add_u32 s63, s68, 0xd0000
buffer_load_dwordx4 v20, s[12:15], s63 offen lds
s_add_u32 m0, s67, 14336
s_add_u32 s63, s68, 0xe0000
buffer_load_dwordx4 v20, s[12:15], s63 offen lds
s_add_u32 m0, s67, 15360
s_add_u32 s63, s68, 0xf0000
buffer_load_dwordx4 v20, s[12:15], s63 offen lds
s_waitcnt vmcnt(12)
ds_read_b64_tr_b16 a[200:201], v21 offset:0
ds_read_b64_tr_b16 a[202:203], v21 offset:256
ds_read_b64_tr_b16 a[208:209], v21 offset:32
ds_read_b64_tr_b16 a[210:211], v21 offset:288
ds_read_b64_tr_b16 a[216:217], v21 offset:64
ds_read_b64_tr_b16 a[218:219], v21 offset:320
ds_read_b64_tr_b16 v[36:37], v21 offset:96
ds_read_b64_tr_b16 v[38:39], v21 offset:352
s_waitcnt lgkmcnt(0)
ds_write_b128 v8, v[36:39] offset:14336
s_waitcnt lgkmcnt(0)
s_xor_b32 s68, s48, 2
s_lshl_b32 s68, s68, 21
s_add_u32 s68, s68, s72
s_add_u32 m0, s67, 0
s_add_u32 s63, s68, 0x100000
buffer_load_dwordx4 v20, s[12:15], s63 offen lds
s_add_u32 m0, s67, 1024
s_add_u32 s63, s68, 0x110000
buffer_load_dwordx4 v20, s[12:15], s63 offen lds
s_add_u32 m0, s67, 2048
s_add_u32 s63, s68, 0x120000
buffer_load_dwordx4 v20, s[12:15], s63 offen lds
s_add_u32 m0, s67, 3072
s_add_u32 s63, s68, 0x130000
buffer_load_dwordx4 v20, s[12:15], s63 offen lds
s_waitcnt vmcnt(12)
ds_read_b64_tr_b16 a[204:205], v21 offset:4096
ds_read_b64_tr_b16 a[206:207], v21 offset:4352
ds_read_b64_tr_b16 a[212:213], v21 offset:4128
ds_read_b64_tr_b16 a[214:215], v21 offset:4384
ds_read_b64_tr_b16 a[220:221], v21 offset:4160
ds_read_b64_tr_b16 a[222:223], v21 offset:4416
ds_read_b64_tr_b16 v[36:37], v21 offset:4192
ds_read_b64_tr_b16 v[38:39], v21 offset:4448
s_waitcnt lgkmcnt(0)
ds_write_b128 v8, v[36:39] offset:15360
s_waitcnt lgkmcnt(0)
s_add_u32 m0, s67, 4096
s_add_u32 s63, s68, 0x140000
buffer_load_dwordx4 v20, s[12:15], s63 offen lds
s_add_u32 m0, s67, 5120
s_add_u32 s63, s68, 0x150000
buffer_load_dwordx4 v20, s[12:15], s63 offen lds
s_add_u32 m0, s67, 6144
s_add_u32 s63, s68, 0x160000
buffer_load_dwordx4 v20, s[12:15], s63 offen lds
s_add_u32 m0, s67, 7168
s_add_u32 s63, s68, 0x170000
buffer_load_dwordx4 v20, s[12:15], s63 offen lds
s_waitcnt vmcnt(12)
ds_read_b64_tr_b16 a[224:225], v21 offset:8192
ds_read_b64_tr_b16 a[226:227], v21 offset:8448
ds_read_b64_tr_b16 a[232:233], v21 offset:8224
ds_read_b64_tr_b16 a[234:235], v21 offset:8480
ds_read_b64_tr_b16 a[240:241], v21 offset:8256
ds_read_b64_tr_b16 a[242:243], v21 offset:8512
ds_read_b64_tr_b16 v[36:37], v21 offset:8288
ds_read_b64_tr_b16 v[38:39], v21 offset:8544
s_waitcnt lgkmcnt(0)
ds_write_b128 v8, v[36:39] offset:16384
s_waitcnt lgkmcnt(0)
s_xor_b32 s68, s48, 2
s_lshl_b32 s68, s68, 21
s_add_u32 s68, s68, s72
s_add_u32 m0, s67, 8192
s_add_u32 s63, s68, 0x180000
buffer_load_dwordx4 v20, s[12:15], s63 offen lds
s_add_u32 m0, s67, 9216
s_add_u32 s63, s68, 0x190000
buffer_load_dwordx4 v20, s[12:15], s63 offen lds
s_add_u32 m0, s67, 10240
s_add_u32 s63, s68, 0x1a0000
buffer_load_dwordx4 v20, s[12:15], s63 offen lds
s_add_u32 m0, s67, 11264
s_add_u32 s63, s68, 0x1b0000
buffer_load_dwordx4 v20, s[12:15], s63 offen lds
s_waitcnt vmcnt(12)
ds_read_b64_tr_b16 a[228:229], v21 offset:12288
ds_read_b64_tr_b16 a[230:231], v21 offset:12544
ds_read_b64_tr_b16 a[236:237], v21 offset:12320
ds_read_b64_tr_b16 a[238:239], v21 offset:12576
ds_read_b64_tr_b16 a[244:245], v21 offset:12352
ds_read_b64_tr_b16 a[246:247], v21 offset:12608
ds_read_b64_tr_b16 v[36:37], v21 offset:12384
ds_read_b64_tr_b16 v[38:39], v21 offset:12640
s_waitcnt lgkmcnt(0)
ds_write_b128 v8, v[36:39] offset:17408
s_waitcnt lgkmcnt(0)
s_add_u32 m0, s67, 12288
s_add_u32 s63, s68, 0x1c0000
buffer_load_dwordx4 v20, s[12:15], s63 offen lds
s_add_u32 m0, s67, 13312
s_add_u32 s63, s68, 0x1d0000
buffer_load_dwordx4 v20, s[12:15], s63 offen lds
s_add_u32 m0, s67, 14336
s_add_u32 s63, s68, 0x1e0000
buffer_load_dwordx4 v20, s[12:15], s63 offen lds
s_add_u32 m0, s67, 15360
s_add_u32 s63, s68, 0x1f0000
buffer_load_dwordx4 v20, s[12:15], s63 offen lds
s_waitcnt vmcnt(12)
ds_read_b64_tr_b16 a[248:249], v21 offset:0
ds_read_b64_tr_b16 a[250:251], v21 offset:256
ds_read_b64_tr_b16 v[96:97], v21 offset:32
ds_read_b64_tr_b16 v[98:99], v21 offset:288
ds_read_b64_tr_b16 v[104:105], v21 offset:64
ds_read_b64_tr_b16 v[106:107], v21 offset:320
ds_read_b64_tr_b16 v[36:37], v21 offset:96
ds_read_b64_tr_b16 v[38:39], v21 offset:352
s_waitcnt lgkmcnt(0)
ds_write_b128 v8, v[36:39] offset:18432
s_waitcnt lgkmcnt(0)
s_xor_b32 s68, s48, 3
s_lshl_b32 s68, s68, 21
s_add_u32 s68, s68, s72
s_add_u32 m0, s67, 0
s_add_u32 s63, s68, 0x0
buffer_load_dwordx4 v20, s[12:15], s63 offen lds
s_add_u32 m0, s67, 1024
s_add_u32 s63, s68, 0x10000
buffer_load_dwordx4 v20, s[12:15], s63 offen lds
s_add_u32 m0, s67, 2048
s_add_u32 s63, s68, 0x20000
buffer_load_dwordx4 v20, s[12:15], s63 offen lds
s_add_u32 m0, s67, 3072
s_add_u32 s63, s68, 0x30000
buffer_load_dwordx4 v20, s[12:15], s63 offen lds
s_waitcnt vmcnt(12)
ds_read_b64_tr_b16 a[252:253], v21 offset:4096
ds_read_b64_tr_b16 a[254:255], v21 offset:4352
ds_read_b64_tr_b16 v[100:101], v21 offset:4128
ds_read_b64_tr_b16 v[102:103], v21 offset:4384
ds_read_b64_tr_b16 v[108:109], v21 offset:4160
ds_read_b64_tr_b16 v[110:111], v21 offset:4416
ds_read_b64_tr_b16 v[36:37], v21 offset:4192
ds_read_b64_tr_b16 v[38:39], v21 offset:4448
s_waitcnt lgkmcnt(0)
ds_write_b128 v8, v[36:39] offset:19456
s_waitcnt lgkmcnt(0)
s_add_u32 m0, s67, 4096
s_add_u32 s63, s68, 0x40000
buffer_load_dwordx4 v20, s[12:15], s63 offen lds
s_add_u32 m0, s67, 5120
s_add_u32 s63, s68, 0x50000
buffer_load_dwordx4 v20, s[12:15], s63 offen lds
s_add_u32 m0, s67, 6144
s_add_u32 s63, s68, 0x60000
buffer_load_dwordx4 v20, s[12:15], s63 offen lds
s_add_u32 m0, s67, 7168
s_add_u32 s63, s68, 0x70000
buffer_load_dwordx4 v20, s[12:15], s63 offen lds
s_waitcnt vmcnt(12)
ds_read_b64_tr_b16 v[112:113], v21 offset:8192
ds_read_b64_tr_b16 v[114:115], v21 offset:8448
ds_read_b64_tr_b16 v[120:121], v21 offset:8224
ds_read_b64_tr_b16 v[122:123], v21 offset:8480
ds_read_b64_tr_b16 v[128:129], v21 offset:8256
ds_read_b64_tr_b16 v[130:131], v21 offset:8512
ds_read_b64_tr_b16 v[36:37], v21 offset:8288
ds_read_b64_tr_b16 v[38:39], v21 offset:8544
s_waitcnt lgkmcnt(0)
ds_write_b128 v8, v[36:39] offset:20480
s_waitcnt lgkmcnt(0)
s_xor_b32 s68, s48, 3
s_lshl_b32 s68, s68, 21
s_add_u32 s68, s68, s72
s_add_u32 m0, s67, 8192
s_add_u32 s63, s68, 0x80000
buffer_load_dwordx4 v20, s[12:15], s63 offen lds
s_add_u32 m0, s67, 9216
s_add_u32 s63, s68, 0x90000
buffer_load_dwordx4 v20, s[12:15], s63 offen lds
s_add_u32 m0, s67, 10240
s_add_u32 s63, s68, 0xa0000
buffer_load_dwordx4 v20, s[12:15], s63 offen lds
s_add_u32 m0, s67, 11264
s_add_u32 s63, s68, 0xb0000
buffer_load_dwordx4 v20, s[12:15], s63 offen lds
s_waitcnt vmcnt(12)
ds_read_b64_tr_b16 v[116:117], v21 offset:12288
ds_read_b64_tr_b16 v[118:119], v21 offset:12544
ds_read_b64_tr_b16 v[124:125], v21 offset:12320
ds_read_b64_tr_b16 v[126:127], v21 offset:12576
ds_read_b64_tr_b16 v[132:133], v21 offset:12352
ds_read_b64_tr_b16 v[134:135], v21 offset:12608
ds_read_b64_tr_b16 v[36:37], v21 offset:12384
ds_read_b64_tr_b16 v[38:39], v21 offset:12640
s_waitcnt lgkmcnt(0)
ds_write_b128 v8, v[36:39] offset:21504
s_waitcnt lgkmcnt(0)
s_add_u32 m0, s67, 12288
s_add_u32 s63, s68, 0xc0000
buffer_load_dwordx4 v20, s[12:15], s63 offen lds
s_add_u32 m0, s67, 13312
s_add_u32 s63, s68, 0xd0000
buffer_load_dwordx4 v20, s[12:15], s63 offen lds
s_add_u32 m0, s67, 14336
s_add_u32 s63, s68, 0xe0000
buffer_load_dwordx4 v20, s[12:15], s63 offen lds
s_add_u32 m0, s67, 15360
s_add_u32 s63, s68, 0xf0000
buffer_load_dwordx4 v20, s[12:15], s63 offen lds
s_waitcnt vmcnt(12)
ds_read_b64_tr_b16 v[136:137], v21 offset:0
ds_read_b64_tr_b16 v[138:139], v21 offset:256
ds_read_b64_tr_b16 v[144:145], v21 offset:32
ds_read_b64_tr_b16 v[146:147], v21 offset:288
ds_read_b64_tr_b16 v[152:153], v21 offset:64
ds_read_b64_tr_b16 v[154:155], v21 offset:320
ds_read_b64_tr_b16 v[36:37], v21 offset:96
ds_read_b64_tr_b16 v[38:39], v21 offset:352
s_waitcnt lgkmcnt(0)
ds_write_b128 v8, v[36:39] offset:22528
s_waitcnt lgkmcnt(0)
s_xor_b32 s68, s48, 3
s_lshl_b32 s68, s68, 21
s_add_u32 s68, s68, s72
s_add_u32 m0, s67, 0
s_add_u32 s63, s68, 0x100000
buffer_load_dwordx4 v20, s[12:15], s63 offen lds
s_add_u32 m0, s67, 1024
s_add_u32 s63, s68, 0x110000
buffer_load_dwordx4 v20, s[12:15], s63 offen lds
s_add_u32 m0, s67, 2048
s_add_u32 s63, s68, 0x120000
buffer_load_dwordx4 v20, s[12:15], s63 offen lds
s_add_u32 m0, s67, 3072
s_add_u32 s63, s68, 0x130000
buffer_load_dwordx4 v20, s[12:15], s63 offen lds
s_waitcnt vmcnt(12)
ds_read_b64_tr_b16 v[140:141], v21 offset:4096
ds_read_b64_tr_b16 v[142:143], v21 offset:4352
ds_read_b64_tr_b16 v[148:149], v21 offset:4128
ds_read_b64_tr_b16 v[150:151], v21 offset:4384
ds_read_b64_tr_b16 v[156:157], v21 offset:4160
ds_read_b64_tr_b16 v[158:159], v21 offset:4416
ds_read_b64_tr_b16 v[36:37], v21 offset:4192
ds_read_b64_tr_b16 v[38:39], v21 offset:4448
s_waitcnt lgkmcnt(0)
ds_write_b128 v8, v[36:39] offset:23552
s_waitcnt lgkmcnt(0)
s_add_u32 m0, s67, 4096
s_add_u32 s63, s68, 0x140000
buffer_load_dwordx4 v20, s[12:15], s63 offen lds
s_add_u32 m0, s67, 5120
s_add_u32 s63, s68, 0x150000
buffer_load_dwordx4 v20, s[12:15], s63 offen lds
s_add_u32 m0, s67, 6144
s_add_u32 s63, s68, 0x160000
buffer_load_dwordx4 v20, s[12:15], s63 offen lds
s_add_u32 m0, s67, 7168
s_add_u32 s63, s68, 0x170000
buffer_load_dwordx4 v20, s[12:15], s63 offen lds
s_waitcnt vmcnt(12)
ds_read_b64_tr_b16 v[160:161], v21 offset:8192
ds_read_b64_tr_b16 v[162:163], v21 offset:8448
ds_read_b64_tr_b16 v[168:169], v21 offset:8224
ds_read_b64_tr_b16 v[170:171], v21 offset:8480
ds_read_b64_tr_b16 v[176:177], v21 offset:8256
ds_read_b64_tr_b16 v[178:179], v21 offset:8512
ds_read_b64_tr_b16 v[184:185], v21 offset:8288
ds_read_b64_tr_b16 v[186:187], v21 offset:8544
s_waitcnt lgkmcnt(0)
s_xor_b32 s68, s48, 3
s_lshl_b32 s68, s68, 21
s_add_u32 s68, s68, s72
s_add_u32 m0, s67, 8192
s_add_u32 s63, s68, 0x180000
buffer_load_dwordx4 v20, s[12:15], s63 offen lds
s_add_u32 m0, s67, 9216
s_add_u32 s63, s68, 0x190000
buffer_load_dwordx4 v20, s[12:15], s63 offen lds
s_add_u32 m0, s67, 10240
s_add_u32 s63, s68, 0x1a0000
buffer_load_dwordx4 v20, s[12:15], s63 offen lds
s_add_u32 m0, s67, 11264
s_add_u32 s63, s68, 0x1b0000
buffer_load_dwordx4 v20, s[12:15], s63 offen lds
s_waitcnt vmcnt(12)
ds_read_b64_tr_b16 v[164:165], v21 offset:12288
ds_read_b64_tr_b16 v[166:167], v21 offset:12544
ds_read_b64_tr_b16 v[172:173], v21 offset:12320
ds_read_b64_tr_b16 v[174:175], v21 offset:12576
ds_read_b64_tr_b16 v[180:181], v21 offset:12352
ds_read_b64_tr_b16 v[182:183], v21 offset:12608
ds_read_b64_tr_b16 v[188:189], v21 offset:12384
ds_read_b64_tr_b16 v[190:191], v21 offset:12640
s_waitcnt lgkmcnt(0)
s_add_u32 m0, s67, 12288
s_add_u32 s63, s68, 0x1c0000
buffer_load_dwordx4 v20, s[12:15], s63 offen lds
s_add_u32 m0, s67, 13312
s_add_u32 s63, s68, 0x1d0000
buffer_load_dwordx4 v20, s[12:15], s63 offen lds
s_add_u32 m0, s67, 14336
s_add_u32 s63, s68, 0x1e0000
buffer_load_dwordx4 v20, s[12:15], s63 offen lds
s_add_u32 m0, s67, 15360
s_add_u32 s63, s68, 0x1f0000
buffer_load_dwordx4 v20, s[12:15], s63 offen lds
v_mov_b32 v56, 0
buffer_load_dwordx4 v[48:51], v56, s[20:23], 0 offen offset:128 sc1
buffer_load_dwordx4 v[52:55], v56, s[20:23], 0 offen offset:144 sc1
buffer_load_dword v58, v56, s[20:23], 0 offen offset:160 sc1
s_waitcnt vmcnt(12)
ds_read_b64_tr_b16 v[192:193], v21 offset:0
ds_read_b64_tr_b16 v[194:195], v21 offset:256
ds_read_b64_tr_b16 v[200:201], v21 offset:32
ds_read_b64_tr_b16 v[202:203], v21 offset:288
ds_read_b64_tr_b16 v[208:209], v21 offset:64
ds_read_b64_tr_b16 v[210:211], v21 offset:320
ds_read_b64_tr_b16 v[216:217], v21 offset:96
ds_read_b64_tr_b16 v[218:219], v21 offset:352
s_waitcnt lgkmcnt(0)
s_waitcnt vmcnt(8)
ds_read_b64_tr_b16 v[196:197], v21 offset:4096
ds_read_b64_tr_b16 v[198:199], v21 offset:4352
ds_read_b64_tr_b16 v[204:205], v21 offset:4128
ds_read_b64_tr_b16 v[206:207], v21 offset:4384
ds_read_b64_tr_b16 v[212:213], v21 offset:4160
ds_read_b64_tr_b16 v[214:215], v21 offset:4416
ds_read_b64_tr_b16 v[220:221], v21 offset:4192
ds_read_b64_tr_b16 v[222:223], v21 offset:4448
s_waitcnt lgkmcnt(0)
s_waitcnt vmcnt(4)
ds_read_b64_tr_b16 v[224:225], v21 offset:8192
ds_read_b64_tr_b16 v[226:227], v21 offset:8448
ds_read_b64_tr_b16 v[232:233], v21 offset:8224
ds_read_b64_tr_b16 v[234:235], v21 offset:8480
ds_read_b64_tr_b16 v[240:241], v21 offset:8256
ds_read_b64_tr_b16 v[242:243], v21 offset:8512
ds_read_b64_tr_b16 v[248:249], v21 offset:8288
ds_read_b64_tr_b16 v[250:251], v21 offset:8544
s_waitcnt lgkmcnt(0)
s_waitcnt vmcnt(0)
ds_read_b64_tr_b16 v[228:229], v21 offset:12288
ds_read_b64_tr_b16 v[230:231], v21 offset:12544
ds_read_b64_tr_b16 v[236:237], v21 offset:12320
ds_read_b64_tr_b16 v[238:239], v21 offset:12576
ds_read_b64_tr_b16 v[244:245], v21 offset:12352
ds_read_b64_tr_b16 v[246:247], v21 offset:12608
ds_read_b64_tr_b16 v[252:253], v21 offset:12384
ds_read_b64_tr_b16 v[254:255], v21 offset:12640
s_waitcnt lgkmcnt(0)
s_waitcnt lgkmcnt(0)
s_cmp_lg_u32 s48, 0
s_cbranch_scc1 Lldd_248
s_mov_b32 s60, 12
v_mov_b32 v2, s60
v_mov_b32 v1, 0x40000000
v_cmp_gt_u32 vcc, 1, v0
s_nop 1
v_cndmask_b32 v2, v1, v2, vcc
v_mov_b32 v3, 1
buffer_atomic_add v3, v2, s[20:23], 0 offen sc1
Lldd_248:
s_lshl_b32 s71, s48, 12
s_add_u32 s60, s71, 98304
v_add_u32 v7, s60, v6
v_mov_b32 v80, -1
v_mov_b32 v81, -1
v_mov_b32 v82, -1
v_mov_b32 v83, -1
v_lshlrev_b32 v11, 7, v0
s_lshl_b32 s60, s49, 2
s_add_u32 s60, s60, s48
s_mul_i32 s60, s60, 10240
v_add_u32 v11, s60, v11
v_mov_b32 v56, 0
s_cmp_lg_u32 s100, 0
s_cbranch_scc1 Lws1_250
s_branch Lwsw1_253
Lws_249:
v_mov_b32 v56, 0
buffer_load_dwordx4 v[48:51], v56, s[20:23], 0 offen offset:128 sc1
buffer_load_dwordx4 v[52:55], v56, s[20:23], 0 offen offset:144 sc1
buffer_load_dword v58, v56, s[20:23], 0 offen offset:160 sc1
Lwsw1_253:
s_waitcnt vmcnt(0)
v_readfirstlane_b32 s97, v58
v_add3_u32 v57, v48, v49, v50
v_add3_u32 v57, v57, v51, v52
v_add3_u32 v57, v57, v53, v54
v_add_u32 v57, v57, v55
v_cmp_le_u32 vcc, 0x100, v57
s_nop 0
s_cmp_eq_u64 vcc, -1
s_cbranch_scc0 Lrt_254
v_or3_b32 v57, v48, v49, v50
v_or3_b32 v57, v57, v51, v52
v_or3_b32 v57, v57, v53, v54
v_or_b32 v57, v57, v55
v_cmp_eq_u32 vcc, 256, v57
s_nop 0
s_cmp_eq_u64 vcc, -1
s_cbranch_scc1 Lws2_251
s_branch L_restart
Lws1_250:
buffer_load_dword v48, v56, s[20:23], 0 offen sc1
s_waitcnt vmcnt(0)
v_cmp_le_u32 vcc, 0x100, v48
s_nop 0
s_cmp_eq_u64 vcc, -1
s_cbranch_scc0 Lrt_255
Lws2_251:
s_add_u32 s64, s100, 1
s_mov_b32 s98, 64
s_mov_b32 s99, 0xfffffff3
s_barrier
s_mov_b32 s62, 0
s_cmp_lg_u32 s100, 0
s_cbranch_scc1 Lnear2_257
s_cmp_lg_u32 s97, 0
s_cbranch_scc1 Lnear3_258
v_mov_b32 v1, 160
Lnear_256:
buffer_load_dword v1, v1, s[20:23], 0 offen sc1
s_waitcnt vmcnt(0)
v_readfirstlane_b32 s97, v1
v_mov_b32 v1, 160
s_cmp_eq_u32 s97, 0
s_cbranch_scc1 Lrt_259
Lnear3_258:
s_and_b32 s62, s97, 2
s_lshl_b32 s62, s62, 12
Lnear2_257:
s_xor_b32 s63, s62, 0x2000
v_add_u32 v9, s62, v9
s_mov_b32 s62, 0
s_cmp_lg_u32 s100, 0
s_cbranch_scc1 Lnear2_261
s_cmp_lg_u32 s97, 0
s_cbranch_scc1 Lnear3_262
v_mov_b32 v1, 160
Lnear_260:
buffer_load_dword v1, v1, s[20:23], 0 offen sc1
s_waitcnt vmcnt(0)
v_readfirstlane_b32 s97, v1
v_mov_b32 v1, 160
s_cmp_eq_u32 s97, 0
s_cbranch_scc1 Lrt_263
Lnear3_262:
s_and_b32 s62, s97, 2
s_lshl_b32 s62, s62, 12
Lnear2_261:
s_add_u32 s73, s73, s62
s_add_u32 s28, s66, 0x0
buffer_load_dword v10, v11, s[4:7], s28 offen sc1
buffer_load_dword v10, v11, s[4:7], s28 offen offset:2048 sc1
s_mov_b32 s52, 0
s_cmp_lg_u32 s64, 1
s_cbranch_scc1 LVM_top_s
.p2align 6
LVM_top_f:
s_cmp_lt_u32 s52, 64
s_cselect_b32 s27, 0, 0xa0000
s_add_u32 s27, s27, s66
s_and_b32 s24, s52, 3
s_lshl_b32 s24, s24, 14
s_add_u32 s24, s24, s27
s_add_u32 s24, s24, s71
buffer_load_dwordx4 v[32:35], v6, s[4:7], s24 offen offset:0 sc1
buffer_load_dwordx4 v[36:39], v6, s[4:7], s24 offen offset:1024 sc1
buffer_load_dwordx4 v[40:43], v6, s[4:7], s24 offen offset:2048 sc1
buffer_load_dwordx4 v[44:47], v6, s[4:7], s24 offen offset:3072 sc1
ds_read_b128 v[60:63], v8 offset:0
ds_read_b128 v[64:67], v8 offset:1024
ds_read_b128 v[68:71], v8 offset:2048
ds_read_b128 v[72:75], v8 offset:3072
v_mov_b32 v16, 0
v_mov_b32 v17, 0
v_mov_b32 v18, 0
v_mov_b32 v19, 0
v_mov_b32 v20, 0
v_mov_b32 v21, 0
v_mov_b32 v22, 0
v_mov_b32 v23, 0
v_mov_b32 v24, 0
v_mov_b32 v25, 0
v_mov_b32 v26, 0
v_mov_b32 v27, 0
v_mov_b32 v28, 0
v_mov_b32 v29, 0
v_mov_b32 v30, 0
v_mov_b32 v31, 0
s_cmp_lt_u32 s52, 64
s_cselect_b32 s27, 0, 0xa0000
s_add_u32 s27, s27, s66
s_and_b32 s25, s52, 3
s_lshl_b32 s25, s25, 15
s_xor_b32 s26, s25, 0x10000
s_add_u32 s26, s26, s27
s_add_u32 s25, s25, s27
s_add_u32 s25, s25, s70
s_add_u32 s26, s26, s70
s_add_u32 s60, s52, 1
s_add_u32 s99, s99, 1
s_cmp_lt_u32 s99, 103
s_cselect_b32 s53, s98, s60
s_cselect_b32 s98, s60, s98
s_branch LVM_chk_f
LVM_poll_f:
buffer_load_dwordx4 v[32:35], v6, s[4:7], s24 offen offset:0 sc1
buffer_load_dwordx4 v[36:39], v6, s[4:7], s24 offen offset:1024 sc1
buffer_load_dwordx4 v[40:43], v6, s[4:7], s24 offen offset:2048 sc1
buffer_load_dwordx4 v[44:47], v6, s[4:7], s24 offen offset:3072 sc1
s_add_u32 s96, s96, 1
s_cmp_ge_u32 s96, 1048576
s_cbranch_scc1 Lto_264
LVM_chk_f:
s_waitcnt vmcnt(3)
v_max3_u32 v0, v32, v33, v34
v_max_u32 v0, v0, v35
s_waitcnt vmcnt(2)
v_max3_u32 v0, v0, v36, v37
v_max3_u32 v0, v0, v38, v39
s_waitcnt vmcnt(1)
v_max3_u32 v0, v0, v40, v41
v_max3_u32 v0, v0, v42, v43
s_waitcnt vmcnt(0)
v_max3_u32 v0, v0, v44, v45
v_max3_u32 v0, v0, v46, v47
v_cmp_eq_u32 vcc, -1, v0
s_nop 0
s_cbranch_vccnz LVM_poll_f
v_smfmac_f32_16x16x64_bf16 v[16:19], v[32:35], a[0:7], v5
ds_write_b128 v7, v[32:35] offset:0
v_smfmac_f32_16x16x64_bf16 v[24:27], v[32:35], a[16:23], v5
ds_write_b128 v7, v[36:39] offset:1024
v_smfmac_f32_16x16x64_bf16 v[20:23], v[32:35], a[8:15], v5
ds_write_b128 v7, v[40:43] offset:2048
v_smfmac_f32_16x16x64_bf16 v[28:31], v[32:35], a[24:31], v5
ds_write_b128 v7, v[44:47] offset:3072
v_smfmac_f32_16x16x64_bf16 v[16:19], v[36:39], a[32:39], v5
v_smfmac_f32_16x16x64_bf16 v[24:27], v[36:39], a[48:55], v5
v_xor_b32 v0, 4096, v7
v_smfmac_f32_16x16x64_bf16 v[20:23], v[36:39], a[40:47], v5
s_waitcnt lgkmcnt(0)
v_smfmac_f32_16x16x64_bf16 v[28:31], v[36:39], v[60:67], v5
s_barrier
ds_read_b128 v[52:55], v0 offset:0
v_smfmac_f32_16x16x64_bf16 v[16:19], v[40:43], a[56:63], v5
ds_read_b128 v[60:63], v8 offset:4096
v_smfmac_f32_16x16x64_bf16 v[24:27], v[40:43], a[72:79], v5
ds_read_b128 v[64:67], v8 offset:5120
v_smfmac_f32_16x16x64_bf16 v[20:23], v[40:43], a[64:71], v5
ds_read_b128 v[56:59], v0 offset:1024
v_smfmac_f32_16x16x64_bf16 v[28:31], v[40:43], v[68:75], v5
ds_read_b128 v[48:51], v0 offset:2048
v_smfmac_f32_16x16x64_bf16 v[16:19], v[44:47], a[80:87], v5
ds_read_b128 v[68:71], v8 offset:6144
v_smfmac_f32_16x16x64_bf16 v[24:27], v[44:47], a[96:103], v5
ds_read_b128 v[72:75], v8 offset:7168
v_smfmac_f32_16x16x64_bf16 v[20:23], v[44:47], a[88:95], v5
s_waitcnt lgkmcnt(4)
v_smfmac_f32_16x16x64_bf16 v[28:31], v[44:47], v[60:67], v5
v_smfmac_f32_16x16x64_bf16 v[16:19], v[52:55], a[104:111], v5
ds_read_b128 v[60:63], v8 offset:8192
v_smfmac_f32_16x16x64_bf16 v[24:27], v[52:55], a[120:127], v5
ds_read_b128 v[64:67], v8 offset:9216
v_smfmac_f32_16x16x64_bf16 v[20:23], v[52:55], a[112:119], v5
s_waitcnt lgkmcnt(2)
v_smfmac_f32_16x16x64_bf16 v[28:31], v[52:55], v[68:75], v5
ds_read_b128 v[52:55], v0 offset:3072
v_smfmac_f32_16x16x64_bf16 v[16:19], v[56:59], a[128:135], v5
ds_read_b128 v[68:71], v8 offset:10240
v_smfmac_f32_16x16x64_bf16 v[24:27], v[56:59], a[144:151], v5
ds_read_b128 v[72:75], v8 offset:11264
v_smfmac_f32_16x16x64_bf16 v[20:23], v[56:59], a[136:143], v5
s_waitcnt lgkmcnt(3)
v_xor_b32 v0, 8192, v7
v_smfmac_f32_16x16x64_bf16 v[28:31], v[56:59], v[60:67], v5
ds_read_b128 v[56:59], v0 offset:0
v_smfmac_f32_16x16x64_bf16 v[16:19], v[48:51], a[152:159], v5
ds_read_b128 v[60:63], v8 offset:12288
v_smfmac_f32_16x16x64_bf16 v[24:27], v[48:51], a[168:175], v5
ds_read_b128 v[64:67], v8 offset:13312
v_smfmac_f32_16x16x64_bf16 v[20:23], v[48:51], a[160:167], v5
s_waitcnt lgkmcnt(3)
v_smfmac_f32_16x16x64_bf16 v[28:31], v[48:51], v[68:75], v5
ds_read_b128 v[48:51], v0 offset:1024
v_smfmac_f32_16x16x64_bf16 v[16:19], v[52:55], a[176:183], v5
ds_read_b128 v[68:71], v8 offset:14336
v_smfmac_f32_16x16x64_bf16 v[24:27], v[52:55], a[192:199], v5
ds_read_b128 v[72:75], v8 offset:15360
v_smfmac_f32_16x16x64_bf16 v[20:23], v[52:55], a[184:191], v5
s_waitcnt lgkmcnt(3)
v_smfmac_f32_16x16x64_bf16 v[28:31], v[52:55], v[60:67], v5
ds_read_b128 v[52:55], v0 offset:2048
v_smfmac_f32_16x16x64_bf16 v[16:19], v[56:59], a[200:207], v5
ds_read_b128 v[60:63], v8 offset:16384
v_smfmac_f32_16x16x64_bf16 v[24:27], v[56:59], a[216:223], v5
ds_read_b128 v[64:67], v8 offset:17408
v_smfmac_f32_16x16x64_bf16 v[20:23], v[56:59], a[208:215], v5
s_waitcnt lgkmcnt(3)
v_smfmac_f32_16x16x64_bf16 v[28:31], v[56:59], v[68:75], v5
ds_read_b128 v[56:59], v0 offset:3072
v_smfmac_f32_16x16x64_bf16 v[16:19], v[48:51], a[224:231], v5
ds_read_b128 v[68:71], v8 offset:18432
v_smfmac_f32_16x16x64_bf16 v[24:27], v[48:51], a[240:247], v5
ds_read_b128 v[72:75], v8 offset:19456
v_smfmac_f32_16x16x64_bf16 v[20:23], v[48:51], a[232:239], v5
s_waitcnt lgkmcnt(3)
v_xor_b32 v0, 12288, v7
v_smfmac_f32_16x16x64_bf16 v[28:31], v[48:51], v[60:67], v5
ds_read_b128 v[48:51], v0 offset:0
v_smfmac_f32_16x16x64_bf16 v[16:19], v[52:55], a[248:255], v5
ds_read_b128 v[60:63], v8 offset:20480
v_smfmac_f32_16x16x64_bf16 v[24:27], v[52:55], v[104:111], v5
ds_read_b128 v[64:67], v8 offset:21504
v_smfmac_f32_16x16x64_bf16 v[20:23], v[52:55], v[96:103], v5
s_waitcnt lgkmcnt(3)
v_smfmac_f32_16x16x64_bf16 v[28:31], v[52:55], v[68:75], v5
ds_read_b128 v[52:55], v0 offset:1024
v_smfmac_f32_16x16x64_bf16 v[16:19], v[56:59], v[112:119], v5
ds_read_b128 v[68:71], v8 offset:22528
v_smfmac_f32_16x16x64_bf16 v[24:27], v[56:59], v[128:135], v5
ds_read_b128 v[72:75], v8 offset:23552
v_smfmac_f32_16x16x64_bf16 v[20:23], v[56:59], v[120:127], v5
s_waitcnt lgkmcnt(3)
v_smfmac_f32_16x16x64_bf16 v[28:31], v[56:59], v[60:67], v5
ds_read_b128 v[56:59], v0 offset:2048
v_smfmac_f32_16x16x64_bf16 v[16:19], v[48:51], v[136:143], v5
v_smfmac_f32_16x16x64_bf16 v[24:27], v[48:51], v[152:159], v5
v_smfmac_f32_16x16x64_bf16 v[20:23], v[48:51], v[144:151], v5
s_waitcnt lgkmcnt(1)
v_smfmac_f32_16x16x64_bf16 v[28:31], v[48:51], v[68:75], v5
ds_read_b128 v[48:51], v0 offset:3072
v_smfmac_f32_16x16x64_bf16 v[16:19], v[52:55], v[160:167], v5
v_smfmac_f32_16x16x64_bf16 v[24:27], v[52:55], v[176:183], v5
s_waitcnt lgkmcnt(1)
v_smfmac_f32_16x16x64_bf16 v[16:19], v[56:59], v[192:199], v5
v_smfmac_f32_16x16x64_bf16 v[24:27], v[56:59], v[208:215], v5
s_waitcnt lgkmcnt(0)
v_smfmac_f32_16x16x64_bf16 v[16:19], v[48:51], v[224:231], v5
v_smfmac_f32_16x16x64_bf16 v[24:27], v[48:51], v[240:247], v5
s_nop 0
v_smfmac_f32_16x16x64_bf16 v[20:23], v[52:55], v[168:175], v5
s_nop 0
v_smfmac_f32_16x16x64_bf16 v[28:31], v[52:55], v[184:191], v5
s_nop 0
v_smfmac_f32_16x16x64_bf16 v[20:23], v[56:59], v[200:207], v5
s_nop 0
v_add_f32 v16, v16, v18
v_smfmac_f32_16x16x64_bf16 v[28:31], v[56:59], v[216:223], v5
v_add_f32 v17, v17, v19
v_smfmac_f32_16x16x64_bf16 v[20:23], v[48:51], v[232:239], v5
v_add_f32 v24, v24, v26
v_smfmac_f32_16x16x64_bf16 v[28:31], v[48:51], v[248:255], v5
v_add_f32 v25, v25, v27
v_cvt_pk_bf16_f32 v76, v16, v17
v_cvt_pk_bf16_f32 v78, v24, v25
s_nop 2
v_pk_add_f32 v[20:21], v[20:21], v[22:23]
s_nop 0
v_pk_add_f32 v[28:29], v[28:29], v[30:31]
v_cvt_pk_bf16_f32 v77, v20, v21
v_cvt_pk_bf16_f32 v79, v28, v29
buffer_store_dwordx4 v[76:79], v6, s[4:7], s25 offen
buffer_store_dwordx4 v[80:83], v6, s[4:7], s26 offen
s_and_b32 s29, s52, 8
s_lshl_b32 s29, s29, 10
s_xor_b32 s29, s29, s73
s_lshl_b32 s61, s52, 18
s_add_u32 s29, s29, s61
buffer_store_dwordx4 v[76:79], v6, s[4:7], s29 offen sc1
s_and_b32 s58, s52, 64
s_lshl_b32 s58, s58, 12
s_add_u32 s60, s52, 1
v_mov_b32 v10, s60
s_waitcnt vmcnt(0)
buffer_store_dword v10, v9, s[4:7], s58 offen sc1
s_cmp_lg_u32 s52, 10
s_cbranch_scc1 Lwarm_265
s_add_u32 s28, s66, 0xa0000
buffer_load_dword v10, v11, s[4:7], s28 offen sc1
buffer_load_dword v10, v11, s[4:7], s28 offen offset:2048 sc1
Lwarm_265:
v_xor_b32 v7, 0x4000, v7
s_mov_b32 s52, s53
s_cmp_lt_u32 s52, 128
s_cbranch_scc1 LVM_top_f
s_waitcnt vmcnt(0)
s_endpgm
Lrt_254:
s_add_u32 s96, s96, 1
s_cmp_lt_u32 s96, 1048576
s_cbranch_scc1 Lws_249
s_mov_b32 s97, 1
s_branch L_fail
Lrt_255:
s_add_u32 s96, s96, 1
s_cmp_lt_u32 s96, 1048576
s_cbranch_scc1 Lws1_250
s_mov_b32 s97, 1
s_branch L_fail
Lrt_259:
s_add_u32 s96, s96, 1
s_cmp_lt_u32 s96, 1048576
s_cbranch_scc1 Lnear_256
s_mov_b32 s97, 24
s_branch L_fail
Lrt_263:
s_add_u32 s96, s96, 1
s_cmp_lt_u32 s96, 1048576
s_cbranch_scc1 Lnear_260
s_mov_b32 s97, 24
s_branch L_fail
Lto_264:
s_mov_b32 s97, 15
s_branch L_fail
.p2align 6
LVM_top_s:
s_cmp_lt_u32 s52, 64
s_cselect_b32 s27, 0, 0xa0000
s_add_u32 s27, s27, s66
s_and_b32 s24, s52, 3
s_lshl_b32 s24, s24, 14
s_add_u32 s24, s24, s27
s_add_u32 s24, s24, s71
buffer_load_dwordx4 v[32:35], v6, s[4:7], s24 offen offset:0 sc1
buffer_load_dwordx4 v[36:39], v6, s[4:7], s24 offen offset:1024 sc1
buffer_load_dwordx4 v[40:43], v6, s[4:7], s24 offen offset:2048 sc1
buffer_load_dwordx4 v[44:47], v6, s[4:7], s24 offen offset:3072 sc1
ds_read_b128 v[60:63], v8 offset:0
ds_read_b128 v[64:67], v8 offset:1024
ds_read_b128 v[68:71], v8 offset:2048
ds_read_b128 v[72:75], v8 offset:3072
v_mov_b32 v16, 0
v_mov_b32 v17, 0
v_mov_b32 v18, 0
v_mov_b32 v19, 0
v_mov_b32 v20, 0
v_mov_b32 v21, 0
v_mov_b32 v22, 0
v_mov_b32 v23, 0
v_mov_b32 v24, 0
v_mov_b32 v25, 0
v_mov_b32 v26, 0
v_mov_b32 v27, 0
v_mov_b32 v28, 0
v_mov_b32 v29, 0
v_mov_b32 v30, 0
v_mov_b32 v31, 0
s_cmp_lt_u32 s52, 64
s_cselect_b32 s27, 0, 0xa0000
s_add_u32 s27, s27, s66
s_and_b32 s25, s52, 3
s_lshl_b32 s25, s25, 15
s_xor_b32 s26, s25, 0x10000
s_add_u32 s26, s26, s27
s_add_u32 s25, s25, s27
s_add_u32 s25, s25, s70
s_add_u32 s26, s26, s70
s_add_u32 s60, s52, 1
s_add_u32 s99, s99, 1
s_cmp_lt_u32 s99, 103
s_cselect_b32 s53, s98, s60
s_cselect_b32 s98, s60, s98
s_branch LVM_chk_s
LVM_poll_s:
buffer_load_dwordx4 v[32:35], v6, s[4:7], s24 offen offset:0 sc1
buffer_load_dwordx4 v[36:39], v6, s[4:7], s24 offen offset:1024 sc1
buffer_load_dwordx4 v[40:43], v6, s[4:7], s24 offen offset:2048 sc1
buffer_load_dwordx4 v[44:47], v6, s[4:7], s24 offen offset:3072 sc1
s_add_u32 s96, s96, 1
s_cmp_ge_u32 s96, 1048576
s_cbranch_scc1 Lto_266
LVM_chk_s:
s_waitcnt vmcnt(3)
v_max3_u32 v0, v32, v33, v34
v_max_u32 v0, v0, v35
s_waitcnt vmcnt(2)
v_max3_u32 v0, v0, v36, v37
v_max3_u32 v0, v0, v38, v39
s_waitcnt vmcnt(1)
v_max3_u32 v0, v0, v40, v41
v_max3_u32 v0, v0, v42, v43
s_waitcnt vmcnt(0)
v_max3_u32 v0, v0, v44, v45
v_max3_u32 v0, v0, v46, v47
v_cmp_eq_u32 vcc, -1, v0
s_nop 0
s_cbranch_vccnz LVM_poll_s
v_smfmac_f32_16x16x64_bf16 v[16:19], v[32:35], a[0:7], v5
ds_write_b128 v7, v[32:35] offset:0
v_smfmac_f32_16x16x64_bf16 v[24:27], v[32:35], a[16:23], v5
ds_write_b128 v7, v[36:39] offset:1024
v_smfmac_f32_16x16x64_bf16 v[20:23], v[32:35], a[8:15], v5
ds_write_b128 v7, v[40:43] offset:2048
v_smfmac_f32_16x16x64_bf16 v[28:31], v[32:35], a[24:31], v5
ds_write_b128 v7, v[44:47] offset:3072
v_smfmac_f32_16x16x64_bf16 v[16:19], v[36:39], a[32:39], v5
v_smfmac_f32_16x16x64_bf16 v[24:27], v[36:39], a[48:55], v5
v_xor_b32 v0, 4096, v7
v_smfmac_f32_16x16x64_bf16 v[20:23], v[36:39], a[40:47], v5
s_waitcnt lgkmcnt(0)
v_smfmac_f32_16x16x64_bf16 v[28:31], v[36:39], v[60:67], v5
s_barrier
ds_read_b128 v[52:55], v0 offset:0
v_smfmac_f32_16x16x64_bf16 v[16:19], v[40:43], a[56:63], v5
ds_read_b128 v[60:63], v8 offset:4096
v_smfmac_f32_16x16x64_bf16 v[24:27], v[40:43], a[72:79], v5
ds_read_b128 v[64:67], v8 offset:5120
v_smfmac_f32_16x16x64_bf16 v[20:23], v[40:43], a[64:71], v5
ds_read_b128 v[56:59], v0 offset:1024
v_smfmac_f32_16x16x64_bf16 v[28:31], v[40:43], v[68:75], v5
ds_read_b128 v[48:51], v0 offset:2048
v_smfmac_f32_16x16x64_bf16 v[16:19], v[44:47], a[80:87], v5
ds_read_b128 v[68:71], v8 offset:6144
v_smfmac_f32_16x16x64_bf16 v[24:27], v[44:47], a[96:103], v5
ds_read_b128 v[72:75], v8 offset:7168
v_smfmac_f32_16x16x64_bf16 v[20:23], v[44:47], a[88:95], v5
s_waitcnt lgkmcnt(4)
v_smfmac_f32_16x16x64_bf16 v[28:31], v[44:47], v[60:67], v5
v_smfmac_f32_16x16x64_bf16 v[16:19], v[52:55], a[104:111], v5
ds_read_b128 v[60:63], v8 offset:8192
v_smfmac_f32_16x16x64_bf16 v[24:27], v[52:55], a[120:127], v5
ds_read_b128 v[64:67], v8 offset:9216
v_smfmac_f32_16x16x64_bf16 v[20:23], v[52:55], a[112:119], v5
s_waitcnt lgkmcnt(2)
v_smfmac_f32_16x16x64_bf16 v[28:31], v[52:55], v[68:75], v5
ds_read_b128 v[52:55], v0 offset:3072
v_smfmac_f32_16x16x64_bf16 v[16:19], v[56:59], a[128:135], v5
ds_read_b128 v[68:71], v8 offset:10240
v_smfmac_f32_16x16x64_bf16 v[24:27], v[56:59], a[144:151], v5
ds_read_b128 v[72:75], v8 offset:11264
v_smfmac_f32_16x16x64_bf16 v[20:23], v[56:59], a[136:143], v5
s_waitcnt lgkmcnt(3)
v_xor_b32 v0, 8192, v7
v_smfmac_f32_16x16x64_bf16 v[28:31], v[56:59], v[60:67], v5
ds_read_b128 v[56:59], v0 offset:0
v_smfmac_f32_16x16x64_bf16 v[16:19], v[48:51], a[152:159], v5
ds_read_b128 v[60:63], v8 offset:12288
v_smfmac_f32_16x16x64_bf16 v[24:27], v[48:51], a[168:175], v5
ds_read_b128 v[64:67], v8 offset:13312
v_smfmac_f32_16x16x64_bf16 v[20:23], v[48:51], a[160:167], v5
s_waitcnt lgkmcnt(3)
v_smfmac_f32_16x16x64_bf16 v[28:31], v[48:51], v[68:75], v5
ds_read_b128 v[48:51], v0 offset:1024
v_smfmac_f32_16x16x64_bf16 v[16:19], v[52:55], a[176:183], v5
ds_read_b128 v[68:71], v8 offset:14336
v_smfmac_f32_16x16x64_bf16 v[24:27], v[52:55], a[192:199], v5
ds_read_b128 v[72:75], v8 offset:15360
v_smfmac_f32_16x16x64_bf16 v[20:23], v[52:55], a[184:191], v5
s_waitcnt lgkmcnt(3)
v_smfmac_f32_16x16x64_bf16 v[28:31], v[52:55], v[60:67], v5
ds_read_b128 v[52:55], v0 offset:2048
v_smfmac_f32_16x16x64_bf16 v[16:19], v[56:59], a[200:207], v5
ds_read_b128 v[60:63], v8 offset:16384
v_smfmac_f32_16x16x64_bf16 v[24:27], v[56:59], a[216:223], v5
ds_read_b128 v[64:67], v8 offset:17408
v_smfmac_f32_16x16x64_bf16 v[20:23], v[56:59], a[208:215], v5
s_waitcnt lgkmcnt(3)
v_smfmac_f32_16x16x64_bf16 v[28:31], v[56:59], v[68:75], v5
ds_read_b128 v[56:59], v0 offset:3072
v_smfmac_f32_16x16x64_bf16 v[16:19], v[48:51], a[224:231], v5
ds_read_b128 v[68:71], v8 offset:18432
v_smfmac_f32_16x16x64_bf16 v[24:27], v[48:51], a[240:247], v5
ds_read_b128 v[72:75], v8 offset:19456
v_smfmac_f32_16x16x64_bf16 v[20:23], v[48:51], a[232:239], v5
s_waitcnt lgkmcnt(3)
v_xor_b32 v0, 12288, v7
v_smfmac_f32_16x16x64_bf16 v[28:31], v[48:51], v[60:67], v5
ds_read_b128 v[48:51], v0 offset:0
v_smfmac_f32_16x16x64_bf16 v[16:19], v[52:55], a[248:255], v5
ds_read_b128 v[60:63], v8 offset:20480
v_smfmac_f32_16x16x64_bf16 v[24:27], v[52:55], v[104:111], v5
ds_read_b128 v[64:67], v8 offset:21504
v_smfmac_f32_16x16x64_bf16 v[20:23], v[52:55], v[96:103], v5
s_waitcnt lgkmcnt(3)
v_smfmac_f32_16x16x64_bf16 v[28:31], v[52:55], v[68:75], v5
ds_read_b128 v[52:55], v0 offset:1024
v_smfmac_f32_16x16x64_bf16 v[16:19], v[56:59], v[112:119], v5
ds_read_b128 v[68:71], v8 offset:22528
v_smfmac_f32_16x16x64_bf16 v[24:27], v[56:59], v[128:135], v5
ds_read_b128 v[72:75], v8 offset:23552
v_smfmac_f32_16x16x64_bf16 v[20:23], v[56:59], v[120:127], v5
s_waitcnt lgkmcnt(3)
v_smfmac_f32_16x16x64_bf16 v[28:31], v[56:59], v[60:67], v5
ds_read_b128 v[56:59], v0 offset:2048
v_smfmac_f32_16x16x64_bf16 v[16:19], v[48:51], v[136:143], v5
v_smfmac_f32_16x16x64_bf16 v[24:27], v[48:51], v[152:159], v5
v_smfmac_f32_16x16x64_bf16 v[20:23], v[48:51], v[144:151], v5
s_waitcnt lgkmcnt(1)
v_smfmac_f32_16x16x64_bf16 v[28:31], v[48:51], v[68:75], v5
ds_read_b128 v[48:51], v0 offset:3072
v_smfmac_f32_16x16x64_bf16 v[16:19], v[52:55], v[160:167], v5
v_smfmac_f32_16x16x64_bf16 v[24:27], v[52:55], v[176:183], v5
s_waitcnt lgkmcnt(1)
v_smfmac_f32_16x16x64_bf16 v[16:19], v[56:59], v[192:199], v5
v_smfmac_f32_16x16x64_bf16 v[24:27], v[56:59], v[208:215], v5
s_waitcnt lgkmcnt(0)
v_smfmac_f32_16x16x64_bf16 v[16:19], v[48:51], v[224:231], v5
v_smfmac_f32_16x16x64_bf16 v[24:27], v[48:51], v[240:247], v5
s_nop 0
v_smfmac_f32_16x16x64_bf16 v[20:23], v[52:55], v[168:175], v5
s_nop 0
v_smfmac_f32_16x16x64_bf16 v[28:31], v[52:55], v[184:191], v5
s_nop 0
v_smfmac_f32_16x16x64_bf16 v[20:23], v[56:59], v[200:207], v5
s_nop 0
v_add_f32 v16, v16, v18
v_smfmac_f32_16x16x64_bf16 v[28:31], v[56:59], v[216:223], v5
v_add_f32 v17, v17, v19
v_smfmac_f32_16x16x64_bf16 v[20:23], v[48:51], v[232:239], v5
v_add_f32 v24, v24, v26
v_smfmac_f32_16x16x64_bf16 v[28:31], v[48:51], v[248:255], v5
v_add_f32 v25, v25, v27
v_cvt_pk_bf16_f32 v76, v16, v17
v_cvt_pk_bf16_f32 v78, v24, v25
s_nop 2
v_pk_add_f32 v[20:21], v[20:21], v[22:23]
s_nop 0
v_pk_add_f32 v[28:29], v[28:29], v[30:31]
v_cvt_pk_bf16_f32 v77, v20, v21
v_cvt_pk_bf16_f32 v79, v28, v29
buffer_store_dwordx4 v[76:79], v6, s[4:7], s25 offen sc1
buffer_store_dwordx4 v[80:83], v6, s[4:7], s26 offen sc1
s_and_b32 s29, s52, 8
s_lshl_b32 s29, s29, 10
s_xor_b32 s29, s29, s73
s_lshl_b32 s61, s52, 18
s_add_u32 s29, s29, s61
buffer_store_dwordx4 v[76:79], v6, s[4:7], s29 offen sc1
s_and_b32 s58, s52, 64
s_lshl_b32 s58, s58, 12
s_add_u32 s60, s52, 1
v_mov_b32 v10, s60
s_waitcnt vmcnt(0)
buffer_store_dword v10, v9, s[4:7], s58 offen sc1
s_cmp_lg_u32 s52, 10
s_cbranch_scc1 Lwarm_267
s_add_u32 s28, s66, 0xa0000
buffer_load_dword v10, v11, s[4:7], s28 offen sc1
buffer_load_dword v10, v11, s[4:7], s28 offen offset:2048 sc1
Lwarm_267:
v_xor_b32 v7, 0x4000, v7
s_mov_b32 s52, s53
s_cmp_lt_u32 s52, 128
s_cbranch_scc1 LVM_top_s
s_waitcnt vmcnt(0)
s_endpgm
Lto_266:
s_mov_b32 s97, 15
s_branch L_fail
L_WM:
s_mov_b32 s12, s34
s_and_b32 s13, s35, 0xffff
s_mov_b32 s14, 0x800000
s_mov_b32 s15, 0x20000
s_mov_b32 s16, s26
s_and_b32 s17, s27, 0xffff
s_mov_b32 s18, 0x4000
s_mov_b32 s19, 0x20000
s_mul_i32 s66, s50, 0x50000
s_add_u32 s66, s66, 0x200000
s_lshl_b32 s67, s48, 14
s_add_u32 s67, s67, 98304
s_lshl_b32 s65, s50, 8
s_add_u32 s65, s65, 0x340000
v_lshlrev_b32 v6, 4, v0
s_mul_i32 s60, s48, 24576
v_add_u32 v8, s60, v6
v_mov_b32 v1, 0x4444
v_mov_b32 v2, 0xeeee
v_and_b32 v3, 2, v0
v_cmp_eq_u32 vcc, 0, v3
s_nop 1
v_cndmask_b32 v5, v2, v1, vcc
v_lshlrev_b32 v11, 3, v0
s_lshl_b32 s71, s49, 2
s_add_u32 s71, s71, s48
s_lshr_b32 s70, s71, 3
s_lshl_b32 s70, s70, 14
s_and_b32 s60, s71, 7
s_lshl_b32 s60, s60, 10
s_add_u32 s70, s70, s60
s_mul_i32 s60, s50, 0x40000
s_add_u32 s70, s70, s60
s_add_u32 s70, s70, 0x80000
v_bfe_u32 v1, v0, 3, 2
v_lshlrev_b32 v1, 12, v1
v_and_b32 v2, 2, v0
v_lshlrev_b32 v2, 10, v2
v_add_u32 v1, v1, v2
v_and_b32 v2, 32, v0
v_add_u32 v1, v1, v2
v_and_b32 v2, 4, v0
v_lshlrev_b32 v2, 2, v2
v_add_u32 v1, v1, v2
v_and_b32 v2, 1, v0
v_lshlrev_b32 v2, 3, v2
v_add_u32 v1, v1, v2
s_lshl_b32 s60, s71, 6
buffer_load_dwordx2 v[20:21], v1, s[16:19], s60 offen
s_lshl_b32 s71, s71, 9
s_cmp_eq_u32 s71, 0
s_cselect_b32 s60, s65, 0x40000000
v_mov_b32 v7, s60
v_mov_b32 v1, 0x40000000
v_cmp_gt_u32 vcc, 1, v0
s_nop 1
v_cndmask_b32 v7, v1, v7, vcc
v_mov_b32 v1, 0
buffer_store_dword v1, v7, s[4:7], 0 offen sc1
v_mov_b32 v2, 64
buffer_store_dword v2, v7, s[4:7], 0 offen offset:512 sc1
v_mov_b32 v16, -1
v_mov_b32 v17, -1
v_mov_b32 v18, -1
v_mov_b32 v19, -1
s_add_u32 s60, s66, 0x4000
s_add_u32 s60, s60, s71
buffer_store_dwordx2 v[16:17], v11, s[4:7], s60 offen sc1
s_add_u32 s60, s66, 0x8000
s_add_u32 s60, s60, s71
buffer_store_dwordx2 v[16:17], v11, s[4:7], s60 offen sc1
s_add_u32 s60, s66, 0xc000
s_add_u32 s60, s60, s71
buffer_store_dwordx2 v[16:17], v11, s[4:7], s60 offen sc1
s_add_u32 s60, s66, 0xa4000
s_add_u32 s60, s60, s71
buffer_store_dwordx2 v[16:17], v11, s[4:7], s60 offen sc1
s_add_u32 s60, s66, 0xa8000
s_add_u32 s60, s60, s71
buffer_store_dwordx2 v[16:17], v11, s[4:7], s60 offen sc1
s_add_u32 s60, s66, 0xac000
s_add_u32 s60, s60, s71
buffer_store_dwordx2 v[16:17], v11, s[4:7], s60 offen sc1
s_add_u32 s60, s70, 0x0
buffer_store_dwordx4 v[16:19], v6, s[4:7], s60 offen sc1
s_add_u32 s60, s70, 0x2000
buffer_store_dwordx4 v[16:19], v6, s[4:7], s60 offen sc1
s_add_u32 s60, s70, 0x10000
buffer_store_dwordx4 v[16:19], v6, s[4:7], s60 offen sc1
s_add_u32 s60, s70, 0x12000
buffer_store_dwordx4 v[16:19], v6, s[4:7], s60 offen sc1
s_add_u32 s60, s70, 0x20000
buffer_store_dwordx4 v[16:19], v6, s[4:7], s60 offen sc1
s_add_u32 s60, s70, 0x22000
buffer_store_dwordx4 v[16:19], v6, s[4:7], s60 offen sc1
s_add_u32 s60, s70, 0x30000
buffer_store_dwordx4 v[16:19], v6, s[4:7], s60 offen sc1
s_add_u32 s60, s70, 0x32000
buffer_store_dwordx4 v[16:19], v6, s[4:7], s60 offen sc1
s_add_u32 s60, s70, 0x80000
buffer_store_dwordx4 v[16:19], v6, s[4:7], s60 offen sc1
s_add_u32 s60, s70, 0x82000
buffer_store_dwordx4 v[16:19], v6, s[4:7], s60 offen sc1
s_add_u32 s60, s70, 0x90000
buffer_store_dwordx4 v[16:19], v6, s[4:7], s60 offen sc1
s_add_u32 s60, s70, 0x92000
buffer_store_dwordx4 v[16:19], v6, s[4:7], s60 offen sc1
s_add_u32 s60, s70, 0xa0000
buffer_store_dwordx4 v[16:19], v6, s[4:7], s60 offen sc1
s_add_u32 s60, s70, 0xa2000
buffer_store_dwordx4 v[16:19], v6, s[4:7], s60 offen sc1
s_add_u32 s60, s70, 0xb0000
buffer_store_dwordx4 v[16:19], v6, s[4:7], s60 offen sc1
s_add_u32 s60, s70, 0xb2000
buffer_store_dwordx4 v[16:19], v6, s[4:7], s60 offen sc1
s_waitcnt vmcnt(0)
s_add_u32 s60, s66, 0x0
s_add_u32 s60, s60, s71
buffer_store_dwordx2 v[20:21], v11, s[4:7], s60 offen sc1
s_add_u32 s60, s66, 0xa0000
s_add_u32 s60, s60, s71
buffer_store_dwordx2 v[20:21], v11, s[4:7], s60 offen sc1
s_waitcnt vmcnt(0)
s_barrier
s_cmp_lg_u32 s48, 0
s_cbranch_scc1 Larr_268
s_mov_b32 s60, 0
v_mov_b32 v2, s60
v_mov_b32 v1, 0x40000000
v_cmp_gt_u32 vcc, 1, v0
s_nop 1
v_cndmask_b32 v2, v1, v2, vcc
s_sub_u32 s61, s101, s2
s_and_b32 s61, s61, 7
s_lshl_b32 s61, s61, 2
s_add_u32 s61, s61, 128
s_cmp_eq_u32 s100, 0
s_cselect_b32 s61, s61, 0
v_mov_b32 v3, 1
buffer_atomic_add v3, v2, s[20:23], s61 offen sc1
Larr_268:
s_lshl_b32 s68, s50, 2
s_add_u32 s68, s68, s48
s_lshl_b32 s68, s68, 20
s_lshl_b32 s60, s49, 8
s_add_u32 s68, s68, s60
v_lshrrev_b32 v1, 3, v0
v_mul_u32_u24 v1, 2048, v1
v_and_b32 v2, 7, v0
v_lshlrev_b32 v2, 4, v2
v_add_u32 v20, v1, v2
v_lshrrev_b32 v1, 4, v0
v_bfe_u32 v2, v0, 2, 2
v_and_b32 v3, 3, v0
v_lshrrev_b32 v4, 1, v1
v_mul_u32_u24 v4, 8, v4
v_and_b32 v1, 1, v1
v_mul_u32_u24 v1, 16, v1
v_add_u32 v1, v1, v4
v_lshrrev_b32 v4, 1, v2
v_mul_u32_u24 v4, 4, v4
v_add_u32 v1, v1, v4
v_and_b32 v2, 1, v2
v_add_u32 v1, v1, v2
v_mul_u32_u24 v1, 128, v1
v_mul_u32_u24 v3, 8, v3
v_add3_u32 v21, v1, v3, s67
s_add_u32 m0, s67, 0
s_add_u32 s63, s68, 0x0
buffer_load_dwordx4 v20, s[12:15], s63 offen lds
s_add_u32 m0, s67, 1024
s_add_u32 s63, s68, 0x4000
buffer_load_dwordx4 v20, s[12:15], s63 offen lds
s_add_u32 m0, s67, 2048
s_add_u32 s63, s68, 0x8000
buffer_load_dwordx4 v20, s[12:15], s63 offen lds
s_add_u32 m0, s67, 3072
s_add_u32 s63, s68, 0xc000
buffer_load_dwordx4 v20, s[12:15], s63 offen lds
s_add_u32 m0, s67, 4096
s_add_u32 s63, s68, 0x10000
buffer_load_dwordx4 v20, s[12:15], s63 offen lds
s_add_u32 m0, s67, 5120
s_add_u32 s63, s68, 0x14000
buffer_load_dwordx4 v20, s[12:15], s63 offen lds
s_add_u32 m0, s67, 6144
s_add_u32 s63, s68, 0x18000
buffer_load_dwordx4 v20, s[12:15], s63 offen lds
s_add_u32 m0, s67, 7168
s_add_u32 s63, s68, 0x1c000
buffer_load_dwordx4 v20, s[12:15], s63 offen lds
s_add_u32 m0, s67, 8192
s_add_u32 s63, s68, 0x80
buffer_load_dwordx4 v20, s[12:15], s63 offen lds
s_add_u32 m0, s67, 9216
s_add_u32 s63, s68, 0x4080
buffer_load_dwordx4 v20, s[12:15], s63 offen lds
s_add_u32 m0, s67, 10240
s_add_u32 s63, s68, 0x8080
buffer_load_dwordx4 v20, s[12:15], s63 offen lds
s_add_u32 m0, s67, 11264
s_add_u32 s63, s68, 0xc080
buffer_load_dwordx4 v20, s[12:15], s63 offen lds
s_add_u32 m0, s67, 12288
s_add_u32 s63, s68, 0x10080
buffer_load_dwordx4 v20, s[12:15], s63 offen lds
s_add_u32 m0, s67, 13312
s_add_u32 s63, s68, 0x14080
buffer_load_dwordx4 v20, s[12:15], s63 offen lds
s_add_u32 m0, s67, 14336
s_add_u32 s63, s68, 0x18080
buffer_load_dwordx4 v20, s[12:15], s63 offen lds
s_add_u32 m0, s67, 15360
s_add_u32 s63, s68, 0x1c080
buffer_load_dwordx4 v20, s[12:15], s63 offen lds
s_waitcnt vmcnt(12)
ds_read_b64_tr_b16 a[0:1], v21 offset:0
ds_read_b64_tr_b16 a[2:3], v21 offset:256
ds_read_b64_tr_b16 a[8:9], v21 offset:32
ds_read_b64_tr_b16 a[10:11], v21 offset:288
ds_read_b64_tr_b16 a[16:17], v21 offset:64
ds_read_b64_tr_b16 a[18:19], v21 offset:320
ds_read_b64_tr_b16 a[24:25], v21 offset:96
ds_read_b64_tr_b16 a[26:27], v21 offset:352
s_waitcnt lgkmcnt(0)
s_add_u32 m0, s67, 0
s_add_u32 s63, s68, 0x20000
buffer_load_dwordx4 v20, s[12:15], s63 offen lds
s_add_u32 m0, s67, 1024
s_add_u32 s63, s68, 0x24000
buffer_load_dwordx4 v20, s[12:15], s63 offen lds
s_add_u32 m0, s67, 2048
s_add_u32 s63, s68, 0x28000
buffer_load_dwordx4 v20, s[12:15], s63 offen lds
s_add_u32 m0, s67, 3072
s_add_u32 s63, s68, 0x2c000
buffer_load_dwordx4 v20, s[12:15], s63 offen lds
s_waitcnt vmcnt(12)
ds_read_b64_tr_b16 a[4:5], v21 offset:4096
ds_read_b64_tr_b16 a[6:7], v21 offset:4352
ds_read_b64_tr_b16 a[12:13], v21 offset:4128
ds_read_b64_tr_b16 a[14:15], v21 offset:4384
ds_read_b64_tr_b16 a[20:21], v21 offset:4160
ds_read_b64_tr_b16 a[22:23], v21 offset:4416
ds_read_b64_tr_b16 a[28:29], v21 offset:4192
ds_read_b64_tr_b16 a[30:31], v21 offset:4448
s_waitcnt lgkmcnt(0)
s_add_u32 m0, s67, 4096
s_add_u32 s63, s68, 0x30000
buffer_load_dwordx4 v20, s[12:15], s63 offen lds
s_add_u32 m0, s67, 5120
s_add_u32 s63, s68, 0x34000
buffer_load_dwordx4 v20, s[12:15], s63 offen lds
s_add_u32 m0, s67, 6144
s_add_u32 s63, s68, 0x38000
buffer_load_dwordx4 v20, s[12:15], s63 offen lds
s_add_u32 m0, s67, 7168
s_add_u32 s63, s68, 0x3c000
buffer_load_dwordx4 v20, s[12:15], s63 offen lds
s_waitcnt vmcnt(12)
ds_read_b64_tr_b16 a[32:33], v21 offset:8192
ds_read_b64_tr_b16 a[34:35], v21 offset:8448
ds_read_b64_tr_b16 v[28:29], v21 offset:8224
ds_read_b64_tr_b16 v[30:31], v21 offset:8480
ds_read_b64_tr_b16 a[40:41], v21 offset:8256
ds_read_b64_tr_b16 a[42:43], v21 offset:8512
ds_read_b64_tr_b16 v[36:37], v21 offset:8288
ds_read_b64_tr_b16 v[38:39], v21 offset:8544
s_waitcnt lgkmcnt(0)
ds_write_b128 v8, v[28:31] offset:0
ds_write_b128 v8, v[36:39] offset:2048
s_waitcnt lgkmcnt(0)
s_add_u32 m0, s67, 8192
s_add_u32 s63, s68, 0x20080
buffer_load_dwordx4 v20, s[12:15], s63 offen lds
s_add_u32 m0, s67, 9216
s_add_u32 s63, s68, 0x24080
buffer_load_dwordx4 v20, s[12:15], s63 offen lds
s_add_u32 m0, s67, 10240
s_add_u32 s63, s68, 0x28080
buffer_load_dwordx4 v20, s[12:15], s63 offen lds
s_add_u32 m0, s67, 11264
s_add_u32 s63, s68, 0x2c080
buffer_load_dwordx4 v20, s[12:15], s63 offen lds
s_waitcnt vmcnt(12)
ds_read_b64_tr_b16 a[36:37], v21 offset:12288
ds_read_b64_tr_b16 a[38:39], v21 offset:12544
ds_read_b64_tr_b16 v[28:29], v21 offset:12320
ds_read_b64_tr_b16 v[30:31], v21 offset:12576
ds_read_b64_tr_b16 a[44:45], v21 offset:12352
ds_read_b64_tr_b16 a[46:47], v21 offset:12608
ds_read_b64_tr_b16 v[36:37], v21 offset:12384
ds_read_b64_tr_b16 v[38:39], v21 offset:12640
s_waitcnt lgkmcnt(0)
ds_write_b128 v8, v[28:31] offset:1024
ds_write_b128 v8, v[36:39] offset:3072
s_waitcnt lgkmcnt(0)
s_add_u32 m0, s67, 12288
s_add_u32 s63, s68, 0x30080
buffer_load_dwordx4 v20, s[12:15], s63 offen lds
s_add_u32 m0, s67, 13312
s_add_u32 s63, s68, 0x34080
buffer_load_dwordx4 v20, s[12:15], s63 offen lds
s_add_u32 m0, s67, 14336
s_add_u32 s63, s68, 0x38080
buffer_load_dwordx4 v20, s[12:15], s63 offen lds
s_add_u32 m0, s67, 15360
s_add_u32 s63, s68, 0x3c080
buffer_load_dwordx4 v20, s[12:15], s63 offen lds
s_waitcnt vmcnt(12)
ds_read_b64_tr_b16 a[48:49], v21 offset:0
ds_read_b64_tr_b16 a[50:51], v21 offset:256
ds_read_b64_tr_b16 a[56:57], v21 offset:32
ds_read_b64_tr_b16 a[58:59], v21 offset:288
ds_read_b64_tr_b16 a[64:65], v21 offset:64
ds_read_b64_tr_b16 a[66:67], v21 offset:320
ds_read_b64_tr_b16 a[72:73], v21 offset:96
ds_read_b64_tr_b16 a[74:75], v21 offset:352
s_waitcnt lgkmcnt(0)
s_add_u32 m0, s67, 0
s_add_u32 s63, s68, 0x40000
buffer_load_dwordx4 v20, s[12:15], s63 offen lds
s_add_u32 m0, s67, 1024
s_add_u32 s63, s68, 0x44000
buffer_load_dwordx4 v20, s[12:15], s63 offen lds
s_add_u32 m0, s67, 2048
s_add_u32 s63, s68, 0x48000
buffer_load_dwordx4 v20, s[12:15], s63 offen lds
s_add_u32 m0, s67, 3072
s_add_u32 s63, s68, 0x4c000
buffer_load_dwordx4 v20, s[12:15], s63 offen lds
s_waitcnt vmcnt(12)
ds_read_b64_tr_b16 a[52:53], v21 offset:4096
ds_read_b64_tr_b16 a[54:55], v21 offset:4352
ds_read_b64_tr_b16 a[60:61], v21 offset:4128
ds_read_b64_tr_b16 a[62:63], v21 offset:4384
ds_read_b64_tr_b16 a[68:69], v21 offset:4160
ds_read_b64_tr_b16 a[70:71], v21 offset:4416
ds_read_b64_tr_b16 a[76:77], v21 offset:4192
ds_read_b64_tr_b16 a[78:79], v21 offset:4448
s_waitcnt lgkmcnt(0)
s_add_u32 m0, s67, 4096
s_add_u32 s63, s68, 0x50000
buffer_load_dwordx4 v20, s[12:15], s63 offen lds
s_add_u32 m0, s67, 5120
s_add_u32 s63, s68, 0x54000
buffer_load_dwordx4 v20, s[12:15], s63 offen lds
s_add_u32 m0, s67, 6144
s_add_u32 s63, s68, 0x58000
buffer_load_dwordx4 v20, s[12:15], s63 offen lds
s_add_u32 m0, s67, 7168
s_add_u32 s63, s68, 0x5c000
buffer_load_dwordx4 v20, s[12:15], s63 offen lds
s_waitcnt vmcnt(12)
ds_read_b64_tr_b16 a[80:81], v21 offset:8192
ds_read_b64_tr_b16 a[82:83], v21 offset:8448
ds_read_b64_tr_b16 v[28:29], v21 offset:8224
ds_read_b64_tr_b16 v[30:31], v21 offset:8480
ds_read_b64_tr_b16 a[88:89], v21 offset:8256
ds_read_b64_tr_b16 a[90:91], v21 offset:8512
ds_read_b64_tr_b16 v[36:37], v21 offset:8288
ds_read_b64_tr_b16 v[38:39], v21 offset:8544
s_waitcnt lgkmcnt(0)
ds_write_b128 v8, v[28:31] offset:4096
ds_write_b128 v8, v[36:39] offset:6144
s_waitcnt lgkmcnt(0)
s_add_u32 m0, s67, 8192
s_add_u32 s63, s68, 0x40080
buffer_load_dwordx4 v20, s[12:15], s63 offen lds
s_add_u32 m0, s67, 9216
s_add_u32 s63, s68, 0x44080
buffer_load_dwordx4 v20, s[12:15], s63 offen lds
s_add_u32 m0, s67, 10240
s_add_u32 s63, s68, 0x48080
buffer_load_dwordx4 v20, s[12:15], s63 offen lds
s_add_u32 m0, s67, 11264
s_add_u32 s63, s68, 0x4c080
buffer_load_dwordx4 v20, s[12:15], s63 offen lds
s_waitcnt vmcnt(12)
ds_read_b64_tr_b16 a[84:85], v21 offset:12288
ds_read_b64_tr_b16 a[86:87], v21 offset:12544
ds_read_b64_tr_b16 v[28:29], v21 offset:12320
ds_read_b64_tr_b16 v[30:31], v21 offset:12576
ds_read_b64_tr_b16 a[92:93], v21 offset:12352
ds_read_b64_tr_b16 a[94:95], v21 offset:12608
ds_read_b64_tr_b16 v[36:37], v21 offset:12384
ds_read_b64_tr_b16 v[38:39], v21 offset:12640
s_waitcnt lgkmcnt(0)
ds_write_b128 v8, v[28:31] offset:5120
ds_write_b128 v8, v[36:39] offset:7168
s_waitcnt lgkmcnt(0)
s_add_u32 m0, s67, 12288
s_add_u32 s63, s68, 0x50080
buffer_load_dwordx4 v20, s[12:15], s63 offen lds
s_add_u32 m0, s67, 13312
s_add_u32 s63, s68, 0x54080
buffer_load_dwordx4 v20, s[12:15], s63 offen lds
s_add_u32 m0, s67, 14336
s_add_u32 s63, s68, 0x58080
buffer_load_dwordx4 v20, s[12:15], s63 offen lds
s_add_u32 m0, s67, 15360
s_add_u32 s63, s68, 0x5c080
buffer_load_dwordx4 v20, s[12:15], s63 offen lds
s_waitcnt vmcnt(12)
ds_read_b64_tr_b16 a[96:97], v21 offset:0
ds_read_b64_tr_b16 a[98:99], v21 offset:256
ds_read_b64_tr_b16 a[104:105], v21 offset:32
ds_read_b64_tr_b16 a[106:107], v21 offset:288
ds_read_b64_tr_b16 a[112:113], v21 offset:64
ds_read_b64_tr_b16 a[114:115], v21 offset:320
ds_read_b64_tr_b16 a[120:121], v21 offset:96
ds_read_b64_tr_b16 a[122:123], v21 offset:352
s_waitcnt lgkmcnt(0)
s_add_u32 m0, s67, 0
s_add_u32 s63, s68, 0x60000
buffer_load_dwordx4 v20, s[12:15], s63 offen lds
s_add_u32 m0, s67, 1024
s_add_u32 s63, s68, 0x64000
buffer_load_dwordx4 v20, s[12:15], s63 offen lds
s_add_u32 m0, s67, 2048
s_add_u32 s63, s68, 0x68000
buffer_load_dwordx4 v20, s[12:15], s63 offen lds
s_add_u32 m0, s67, 3072
s_add_u32 s63, s68, 0x6c000
buffer_load_dwordx4 v20, s[12:15], s63 offen lds
s_waitcnt vmcnt(12)
ds_read_b64_tr_b16 a[100:101], v21 offset:4096
ds_read_b64_tr_b16 a[102:103], v21 offset:4352
ds_read_b64_tr_b16 a[108:109], v21 offset:4128
ds_read_b64_tr_b16 a[110:111], v21 offset:4384
ds_read_b64_tr_b16 a[116:117], v21 offset:4160
ds_read_b64_tr_b16 a[118:119], v21 offset:4416
ds_read_b64_tr_b16 a[124:125], v21 offset:4192
ds_read_b64_tr_b16 a[126:127], v21 offset:4448
s_waitcnt lgkmcnt(0)
s_add_u32 m0, s67, 4096
s_add_u32 s63, s68, 0x70000
buffer_load_dwordx4 v20, s[12:15], s63 offen lds
s_add_u32 m0, s67, 5120
s_add_u32 s63, s68, 0x74000
buffer_load_dwordx4 v20, s[12:15], s63 offen lds
s_add_u32 m0, s67, 6144
s_add_u32 s63, s68, 0x78000
buffer_load_dwordx4 v20, s[12:15], s63 offen lds
s_add_u32 m0, s67, 7168
s_add_u32 s63, s68, 0x7c000
buffer_load_dwordx4 v20, s[12:15], s63 offen lds
s_waitcnt vmcnt(12)
ds_read_b64_tr_b16 a[128:129], v21 offset:8192
ds_read_b64_tr_b16 a[130:131], v21 offset:8448
ds_read_b64_tr_b16 v[28:29], v21 offset:8224
ds_read_b64_tr_b16 v[30:31], v21 offset:8480
ds_read_b64_tr_b16 a[136:137], v21 offset:8256
ds_read_b64_tr_b16 a[138:139], v21 offset:8512
ds_read_b64_tr_b16 v[36:37], v21 offset:8288
ds_read_b64_tr_b16 v[38:39], v21 offset:8544
s_waitcnt lgkmcnt(0)
ds_write_b128 v8, v[28:31] offset:8192
ds_write_b128 v8, v[36:39] offset:10240
s_waitcnt lgkmcnt(0)
s_add_u32 m0, s67, 8192
s_add_u32 s63, s68, 0x60080
buffer_load_dwordx4 v20, s[12:15], s63 offen lds
s_add_u32 m0, s67, 9216
s_add_u32 s63, s68, 0x64080
buffer_load_dwordx4 v20, s[12:15], s63 offen lds
s_add_u32 m0, s67, 10240
s_add_u32 s63, s68, 0x68080
buffer_load_dwordx4 v20, s[12:15], s63 offen lds
s_add_u32 m0, s67, 11264
s_add_u32 s63, s68, 0x6c080
buffer_load_dwordx4 v20, s[12:15], s63 offen lds
s_waitcnt vmcnt(12)
ds_read_b64_tr_b16 a[132:133], v21 offset:12288
ds_read_b64_tr_b16 a[134:135], v21 offset:12544
ds_read_b64_tr_b16 v[28:29], v21 offset:12320
ds_read_b64_tr_b16 v[30:31], v21 offset:12576
ds_read_b64_tr_b16 a[140:141], v21 offset:12352
ds_read_b64_tr_b16 a[142:143], v21 offset:12608
ds_read_b64_tr_b16 v[36:37], v21 offset:12384
ds_read_b64_tr_b16 v[38:39], v21 offset:12640
s_waitcnt lgkmcnt(0)
ds_write_b128 v8, v[28:31] offset:9216
ds_write_b128 v8, v[36:39] offset:11264
s_waitcnt lgkmcnt(0)
s_add_u32 m0, s67, 12288
s_add_u32 s63, s68, 0x70080
buffer_load_dwordx4 v20, s[12:15], s63 offen lds
s_add_u32 m0, s67, 13312
s_add_u32 s63, s68, 0x74080
buffer_load_dwordx4 v20, s[12:15], s63 offen lds
s_add_u32 m0, s67, 14336
s_add_u32 s63, s68, 0x78080
buffer_load_dwordx4 v20, s[12:15], s63 offen lds
s_add_u32 m0, s67, 15360
s_add_u32 s63, s68, 0x7c080
buffer_load_dwordx4 v20, s[12:15], s63 offen lds
s_waitcnt vmcnt(12)
ds_read_b64_tr_b16 a[144:145], v21 offset:0
ds_read_b64_tr_b16 a[146:147], v21 offset:256
ds_read_b64_tr_b16 a[152:153], v21 offset:32
ds_read_b64_tr_b16 a[154:155], v21 offset:288
ds_read_b64_tr_b16 a[160:161], v21 offset:64
ds_read_b64_tr_b16 a[162:163], v21 offset:320
ds_read_b64_tr_b16 a[168:169], v21 offset:96
ds_read_b64_tr_b16 a[170:171], v21 offset:352
s_waitcnt lgkmcnt(0)
s_add_u32 m0, s67, 0
s_add_u32 s63, s68, 0x80000
buffer_load_dwordx4 v20, s[12:15], s63 offen lds
s_add_u32 m0, s67, 1024
s_add_u32 s63, s68, 0x84000
buffer_load_dwordx4 v20, s[12:15], s63 offen lds
s_add_u32 m0, s67, 2048
s_add_u32 s63, s68, 0x88000
buffer_load_dwordx4 v20, s[12:15], s63 offen lds
s_add_u32 m0, s67, 3072
s_add_u32 s63, s68, 0x8c000
buffer_load_dwordx4 v20, s[12:15], s63 offen lds
s_waitcnt vmcnt(12)
ds_read_b64_tr_b16 a[148:149], v21 offset:4096
ds_read_b64_tr_b16 a[150:151], v21 offset:4352
ds_read_b64_tr_b16 a[156:157], v21 offset:4128
ds_read_b64_tr_b16 a[158:159], v21 offset:4384
ds_read_b64_tr_b16 a[164:165], v21 offset:4160
ds_read_b64_tr_b16 a[166:167], v21 offset:4416
ds_read_b64_tr_b16 a[172:173], v21 offset:4192
ds_read_b64_tr_b16 a[174:175], v21 offset:4448
s_waitcnt lgkmcnt(0)
s_add_u32 m0, s67, 4096
s_add_u32 s63, s68, 0x90000
buffer_load_dwordx4 v20, s[12:15], s63 offen lds
s_add_u32 m0, s67, 5120
s_add_u32 s63, s68, 0x94000
buffer_load_dwordx4 v20, s[12:15], s63 offen lds
s_add_u32 m0, s67, 6144
s_add_u32 s63, s68, 0x98000
buffer_load_dwordx4 v20, s[12:15], s63 offen lds
s_add_u32 m0, s67, 7168
s_add_u32 s63, s68, 0x9c000
buffer_load_dwordx4 v20, s[12:15], s63 offen lds
s_waitcnt vmcnt(12)
ds_read_b64_tr_b16 a[176:177], v21 offset:8192
ds_read_b64_tr_b16 a[178:179], v21 offset:8448
ds_read_b64_tr_b16 v[28:29], v21 offset:8224
ds_read_b64_tr_b16 v[30:31], v21 offset:8480
ds_read_b64_tr_b16 a[184:185], v21 offset:8256
ds_read_b64_tr_b16 a[186:187], v21 offset:8512
ds_read_b64_tr_b16 v[36:37], v21 offset:8288
ds_read_b64_tr_b16 v[38:39], v21 offset:8544
s_waitcnt lgkmcnt(0)
ds_write_b128 v8, v[28:31] offset:12288
ds_write_b128 v8, v[36:39] offset:14336
s_waitcnt lgkmcnt(0)
s_add_u32 m0, s67, 8192
s_add_u32 s63, s68, 0x80080
buffer_load_dwordx4 v20, s[12:15], s63 offen lds
s_add_u32 m0, s67, 9216
s_add_u32 s63, s68, 0x84080
buffer_load_dwordx4 v20, s[12:15], s63 offen lds
s_add_u32 m0, s67, 10240
s_add_u32 s63, s68, 0x88080
buffer_load_dwordx4 v20, s[12:15], s63 offen lds
s_add_u32 m0, s67, 11264
s_add_u32 s63, s68, 0x8c080
buffer_load_dwordx4 v20, s[12:15], s63 offen lds
s_waitcnt vmcnt(12)
ds_read_b64_tr_b16 a[180:181], v21 offset:12288
ds_read_b64_tr_b16 a[182:183], v21 offset:12544
ds_read_b64_tr_b16 v[28:29], v21 offset:12320
ds_read_b64_tr_b16 v[30:31], v21 offset:12576
ds_read_b64_tr_b16 a[188:189], v21 offset:12352
ds_read_b64_tr_b16 a[190:191], v21 offset:12608
ds_read_b64_tr_b16 v[36:37], v21 offset:12384
ds_read_b64_tr_b16 v[38:39], v21 offset:12640
s_waitcnt lgkmcnt(0)
ds_write_b128 v8, v[28:31] offset:13312
ds_write_b128 v8, v[36:39] offset:15360
s_waitcnt lgkmcnt(0)
s_add_u32 m0, s67, 12288
s_add_u32 s63, s68, 0x90080
buffer_load_dwordx4 v20, s[12:15], s63 offen lds
s_add_u32 m0, s67, 13312
s_add_u32 s63, s68, 0x94080
buffer_load_dwordx4 v20, s[12:15], s63 offen lds
s_add_u32 m0, s67, 14336
s_add_u32 s63, s68, 0x98080
buffer_load_dwordx4 v20, s[12:15], s63 offen lds
s_add_u32 m0, s67, 15360
s_add_u32 s63, s68, 0x9c080
buffer_load_dwordx4 v20, s[12:15], s63 offen lds
s_waitcnt vmcnt(12)
ds_read_b64_tr_b16 a[192:193], v21 offset:0
ds_read_b64_tr_b16 a[194:195], v21 offset:256
ds_read_b64_tr_b16 a[200:201], v21 offset:32
ds_read_b64_tr_b16 a[202:203], v21 offset:288
ds_read_b64_tr_b16 a[208:209], v21 offset:64
ds_read_b64_tr_b16 a[210:211], v21 offset:320
ds_read_b64_tr_b16 a[216:217], v21 offset:96
ds_read_b64_tr_b16 a[218:219], v21 offset:352
s_waitcnt lgkmcnt(0)
s_add_u32 m0, s67, 0
s_add_u32 s63, s68, 0xa0000
buffer_load_dwordx4 v20, s[12:15], s63 offen lds
s_add_u32 m0, s67, 1024
s_add_u32 s63, s68, 0xa4000
buffer_load_dwordx4 v20, s[12:15], s63 offen lds
s_add_u32 m0, s67, 2048
s_add_u32 s63, s68, 0xa8000
buffer_load_dwordx4 v20, s[12:15], s63 offen lds
s_add_u32 m0, s67, 3072
s_add_u32 s63, s68, 0xac000
buffer_load_dwordx4 v20, s[12:15], s63 offen lds
s_waitcnt vmcnt(12)
ds_read_b64_tr_b16 a[196:197], v21 offset:4096
ds_read_b64_tr_b16 a[198:199], v21 offset:4352
ds_read_b64_tr_b16 a[204:205], v21 offset:4128
ds_read_b64_tr_b16 a[206:207], v21 offset:4384
ds_read_b64_tr_b16 a[212:213], v21 offset:4160
ds_read_b64_tr_b16 a[214:215], v21 offset:4416
ds_read_b64_tr_b16 a[220:221], v21 offset:4192
ds_read_b64_tr_b16 a[222:223], v21 offset:4448
s_waitcnt lgkmcnt(0)
s_add_u32 m0, s67, 4096
s_add_u32 s63, s68, 0xb0000
buffer_load_dwordx4 v20, s[12:15], s63 offen lds
s_add_u32 m0, s67, 5120
s_add_u32 s63, s68, 0xb4000
buffer_load_dwordx4 v20, s[12:15], s63 offen lds
s_add_u32 m0, s67, 6144
s_add_u32 s63, s68, 0xb8000
buffer_load_dwordx4 v20, s[12:15], s63 offen lds
s_add_u32 m0, s67, 7168
s_add_u32 s63, s68, 0xbc000
buffer_load_dwordx4 v20, s[12:15], s63 offen lds
s_waitcnt vmcnt(12)
ds_read_b64_tr_b16 a[224:225], v21 offset:8192
ds_read_b64_tr_b16 a[226:227], v21 offset:8448
ds_read_b64_tr_b16 v[28:29], v21 offset:8224
ds_read_b64_tr_b16 v[30:31], v21 offset:8480
ds_read_b64_tr_b16 a[232:233], v21 offset:8256
ds_read_b64_tr_b16 a[234:235], v21 offset:8512
ds_read_b64_tr_b16 v[36:37], v21 offset:8288
ds_read_b64_tr_b16 v[38:39], v21 offset:8544
s_waitcnt lgkmcnt(0)
ds_write_b128 v8, v[28:31] offset:16384
ds_write_b128 v8, v[36:39] offset:18432
s_waitcnt lgkmcnt(0)
s_add_u32 m0, s67, 8192
s_add_u32 s63, s68, 0xa0080
buffer_load_dwordx4 v20, s[12:15], s63 offen lds
s_add_u32 m0, s67, 9216
s_add_u32 s63, s68, 0xa4080
buffer_load_dwordx4 v20, s[12:15], s63 offen lds
s_add_u32 m0, s67, 10240
s_add_u32 s63, s68, 0xa8080
buffer_load_dwordx4 v20, s[12:15], s63 offen lds
s_add_u32 m0, s67, 11264
s_add_u32 s63, s68, 0xac080
buffer_load_dwordx4 v20, s[12:15], s63 offen lds
s_waitcnt vmcnt(12)
ds_read_b64_tr_b16 a[228:229], v21 offset:12288
ds_read_b64_tr_b16 a[230:231], v21 offset:12544
ds_read_b64_tr_b16 v[28:29], v21 offset:12320
ds_read_b64_tr_b16 v[30:31], v21 offset:12576
ds_read_b64_tr_b16 a[236:237], v21 offset:12352
ds_read_b64_tr_b16 a[238:239], v21 offset:12608
ds_read_b64_tr_b16 v[36:37], v21 offset:12384
ds_read_b64_tr_b16 v[38:39], v21 offset:12640
s_waitcnt lgkmcnt(0)
ds_write_b128 v8, v[28:31] offset:17408
ds_write_b128 v8, v[36:39] offset:19456
s_waitcnt lgkmcnt(0)
s_add_u32 m0, s67, 12288
s_add_u32 s63, s68, 0xb0080
buffer_load_dwordx4 v20, s[12:15], s63 offen lds
s_add_u32 m0, s67, 13312
s_add_u32 s63, s68, 0xb4080
buffer_load_dwordx4 v20, s[12:15], s63 offen lds
s_add_u32 m0, s67, 14336
s_add_u32 s63, s68, 0xb8080
buffer_load_dwordx4 v20, s[12:15], s63 offen lds
s_add_u32 m0, s67, 15360
s_add_u32 s63, s68, 0xbc080
buffer_load_dwordx4 v20, s[12:15], s63 offen lds
s_waitcnt vmcnt(12)
ds_read_b64_tr_b16 a[240:241], v21 offset:0
ds_read_b64_tr_b16 a[242:243], v21 offset:256
ds_read_b64_tr_b16 a[248:249], v21 offset:32
ds_read_b64_tr_b16 a[250:251], v21 offset:288
ds_read_b64_tr_b16 v[96:97], v21 offset:64
ds_read_b64_tr_b16 v[98:99], v21 offset:320
ds_read_b64_tr_b16 v[104:105], v21 offset:96
ds_read_b64_tr_b16 v[106:107], v21 offset:352
s_waitcnt lgkmcnt(0)
s_add_u32 m0, s67, 0
s_add_u32 s63, s68, 0xc0000
buffer_load_dwordx4 v20, s[12:15], s63 offen lds
s_add_u32 m0, s67, 1024
s_add_u32 s63, s68, 0xc4000
buffer_load_dwordx4 v20, s[12:15], s63 offen lds
s_add_u32 m0, s67, 2048
s_add_u32 s63, s68, 0xc8000
buffer_load_dwordx4 v20, s[12:15], s63 offen lds
s_add_u32 m0, s67, 3072
s_add_u32 s63, s68, 0xcc000
buffer_load_dwordx4 v20, s[12:15], s63 offen lds
s_waitcnt vmcnt(12)
ds_read_b64_tr_b16 a[244:245], v21 offset:4096
ds_read_b64_tr_b16 a[246:247], v21 offset:4352
ds_read_b64_tr_b16 a[252:253], v21 offset:4128
ds_read_b64_tr_b16 a[254:255], v21 offset:4384
ds_read_b64_tr_b16 v[100:101], v21 offset:4160
ds_read_b64_tr_b16 v[102:103], v21 offset:4416
ds_read_b64_tr_b16 v[108:109], v21 offset:4192
ds_read_b64_tr_b16 v[110:111], v21 offset:4448
s_waitcnt lgkmcnt(0)
s_add_u32 m0, s67, 4096
s_add_u32 s63, s68, 0xd0000
buffer_load_dwordx4 v20, s[12:15], s63 offen lds
s_add_u32 m0, s67, 5120
s_add_u32 s63, s68, 0xd4000
buffer_load_dwordx4 v20, s[12:15], s63 offen lds
s_add_u32 m0, s67, 6144
s_add_u32 s63, s68, 0xd8000
buffer_load_dwordx4 v20, s[12:15], s63 offen lds
s_add_u32 m0, s67, 7168
s_add_u32 s63, s68, 0xdc000
buffer_load_dwordx4 v20, s[12:15], s63 offen lds
s_waitcnt vmcnt(12)
ds_read_b64_tr_b16 v[112:113], v21 offset:8192
ds_read_b64_tr_b16 v[114:115], v21 offset:8448
ds_read_b64_tr_b16 v[28:29], v21 offset:8224
ds_read_b64_tr_b16 v[30:31], v21 offset:8480
ds_read_b64_tr_b16 v[120:121], v21 offset:8256
ds_read_b64_tr_b16 v[122:123], v21 offset:8512
ds_read_b64_tr_b16 v[36:37], v21 offset:8288
ds_read_b64_tr_b16 v[38:39], v21 offset:8544
s_waitcnt lgkmcnt(0)
ds_write_b128 v8, v[28:31] offset:20480
ds_write_b128 v8, v[36:39] offset:22528
s_waitcnt lgkmcnt(0)
s_add_u32 m0, s67, 8192
s_add_u32 s63, s68, 0xc0080
buffer_load_dwordx4 v20, s[12:15], s63 offen lds
s_add_u32 m0, s67, 9216
s_add_u32 s63, s68, 0xc4080
buffer_load_dwordx4 v20, s[12:15], s63 offen lds
s_add_u32 m0, s67, 10240
s_add_u32 s63, s68, 0xc8080
buffer_load_dwordx4 v20, s[12:15], s63 offen lds
s_add_u32 m0, s67, 11264
s_add_u32 s63, s68, 0xcc080
buffer_load_dwordx4 v20, s[12:15], s63 offen lds
s_waitcnt vmcnt(12)
ds_read_b64_tr_b16 v[116:117], v21 offset:12288
ds_read_b64_tr_b16 v[118:119], v21 offset:12544
ds_read_b64_tr_b16 v[28:29], v21 offset:12320
ds_read_b64_tr_b16 v[30:31], v21 offset:12576
ds_read_b64_tr_b16 v[124:125], v21 offset:12352
ds_read_b64_tr_b16 v[126:127], v21 offset:12608
ds_read_b64_tr_b16 v[36:37], v21 offset:12384
ds_read_b64_tr_b16 v[38:39], v21 offset:12640
s_waitcnt lgkmcnt(0)
ds_write_b128 v8, v[28:31] offset:21504
ds_write_b128 v8, v[36:39] offset:23552
s_waitcnt lgkmcnt(0)
s_add_u32 m0, s67, 12288
s_add_u32 s63, s68, 0xd0080
buffer_load_dwordx4 v20, s[12:15], s63 offen lds
s_add_u32 m0, s67, 13312
s_add_u32 s63, s68, 0xd4080
buffer_load_dwordx4 v20, s[12:15], s63 offen lds
s_add_u32 m0, s67, 14336
s_add_u32 s63, s68, 0xd8080
buffer_load_dwordx4 v20, s[12:15], s63 offen lds
s_add_u32 m0, s67, 15360
s_add_u32 s63, s68, 0xdc080
buffer_load_dwordx4 v20, s[12:15], s63 offen lds
s_waitcnt vmcnt(12)
ds_read_b64_tr_b16 v[128:129], v21 offset:0
ds_read_b64_tr_b16 v[130:131], v21 offset:256
ds_read_b64_tr_b16 v[136:137], v21 offset:32
ds_read_b64_tr_b16 v[138:139], v21 offset:288
ds_read_b64_tr_b16 v[144:145], v21 offset:64
ds_read_b64_tr_b16 v[146:147], v21 offset:320
ds_read_b64_tr_b16 v[152:153], v21 offset:96
ds_read_b64_tr_b16 v[154:155], v21 offset:352
s_waitcnt lgkmcnt(0)
s_add_u32 m0, s67, 0
s_add_u32 s63, s68, 0xe0000
buffer_load_dwordx4 v20, s[12:15], s63 offen lds
s_add_u32 m0, s67, 1024
s_add_u32 s63, s68, 0xe4000
buffer_load_dwordx4 v20, s[12:15], s63 offen lds
s_add_u32 m0, s67, 2048
s_add_u32 s63, s68, 0xe8000
buffer_load_dwordx4 v20, s[12:15], s63 offen lds
s_add_u32 m0, s67, 3072
s_add_u32 s63, s68, 0xec000
buffer_load_dwordx4 v20, s[12:15], s63 offen lds
s_waitcnt vmcnt(12)
ds_read_b64_tr_b16 v[132:133], v21 offset:4096
ds_read_b64_tr_b16 v[134:135], v21 offset:4352
ds_read_b64_tr_b16 v[140:141], v21 offset:4128
ds_read_b64_tr_b16 v[142:143], v21 offset:4384
ds_read_b64_tr_b16 v[148:149], v21 offset:4160
ds_read_b64_tr_b16 v[150:151], v21 offset:4416
ds_read_b64_tr_b16 v[156:157], v21 offset:4192
ds_read_b64_tr_b16 v[158:159], v21 offset:4448
s_waitcnt lgkmcnt(0)
s_add_u32 m0, s67, 4096
s_add_u32 s63, s68, 0xf0000
buffer_load_dwordx4 v20, s[12:15], s63 offen lds
s_add_u32 m0, s67, 5120
s_add_u32 s63, s68, 0xf4000
buffer_load_dwordx4 v20, s[12:15], s63 offen lds
s_add_u32 m0, s67, 6144
s_add_u32 s63, s68, 0xf8000
buffer_load_dwordx4 v20, s[12:15], s63 offen lds
s_add_u32 m0, s67, 7168
s_add_u32 s63, s68, 0xfc000
buffer_load_dwordx4 v20, s[12:15], s63 offen lds
s_waitcnt vmcnt(12)
ds_read_b64_tr_b16 v[160:161], v21 offset:8192
ds_read_b64_tr_b16 v[162:163], v21 offset:8448
ds_read_b64_tr_b16 v[168:169], v21 offset:8224
ds_read_b64_tr_b16 v[170:171], v21 offset:8480
ds_read_b64_tr_b16 v[176:177], v21 offset:8256
ds_read_b64_tr_b16 v[178:179], v21 offset:8512
ds_read_b64_tr_b16 v[184:185], v21 offset:8288
ds_read_b64_tr_b16 v[186:187], v21 offset:8544
s_waitcnt lgkmcnt(0)
s_add_u32 m0, s67, 8192
s_add_u32 s63, s68, 0xe0080
buffer_load_dwordx4 v20, s[12:15], s63 offen lds
s_add_u32 m0, s67, 9216
s_add_u32 s63, s68, 0xe4080
buffer_load_dwordx4 v20, s[12:15], s63 offen lds
s_add_u32 m0, s67, 10240
s_add_u32 s63, s68, 0xe8080
buffer_load_dwordx4 v20, s[12:15], s63 offen lds
s_add_u32 m0, s67, 11264
s_add_u32 s63, s68, 0xec080
buffer_load_dwordx4 v20, s[12:15], s63 offen lds
s_waitcnt vmcnt(12)
ds_read_b64_tr_b16 v[164:165], v21 offset:12288
ds_read_b64_tr_b16 v[166:167], v21 offset:12544
ds_read_b64_tr_b16 v[172:173], v21 offset:12320
ds_read_b64_tr_b16 v[174:175], v21 offset:12576
ds_read_b64_tr_b16 v[180:181], v21 offset:12352
ds_read_b64_tr_b16 v[182:183], v21 offset:12608
ds_read_b64_tr_b16 v[188:189], v21 offset:12384
ds_read_b64_tr_b16 v[190:191], v21 offset:12640
s_waitcnt lgkmcnt(0)
s_add_u32 m0, s67, 12288
s_add_u32 s63, s68, 0xf0080
buffer_load_dwordx4 v20, s[12:15], s63 offen lds
s_add_u32 m0, s67, 13312
s_add_u32 s63, s68, 0xf4080
buffer_load_dwordx4 v20, s[12:15], s63 offen lds
s_add_u32 m0, s67, 14336
s_add_u32 s63, s68, 0xf8080
buffer_load_dwordx4 v20, s[12:15], s63 offen lds
s_add_u32 m0, s67, 15360
s_add_u32 s63, s68, 0xfc080
buffer_load_dwordx4 v20, s[12:15], s63 offen lds
v_mov_b32 v56, 0
buffer_load_dwordx4 v[48:51], v56, s[20:23], 0 offen offset:128 sc1
buffer_load_dwordx4 v[52:55], v56, s[20:23], 0 offen offset:144 sc1
buffer_load_dword v58, v56, s[20:23], 0 offen offset:160 sc1
s_waitcnt vmcnt(12)
ds_read_b64_tr_b16 v[192:193], v21 offset:0
ds_read_b64_tr_b16 v[194:195], v21 offset:256
ds_read_b64_tr_b16 v[200:201], v21 offset:32
ds_read_b64_tr_b16 v[202:203], v21 offset:288
ds_read_b64_tr_b16 v[208:209], v21 offset:64
ds_read_b64_tr_b16 v[210:211], v21 offset:320
ds_read_b64_tr_b16 v[216:217], v21 offset:96
ds_read_b64_tr_b16 v[218:219], v21 offset:352
s_waitcnt lgkmcnt(0)
s_waitcnt vmcnt(8)
ds_read_b64_tr_b16 v[196:197], v21 offset:4096
ds_read_b64_tr_b16 v[198:199], v21 offset:4352
ds_read_b64_tr_b16 v[204:205], v21 offset:4128
ds_read_b64_tr_b16 v[206:207], v21 offset:4384
ds_read_b64_tr_b16 v[212:213], v21 offset:4160
ds_read_b64_tr_b16 v[214:215], v21 offset:4416
ds_read_b64_tr_b16 v[220:221], v21 offset:4192
ds_read_b64_tr_b16 v[222:223], v21 offset:4448
s_waitcnt lgkmcnt(0)
s_waitcnt vmcnt(4)
ds_read_b64_tr_b16 v[224:225], v21 offset:8192
ds_read_b64_tr_b16 v[226:227], v21 offset:8448
ds_read_b64_tr_b16 v[232:233], v21 offset:8224
ds_read_b64_tr_b16 v[234:235], v21 offset:8480
ds_read_b64_tr_b16 v[240:241], v21 offset:8256
ds_read_b64_tr_b16 v[242:243], v21 offset:8512
ds_read_b64_tr_b16 v[248:249], v21 offset:8288
ds_read_b64_tr_b16 v[250:251], v21 offset:8544
s_waitcnt lgkmcnt(0)
s_waitcnt vmcnt(0)
ds_read_b64_tr_b16 v[228:229], v21 offset:12288
ds_read_b64_tr_b16 v[230:231], v21 offset:12544
ds_read_b64_tr_b16 v[236:237], v21 offset:12320
ds_read_b64_tr_b16 v[238:239], v21 offset:12576
ds_read_b64_tr_b16 v[244:245], v21 offset:12352
ds_read_b64_tr_b16 v[246:247], v21 offset:12608
ds_read_b64_tr_b16 v[252:253], v21 offset:12384
ds_read_b64_tr_b16 v[254:255], v21 offset:12640
s_waitcnt lgkmcnt(0)
s_waitcnt lgkmcnt(0)
s_cmp_lg_u32 s48, 0
s_cbranch_scc1 Lldd_269
s_mov_b32 s60, 12
v_mov_b32 v2, s60
v_mov_b32 v1, 0x40000000
v_cmp_gt_u32 vcc, 1, v0
s_nop 1
v_cndmask_b32 v2, v1, v2, vcc
v_mov_b32 v3, 1
buffer_atomic_add v3, v2, s[20:23], 0 offen sc1
Lldd_269:
v_bfe_u32 v2, v0, 2, 2
v_mul_u32_u24 v2, 1088, v2
v_and_b32 v3, 3, v0
v_mul_u32_u24 v3, 272, v3
v_add_u32 v2, v2, v3
v_and_b32 v3, 48, v0
v_add_u32 v2, v2, v3
s_lshl_b32 s60, s48, 6
s_add_u32 s60, s60, 98304
v_add_u32 v9, s60, v2
v_lshrrev_b32 v2, 5, v0
v_lshlrev_b32 v2, 1, v2
v_and_b32 v3, 1, v0
v_add_u32 v2, v2, v3
v_mul_u32_u24 v2, 1088, v2
v_bfe_u32 v3, v0, 1, 4
v_lshlrev_b32 v3, 2, v3
v_add_u32 v2, v2, v3
s_mul_i32 s60, s48, 4352
s_add_u32 s60, s60, 98304
v_add_u32 v10, s60, v2
v_and_b32 v1, 27, v0
v_lshlrev_b32 v1, 3, v1
v_and_b32 v2, 4, v0
v_lshlrev_b32 v2, 6, v2
v_add_u32 v1, v1, v2
v_and_b32 v2, 32, v0
v_add_u32 v11, v1, v2
s_lshl_b32 s72, s48, 13
s_add_u32 s72, s72, 0x10000
v_mov_b32 v12, -1
v_mov_b32 v13, -1
v_mov_b32 v14, -1
v_mov_b32 v15, -1
s_mov_b32 s73, 17408
s_cmp_eq_u32 s50, 0
s_mov_b32 s74, 0x40000
s_cselect_b32 s74, s74, 0xfffc0000
v_mov_b32 v56, 0
s_cmp_lg_u32 s100, 0
s_cbranch_scc1 Lws1_271
s_branch Lwsw1_274
Lws_270:
v_mov_b32 v56, 0
buffer_load_dwordx4 v[48:51], v56, s[20:23], 0 offen offset:128 sc1
buffer_load_dwordx4 v[52:55], v56, s[20:23], 0 offen offset:144 sc1
buffer_load_dword v58, v56, s[20:23], 0 offen offset:160 sc1
Lwsw1_274:
s_waitcnt vmcnt(0)
v_readfirstlane_b32 s97, v58
v_add3_u32 v57, v48, v49, v50
v_add3_u32 v57, v57, v51, v52
v_add3_u32 v57, v57, v53, v54
v_add_u32 v57, v57, v55
v_cmp_le_u32 vcc, 0x100, v57
s_nop 0
s_cmp_eq_u64 vcc, -1
s_cbranch_scc0 Lrt_275
v_or3_b32 v57, v48, v49, v50
v_or3_b32 v57, v57, v51, v52
v_or3_b32 v57, v57, v53, v54
v_or_b32 v57, v57, v55
v_cmp_eq_u32 vcc, 256, v57
s_nop 0
s_cmp_eq_u64 vcc, -1
s_cbranch_scc1 Lws2_272
s_branch L_restart
Lws1_271:
buffer_load_dword v48, v56, s[20:23], 0 offen sc1
s_waitcnt vmcnt(0)
v_cmp_le_u32 vcc, 0x100, v48
s_nop 0
s_cmp_eq_u64 vcc, -1
s_cbranch_scc0 Lrt_276
Lws2_272:
s_add_u32 s64, s100, 1
s_mov_b32 s98, 64
s_mov_b32 s99, 0xfffffff3
s_barrier
s_mov_b32 s62, 0
s_cmp_lg_u32 s100, 0
s_cbranch_scc1 Lnear2_278
s_cmp_lg_u32 s97, 0
s_cbranch_scc1 Lnear3_279
v_mov_b32 v1, 160
Lnear_277:
buffer_load_dword v1, v1, s[20:23], 0 offen sc1
s_waitcnt vmcnt(0)
v_readfirstlane_b32 s97, v1
v_mov_b32 v1, 160
s_cmp_eq_u32 s97, 0
s_cbranch_scc1 Lrt_280
Lnear3_279:
s_and_b32 s62, s97, 2
s_lshl_b32 s62, s62, 12
Lnear2_278:
s_add_u32 s70, s70, s62
s_mov_b32 s52, 0
s_mov_b32 s30, 0x40000000
s_cmp_lt_u32 s52, 64
s_cselect_b32 s31, 0, 0xa0000
s_add_u32 s31, s31, s66
s_and_b32 s24, s52, 3
s_lshl_b32 s24, s24, 15
s_add_u32 s24, s24, s31
s_add_u32 s24, s24, s72
s_add_u32 s25, s24, 4096
s_and_b32 s31, s52, 64
s_lshl_b32 s31, s31, 13
s_add_u32 s31, s31, s70
s_and_b32 s26, s52, 3
s_lshl_b32 s26, s26, 16
s_xor_b32 s27, s26, 0x20000
s_add_u32 s26, s26, s31
s_add_u32 s27, s27, s31
ds_read_b128 v[80:83], v8 offset:0
ds_read_b128 v[84:87], v8 offset:1024
ds_read_b128 v[88:91], v8 offset:2048
ds_read_b128 v[92:95], v8 offset:3072
v_mov_b32 v16, 0
v_mov_b32 v17, 0
v_mov_b32 v18, 0
v_mov_b32 v19, 0
v_mov_b32 v20, 0
v_mov_b32 v21, 0
v_mov_b32 v22, 0
v_mov_b32 v23, 0
v_mov_b32 v24, 0
v_mov_b32 v25, 0
v_mov_b32 v26, 0
v_mov_b32 v27, 0
v_mov_b32 v28, 0
v_mov_b32 v29, 0
v_mov_b32 v30, 0
v_mov_b32 v31, 0
v_mov_b32 v32, 0
v_mov_b32 v33, 0
v_mov_b32 v34, 0
v_mov_b32 v35, 0
v_mov_b32 v36, 0
v_mov_b32 v37, 0
v_mov_b32 v38, 0
v_mov_b32 v39, 0
v_mov_b32 v40, 0
v_mov_b32 v41, 0
v_mov_b32 v42, 0
v_mov_b32 v43, 0
v_mov_b32 v44, 0
v_mov_b32 v45, 0
v_mov_b32 v46, 0
v_mov_b32 v47, 0
s_cmp_lg_u32 s64, 1
s_cbranch_scc1 LWM_poll_s
.p2align 6
LWM_poll_f:
buffer_load_dwordx4 v[48:51], v6, s[4:7], s24 offen offset:0 sc1
buffer_load_dwordx4 v[52:55], v6, s[4:7], s24 offen offset:1024 sc1
s_add_u32 s96, s96, 1
s_cmp_ge_u32 s96, 1048576
s_cbranch_scc1 Lto_281
s_waitcnt vmcnt(0)
v_max3_u32 v0, v48, v49, v50
v_max_u32 v0, v0, v51
v_cmp_eq_u32 vcc, -1, v0
s_nop 0
s_cbranch_vccnz LWM_poll_f
LWM_go_f:
v_smfmac_f32_16x16x64_bf16 v[16:19], v[48:51], a[0:7], v5
buffer_load_dwordx4 v[56:59], v6, s[4:7], s24 offen offset:2048 sc1
v_smfmac_f32_16x16x64_bf16 v[20:23], v[48:51], a[8:15], v5
buffer_load_dwordx4 v[60:63], v6, s[4:7], s24 offen offset:3072 sc1
v_smfmac_f32_16x16x64_bf16 v[24:27], v[48:51], a[16:23], v5
buffer_load_dwordx4 v[64:67], v6, s[4:7], s25 offen offset:0 sc1
v_smfmac_f32_16x16x64_bf16 v[28:31], v[48:51], a[24:31], v5
v_max3_u32 v0, v52, v53, v54
v_smfmac_f32_16x16x64_bf16 v[32:35], v[48:51], a[32:39], v5
s_waitcnt lgkmcnt(2)
v_max_u32 v0, v0, v55
v_smfmac_f32_16x16x64_bf16 v[36:39], v[48:51], v[80:87], v5
v_cmp_eq_u32 vcc, -1, v0
v_smfmac_f32_16x16x64_bf16 v[40:43], v[48:51], a[40:47], v5
s_waitcnt lgkmcnt(0)
ds_read_b128 v[80:83], v8 offset:4096
v_smfmac_f32_16x16x64_bf16 v[44:47], v[48:51], v[88:95], v5
s_cbranch_vccnz Lwb_282
Lwc_283:
ds_read_b128 v[84:87], v8 offset:5120
v_smfmac_f32_16x16x64_bf16 v[16:19], v[52:55], a[48:55], v5
ds_read_b128 v[88:91], v8 offset:6144
buffer_load_dwordx4 v[68:71], v6, s[4:7], s25 offen offset:1024 sc1
v_smfmac_f32_16x16x64_bf16 v[20:23], v[52:55], a[56:63], v5
ds_read_b128 v[92:95], v8 offset:7168
v_smfmac_f32_16x16x64_bf16 v[24:27], v[52:55], a[64:71], v5
buffer_load_dwordx4 v[72:75], v6, s[4:7], s25 offen offset:2048 sc1
v_smfmac_f32_16x16x64_bf16 v[28:31], v[52:55], a[72:79], v5
s_waitcnt vmcnt(4)
v_max3_u32 v0, v56, v57, v58
v_smfmac_f32_16x16x64_bf16 v[32:35], v[52:55], a[80:87], v5
s_waitcnt lgkmcnt(2)
v_max_u32 v0, v0, v59
v_smfmac_f32_16x16x64_bf16 v[36:39], v[52:55], v[80:87], v5
v_cmp_eq_u32 vcc, -1, v0
v_smfmac_f32_16x16x64_bf16 v[40:43], v[52:55], a[88:95], v5
s_waitcnt lgkmcnt(0)
ds_read_b128 v[80:83], v8 offset:8192
v_smfmac_f32_16x16x64_bf16 v[44:47], v[52:55], v[88:95], v5
s_cbranch_vccnz Lwb_285
Lwc_286:
ds_read_b128 v[84:87], v8 offset:9216
v_smfmac_f32_16x16x64_bf16 v[16:19], v[56:59], a[96:103], v5
ds_read_b128 v[88:91], v8 offset:10240
v_smfmac_f32_16x16x64_bf16 v[20:23], v[56:59], a[104:111], v5
ds_read_b128 v[92:95], v8 offset:11264
v_smfmac_f32_16x16x64_bf16 v[24:27], v[56:59], a[112:119], v5
buffer_load_dwordx4 v[76:79], v6, s[4:7], s25 offen offset:3072 sc1
v_smfmac_f32_16x16x64_bf16 v[28:31], v[56:59], a[120:127], v5
s_waitcnt vmcnt(4)
v_max3_u32 v0, v60, v61, v62
v_smfmac_f32_16x16x64_bf16 v[32:35], v[56:59], a[128:135], v5
s_waitcnt lgkmcnt(2)
v_max_u32 v0, v0, v63
v_smfmac_f32_16x16x64_bf16 v[36:39], v[56:59], v[80:87], v5
v_cmp_eq_u32 vcc, -1, v0
v_smfmac_f32_16x16x64_bf16 v[40:43], v[56:59], a[136:143], v5
s_waitcnt lgkmcnt(0)
ds_read_b128 v[80:83], v8 offset:12288
v_smfmac_f32_16x16x64_bf16 v[44:47], v[56:59], v[88:95], v5
s_cbranch_vccnz Lwb_288
Lwc_289:
ds_read_b128 v[84:87], v8 offset:13312
v_smfmac_f32_16x16x64_bf16 v[16:19], v[60:63], a[144:151], v5
ds_read_b128 v[88:91], v8 offset:14336
v_smfmac_f32_16x16x64_bf16 v[20:23], v[60:63], a[152:159], v5
ds_read_b128 v[92:95], v8 offset:15360
v_smfmac_f32_16x16x64_bf16 v[24:27], v[60:63], a[160:167], v5
v_smfmac_f32_16x16x64_bf16 v[28:31], v[60:63], a[168:175], v5
s_waitcnt vmcnt(3)
v_max3_u32 v0, v64, v65, v66
v_smfmac_f32_16x16x64_bf16 v[32:35], v[60:63], a[176:183], v5
s_waitcnt lgkmcnt(2)
v_max_u32 v0, v0, v67
v_smfmac_f32_16x16x64_bf16 v[36:39], v[60:63], v[80:87], v5
v_cmp_eq_u32 vcc, -1, v0
v_smfmac_f32_16x16x64_bf16 v[40:43], v[60:63], a[184:191], v5
s_waitcnt lgkmcnt(0)
ds_read_b128 v[80:83], v8 offset:16384
v_smfmac_f32_16x16x64_bf16 v[44:47], v[60:63], v[88:95], v5
s_cbranch_vccnz Lwb_291
Lwc_292:
ds_read_b128 v[84:87], v8 offset:17408
v_smfmac_f32_16x16x64_bf16 v[16:19], v[64:67], a[192:199], v5
ds_read_b128 v[88:91], v8 offset:18432
v_smfmac_f32_16x16x64_bf16 v[20:23], v[64:67], a[200:207], v5
ds_read_b128 v[92:95], v8 offset:19456
v_smfmac_f32_16x16x64_bf16 v[24:27], v[64:67], a[208:215], v5
v_smfmac_f32_16x16x64_bf16 v[28:31], v[64:67], a[216:223], v5
s_waitcnt vmcnt(2)
v_max3_u32 v0, v68, v69, v70
v_smfmac_f32_16x16x64_bf16 v[32:35], v[64:67], a[224:231], v5
s_waitcnt lgkmcnt(2)
v_max_u32 v0, v0, v71
v_smfmac_f32_16x16x64_bf16 v[36:39], v[64:67], v[80:87], v5
v_cmp_eq_u32 vcc, -1, v0
v_smfmac_f32_16x16x64_bf16 v[40:43], v[64:67], a[232:239], v5
s_waitcnt lgkmcnt(0)
ds_read_b128 v[80:83], v8 offset:20480
v_smfmac_f32_16x16x64_bf16 v[44:47], v[64:67], v[88:95], v5
s_cbranch_vccnz Lwb_294
Lwc_295:
ds_read_b128 v[84:87], v8 offset:21504
v_smfmac_f32_16x16x64_bf16 v[16:19], v[68:71], a[240:247], v5
ds_read_b128 v[88:91], v8 offset:22528
v_smfmac_f32_16x16x64_bf16 v[20:23], v[68:71], a[248:255], v5
s_waitcnt vmcnt(0)
ds_read_b128 v[92:95], v8 offset:23552
v_max3_u32 v0, v72, v73, v74
v_smfmac_f32_16x16x64_bf16 v[24:27], v[68:71], v[96:103], v5
v_max3_u32 v0, v0, v75, v76
v_smfmac_f32_16x16x64_bf16 v[28:31], v[68:71], v[104:111], v5
v_max3_u32 v0, v0, v77, v78
v_smfmac_f32_16x16x64_bf16 v[32:35], v[68:71], v[112:119], v5
s_waitcnt lgkmcnt(2)
v_max_u32 v0, v0, v79
v_smfmac_f32_16x16x64_bf16 v[36:39], v[68:71], v[80:87], v5
v_cmp_eq_u32 vcc, -1, v0
v_smfmac_f32_16x16x64_bf16 v[40:43], v[68:71], v[120:127], v5
s_waitcnt lgkmcnt(0)
v_smfmac_f32_16x16x64_bf16 v[44:47], v[68:71], v[88:95], v5
s_cbranch_vccnz Lwb_297
Lwc_298:
v_smfmac_f32_16x16x64_bf16 v[16:19], v[72:75], v[128:135], v5
s_add_u32 s60, s52, 1
buffer_store_dwordx4 v[12:15], v6, s[4:7], s27 offen sc1
v_smfmac_f32_16x16x64_bf16 v[16:19], v[76:79], v[192:199], v5
s_add_u32 s99, s99, 1
v_smfmac_f32_16x16x64_bf16 v[20:23], v[72:75], v[136:143], v5
s_cmp_lt_u32 s99, 103
s_cselect_b32 s53, s98, s60
s_cselect_b32 s98, s60, s98
v_smfmac_f32_16x16x64_bf16 v[20:23], v[76:79], v[200:207], v5
s_add_u32 s28, s26, s74
buffer_store_dwordx2 v[12:13], v11, s[4:7], s30 offen
v_smfmac_f32_16x16x64_bf16 v[24:27], v[72:75], v[144:151], v5
s_nop 1
v_add_f32 v16, v16, v18
v_smfmac_f32_16x16x64_bf16 v[24:27], v[76:79], v[208:215], v5
s_nop 1
v_add_f32 v17, v17, v19
v_smfmac_f32_16x16x64_bf16 v[28:31], v[72:75], v[152:159], v5
s_nop 1
v_add_f32 v18, v20, v22
v_smfmac_f32_16x16x64_bf16 v[28:31], v[76:79], v[216:223], v5
s_nop 1
v_add_f32 v19, v21, v23
v_smfmac_f32_16x16x64_bf16 v[32:35], v[72:75], v[160:167], v5
s_nop 1
ds_write_b128 v9, v[16:19] offset:0
v_smfmac_f32_16x16x64_bf16 v[32:35], v[76:79], v[224:231], v5
s_nop 1
v_add_f32 v24, v24, v26
v_smfmac_f32_16x16x64_bf16 v[36:39], v[72:75], v[168:175], v5
s_nop 1
v_add_f32 v25, v25, v27
v_smfmac_f32_16x16x64_bf16 v[36:39], v[76:79], v[232:239], v5
s_nop 1
v_add_f32 v26, v28, v30
v_smfmac_f32_16x16x64_bf16 v[40:43], v[72:75], v[176:183], v5
s_nop 1
v_add_f32 v27, v29, v31
v_smfmac_f32_16x16x64_bf16 v[40:43], v[76:79], v[240:247], v5
s_nop 1
ds_write_b128 v9, v[24:27] offset:4352
v_smfmac_f32_16x16x64_bf16 v[44:47], v[72:75], v[184:191], v5
s_nop 1
v_add_f32 v32, v32, v34
v_smfmac_f32_16x16x64_bf16 v[44:47], v[76:79], v[248:255], v5
s_nop 1
v_add_f32 v33, v33, v35
v_add_f32 v34, v36, v38
v_add_f32 v35, v37, v39
ds_write_b128 v9, v[32:35] offset:8704
v_pk_add_f32 v[40:41], v[40:41], v[42:43]
s_nop 0
v_pk_add_f32 v[42:43], v[44:45], v[46:47]
ds_write_b128 v9, v[40:43] offset:13056
s_waitcnt lgkmcnt(0)
s_barrier
ds_read2_b32 v[60:61], v10 offset0:0 offset1:68
ds_read2_b32 v[62:63], v10 offset0:136 offset1:204
ds_read2_b32 v[64:65], v10 offset0:16 offset1:84
ds_read2_b32 v[66:67], v10 offset0:152 offset1:220
ds_read2_b32 v[68:69], v10 offset0:32 offset1:100
ds_read2_b32 v[70:71], v10 offset0:168 offset1:236
ds_read2_b32 v[72:73], v10 offset0:48 offset1:116
ds_read2_b32 v[74:75], v10 offset0:184 offset1:252
s_waitcnt lgkmcnt(4)
v_pk_add_f32 v[76:77], v[60:61], v[64:65]
v_pk_add_f32 v[78:79], v[62:63], v[66:67]
s_waitcnt lgkmcnt(2)
v_pk_add_f32 v[76:77], v[76:77], v[68:69]
v_pk_add_f32 v[78:79], v[78:79], v[70:71]
s_waitcnt lgkmcnt(0)
v_pk_add_f32 v[76:77], v[76:77], v[72:73]
v_pk_add_f32 v[78:79], v[78:79], v[74:75]
buffer_store_dwordx4 v[76:79], v6, s[4:7], s26 offen sc1
v_add_u32 v9, s73, v9
v_add_u32 v10, s73, v10
s_sub_u32 s73, 0, s73
ds_read_b128 v[80:83], v8 offset:0
ds_read_b128 v[84:87], v8 offset:1024
ds_read_b128 v[88:91], v8 offset:2048
ds_read_b128 v[92:95], v8 offset:3072
v_mov_b32 v16, 0
v_mov_b32 v17, 0
v_mov_b32 v18, 0
v_mov_b32 v19, 0
v_mov_b32 v20, 0
v_mov_b32 v21, 0
v_mov_b32 v22, 0
v_mov_b32 v23, 0
v_mov_b32 v24, 0
v_mov_b32 v25, 0
v_mov_b32 v26, 0
v_mov_b32 v27, 0
v_mov_b32 v28, 0
v_mov_b32 v29, 0
v_mov_b32 v30, 0
v_mov_b32 v31, 0
v_mov_b32 v32, 0
v_mov_b32 v33, 0
v_mov_b32 v34, 0
v_mov_b32 v35, 0
v_mov_b32 v36, 0
v_mov_b32 v37, 0
v_mov_b32 v38, 0
v_mov_b32 v39, 0
v_mov_b32 v40, 0
v_mov_b32 v41, 0
v_mov_b32 v42, 0
v_mov_b32 v43, 0
v_mov_b32 v44, 0
v_mov_b32 v45, 0
v_mov_b32 v46, 0
v_mov_b32 v47, 0
s_cmp_lt_u32 s52, 64
s_cselect_b32 s31, 0, 0xa0000
s_add_u32 s31, s31, s66
s_add_u32 s29, s52, 1
s_and_b32 s29, s29, 3
s_lshl_b32 s29, s29, 14
s_xor_b32 s30, s29, 0x8000
s_add_u32 s30, s30, s31
s_add_u32 s29, s29, s31
s_add_u32 s29, s29, s71
s_add_u32 s30, s30, s71
s_cmp_lt_u32 s53, 64
s_cselect_b32 s31, 0, 0xa0000
s_add_u32 s31, s31, s66
s_and_b32 s24, s53, 3
s_lshl_b32 s24, s24, 15
s_add_u32 s24, s24, s31
s_add_u32 s24, s24, s72
s_add_u32 s25, s24, 4096
s_and_b32 s31, s53, 64
s_lshl_b32 s31, s31, 13
s_add_u32 s31, s31, s70
s_and_b32 s26, s53, 3
s_lshl_b32 s26, s26, 16
s_xor_b32 s27, s26, 0x20000
s_add_u32 s26, s26, s31
s_add_u32 s27, s27, s31
Ltw_300:
buffer_load_dwordx4 v[64:67], v6, s[4:7], s28 offen sc1
s_add_u32 s96, s96, 1
s_cmp_ge_u32 s96, 1048576
s_cbranch_scc1 Lto_301
s_waitcnt vmcnt(0)
v_max3_u32 v0, v64, v65, v66
v_max_u32 v0, v0, v67
v_cmp_eq_u32 vcc, -1, v0
v_pk_add_f32 v[68:69], v[76:77], v[64:65]
v_pk_add_f32 v[70:71], v[78:79], v[66:67]
s_cbranch_vccnz Ltw_300
v_cvt_pk_bf16_f32 v72, v68, v69
v_cvt_pk_bf16_f32 v73, v70, v71
buffer_store_dwordx2 v[72:73], v11, s[4:7], s29 offen
s_mov_b32 s52, s53
s_cmp_ge_u32 s52, 128
s_cbranch_scc1 Lwmx_302
s_branch LWM_poll_f
Lwmx_302:
s_waitcnt vmcnt(0)
s_endpgm
Lrt_275:
s_add_u32 s96, s96, 1
s_cmp_lt_u32 s96, 1048576
s_cbranch_scc1 Lws_270
s_mov_b32 s97, 1
s_branch L_fail
Lrt_276:
s_add_u32 s96, s96, 1
s_cmp_lt_u32 s96, 1048576
s_cbranch_scc1 Lws1_271
s_mov_b32 s97, 1
s_branch L_fail
Lrt_280:
s_add_u32 s96, s96, 1
s_cmp_lt_u32 s96, 1048576
s_cbranch_scc1 Lnear_277
s_mov_b32 s97, 24
s_branch L_fail
Lto_281:
s_mov_b32 s97, 16
s_branch L_fail
Lto_284:
s_mov_b32 s97, 17
s_branch L_fail
Lwb_282:
buffer_load_dwordx4 v[52:55], v6, s[4:7], s24 offen offset:1024 sc1
buffer_load_dwordx4 v[56:59], v6, s[4:7], s24 offen offset:2048 sc1
buffer_load_dwordx4 v[60:63], v6, s[4:7], s24 offen offset:3072 sc1
buffer_load_dwordx4 v[64:67], v6, s[4:7], s25 offen offset:0 sc1
s_add_u32 s96, s96, 1
s_cmp_ge_u32 s96, 1048576
s_cbranch_scc1 Lto_284
s_waitcnt vmcnt(3)
v_max3_u32 v0, v52, v53, v54
v_max_u32 v0, v0, v55
v_cmp_eq_u32 vcc, -1, v0
s_nop 0
s_cbranch_vccz Lwc_283
s_branch Lwb_282
Lto_287:
s_mov_b32 s97, 17
s_branch L_fail
Lwb_285:
buffer_load_dwordx4 v[56:59], v6, s[4:7], s24 offen offset:2048 sc1
buffer_load_dwordx4 v[60:63], v6, s[4:7], s24 offen offset:3072 sc1
buffer_load_dwordx4 v[64:67], v6, s[4:7], s25 offen offset:0 sc1
buffer_load_dwordx4 v[68:71], v6, s[4:7], s25 offen offset:1024 sc1
buffer_load_dwordx4 v[72:75], v6, s[4:7], s25 offen offset:2048 sc1
s_add_u32 s96, s96, 1
s_cmp_ge_u32 s96, 1048576
s_cbranch_scc1 Lto_287
s_waitcnt vmcnt(4)
v_max3_u32 v0, v56, v57, v58
v_max_u32 v0, v0, v59
v_cmp_eq_u32 vcc, -1, v0
s_nop 0
s_cbranch_vccz Lwc_286
s_branch Lwb_285
Lto_290:
s_mov_b32 s97, 17
s_branch L_fail
Lwb_288:
buffer_load_dwordx4 v[60:63], v6, s[4:7], s24 offen offset:3072 sc1
buffer_load_dwordx4 v[64:67], v6, s[4:7], s25 offen offset:0 sc1
buffer_load_dwordx4 v[68:71], v6, s[4:7], s25 offen offset:1024 sc1
buffer_load_dwordx4 v[72:75], v6, s[4:7], s25 offen offset:2048 sc1
buffer_load_dwordx4 v[76:79], v6, s[4:7], s25 offen offset:3072 sc1
s_add_u32 s96, s96, 1
s_cmp_ge_u32 s96, 1048576
s_cbranch_scc1 Lto_290
s_waitcnt vmcnt(4)
v_max3_u32 v0, v60, v61, v62
v_max_u32 v0, v0, v63
v_cmp_eq_u32 vcc, -1, v0
s_nop 0
s_cbranch_vccz Lwc_289
s_branch Lwb_288
Lto_293:
s_mov_b32 s97, 17
s_branch L_fail
Lwb_291:
buffer_load_dwordx4 v[64:67], v6, s[4:7], s25 offen offset:0 sc1
buffer_load_dwordx4 v[68:71], v6, s[4:7], s25 offen offset:1024 sc1
buffer_load_dwordx4 v[72:75], v6, s[4:7], s25 offen offset:2048 sc1
buffer_load_dwordx4 v[76:79], v6, s[4:7], s25 offen offset:3072 sc1
s_add_u32 s96, s96, 1
s_cmp_ge_u32 s96, 1048576
s_cbranch_scc1 Lto_293
s_waitcnt vmcnt(3)
v_max3_u32 v0, v64, v65, v66
v_max_u32 v0, v0, v67
v_cmp_eq_u32 vcc, -1, v0
s_nop 0
s_cbranch_vccz Lwc_292
s_branch Lwb_291
Lto_296:
s_mov_b32 s97, 17
s_branch L_fail
Lwb_294:
buffer_load_dwordx4 v[68:71], v6, s[4:7], s25 offen offset:1024 sc1
buffer_load_dwordx4 v[72:75], v6, s[4:7], s25 offen offset:2048 sc1
buffer_load_dwordx4 v[76:79], v6, s[4:7], s25 offen offset:3072 sc1
s_add_u32 s96, s96, 1
s_cmp_ge_u32 s96, 1048576
s_cbranch_scc1 Lto_296
s_waitcnt vmcnt(2)
v_max3_u32 v0, v68, v69, v70
v_max_u32 v0, v0, v71
v_cmp_eq_u32 vcc, -1, v0
s_nop 0
s_cbranch_vccz Lwc_295
s_branch Lwb_294
Lto_299:
s_mov_b32 s97, 17
s_branch L_fail
Lwb_297:
buffer_load_dwordx4 v[72:75], v6, s[4:7], s25 offen offset:2048 sc1
buffer_load_dwordx4 v[76:79], v6, s[4:7], s25 offen offset:3072 sc1
s_add_u32 s96, s96, 1
s_cmp_ge_u32 s96, 1048576
s_cbranch_scc1 Lto_299
s_waitcnt vmcnt(0)
v_max3_u32 v0, v72, v73, v74
v_max3_u32 v0, v0, v75, v76
v_max3_u32 v0, v0, v77, v78
v_max_u32 v0, v0, v79
v_cmp_eq_u32 vcc, -1, v0
s_nop 0
s_cbranch_vccz Lwc_298
s_branch Lwb_297
Lto_301:
s_mov_b32 s97, 18
s_branch L_fail
.p2align 6
LWM_poll_s:
buffer_load_dwordx4 v[48:51], v6, s[4:7], s24 offen offset:0 sc1
buffer_load_dwordx4 v[52:55], v6, s[4:7], s24 offen offset:1024 sc1
s_add_u32 s96, s96, 1
s_cmp_ge_u32 s96, 1048576
s_cbranch_scc1 Lto_303
s_waitcnt vmcnt(0)
v_max3_u32 v0, v48, v49, v50
v_max_u32 v0, v0, v51
v_cmp_eq_u32 vcc, -1, v0
s_nop 0
s_cbranch_vccnz LWM_poll_s
LWM_go_s:
v_smfmac_f32_16x16x64_bf16 v[16:19], v[48:51], a[0:7], v5
buffer_load_dwordx4 v[56:59], v6, s[4:7], s24 offen offset:2048 sc1
v_smfmac_f32_16x16x64_bf16 v[20:23], v[48:51], a[8:15], v5
buffer_load_dwordx4 v[60:63], v6, s[4:7], s24 offen offset:3072 sc1
v_smfmac_f32_16x16x64_bf16 v[24:27], v[48:51], a[16:23], v5
buffer_load_dwordx4 v[64:67], v6, s[4:7], s25 offen offset:0 sc1
v_smfmac_f32_16x16x64_bf16 v[28:31], v[48:51], a[24:31], v5
v_max3_u32 v0, v52, v53, v54
v_smfmac_f32_16x16x64_bf16 v[32:35], v[48:51], a[32:39], v5
s_waitcnt lgkmcnt(2)
v_max_u32 v0, v0, v55
v_smfmac_f32_16x16x64_bf16 v[36:39], v[48:51], v[80:87], v5
v_cmp_eq_u32 vcc, -1, v0
v_smfmac_f32_16x16x64_bf16 v[40:43], v[48:51], a[40:47], v5
s_waitcnt lgkmcnt(0)
ds_read_b128 v[80:83], v8 offset:4096
v_smfmac_f32_16x16x64_bf16 v[44:47], v[48:51], v[88:95], v5
s_cbranch_vccnz Lwb_304
Lwc_305:
ds_read_b128 v[84:87], v8 offset:5120
v_smfmac_f32_16x16x64_bf16 v[16:19], v[52:55], a[48:55], v5
ds_read_b128 v[88:91], v8 offset:6144
buffer_load_dwordx4 v[68:71], v6, s[4:7], s25 offen offset:1024 sc1
v_smfmac_f32_16x16x64_bf16 v[20:23], v[52:55], a[56:63], v5
ds_read_b128 v[92:95], v8 offset:7168
v_smfmac_f32_16x16x64_bf16 v[24:27], v[52:55], a[64:71], v5
buffer_load_dwordx4 v[72:75], v6, s[4:7], s25 offen offset:2048 sc1
v_smfmac_f32_16x16x64_bf16 v[28:31], v[52:55], a[72:79], v5
s_waitcnt vmcnt(4)
v_max3_u32 v0, v56, v57, v58
v_smfmac_f32_16x16x64_bf16 v[32:35], v[52:55], a[80:87], v5
s_waitcnt lgkmcnt(2)
v_max_u32 v0, v0, v59
v_smfmac_f32_16x16x64_bf16 v[36:39], v[52:55], v[80:87], v5
v_cmp_eq_u32 vcc, -1, v0
v_smfmac_f32_16x16x64_bf16 v[40:43], v[52:55], a[88:95], v5
s_waitcnt lgkmcnt(0)
ds_read_b128 v[80:83], v8 offset:8192
v_smfmac_f32_16x16x64_bf16 v[44:47], v[52:55], v[88:95], v5
s_cbranch_vccnz Lwb_307
Lwc_308:
ds_read_b128 v[84:87], v8 offset:9216
v_smfmac_f32_16x16x64_bf16 v[16:19], v[56:59], a[96:103], v5
ds_read_b128 v[88:91], v8 offset:10240
v_smfmac_f32_16x16x64_bf16 v[20:23], v[56:59], a[104:111], v5
ds_read_b128 v[92:95], v8 offset:11264
v_smfmac_f32_16x16x64_bf16 v[24:27], v[56:59], a[112:119], v5
buffer_load_dwordx4 v[76:79], v6, s[4:7], s25 offen offset:3072 sc1
v_smfmac_f32_16x16x64_bf16 v[28:31], v[56:59], a[120:127], v5
s_waitcnt vmcnt(4)
v_max3_u32 v0, v60, v61, v62
v_smfmac_f32_16x16x64_bf16 v[32:35], v[56:59], a[128:135], v5
s_waitcnt lgkmcnt(2)
v_max_u32 v0, v0, v63
v_smfmac_f32_16x16x64_bf16 v[36:39], v[56:59], v[80:87], v5
v_cmp_eq_u32 vcc, -1, v0
v_smfmac_f32_16x16x64_bf16 v[40:43], v[56:59], a[136:143], v5
s_waitcnt lgkmcnt(0)
ds_read_b128 v[80:83], v8 offset:12288
v_smfmac_f32_16x16x64_bf16 v[44:47], v[56:59], v[88:95], v5
s_cbranch_vccnz Lwb_310
Lwc_311:
ds_read_b128 v[84:87], v8 offset:13312
v_smfmac_f32_16x16x64_bf16 v[16:19], v[60:63], a[144:151], v5
ds_read_b128 v[88:91], v8 offset:14336
v_smfmac_f32_16x16x64_bf16 v[20:23], v[60:63], a[152:159], v5
ds_read_b128 v[92:95], v8 offset:15360
v_smfmac_f32_16x16x64_bf16 v[24:27], v[60:63], a[160:167], v5
v_smfmac_f32_16x16x64_bf16 v[28:31], v[60:63], a[168:175], v5
s_waitcnt vmcnt(3)
v_max3_u32 v0, v64, v65, v66
v_smfmac_f32_16x16x64_bf16 v[32:35], v[60:63], a[176:183], v5
s_waitcnt lgkmcnt(2)
v_max_u32 v0, v0, v67
v_smfmac_f32_16x16x64_bf16 v[36:39], v[60:63], v[80:87], v5
v_cmp_eq_u32 vcc, -1, v0
v_smfmac_f32_16x16x64_bf16 v[40:43], v[60:63], a[184:191], v5
s_waitcnt lgkmcnt(0)
ds_read_b128 v[80:83], v8 offset:16384
v_smfmac_f32_16x16x64_bf16 v[44:47], v[60:63], v[88:95], v5
s_cbranch_vccnz Lwb_313
Lwc_314:
ds_read_b128 v[84:87], v8 offset:17408
v_smfmac_f32_16x16x64_bf16 v[16:19], v[64:67], a[192:199], v5
ds_read_b128 v[88:91], v8 offset:18432
v_smfmac_f32_16x16x64_bf16 v[20:23], v[64:67], a[200:207], v5
ds_read_b128 v[92:95], v8 offset:19456
v_smfmac_f32_16x16x64_bf16 v[24:27], v[64:67], a[208:215], v5
v_smfmac_f32_16x16x64_bf16 v[28:31], v[64:67], a[216:223], v5
s_waitcnt vmcnt(2)
v_max3_u32 v0, v68, v69, v70
v_smfmac_f32_16x16x64_bf16 v[32:35], v[64:67], a[224:231], v5
s_waitcnt lgkmcnt(2)
v_max_u32 v0, v0, v71
v_smfmac_f32_16x16x64_bf16 v[36:39], v[64:67], v[80:87], v5
v_cmp_eq_u32 vcc, -1, v0
v_smfmac_f32_16x16x64_bf16 v[40:43], v[64:67], a[232:239], v5
s_waitcnt lgkmcnt(0)
ds_read_b128 v[80:83], v8 offset:20480
v_smfmac_f32_16x16x64_bf16 v[44:47], v[64:67], v[88:95], v5
s_cbranch_vccnz Lwb_316
Lwc_317:
ds_read_b128 v[84:87], v8 offset:21504
v_smfmac_f32_16x16x64_bf16 v[16:19], v[68:71], a[240:247], v5
ds_read_b128 v[88:91], v8 offset:22528
v_smfmac_f32_16x16x64_bf16 v[20:23], v[68:71], a[248:255], v5
s_waitcnt vmcnt(0)
ds_read_b128 v[92:95], v8 offset:23552
v_max3_u32 v0, v72, v73, v74
v_smfmac_f32_16x16x64_bf16 v[24:27], v[68:71], v[96:103], v5
v_max3_u32 v0, v0, v75, v76
v_smfmac_f32_16x16x64_bf16 v[28:31], v[68:71], v[104:111], v5
v_max3_u32 v0, v0, v77, v78
v_smfmac_f32_16x16x64_bf16 v[32:35], v[68:71], v[112:119], v5
s_waitcnt lgkmcnt(2)
v_max_u32 v0, v0, v79
v_smfmac_f32_16x16x64_bf16 v[36:39], v[68:71], v[80:87], v5
v_cmp_eq_u32 vcc, -1, v0
v_smfmac_f32_16x16x64_bf16 v[40:43], v[68:71], v[120:127], v5
s_waitcnt lgkmcnt(0)
v_smfmac_f32_16x16x64_bf16 v[44:47], v[68:71], v[88:95], v5
s_cbranch_vccnz Lwb_319
Lwc_320:
v_smfmac_f32_16x16x64_bf16 v[16:19], v[72:75], v[128:135], v5
s_add_u32 s60, s52, 1
buffer_store_dwordx4 v[12:15], v6, s[4:7], s27 offen sc1
v_smfmac_f32_16x16x64_bf16 v[16:19], v[76:79], v[192:199], v5
s_add_u32 s99, s99, 1
v_smfmac_f32_16x16x64_bf16 v[20:23], v[72:75], v[136:143], v5
s_cmp_lt_u32 s99, 103
s_cselect_b32 s53, s98, s60
s_cselect_b32 s98, s60, s98
v_smfmac_f32_16x16x64_bf16 v[20:23], v[76:79], v[200:207], v5
s_add_u32 s28, s26, s74
buffer_store_dwordx2 v[12:13], v11, s[4:7], s30 offen sc1
v_smfmac_f32_16x16x64_bf16 v[24:27], v[72:75], v[144:151], v5
s_nop 1
v_add_f32 v16, v16, v18
v_smfmac_f32_16x16x64_bf16 v[24:27], v[76:79], v[208:215], v5
s_nop 1
v_add_f32 v17, v17, v19
v_smfmac_f32_16x16x64_bf16 v[28:31], v[72:75], v[152:159], v5
s_nop 1
v_add_f32 v18, v20, v22
v_smfmac_f32_16x16x64_bf16 v[28:31], v[76:79], v[216:223], v5
s_nop 1
v_add_f32 v19, v21, v23
v_smfmac_f32_16x16x64_bf16 v[32:35], v[72:75], v[160:167], v5
s_nop 1
ds_write_b128 v9, v[16:19] offset:0
v_smfmac_f32_16x16x64_bf16 v[32:35], v[76:79], v[224:231], v5
s_nop 1
v_add_f32 v24, v24, v26
v_smfmac_f32_16x16x64_bf16 v[36:39], v[72:75], v[168:175], v5
s_nop 1
v_add_f32 v25, v25, v27
v_smfmac_f32_16x16x64_bf16 v[36:39], v[76:79], v[232:239], v5
s_nop 1
v_add_f32 v26, v28, v30
v_smfmac_f32_16x16x64_bf16 v[40:43], v[72:75], v[176:183], v5
s_nop 1
v_add_f32 v27, v29, v31
v_smfmac_f32_16x16x64_bf16 v[40:43], v[76:79], v[240:247], v5
s_nop 1
ds_write_b128 v9, v[24:27] offset:4352
v_smfmac_f32_16x16x64_bf16 v[44:47], v[72:75], v[184:191], v5
s_nop 1
v_add_f32 v32, v32, v34
v_smfmac_f32_16x16x64_bf16 v[44:47], v[76:79], v[248:255], v5
s_nop 1
v_add_f32 v33, v33, v35
v_add_f32 v34, v36, v38
v_add_f32 v35, v37, v39
ds_write_b128 v9, v[32:35] offset:8704
v_pk_add_f32 v[40:41], v[40:41], v[42:43]
s_nop 0
v_pk_add_f32 v[42:43], v[44:45], v[46:47]
ds_write_b128 v9, v[40:43] offset:13056
s_waitcnt lgkmcnt(0)
s_barrier
ds_read2_b32 v[60:61], v10 offset0:0 offset1:68
ds_read2_b32 v[62:63], v10 offset0:136 offset1:204
ds_read2_b32 v[64:65], v10 offset0:16 offset1:84
ds_read2_b32 v[66:67], v10 offset0:152 offset1:220
ds_read2_b32 v[68:69], v10 offset0:32 offset1:100
ds_read2_b32 v[70:71], v10 offset0:168 offset1:236
ds_read2_b32 v[72:73], v10 offset0:48 offset1:116
ds_read2_b32 v[74:75], v10 offset0:184 offset1:252
s_waitcnt lgkmcnt(4)
v_pk_add_f32 v[76:77], v[60:61], v[64:65]
v_pk_add_f32 v[78:79], v[62:63], v[66:67]
s_waitcnt lgkmcnt(2)
v_pk_add_f32 v[76:77], v[76:77], v[68:69]
v_pk_add_f32 v[78:79], v[78:79], v[70:71]
s_waitcnt lgkmcnt(0)
v_pk_add_f32 v[76:77], v[76:77], v[72:73]
v_pk_add_f32 v[78:79], v[78:79], v[74:75]
buffer_store_dwordx4 v[76:79], v6, s[4:7], s26 offen sc1
v_add_u32 v9, s73, v9
v_add_u32 v10, s73, v10
s_sub_u32 s73, 0, s73
ds_read_b128 v[80:83], v8 offset:0
ds_read_b128 v[84:87], v8 offset:1024
ds_read_b128 v[88:91], v8 offset:2048
ds_read_b128 v[92:95], v8 offset:3072
v_mov_b32 v16, 0
v_mov_b32 v17, 0
v_mov_b32 v18, 0
v_mov_b32 v19, 0
v_mov_b32 v20, 0
v_mov_b32 v21, 0
v_mov_b32 v22, 0
v_mov_b32 v23, 0
v_mov_b32 v24, 0
v_mov_b32 v25, 0
v_mov_b32 v26, 0
v_mov_b32 v27, 0
v_mov_b32 v28, 0
v_mov_b32 v29, 0
v_mov_b32 v30, 0
v_mov_b32 v31, 0
v_mov_b32 v32, 0
v_mov_b32 v33, 0
v_mov_b32 v34, 0
v_mov_b32 v35, 0
v_mov_b32 v36, 0
v_mov_b32 v37, 0
v_mov_b32 v38, 0
v_mov_b32 v39, 0
v_mov_b32 v40, 0
v_mov_b32 v41, 0
v_mov_b32 v42, 0
v_mov_b32 v43, 0
v_mov_b32 v44, 0
v_mov_b32 v45, 0
v_mov_b32 v46, 0
v_mov_b32 v47, 0
s_cmp_lt_u32 s52, 64
s_cselect_b32 s31, 0, 0xa0000
s_add_u32 s31, s31, s66
s_add_u32 s29, s52, 1
s_and_b32 s29, s29, 3
s_lshl_b32 s29, s29, 14
s_xor_b32 s30, s29, 0x8000
s_add_u32 s30, s30, s31
s_add_u32 s29, s29, s31
s_add_u32 s29, s29, s71
s_add_u32 s30, s30, s71
s_cmp_lt_u32 s53, 64
s_cselect_b32 s31, 0, 0xa0000
s_add_u32 s31, s31, s66
s_and_b32 s24, s53, 3
s_lshl_b32 s24, s24, 15
s_add_u32 s24, s24, s31
s_add_u32 s24, s24, s72
s_add_u32 s25, s24, 4096
s_and_b32 s31, s53, 64
s_lshl_b32 s31, s31, 13
s_add_u32 s31, s31, s70
s_and_b32 s26, s53, 3
s_lshl_b32 s26, s26, 16
s_xor_b32 s27, s26, 0x20000
s_add_u32 s26, s26, s31
s_add_u32 s27, s27, s31
Ltw_322:
buffer_load_dwordx4 v[64:67], v6, s[4:7], s28 offen sc1
s_add_u32 s96, s96, 1
s_cmp_ge_u32 s96, 1048576
s_cbranch_scc1 Lto_323
s_waitcnt vmcnt(0)
v_max3_u32 v0, v64, v65, v66
v_max_u32 v0, v0, v67
v_cmp_eq_u32 vcc, -1, v0
v_pk_add_f32 v[68:69], v[76:77], v[64:65]
v_pk_add_f32 v[70:71], v[78:79], v[66:67]
s_cbranch_vccnz Ltw_322
v_cvt_pk_bf16_f32 v72, v68, v69
v_cvt_pk_bf16_f32 v73, v70, v71
buffer_store_dwordx2 v[72:73], v11, s[4:7], s29 offen sc1
s_mov_b32 s52, s53
s_cmp_ge_u32 s52, 128
s_cbranch_scc1 Lwmx_324
s_branch LWM_poll_s
Lwmx_324:
s_waitcnt vmcnt(0)
s_endpgm
Lto_303:
s_mov_b32 s97, 16
s_branch L_fail
Lto_306:
s_mov_b32 s97, 17
s_branch L_fail
Lwb_304:
buffer_load_dwordx4 v[52:55], v6, s[4:7], s24 offen offset:1024 sc1
buffer_load_dwordx4 v[56:59], v6, s[4:7], s24 offen offset:2048 sc1
buffer_load_dwordx4 v[60:63], v6, s[4:7], s24 offen offset:3072 sc1
buffer_load_dwordx4 v[64:67], v6, s[4:7], s25 offen offset:0 sc1
s_add_u32 s96, s96, 1
s_cmp_ge_u32 s96, 1048576
s_cbranch_scc1 Lto_306
s_waitcnt vmcnt(3)
v_max3_u32 v0, v52, v53, v54
v_max_u32 v0, v0, v55
v_cmp_eq_u32 vcc, -1, v0
s_nop 0
s_cbranch_vccz Lwc_305
s_branch Lwb_304
Lto_309:
s_mov_b32 s97, 17
s_branch L_fail
Lwb_307:
buffer_load_dwordx4 v[56:59], v6, s[4:7], s24 offen offset:2048 sc1
buffer_load_dwordx4 v[60:63], v6, s[4:7], s24 offen offset:3072 sc1
buffer_load_dwordx4 v[64:67], v6, s[4:7], s25 offen offset:0 sc1
buffer_load_dwordx4 v[68:71], v6, s[4:7], s25 offen offset:1024 sc1
buffer_load_dwordx4 v[72:75], v6, s[4:7], s25 offen offset:2048 sc1
s_add_u32 s96, s96, 1
s_cmp_ge_u32 s96, 1048576
s_cbranch_scc1 Lto_309
s_waitcnt vmcnt(4)
v_max3_u32 v0, v56, v57, v58
v_max_u32 v0, v0, v59
v_cmp_eq_u32 vcc, -1, v0
s_nop 0
s_cbranch_vccz Lwc_308
s_branch Lwb_307
Lto_312:
s_mov_b32 s97, 17
s_branch L_fail
Lwb_310:
buffer_load_dwordx4 v[60:63], v6, s[4:7], s24 offen offset:3072 sc1
buffer_load_dwordx4 v[64:67], v6, s[4:7], s25 offen offset:0 sc1
buffer_load_dwordx4 v[68:71], v6, s[4:7], s25 offen offset:1024 sc1
buffer_load_dwordx4 v[72:75], v6, s[4:7], s25 offen offset:2048 sc1
buffer_load_dwordx4 v[76:79], v6, s[4:7], s25 offen offset:3072 sc1
s_add_u32 s96, s96, 1
s_cmp_ge_u32 s96, 1048576
s_cbranch_scc1 Lto_312
s_waitcnt vmcnt(4)
v_max3_u32 v0, v60, v61, v62
v_max_u32 v0, v0, v63
v_cmp_eq_u32 vcc, -1, v0
s_nop 0
s_cbranch_vccz Lwc_311
s_branch Lwb_310
Lto_315:
s_mov_b32 s97, 17
s_branch L_fail
Lwb_313:
buffer_load_dwordx4 v[64:67], v6, s[4:7], s25 offen offset:0 sc1
buffer_load_dwordx4 v[68:71], v6, s[4:7], s25 offen offset:1024 sc1
buffer_load_dwordx4 v[72:75], v6, s[4:7], s25 offen offset:2048 sc1
buffer_load_dwordx4 v[76:79], v6, s[4:7], s25 offen offset:3072 sc1
s_add_u32 s96, s96, 1
s_cmp_ge_u32 s96, 1048576
s_cbranch_scc1 Lto_315
s_waitcnt vmcnt(3)
v_max3_u32 v0, v64, v65, v66
v_max_u32 v0, v0, v67
v_cmp_eq_u32 vcc, -1, v0
s_nop 0
s_cbranch_vccz Lwc_314
s_branch Lwb_313
Lto_318:
s_mov_b32 s97, 17
s_branch L_fail
Lwb_316:
buffer_load_dwordx4 v[68:71], v6, s[4:7], s25 offen offset:1024 sc1
buffer_load_dwordx4 v[72:75], v6, s[4:7], s25 offen offset:2048 sc1
buffer_load_dwordx4 v[76:79], v6, s[4:7], s25 offen offset:3072 sc1
s_add_u32 s96, s96, 1
s_cmp_ge_u32 s96, 1048576
s_cbranch_scc1 Lto_318
s_waitcnt vmcnt(2)
v_max3_u32 v0, v68, v69, v70
v_max_u32 v0, v0, v71
v_cmp_eq_u32 vcc, -1, v0
s_nop 0
s_cbranch_vccz Lwc_317
s_branch Lwb_316
Lto_321:
s_mov_b32 s97, 17
s_branch L_fail
Lwb_319:
buffer_load_dwordx4 v[72:75], v6, s[4:7], s25 offen offset:2048 sc1
buffer_load_dwordx4 v[76:79], v6, s[4:7], s25 offen offset:3072 sc1
s_add_u32 s96, s96, 1
s_cmp_ge_u32 s96, 1048576
s_cbranch_scc1 Lto_321
s_waitcnt vmcnt(0)
v_max3_u32 v0, v72, v73, v74
v_max3_u32 v0, v0, v75, v76
v_max3_u32 v0, v0, v77, v78
v_max_u32 v0, v0, v79
v_cmp_eq_u32 vcc, -1, v0
s_nop 0
s_cbranch_vccz Lwc_320
s_branch Lwb_319
Lto_323:
s_mov_b32 s97, 18
s_branch L_fail
.section .rodata,"a"
.p2align 6
.amdhsa_kernel interleave_layers__memory_aug_recurrent_mem_tr__glu_gated_geglu__prompt_kernel
.amdhsa_next_free_vgpr 512
.amdhsa_next_free_sgpr 102
.amdhsa_accum_offset 256
.amdhsa_group_segment_fixed_size 0
.amdhsa_kernarg_size 112
.amdhsa_user_sgpr_count 2
.amdhsa_user_sgpr_kernarg_segment_ptr 1
.amdhsa_system_sgpr_workgroup_id_x 1
.end_amdhsa_kernel
```
